```python
import torch

def _softmax(x, axis=-1):
    return torch.softmax(x, dim=axis)
def _gelu(x):
    return torch.nn.functional.gelu(x, approximate="tanh")
def _silu(x):
    return torch.nn.functional.silu(x)
def _sigmoid(x):
    return torch.sigmoid(x)
def _layernorm(x, axis=-1, eps=1e-5):
    m = x.mean(dim=axis, keepdim=True)
    v = x.var(dim=axis, keepdim=True, unbiased=False)
    return (x - m) / torch.sqrt(v + eps)
def _scatter_add(tgt, idx, src, axis=0):
    return tgt.clone().index_add_(axis, idx, src)
def _segment_sum(src, seg, n):
    out = torch.zeros((n,) + src.shape[1:], dtype=src.dtype)
    return out.index_add_(0, seg, src)
def _pad(x, pw):
    flat = tuple(v for pair in reversed(pw) for v in pair)
    return torch.nn.functional.pad(x, flat)

kernel_name = 'gated_mix__ssm_conv_h3__geglu_ffn__prompt'

def setup_inputs():

    _w = (lambda a: (lambda t: t.to(torch.bfloat16) if t.is_floating_point() else t)(torch.as_tensor(a)))
    def _A_setup():
        B, S, D = 1, 2048, 576
        ks = 4
        return {
            "q": _w((lambda *s: torch.randn(*s, dtype=torch.bfloat16) * 0.05)(B, S, D)),
            "k": _w((lambda *s: torch.randn(*s, dtype=torch.bfloat16) * 0.4)(B, S, D)),
            "v": _w((lambda *s: torch.randn(*s, dtype=torch.bfloat16) * 0.4)(B, S, D)),
            "shift_k": _w((lambda *s: torch.randn(*s, dtype=torch.bfloat16) * 0.4)(D, ks) * 0.5),
            "ssm_k": _w((lambda *s: torch.randn(*s, dtype=torch.bfloat16) * 0.4)(D, S) * (1.0 / S ** 0.5)),
            "ssm_D": _w((lambda *s: torch.randn(*s, dtype=torch.bfloat16) * 0.4)(D)),
        }
    _A_in = _A_setup()

    def _B_setup():
        B, S, D, F = 1, 2048, 576, 4608
        return {
            "x": _w((lambda *s: torch.randn(*s, dtype=torch.bfloat16) * 0.05)(B, S, D)),
            "w_gate": _w((lambda *s: torch.randn(*s, dtype=torch.bfloat16) * 0.05)(D, F)),
            "w_up": _w((lambda *s: torch.randn(*s, dtype=torch.bfloat16) * 0.05)(D, F)),
            "w_down": _w((lambda *s: torch.randn(*s, dtype=torch.bfloat16) * 0.05)(F, D)),
        }
    _B_in = _B_setup()

    return {
        "A_q": _A_in["q"],
        "A_k": _A_in["k"],
        "A_v": _A_in["v"],
        "A_shift_k": _A_in["shift_k"],
        "A_ssm_k": _A_in["ssm_k"],
        "A_ssm_D": _A_in["ssm_D"],
        "B_x": _B_in["x"],
        "B_w_gate": _B_in["w_gate"],
        "B_w_up": _B_in["w_up"],
        "B_w_down": _B_in["w_down"],
        "gate_w": _w((lambda *s: torch.randn(*s, dtype=torch.bfloat16) * 0.05)(576) * 16.0),
    }

def reference(A_q, A_k, A_v, A_shift_k, A_ssm_k, A_ssm_D, B_x, B_w_gate, B_w_up, B_w_down, gate_w):
    def _A_ref(q, k, v, shift_k, ssm_k, ssm_D):
        B, S, D = q.shape
        ks = shift_k.shape[-1]
        k_pad = _pad(k, ((0, 0), (ks - 1, 0), (0, 0)))
        k_shift = torch.zeros_like(k)
        for t in range(ks):
            k_shift = k_shift + k_pad[:, t:t + S, :] * shift_k[:, ks - 1 - t][None, None, :]
        kv = k_shift * v
        L = 2 * S
        kv_pad = _pad(kv, ((0, 0), (0, S), (0, 0)))
        kf_pad = _pad(ssm_k, ((0, 0), (0, S)))
        kv_f = (lambda x, axes=(-2,-1): torch.fft.rfft2(x.float(), dim=axes))(kv_pad[:, None, :, :], axes=(1, 2))
        kf_f = (lambda x, axes=(-2,-1): torch.fft.rfft2(x.float(), dim=axes))(kf_pad[:, None, :], axes=(1, 2))
        kf_f = (lambda x, *d: x.permute(*d))(kf_f, 1, 2, 0)
        y_f = kv_f * kf_f[None, :, :, :]
        y = (lambda x, s, axes=(-2,-1): torch.fft.irfft2(x, s=s, dim=axes).to(torch.bfloat16))(y_f, (1, L), axes=(1, 2))[:, 0, :S, :]
        y = y + kv * ssm_D[None, None, :]
        return q * y

    def _B_ref(x, w_gate, w_up, w_down):
        return (_gelu(x @ w_gate) * (x @ w_up)) @ w_down

    x = A_q
    g = _sigmoid((x * gate_w).sum(-1, keepdims=True))
    a = _A_ref(x, A_k, A_v, A_shift_k, A_ssm_k, A_ssm_D)
    b = _B_ref(x, B_w_gate, B_w_up, B_w_down)
    return g * a + (1 - g) * b
```

```asm
; @launch grid=(256,1,1) block=(256,1,1) lds=163840
.amdgcn_target "amdgcn-amd-amdhsa--gfx950"
.text
.globl gated_mix__ssm_conv_h3__geglu_ffn__prompt_kernel
.p2align 8
.type gated_mix__ssm_conv_h3__geglu_ffn__prompt_kernel,@function
gated_mix__ssm_conv_h3__geglu_ffn__prompt_kernel:
s_cmp_ge_u32 s2, 256
s_cbranch_scc1 L_end1
s_load_dwordx2 s[12:13], s[0:1], 0
s_load_dwordx2 s[4:5], s[0:1], 56
s_load_dwordx2 s[8:9], s[0:1], 64
s_getpc_b64 s[48:49]
L_pc:
s_movk_i32 s42, 22+64
s_lshr_b32 s41, s2, 3
s_mul_i32 s41, s41, 22
v_cmp_gt_u32 vcc, 64, v0
v_add_u32 v25, s41, v0
v_cmp_gt_u32 s[44:45], s42, v0
v_cndmask_b32 v25, v25, v0, vcc
v_lshlrev_b32 v25, 7, v25
v_min_u32 v25, L_end1-L_pc, v25
s_mov_b64 exec, s[44:45]
global_load_dword v223, v25, s[48:49]
s_mov_b64 exec, -1
s_load_dwordx2 s[16:17], s[0:1], 72
s_load_dwordx2 s[24:25], s[0:1], 96
s_load_dwordx2 s[20:21], s[0:1], 104
s_load_dwordx2 s[52:53], s[0:1], 8
s_load_dwordx2 s[96:97], s[0:1], 16
s_load_dwordx2 s[92:93], s[0:1], 80
s_load_dwordx2 s[50:51], s[0:1], 40
s_load_dwordx2 s[88:89], s[0:1], 32
s_load_dwordx2 s[90:91], s[0:1], 24
s_load_dwordx2 s[0:1], s[0:1], 88
v_lshrrev_b32 v24, 6, v0
v_and_b32 v1, 63, v0
v_readfirstlane_b32 s38, v24
s_and_b32 s41, s2, 1
s_lshl_b32 s41, s41, 3
s_bfe_u32 s42, s2, 0x30003
s_add_u32 s39, s41, s42
s_and_b32 s41, s2, 6
s_bfe_u32 s42, s2, 0x10006
s_add_u32 s40, s41, s42
s_lshl_b32 s37, s38, 12
v_lshrrev_b32 v25, 3, v1
v_and_b32 v26, 7, v1
v_lshrrev_b32 v27, 1, v25
v_lshl_add_u32 v28, v24, 5, v25
s_and_b32 s41, s40, 3
s_lshl_b32 s41, s41, 4
v_xor_b32 v28, s41, v28
v_xor_b32 v30, 16, v28
v_mul_u32_u24 v28, 0x480, v28
v_mul_u32_u24 v30, 0x480, v30
v_xor_b32 v29, v26, v27
v_lshl_add_u32 v72, v29, 4, v28
v_lshl_add_u32 v92, v29, 4, v30
v_xor_b32 v29, 4, v29
v_lshl_add_u32 v73, v29, 4, v28
v_lshl_add_u32 v93, v29, 4, v30
v_add_u32 v72, 2048, v72
v_add_u32 v73, 10240, v73
v_add_u32 v93, 8192, v93
v_lshl_add_u32 v28, v24, 4, v25
v_mul_u32_u24 v30, 0x2400, v28
v_and_b32 v29, 2, v25
v_xor_b32 v29, v26, v29
v_lshl_add_u32 v10, v29, 4, v30
v_xor_b32 v29, 4, v29
v_lshl_add_u32 v11, v29, 4, v30
v_add_u32 v11, 72704, v11
s_mov_b32 s28, 0
s_mov_b32 s29, 589824
s_mov_b32 s30, 1179648
s_mov_b32 s31, 1769472
s_mov_b32 s32, 2359296
s_mov_b32 s33, 2949120
s_mov_b32 s34, 3538944
s_mov_b32 s35, 4128768
s_mov_b32 s36, 4718592
s_mov_b32 s14, 149504
s_mov_b32 s15, 0x20000
s_mov_b32 s6, 5308416
s_mov_b32 s7, 0x20000
s_mov_b32 s10, 5310464
s_mov_b32 s11, 0x20000
s_mul_i32 s41, s39, 147456
s_mul_i32 s42, s40, 1152
s_lshr_b32 s43, s2, 7
s_mul_i32 s43, s43, 640
s_add_u32 s42, s42, s43
s_waitcnt lgkmcnt(0)
s_add_u32 s12, s12, s41
s_addc_u32 s13, s13, 0
s_sub_u32 s12, s12, 2048
s_subb_u32 s13, s13, 0
s_add_u32 s4, s4, s42
s_addc_u32 s5, s5, 0
s_add_u32 s8, s8, s42
s_addc_u32 s9, s9, 0
s_sub_u32 s8, s8, 2048
s_subb_u32 s9, s9, 0
s_mov_b32 s22, 268435456
s_mov_b32 s23, 0x20000
s_cmp_eq_u32 s2, 0
s_mov_b32 s41, 2146435072
s_cmov_b32 s41, 76546048
v_lshl_add_u32 v29, v0, 8, s41
v_mov_b32 v20, 0
buffer_store_dword v20, v29, s[20:23], 0 offen sc1
s_mov_b32 s48, 0
s_add_u32 m0, s37, 81920
s_nop 0
buffer_load_dwordx4 v72, s[12:15], s48 offen offset:0 lds
buffer_load_dwordx4 v73, s[12:15], s48 offen offset:1024 lds
buffer_load_dwordx4 v92, s[12:15], s48 offen offset:2048 lds
buffer_load_dwordx4 v93, s[12:15], s48 offen offset:3072 lds
s_add_u32 m0, s37, 0
s_nop 0
buffer_load_dwordx4 v10, s[4:7], s28 offen offset:0 lds
buffer_load_dwordx4 v11, s[4:7], s28 offen offset:1024 lds
buffer_load_dwordx4 v10, s[8:11], s28 offen offset:2048 lds
buffer_load_dwordx4 v11, s[8:11], s28 offen offset:3072 lds
s_mov_b32 s58, s39
s_lshl_b32 s58, s58, 2
s_add_u32 s58, s58, s38
s_mul_i32 s58, s58, 9
v_add_u32 v222, 55, v1
v_and_b32 v222, 64, v222
v_lshl_add_u32 v222, v222, 8, v1
v_add_u32 v222, s58, v222
v_mul_u32_u24 v222, 0x2400, v222
v_lshrrev_b32 v166, 3, v1
v_lshrrev_b32 v167, 4, v1
v_lshl_add_u32 v166, v167, 12, v166
s_lshr_b32 s58, s2, 7
s_lshl_b32 s58, s58, 3
s_add_u32 s58, s58, s40
s_lshl_b32 s58, s58, 2
s_add_u32 s58, s58, s38
s_lshl_b32 s58, s58, 1
v_add_u32 v166, s58, v166
v_mul_u32_u24 v166, 0x480, v166
v_and_b32 v167, 7, v0
v_lshl_add_u32 v166, v167, 7, v166
buffer_load_dword v223, v166, s[12:15], 0 offen offset:2176
buffer_load_dword v223, v222, s[4:7], 0 offen offset:0
buffer_load_dword v223, v222, s[8:11], 0 offen offset:2048
s_mov_b32 s48, 128
s_add_u32 m0, s37, 98304
s_nop 0
buffer_load_dwordx4 v72, s[12:15], s48 offen offset:0 lds
buffer_load_dwordx4 v73, s[12:15], s48 offen offset:1024 lds
buffer_load_dwordx4 v92, s[12:15], s48 offen offset:2048 lds
buffer_load_dwordx4 v93, s[12:15], s48 offen offset:3072 lds
s_add_u32 m0, s37, 16384
s_nop 0
buffer_load_dwordx4 v10, s[4:7], s29 offen offset:0 lds
buffer_load_dwordx4 v11, s[4:7], s29 offen offset:1024 lds
buffer_load_dwordx4 v10, s[8:11], s29 offen offset:2048 lds
buffer_load_dwordx4 v11, s[8:11], s29 offen offset:3072 lds
s_bfe_u32 s44, s2, 0x30003
s_mul_i32 s44, s44, 72
s_and_b32 s45, s2, 7
s_lshl_b32 s45, s45, 2
s_lshr_b32 s46, s2, 6
s_add_u32 s45, s45, s46
s_lshl_b32 s45, s45, 2
s_add_u32 s45, s45, s38
s_lshl_b32 s45, s45, 4
s_mul_i32 s46, s45, 576
s_add_u32 s46, s46, s44
s_lshl_b32 s46, s46, 1
s_mov_b32 s54, 2359296
s_mov_b32 s55, 0x20000
s_mov_b32 s98, 2359296
s_mov_b32 s99, 0x20000
s_mov_b32 s94, 1152
s_mov_b32 s95, 0x20000
v_lshl_add_u32 v86, v1, 4, s46
v_mul_u32_u24 v80, 57, v1
v_add_u32 v81, 3648, v80
v_add_u32 v82, 7296, v80
s_movk_i32 s58, 1008
v_lshrrev_b32 v80, 9, v80
v_lshrrev_b32 v81, 9, v81
v_lshrrev_b32 v82, 9, v82
v_mad_u32_u24 v80, v80, s58, v86
v_mad_u32_u24 v81, v81, s58, v86
v_mad_u32_u24 v82, v82, s58, v86
v_add_u32 v86, 21, v1
v_and_b32 v86, 64, v86
v_lshl_add_u32 v85, v86, 22, v82
v_add_u32 v83, 4294963840, v80
v_add_u32 v84, 4294963840, v81
v_add_u32 v85, 4294963840, v85
v_and_b32 v86, 48, v1
v_lshl_add_u32 v82, v86, 22, v82
s_lshl_b32 s46, s44, 3
v_lshl_add_u32 v86, v1, 4, s46
s_and_b32 s46, s2, 7
s_add_u32 s100, s44, s46
s_add_u32 s100, s100, 64
s_lshl_b32 s46, s46, 3
s_add_u32 s3, s44, s46
s_bfe_u32 s46, s2, 0x10006
s_lshl_b32 s46, s46, 2
s_add_u32 s3, s3, s46
s_add_u32 s3, s3, s38
s_lshr_b32 s46, s3, 1
s_lshl_b32 s46, s46, 2
s_load_dword s56, s[50:51], s46
s_lshr_b32 s58, s100, 1
s_lshl_b32 s58, s58, 2
s_load_dword s59, s[50:51], s58
s_mul_i32 s43, s38, 4112
s_mul_i32 s58, s38, 3
v_lshrrev_b32 v161, 4, v1
v_add_u32 v161, s58, v161
v_and_b32 v160, 3, v1
v_mul_u32_u24 v87, 576, v160
v_bfe_u32 v160, v1, 2, 2
v_mul_u32_u24 v160, 4112, v160
v_mad_u32_u24 v87, v161, 12, v87
v_add_u32 v87, v160, v87
v_add_u32 v87, 131072, v87
v_add_u32 v88, 16448, v87
v_mul_u32_u24 v89, 48, v161
v_add_u32 v89, 131072, v89
v_mad_u32_u24 v161, v161, 6, s44
v_and_b32 v160, 15, v1
s_andn2_b32 s45, s45, 63
v_lshl_add_u32 v162, v160, 2, s45
v_mul_u32_u24 v161, 4224, v161
v_lshl_add_u32 v161, v162, 1, v161
v_mov_b32 v164, 2146435072
v_cmp_gt_u32 vcc, 48, v1
s_lshr_b32 s46, s45, 6
s_mul_i32 s46, s46, 9
s_add_u32 s46, s46, s44
v_cndmask_b32 v90, v164, v161, vcc
v_lshrrev_b32 v162, 3, v0
v_add_u32 v162, s46, v162
v_mul_u32_u24 v162, 4224, v162
v_and_b32 v160, 7, v0
s_cmp_lt_u32 s45, 512
s_cselect_b32 s46, 72, 0
v_cmp_gt_u32 vcc, s46, v0
v_lshl_add_u32 v162, v160, 4, v162
s_nop 0
v_cndmask_b32 v91, v164, v162, vcc
v_mul_u32_u24 v30, 0x480, v28
v_and_b32 v29, 6, v25
v_xor_b32 v29, v26, v29
v_lshl_add_u32 v12, v29, 4, v30
v_add_u32 v13, 8192, v12
s_mov_b32 s18, 5310464
s_mov_b32 s19, 0x20000
s_mov_b32 s26, 256
s_mov_b32 s57, 0
s_mov_b32 s27, 0x20000
s_mul_i32 s41, s40, 663552
s_add_u32 s16, s16, s41
s_addc_u32 s17, s17, 0
s_sub_u32 s16, s16, 2048
s_subb_u32 s17, s17, 0
s_mul_i32 s44, s2, 16384
s_xor_b32 s41, s2, 128
s_mul_i32 s45, s41, 16384
s_lshr_b32 s46, s40, 1
s_xor_b32 s46, s46, s38
s_lshr_b32 s46, s46, 1
s_and_b32 s41, s40, 3
s_lshl1_add_u32 s46, s41, s46
s_lshl_b32 s46, s46, 12
s_add_u32 s46, s46, 33554432
s_mul_i32 s42, s39, 131072
s_mov_b32 s47, 0xbdd2d3e8
v_mov_b32 v18, 0xc0135761
v_lshrrev_b32 v31, 4, v1
v_bfe_u32 v32, v1, 2, 2
v_and_b32 v33, 3, v1
v_bfe_u32 v34, v1, 3, 2
v_and_b32 v35, 1, v24
v_lshrrev_b32 v36, 1, v24
v_and_b32 v37, 15, v1
v_lshlrev_b32 v38, 1, v35
v_xor_b32 v38, v38, v34
v_lshlrev_b32 v38, 5, v38
v_lshl_add_u32 v38, v33, 3, v38
v_lshrrev_b32 v39, 2, v1
v_lshl_add_u32 v6, v39, 7, v38
v_xor_b32 v7, 32, v6
v_lshl_add_u32 v38, v32, 7, v38
v_and_b32 v39, 1, v31
v_lshl_add_u32 v38, v39, 10, v38
v_lshrrev_b32 v39, 1, v31
v_lshl_add_u32 v2, v39, 12, v38
v_xor_b32 v3, 32, v2
v_add_u32 v4, 0x10000, v2
v_add_u32 v5, 0x10000, v3
v_lshrrev_b32 v38, 1, v37
v_xor_b32 v38, v38, v31
v_lshlrev_b32 v38, 4, v38
v_lshl_add_u32 v39, v36, 6, v37
v_lshl_add_u32 v38, v39, 7, v38
v_add_u32 v74, 81920, v38
v_xor_b32 v75, 64, v74
v_add_u32 v76, 0x10000, v74
v_add_u32 v77, 0x10000, v75
v_lshlrev_b32 v38, 4, v1
v_lshl_add_u32 v21, v24, 15, v38
v_add_u32 v21, s42, v21
v_lshl_add_u32 v17, v36, 12, v38
v_lshl_add_u32 v16, v35, 13, v17
v_add_u32 v15, 81920, v17
v_add_u32 v14, 81920, v16
v_add_u32 v23, 0x10000, v15
v_add_u32 v22, 0x10000, v14
s_bfe_u32 s41, s2, 0x30003
s_lshl_b32 s41, s41, 5
s_and_b32 s42, s2, 7
s_lshl_b32 s42, s42, 2
s_add_u32 s41, s41, s42
s_lshr_b32 s42, s2, 6
s_add_u32 s41, s41, s42
s_lshl_b32 s41, s41, 8
s_add_u32 s41, s41, 76546048
s_xor_b32 s42, s41, 512
v_mov_b32 v79, s42
v_mov_b32 v38, s41
v_mov_b32 v39, 0x7fffff00
v_cmp_eq_u32 vcc, 0, v0
s_nop 1
v_cndmask_b32 v19, v39, v38, vcc
v_cmp_gt_u32 vcc, 8, v0
v_lshl_add_u32 v217, v0, 4, v38
s_nop 0
v_cndmask_b32 v217, v39, v217, vcc
v_lshlrev_b32 v221, 8, v0
s_lshl_b32 s41, s2, 8
v_add_u32 v220, s41, v221
s_cmp_eq_u32 s38, 0
s_cselect_b32 s101, 1, 0
v_cmp_eq_u32 vcc, 0, v1
s_nop 1
v_cndmask_b32 v79, v39, v79, vcc
s_mov_b32 s48, 256
s_add_u32 m0, s37, 114688
s_nop 0
buffer_load_dwordx4 v72, s[12:15], s48 offen offset:0 lds
buffer_load_dwordx4 v73, s[12:15], s48 offen offset:1024 lds
buffer_load_dwordx4 v92, s[12:15], s48 offen offset:2048 lds
buffer_load_dwordx4 v93, s[12:15], s48 offen offset:3072 lds
s_add_u32 m0, s37, 32768
s_nop 0
buffer_load_dwordx4 v10, s[4:7], s30 offen offset:0 lds
buffer_load_dwordx4 v11, s[4:7], s30 offen offset:1024 lds
buffer_load_dwordx4 v10, s[8:11], s30 offen offset:2048 lds
buffer_load_dwordx4 v11, s[8:11], s30 offen offset:3072 lds
s_cmp_ge_u32 s2, 128
s_cbranch_scc1 L_typeb
v_add_u32 v8, 0x10000, v6
v_add_u32 v9, 0x10000, v7
s_waitcnt vmcnt(19)
s_barrier
ds_read_b128 a[0:3], v74 offset:0
ds_read_b128 a[4:7], v74 offset:2048
ds_read_b128 a[8:11], v74 offset:4096
ds_read_b128 a[12:15], v74 offset:6144
ds_read_b128 a[16:19], v75 offset:0
ds_read_b128 a[20:23], v75 offset:2048
ds_read_b128 a[24:27], v75 offset:4096
ds_read_b128 a[28:31], v75 offset:6144
ds_read_b64_tr_b16 v[40:41], v2 offset:0
ds_read_b64_tr_b16 v[42:43], v2 offset:512
ds_read_b64_tr_b16 v[44:45], v2 offset:8192
ds_read_b64_tr_b16 v[46:47], v2 offset:8704
ds_read_b64_tr_b16 v[48:49], v2 offset:2048
ds_read_b64_tr_b16 v[50:51], v2 offset:2560
ds_read_b64_tr_b16 v[52:53], v2 offset:10240
ds_read_b64_tr_b16 v[54:55], v2 offset:10752
s_waitcnt lgkmcnt(0)
v_mfma_f32_16x16x32_bf16 v[96:99], v[40:43], a[0:3], 0
v_mfma_f32_16x16x32_bf16 v[96:99], v[44:47], a[16:19], v[96:99]
ds_read_b64_tr_b16 v[56:57], v3 offset:0
s_add_u32 m0, s37, 49152
v_mfma_f32_16x16x32_bf16 v[100:103], v[40:43], a[4:7], 0
ds_read_b64_tr_b16 v[58:59], v3 offset:512
v_mfma_f32_16x16x32_bf16 v[100:103], v[44:47], a[20:23], v[100:103]
ds_read_b64_tr_b16 v[60:61], v3 offset:8192
v_mfma_f32_16x16x32_bf16 v[104:107], v[40:43], a[8:11], 0
buffer_load_dwordx4 v10, s[4:7], s31 offen offset:0 lds
v_mfma_f32_16x16x32_bf16 v[104:107], v[44:47], a[24:27], v[104:107]
ds_read_b64_tr_b16 v[62:63], v3 offset:8704
v_mfma_f32_16x16x32_bf16 v[108:111], v[40:43], a[12:15], 0
ds_read_b64_tr_b16 v[64:65], v3 offset:2048
v_mfma_f32_16x16x32_bf16 v[108:111], v[44:47], a[28:31], v[108:111]
ds_read_b64_tr_b16 v[66:67], v3 offset:2560
v_mfma_f32_16x16x32_bf16 v[112:115], v[48:51], a[0:3], 0
buffer_load_dwordx4 v11, s[4:7], s31 offen offset:1024 lds
v_mfma_f32_16x16x32_bf16 v[112:115], v[52:55], a[16:19], v[112:115]
ds_read_b64_tr_b16 v[68:69], v3 offset:10240
v_mov_b32 v20, 1
v_mfma_f32_16x16x32_bf16 v[116:119], v[48:51], a[4:7], 0
ds_read_b64_tr_b16 v[70:71], v3 offset:10752
v_mfma_f32_16x16x32_bf16 v[116:119], v[52:55], a[20:23], v[116:119]
buffer_store_dword v20, v220, s[24:27], 0 offen sc1
v_mfma_f32_16x16x32_bf16 v[120:123], v[48:51], a[8:11], 0
buffer_load_dwordx4 v10, s[8:11], s31 offen offset:2048 lds
v_mfma_f32_16x16x32_bf16 v[120:123], v[52:55], a[24:27], v[120:123]
v_mfma_f32_16x16x32_bf16 v[124:127], v[48:51], a[12:15], 0
s_waitcnt vmcnt(12) lgkmcnt(0)
v_mfma_f32_16x16x32_bf16 v[124:127], v[52:55], a[28:31], v[124:127]
s_barrier
v_mfma_f32_16x16x32_bf16 v[128:131], v[56:59], a[0:3], 0
buffer_load_dwordx4 v11, s[8:11], s31 offen offset:3072 lds
v_mfma_f32_16x16x32_bf16 v[128:131], v[60:63], a[16:19], v[128:131]
ds_read_b128 a[32:35], v74 offset:16384
ds_read_b128 a[36:39], v74 offset:18432
s_mov_b32 s48, 384
v_mfma_f32_16x16x32_bf16 v[132:135], v[56:59], a[4:7], 0
ds_read_b128 a[40:43], v74 offset:20480
ds_read_b128 a[44:47], v74 offset:22528
s_add_u32 m0, s37, 131072
v_mfma_f32_16x16x32_bf16 v[132:135], v[60:63], a[20:23], v[132:135]
ds_read_b128 a[48:51], v75 offset:16384
ds_read_b128 a[52:55], v75 offset:18432
v_mfma_f32_16x16x32_bf16 v[136:139], v[56:59], a[8:11], 0
buffer_load_dwordx4 v72, s[12:15], s48 offen offset:0 lds
v_mfma_f32_16x16x32_bf16 v[136:139], v[60:63], a[24:27], v[136:139]
ds_read_b128 a[56:59], v75 offset:20480
ds_read_b128 a[60:63], v75 offset:22528
v_mfma_f32_16x16x32_bf16 v[140:143], v[56:59], a[12:15], 0
ds_read_b64_tr_b16 v[40:41], v2 offset:16384
ds_read_b64_tr_b16 v[42:43], v2 offset:16896
v_mfma_f32_16x16x32_bf16 v[140:143], v[60:63], a[28:31], v[140:143]
ds_read_b64_tr_b16 v[44:45], v2 offset:24576
ds_read_b64_tr_b16 v[46:47], v2 offset:25088
v_mfma_f32_16x16x32_bf16 v[144:147], v[64:67], a[0:3], 0
buffer_load_dwordx4 v73, s[12:15], s48 offen offset:1024 lds
v_mfma_f32_16x16x32_bf16 v[144:147], v[68:71], a[16:19], v[144:147]
ds_read_b64_tr_b16 v[48:49], v2 offset:18432
ds_read_b64_tr_b16 v[50:51], v2 offset:18944
v_mfma_f32_16x16x32_bf16 v[148:151], v[64:67], a[4:7], 0
ds_read_b64_tr_b16 v[52:53], v2 offset:26624
ds_read_b64_tr_b16 v[54:55], v2 offset:27136
v_mfma_f32_16x16x32_bf16 v[148:151], v[68:71], a[20:23], v[148:151]
v_mfma_f32_16x16x32_bf16 v[152:155], v[64:67], a[8:11], 0
buffer_load_dwordx4 v92, s[12:15], s48 offen offset:2048 lds
v_mfma_f32_16x16x32_bf16 v[152:155], v[68:71], a[24:27], v[152:155]
v_mfma_f32_16x16x32_bf16 v[156:159], v[64:67], a[12:15], 0
v_mfma_f32_16x16x32_bf16 v[156:159], v[68:71], a[28:31], v[156:159]
s_waitcnt lgkmcnt(0)
v_mfma_f32_16x16x32_bf16 v[96:99], v[40:43], a[32:35], v[96:99]
buffer_load_dwordx4 v93, s[12:15], s48 offen offset:3072 lds
v_mfma_f32_16x16x32_bf16 v[96:99], v[44:47], a[48:51], v[96:99]
ds_read_b64_tr_b16 v[56:57], v3 offset:16384
s_add_u32 m0, s37, 65536
v_mfma_f32_16x16x32_bf16 v[100:103], v[40:43], a[36:39], v[100:103]
ds_read_b64_tr_b16 v[58:59], v3 offset:16896
v_mfma_f32_16x16x32_bf16 v[100:103], v[44:47], a[52:55], v[100:103]
ds_read_b64_tr_b16 v[60:61], v3 offset:24576
v_mfma_f32_16x16x32_bf16 v[104:107], v[40:43], a[40:43], v[104:107]
buffer_load_dwordx4 v10, s[4:7], s32 offen offset:0 lds
v_mfma_f32_16x16x32_bf16 v[104:107], v[44:47], a[56:59], v[104:107]
ds_read_b64_tr_b16 v[62:63], v3 offset:25088
v_mfma_f32_16x16x32_bf16 v[108:111], v[40:43], a[44:47], v[108:111]
ds_read_b64_tr_b16 v[64:65], v3 offset:18432
v_mfma_f32_16x16x32_bf16 v[108:111], v[44:47], a[60:63], v[108:111]
ds_read_b64_tr_b16 v[66:67], v3 offset:18944
v_mfma_f32_16x16x32_bf16 v[112:115], v[48:51], a[32:35], v[112:115]
buffer_load_dwordx4 v11, s[4:7], s32 offen offset:1024 lds
v_mfma_f32_16x16x32_bf16 v[112:115], v[52:55], a[48:51], v[112:115]
ds_read_b64_tr_b16 v[68:69], v3 offset:26624
v_mfma_f32_16x16x32_bf16 v[116:119], v[48:51], a[36:39], v[116:119]
ds_read_b64_tr_b16 v[70:71], v3 offset:27136
v_mfma_f32_16x16x32_bf16 v[116:119], v[52:55], a[52:55], v[116:119]
v_mfma_f32_16x16x32_bf16 v[120:123], v[48:51], a[40:43], v[120:123]
buffer_load_dwordx4 v10, s[8:11], s32 offen offset:2048 lds
v_mfma_f32_16x16x32_bf16 v[120:123], v[52:55], a[56:59], v[120:123]
v_mfma_f32_16x16x32_bf16 v[124:127], v[48:51], a[44:47], v[124:127]
s_waitcnt vmcnt(12) lgkmcnt(0)
v_mfma_f32_16x16x32_bf16 v[124:127], v[52:55], a[60:63], v[124:127]
s_barrier
v_mfma_f32_16x16x32_bf16 v[128:131], v[56:59], a[32:35], v[128:131]
buffer_load_dwordx4 v11, s[8:11], s32 offen offset:3072 lds
v_mfma_f32_16x16x32_bf16 v[128:131], v[60:63], a[48:51], v[128:131]
ds_read_b128 a[64:67], v74 offset:32768
ds_read_b128 a[68:71], v74 offset:34816
s_mov_b32 s48, 512
v_mfma_f32_16x16x32_bf16 v[132:135], v[56:59], a[36:39], v[132:135]
ds_read_b128 a[72:75], v74 offset:36864
ds_read_b128 a[76:79], v74 offset:38912
s_add_u32 m0, s37, 147456
v_mfma_f32_16x16x32_bf16 v[132:135], v[60:63], a[52:55], v[132:135]
ds_read_b128 a[80:83], v75 offset:32768
ds_read_b128 a[84:87], v75 offset:34816
v_mfma_f32_16x16x32_bf16 v[136:139], v[56:59], a[40:43], v[136:139]
buffer_load_dwordx4 v72, s[12:15], s48 offen offset:0 lds
v_mfma_f32_16x16x32_bf16 v[136:139], v[60:63], a[56:59], v[136:139]
ds_read_b128 a[88:91], v75 offset:36864
ds_read_b128 a[92:95], v75 offset:38912
v_mfma_f32_16x16x32_bf16 v[140:143], v[56:59], a[44:47], v[140:143]
ds_read_b64_tr_b16 v[40:41], v2 offset:32768
ds_read_b64_tr_b16 v[42:43], v2 offset:33280
v_mfma_f32_16x16x32_bf16 v[140:143], v[60:63], a[60:63], v[140:143]
ds_read_b64_tr_b16 v[44:45], v2 offset:40960
ds_read_b64_tr_b16 v[46:47], v2 offset:41472
v_mfma_f32_16x16x32_bf16 v[144:147], v[64:67], a[32:35], v[144:147]
buffer_load_dwordx4 v73, s[12:15], s48 offen offset:1024 lds
v_mfma_f32_16x16x32_bf16 v[144:147], v[68:71], a[48:51], v[144:147]
ds_read_b64_tr_b16 v[48:49], v2 offset:34816
ds_read_b64_tr_b16 v[50:51], v2 offset:35328
v_mfma_f32_16x16x32_bf16 v[148:151], v[64:67], a[36:39], v[148:151]
ds_read_b64_tr_b16 v[52:53], v2 offset:43008
ds_read_b64_tr_b16 v[54:55], v2 offset:43520
v_mfma_f32_16x16x32_bf16 v[148:151], v[68:71], a[52:55], v[148:151]
s_lshl2_add_u32 s58, s39, s38
s_mul_i32 s58, s58, 82944
v_mfma_f32_16x16x32_bf16 v[152:155], v[64:67], a[40:43], v[152:155]
buffer_load_dwordx4 v92, s[12:15], s48 offen offset:2048 lds
v_mfma_f32_16x16x32_bf16 v[152:155], v[68:71], a[56:59], v[152:155]
v_mul_u32_u24 v218, 128, v1
v_lshrrev_b32 v218, 8, v218
v_mfma_f32_16x16x32_bf16 v[156:159], v[64:67], a[44:47], v[156:159]
v_mul_u32_u24 v218, 8960, v218
v_lshl_add_u32 v218, v1, 7, v218
v_mfma_f32_16x16x32_bf16 v[156:159], v[68:71], a[60:63], v[156:159]
v_add_u32 v219, 46, v1
s_waitcnt lgkmcnt(0)
v_mfma_f32_16x16x32_bf16 v[96:99], v[40:43], a[64:67], v[96:99]
buffer_load_dwordx4 v93, s[12:15], s48 offen offset:3072 lds
v_mfma_f32_16x16x32_bf16 v[96:99], v[44:47], a[80:83], v[96:99]
ds_read_b64_tr_b16 v[56:57], v3 offset:32768
v_and_b32 v219, 64, v219
v_mfma_f32_16x16x32_bf16 v[100:103], v[40:43], a[68:71], v[100:103]
ds_read_b64_tr_b16 v[58:59], v3 offset:33280
v_lshl_add_u32 v218, v219, 22, v218
v_mfma_f32_16x16x32_bf16 v[100:103], v[44:47], a[84:87], v[100:103]
ds_read_b64_tr_b16 v[60:61], v3 offset:40960
v_add_u32 v218, s58, v218
v_mfma_f32_16x16x32_bf16 v[104:107], v[40:43], a[72:75], v[104:107]
buffer_load_dword v95, v218, s[4:7], 0 offen offset:128
v_mfma_f32_16x16x32_bf16 v[104:107], v[44:47], a[88:91], v[104:107]
ds_read_b64_tr_b16 v[62:63], v3 offset:41472
v_mfma_f32_16x16x32_bf16 v[108:111], v[40:43], a[76:79], v[108:111]
ds_read_b64_tr_b16 v[64:65], v3 offset:34816
v_mfma_f32_16x16x32_bf16 v[108:111], v[44:47], a[92:95], v[108:111]
ds_read_b64_tr_b16 v[66:67], v3 offset:35328
v_mfma_f32_16x16x32_bf16 v[112:115], v[48:51], a[64:67], v[112:115]
buffer_load_dword v95, v218, s[8:11], 0 offen offset:2176
v_mfma_f32_16x16x32_bf16 v[112:115], v[52:55], a[80:83], v[112:115]
ds_read_b64_tr_b16 v[68:69], v3 offset:43008
s_add_u32 m0, s37, 0
v_mfma_f32_16x16x32_bf16 v[116:119], v[48:51], a[68:71], v[116:119]
ds_read_b64_tr_b16 v[70:71], v3 offset:43520
v_mfma_f32_16x16x32_bf16 v[116:119], v[52:55], a[84:87], v[116:119]
v_mfma_f32_16x16x32_bf16 v[120:123], v[48:51], a[72:75], v[120:123]
buffer_load_dwordx4 v10, s[4:7], s33 offen offset:0 lds
v_mfma_f32_16x16x32_bf16 v[120:123], v[52:55], a[88:91], v[120:123]
v_mfma_f32_16x16x32_bf16 v[124:127], v[48:51], a[76:79], v[124:127]
s_waitcnt vmcnt(11) lgkmcnt(0)
v_mfma_f32_16x16x32_bf16 v[124:127], v[52:55], a[92:95], v[124:127]
s_barrier
v_mfma_f32_16x16x32_bf16 v[128:131], v[56:59], a[64:67], v[128:131]
buffer_load_dwordx4 v11, s[4:7], s33 offen offset:1024 lds
v_mfma_f32_16x16x32_bf16 v[128:131], v[60:63], a[80:83], v[128:131]
ds_read_b128 a[96:99], v74 offset:49152
ds_read_b128 a[100:103], v74 offset:51200
v_mfma_f32_16x16x32_bf16 v[132:135], v[56:59], a[68:71], v[132:135]
ds_read_b128 a[104:107], v74 offset:53248
ds_read_b128 a[108:111], v74 offset:55296
v_mfma_f32_16x16x32_bf16 v[132:135], v[60:63], a[84:87], v[132:135]
ds_read_b128 a[112:115], v75 offset:49152
ds_read_b128 a[116:119], v75 offset:51200
v_mfma_f32_16x16x32_bf16 v[136:139], v[56:59], a[72:75], v[136:139]
buffer_load_dwordx4 v10, s[8:11], s33 offen offset:2048 lds
v_mfma_f32_16x16x32_bf16 v[136:139], v[60:63], a[88:91], v[136:139]
ds_read_b128 a[120:123], v75 offset:53248
ds_read_b128 a[124:127], v75 offset:55296
v_mfma_f32_16x16x32_bf16 v[140:143], v[56:59], a[76:79], v[140:143]
ds_read_b64_tr_b16 v[40:41], v2 offset:49152
ds_read_b64_tr_b16 v[42:43], v2 offset:49664
v_mfma_f32_16x16x32_bf16 v[140:143], v[60:63], a[92:95], v[140:143]
ds_read_b64_tr_b16 v[44:45], v2 offset:57344
ds_read_b64_tr_b16 v[46:47], v2 offset:57856
v_mfma_f32_16x16x32_bf16 v[144:147], v[64:67], a[64:67], v[144:147]
buffer_load_dwordx4 v11, s[8:11], s33 offen offset:3072 lds
v_mfma_f32_16x16x32_bf16 v[144:147], v[68:71], a[80:83], v[144:147]
ds_read_b64_tr_b16 v[48:49], v2 offset:51200
ds_read_b64_tr_b16 v[50:51], v2 offset:51712
s_mov_b32 s48, 640
v_mfma_f32_16x16x32_bf16 v[148:151], v[64:67], a[68:71], v[148:151]
ds_read_b64_tr_b16 v[52:53], v2 offset:59392
ds_read_b64_tr_b16 v[54:55], v2 offset:59904
s_add_u32 m0, s37, 81920
v_mfma_f32_16x16x32_bf16 v[148:151], v[68:71], a[84:87], v[148:151]
v_mfma_f32_16x16x32_bf16 v[152:155], v[64:67], a[72:75], v[152:155]
buffer_load_dwordx4 v72, s[12:15], s48 offen offset:0 lds
v_mfma_f32_16x16x32_bf16 v[152:155], v[68:71], a[88:91], v[152:155]
v_mfma_f32_16x16x32_bf16 v[156:159], v[64:67], a[76:79], v[156:159]
v_mfma_f32_16x16x32_bf16 v[156:159], v[68:71], a[92:95], v[156:159]
s_waitcnt lgkmcnt(0)
v_mfma_f32_16x16x32_bf16 v[96:99], v[40:43], a[96:99], v[96:99]
buffer_load_dwordx4 v73, s[12:15], s48 offen offset:1024 lds
v_mfma_f32_16x16x32_bf16 v[96:99], v[44:47], a[112:115], v[96:99]
ds_read_b64_tr_b16 v[56:57], v3 offset:49152
v_mfma_f32_16x16x32_bf16 v[100:103], v[40:43], a[100:103], v[100:103]
ds_read_b64_tr_b16 v[58:59], v3 offset:49664
v_mfma_f32_16x16x32_bf16 v[100:103], v[44:47], a[116:119], v[100:103]
ds_read_b64_tr_b16 v[60:61], v3 offset:57344
v_mfma_f32_16x16x32_bf16 v[104:107], v[40:43], a[104:107], v[104:107]
buffer_load_dwordx4 v92, s[12:15], s48 offen offset:2048 lds
v_mfma_f32_16x16x32_bf16 v[104:107], v[44:47], a[120:123], v[104:107]
ds_read_b64_tr_b16 v[62:63], v3 offset:57856
v_mfma_f32_16x16x32_bf16 v[108:111], v[40:43], a[108:111], v[108:111]
ds_read_b64_tr_b16 v[64:65], v3 offset:51200
v_mfma_f32_16x16x32_bf16 v[108:111], v[44:47], a[124:127], v[108:111]
ds_read_b64_tr_b16 v[66:67], v3 offset:51712
v_mfma_f32_16x16x32_bf16 v[112:115], v[48:51], a[96:99], v[112:115]
buffer_load_dwordx4 v93, s[12:15], s48 offen offset:3072 lds
v_mfma_f32_16x16x32_bf16 v[112:115], v[52:55], a[112:115], v[112:115]
ds_read_b64_tr_b16 v[68:69], v3 offset:59392
s_add_u32 m0, s37, 16384
v_mfma_f32_16x16x32_bf16 v[116:119], v[48:51], a[100:103], v[116:119]
ds_read_b64_tr_b16 v[70:71], v3 offset:59904
v_mfma_f32_16x16x32_bf16 v[116:119], v[52:55], a[116:119], v[116:119]
v_mfma_f32_16x16x32_bf16 v[120:123], v[48:51], a[104:107], v[120:123]
buffer_load_dwordx4 v10, s[4:7], s34 offen offset:0 lds
v_mfma_f32_16x16x32_bf16 v[120:123], v[52:55], a[120:123], v[120:123]
v_mfma_f32_16x16x32_bf16 v[124:127], v[48:51], a[108:111], v[124:127]
s_waitcnt vmcnt(11) lgkmcnt(0)
v_mfma_f32_16x16x32_bf16 v[124:127], v[52:55], a[124:127], v[124:127]
s_barrier
v_mfma_f32_16x16x32_bf16 v[128:131], v[56:59], a[96:99], v[128:131]
buffer_load_dwordx4 v11, s[4:7], s34 offen offset:1024 lds
v_mfma_f32_16x16x32_bf16 v[128:131], v[60:63], a[112:115], v[128:131]
ds_read_b128 a[128:131], v76 offset:0
ds_read_b128 a[132:135], v76 offset:2048
v_mfma_f32_16x16x32_bf16 v[132:135], v[56:59], a[100:103], v[132:135]
ds_read_b128 a[136:139], v76 offset:4096
ds_read_b128 a[140:143], v76 offset:6144
v_mfma_f32_16x16x32_bf16 v[132:135], v[60:63], a[116:119], v[132:135]
ds_read_b128 a[144:147], v77 offset:0
ds_read_b128 a[148:151], v77 offset:2048
v_mfma_f32_16x16x32_bf16 v[136:139], v[56:59], a[104:107], v[136:139]
buffer_load_dwordx4 v10, s[8:11], s34 offen offset:2048 lds
v_mfma_f32_16x16x32_bf16 v[136:139], v[60:63], a[120:123], v[136:139]
ds_read_b128 a[152:155], v77 offset:4096
ds_read_b128 a[156:159], v77 offset:6144
v_mfma_f32_16x16x32_bf16 v[140:143], v[56:59], a[108:111], v[140:143]
ds_read_b64_tr_b16 v[40:41], v4 offset:0
ds_read_b64_tr_b16 v[42:43], v4 offset:512
v_mfma_f32_16x16x32_bf16 v[140:143], v[60:63], a[124:127], v[140:143]
ds_read_b64_tr_b16 v[44:45], v4 offset:8192
ds_read_b64_tr_b16 v[46:47], v4 offset:8704
v_mfma_f32_16x16x32_bf16 v[144:147], v[64:67], a[96:99], v[144:147]
buffer_load_dwordx4 v11, s[8:11], s34 offen offset:3072 lds
v_mfma_f32_16x16x32_bf16 v[144:147], v[68:71], a[112:115], v[144:147]
ds_read_b64_tr_b16 v[48:49], v4 offset:2048
ds_read_b64_tr_b16 v[50:51], v4 offset:2560
s_mov_b32 s48, 768
v_mfma_f32_16x16x32_bf16 v[148:151], v[64:67], a[100:103], v[148:151]
ds_read_b64_tr_b16 v[52:53], v4 offset:10240
ds_read_b64_tr_b16 v[54:55], v4 offset:10752
s_add_u32 m0, s37, 98304
v_mfma_f32_16x16x32_bf16 v[148:151], v[68:71], a[116:119], v[148:151]
v_mfma_f32_16x16x32_bf16 v[152:155], v[64:67], a[104:107], v[152:155]
buffer_load_dwordx4 v72, s[12:15], s48 offen offset:0 lds
v_mfma_f32_16x16x32_bf16 v[152:155], v[68:71], a[120:123], v[152:155]
v_mfma_f32_16x16x32_bf16 v[156:159], v[64:67], a[108:111], v[156:159]
v_mfma_f32_16x16x32_bf16 v[156:159], v[68:71], a[124:127], v[156:159]
s_waitcnt lgkmcnt(0)
v_mfma_f32_16x16x32_bf16 v[96:99], v[40:43], a[128:131], v[96:99]
buffer_load_dwordx4 v73, s[12:15], s48 offen offset:1024 lds
v_mfma_f32_16x16x32_bf16 v[96:99], v[44:47], a[144:147], v[96:99]
ds_read_b64_tr_b16 v[56:57], v5 offset:0
v_mfma_f32_16x16x32_bf16 v[100:103], v[40:43], a[132:135], v[100:103]
ds_read_b64_tr_b16 v[58:59], v5 offset:512
v_mfma_f32_16x16x32_bf16 v[100:103], v[44:47], a[148:151], v[100:103]
ds_read_b64_tr_b16 v[60:61], v5 offset:8192
v_mfma_f32_16x16x32_bf16 v[104:107], v[40:43], a[136:139], v[104:107]
buffer_load_dwordx4 v92, s[12:15], s48 offen offset:2048 lds
v_mfma_f32_16x16x32_bf16 v[104:107], v[44:47], a[152:155], v[104:107]
ds_read_b64_tr_b16 v[62:63], v5 offset:8704
v_mfma_f32_16x16x32_bf16 v[108:111], v[40:43], a[140:143], v[108:111]
ds_read_b64_tr_b16 v[64:65], v5 offset:2048
v_mfma_f32_16x16x32_bf16 v[108:111], v[44:47], a[156:159], v[108:111]
ds_read_b64_tr_b16 v[66:67], v5 offset:2560
v_mfma_f32_16x16x32_bf16 v[112:115], v[48:51], a[128:131], v[112:115]
buffer_load_dwordx4 v93, s[12:15], s48 offen offset:3072 lds
v_mfma_f32_16x16x32_bf16 v[112:115], v[52:55], a[144:147], v[112:115]
ds_read_b64_tr_b16 v[68:69], v5 offset:10240
s_add_u32 m0, s37, 32768
v_mfma_f32_16x16x32_bf16 v[116:119], v[48:51], a[132:135], v[116:119]
ds_read_b64_tr_b16 v[70:71], v5 offset:10752
v_mfma_f32_16x16x32_bf16 v[116:119], v[52:55], a[148:151], v[116:119]
v_mfma_f32_16x16x32_bf16 v[120:123], v[48:51], a[136:139], v[120:123]
buffer_load_dwordx4 v10, s[4:7], s35 offen offset:0 lds
v_mfma_f32_16x16x32_bf16 v[120:123], v[52:55], a[152:155], v[120:123]
v_mfma_f32_16x16x32_bf16 v[124:127], v[48:51], a[140:143], v[124:127]
s_waitcnt vmcnt(9) lgkmcnt(0)
v_mfma_f32_16x16x32_bf16 v[124:127], v[52:55], a[156:159], v[124:127]
s_barrier
v_mfma_f32_16x16x32_bf16 v[128:131], v[56:59], a[128:131], v[128:131]
buffer_load_dwordx4 v11, s[4:7], s35 offen offset:1024 lds
v_mfma_f32_16x16x32_bf16 v[128:131], v[60:63], a[144:147], v[128:131]
ds_read_b128 a[160:163], v74 offset:0
ds_read_b128 a[164:167], v74 offset:2048
v_mfma_f32_16x16x32_bf16 v[132:135], v[56:59], a[132:135], v[132:135]
ds_read_b128 a[168:171], v74 offset:4096
ds_read_b128 a[172:175], v74 offset:6144
v_mfma_f32_16x16x32_bf16 v[132:135], v[60:63], a[148:151], v[132:135]
ds_read_b128 a[176:179], v75 offset:0
ds_read_b128 a[180:183], v75 offset:2048
v_mfma_f32_16x16x32_bf16 v[136:139], v[56:59], a[136:139], v[136:139]
buffer_load_dwordx4 v10, s[8:11], s35 offen offset:2048 lds
v_mfma_f32_16x16x32_bf16 v[136:139], v[60:63], a[152:155], v[136:139]
ds_read_b128 a[184:187], v75 offset:4096
ds_read_b128 a[188:191], v75 offset:6144
v_mfma_f32_16x16x32_bf16 v[140:143], v[56:59], a[140:143], v[140:143]
ds_read_b64_tr_b16 v[40:41], v2 offset:0
ds_read_b64_tr_b16 v[42:43], v2 offset:512
v_mfma_f32_16x16x32_bf16 v[140:143], v[60:63], a[156:159], v[140:143]
ds_read_b64_tr_b16 v[44:45], v2 offset:8192
ds_read_b64_tr_b16 v[46:47], v2 offset:8704
v_mfma_f32_16x16x32_bf16 v[144:147], v[64:67], a[128:131], v[144:147]
buffer_load_dwordx4 v11, s[8:11], s35 offen offset:3072 lds
v_mfma_f32_16x16x32_bf16 v[144:147], v[68:71], a[144:147], v[144:147]
ds_read_b64_tr_b16 v[48:49], v2 offset:2048
ds_read_b64_tr_b16 v[50:51], v2 offset:2560
s_mov_b32 s48, 896
v_mfma_f32_16x16x32_bf16 v[148:151], v[64:67], a[132:135], v[148:151]
ds_read_b64_tr_b16 v[52:53], v2 offset:10240
ds_read_b64_tr_b16 v[54:55], v2 offset:10752
s_add_u32 m0, s37, 114688
v_mfma_f32_16x16x32_bf16 v[148:151], v[68:71], a[148:151], v[148:151]
v_mfma_f32_16x16x32_bf16 v[152:155], v[64:67], a[136:139], v[152:155]
buffer_load_dwordx4 v72, s[12:15], s48 offen offset:0 lds
v_mfma_f32_16x16x32_bf16 v[152:155], v[68:71], a[152:155], v[152:155]
v_mfma_f32_16x16x32_bf16 v[156:159], v[64:67], a[140:143], v[156:159]
v_mfma_f32_16x16x32_bf16 v[156:159], v[68:71], a[156:159], v[156:159]
s_waitcnt lgkmcnt(0)
v_mfma_f32_16x16x32_bf16 v[96:99], v[40:43], a[160:163], v[96:99]
buffer_load_dwordx4 v73, s[12:15], s48 offen offset:1024 lds
v_mfma_f32_16x16x32_bf16 v[96:99], v[44:47], a[176:179], v[96:99]
ds_read_b64_tr_b16 v[56:57], v3 offset:0
v_mfma_f32_16x16x32_bf16 v[100:103], v[40:43], a[164:167], v[100:103]
ds_read_b64_tr_b16 v[58:59], v3 offset:512
v_mfma_f32_16x16x32_bf16 v[100:103], v[44:47], a[180:183], v[100:103]
ds_read_b64_tr_b16 v[60:61], v3 offset:8192
v_mfma_f32_16x16x32_bf16 v[104:107], v[40:43], a[168:171], v[104:107]
buffer_load_dwordx4 v92, s[12:15], s48 offen offset:2048 lds
v_mfma_f32_16x16x32_bf16 v[104:107], v[44:47], a[184:187], v[104:107]
ds_read_b64_tr_b16 v[62:63], v3 offset:8704
v_mfma_f32_16x16x32_bf16 v[108:111], v[40:43], a[172:175], v[108:111]
ds_read_b64_tr_b16 v[64:65], v3 offset:2048
v_mfma_f32_16x16x32_bf16 v[108:111], v[44:47], a[188:191], v[108:111]
ds_read_b64_tr_b16 v[66:67], v3 offset:2560
v_mfma_f32_16x16x32_bf16 v[112:115], v[48:51], a[160:163], v[112:115]
buffer_load_dwordx4 v93, s[12:15], s48 offen offset:3072 lds
v_mfma_f32_16x16x32_bf16 v[112:115], v[52:55], a[176:179], v[112:115]
ds_read_b64_tr_b16 v[68:69], v3 offset:10240
s_add_u32 m0, s37, 49152
v_mfma_f32_16x16x32_bf16 v[116:119], v[48:51], a[164:167], v[116:119]
ds_read_b64_tr_b16 v[70:71], v3 offset:10752
v_mfma_f32_16x16x32_bf16 v[116:119], v[52:55], a[180:183], v[116:119]
v_mfma_f32_16x16x32_bf16 v[120:123], v[48:51], a[168:171], v[120:123]
buffer_load_dwordx4 v10, s[4:7], s36 offen offset:0 lds
v_mfma_f32_16x16x32_bf16 v[120:123], v[52:55], a[184:187], v[120:123]
v_mfma_f32_16x16x32_bf16 v[124:127], v[48:51], a[172:175], v[124:127]
s_waitcnt vmcnt(9) lgkmcnt(0)
v_mfma_f32_16x16x32_bf16 v[124:127], v[52:55], a[188:191], v[124:127]
s_barrier
v_mfma_f32_16x16x32_bf16 v[128:131], v[56:59], a[160:163], v[128:131]
buffer_load_dwordx4 v11, s[4:7], s36 offen offset:1024 lds
v_mfma_f32_16x16x32_bf16 v[128:131], v[60:63], a[176:179], v[128:131]
ds_read_b128 a[192:195], v74 offset:16384
ds_read_b128 a[196:199], v74 offset:18432
v_mfma_f32_16x16x32_bf16 v[132:135], v[56:59], a[164:167], v[132:135]
ds_read_b128 a[200:203], v74 offset:20480
ds_read_b128 a[204:207], v74 offset:22528
v_mfma_f32_16x16x32_bf16 v[132:135], v[60:63], a[180:183], v[132:135]
ds_read_b128 a[208:211], v75 offset:16384
ds_read_b128 a[212:215], v75 offset:18432
v_mfma_f32_16x16x32_bf16 v[136:139], v[56:59], a[168:171], v[136:139]
buffer_load_dwordx4 v10, s[8:11], s36 offen offset:2048 lds
v_mfma_f32_16x16x32_bf16 v[136:139], v[60:63], a[184:187], v[136:139]
ds_read_b128 a[216:219], v75 offset:20480
ds_read_b128 a[220:223], v75 offset:22528
v_mfma_f32_16x16x32_bf16 v[140:143], v[56:59], a[172:175], v[140:143]
ds_read_b64_tr_b16 v[40:41], v2 offset:16384
ds_read_b64_tr_b16 v[42:43], v2 offset:16896
v_mfma_f32_16x16x32_bf16 v[140:143], v[60:63], a[188:191], v[140:143]
ds_read_b64_tr_b16 v[44:45], v2 offset:24576
ds_read_b64_tr_b16 v[46:47], v2 offset:25088
v_mfma_f32_16x16x32_bf16 v[144:147], v[64:67], a[160:163], v[144:147]
buffer_load_dwordx4 v11, s[8:11], s36 offen offset:3072 lds
v_mfma_f32_16x16x32_bf16 v[144:147], v[68:71], a[176:179], v[144:147]
ds_read_b64_tr_b16 v[48:49], v2 offset:18432
ds_read_b64_tr_b16 v[50:51], v2 offset:18944
s_mov_b32 s48, 1024
v_mfma_f32_16x16x32_bf16 v[148:151], v[64:67], a[164:167], v[148:151]
ds_read_b64_tr_b16 v[52:53], v2 offset:26624
ds_read_b64_tr_b16 v[54:55], v2 offset:27136
s_add_u32 m0, s37, 131072
v_mfma_f32_16x16x32_bf16 v[148:151], v[68:71], a[180:183], v[148:151]
v_mfma_f32_16x16x32_bf16 v[152:155], v[64:67], a[168:171], v[152:155]
buffer_load_dwordx4 v72, s[12:15], s48 offen offset:0 lds
v_mfma_f32_16x16x32_bf16 v[152:155], v[68:71], a[184:187], v[152:155]
v_mfma_f32_16x16x32_bf16 v[156:159], v[64:67], a[172:175], v[156:159]
v_mfma_f32_16x16x32_bf16 v[156:159], v[68:71], a[188:191], v[156:159]
s_waitcnt lgkmcnt(0)
v_mfma_f32_16x16x32_bf16 v[96:99], v[40:43], a[192:195], v[96:99]
buffer_load_dwordx4 v73, s[12:15], s48 offen offset:1024 lds
v_mfma_f32_16x16x32_bf16 v[96:99], v[44:47], a[208:211], v[96:99]
ds_read_b64_tr_b16 v[56:57], v3 offset:16384
v_mov_b32 v160, 0
v_mfma_f32_16x16x32_bf16 v[100:103], v[40:43], a[196:199], v[100:103]
ds_read_b64_tr_b16 v[58:59], v3 offset:16896
v_mov_b32 v161, 0
v_mfma_f32_16x16x32_bf16 v[100:103], v[44:47], a[212:215], v[100:103]
ds_read_b64_tr_b16 v[60:61], v3 offset:24576
v_mov_b32 v162, 0
v_mfma_f32_16x16x32_bf16 v[104:107], v[40:43], a[200:203], v[104:107]
buffer_load_dwordx4 v92, s[12:15], s48 offen offset:2048 lds
v_mfma_f32_16x16x32_bf16 v[104:107], v[44:47], a[216:219], v[104:107]
ds_read_b64_tr_b16 v[62:63], v3 offset:25088
v_mov_b32 v163, 0
v_mfma_f32_16x16x32_bf16 v[108:111], v[40:43], a[204:207], v[108:111]
ds_read_b64_tr_b16 v[64:65], v3 offset:18432
s_mov_b32 s50, 67112960
v_mfma_f32_16x16x32_bf16 v[108:111], v[44:47], a[220:223], v[108:111]
ds_read_b64_tr_b16 v[66:67], v3 offset:18944
v_mfma_f32_16x16x32_bf16 v[112:115], v[48:51], a[192:195], v[112:115]
buffer_load_dwordx4 v93, s[12:15], s48 offen offset:3072 lds
v_mfma_f32_16x16x32_bf16 v[112:115], v[52:55], a[208:211], v[112:115]
ds_read_b64_tr_b16 v[68:69], v3 offset:26624
v_add_u32 v10, 128, v10
v_mfma_f32_16x16x32_bf16 v[116:119], v[48:51], a[196:199], v[116:119]
ds_read_b64_tr_b16 v[70:71], v3 offset:27136
v_add_u32 v11, 128, v11
s_add_u32 m0, s37, 65536
v_mfma_f32_16x16x32_bf16 v[116:119], v[52:55], a[212:215], v[116:119]
buffer_store_dwordx4 v[160:163], v91, s[20:23], s50 offen sc1
v_mfma_f32_16x16x32_bf16 v[120:123], v[48:51], a[200:203], v[120:123]
buffer_load_dwordx4 v10, s[4:7], s28 offen offset:0 lds
v_mfma_f32_16x16x32_bf16 v[120:123], v[52:55], a[216:219], v[120:123]
buffer_store_dwordx4 v[160:163], v217, s[20:23], 0 offen offset:128 sc1
v_mfma_f32_16x16x32_bf16 v[124:127], v[48:51], a[204:207], v[124:127]
s_waitcnt vmcnt(11) lgkmcnt(0)
v_mfma_f32_16x16x32_bf16 v[124:127], v[52:55], a[220:223], v[124:127]
s_barrier
v_mfma_f32_16x16x32_bf16 v[128:131], v[56:59], a[192:195], v[128:131]
buffer_load_dwordx4 v11, s[4:7], s28 offen offset:1024 lds
v_mfma_f32_16x16x32_bf16 v[128:131], v[60:63], a[208:211], v[128:131]
ds_read_b128 a[224:227], v74 offset:32768
ds_read_b128 a[228:231], v74 offset:34816
v_mfma_f32_16x16x32_bf16 v[132:135], v[56:59], a[196:199], v[132:135]
ds_read_b128 a[232:235], v74 offset:36864
ds_read_b128 a[236:239], v74 offset:38912
v_mfma_f32_16x16x32_bf16 v[132:135], v[60:63], a[212:215], v[132:135]
ds_read_b128 a[240:243], v75 offset:32768
ds_read_b128 a[244:247], v75 offset:34816
v_mfma_f32_16x16x32_bf16 v[136:139], v[56:59], a[200:203], v[136:139]
buffer_load_dwordx4 v10, s[8:11], s28 offen offset:2048 lds
v_mfma_f32_16x16x32_bf16 v[136:139], v[60:63], a[216:219], v[136:139]
ds_read_b128 a[248:251], v75 offset:36864
ds_read_b128 a[252:255], v75 offset:38912
v_mfma_f32_16x16x32_bf16 v[140:143], v[56:59], a[204:207], v[140:143]
ds_read_b64_tr_b16 v[40:41], v2 offset:32768
ds_read_b64_tr_b16 v[42:43], v2 offset:33280
v_mfma_f32_16x16x32_bf16 v[140:143], v[60:63], a[220:223], v[140:143]
ds_read_b64_tr_b16 v[44:45], v2 offset:40960
ds_read_b64_tr_b16 v[46:47], v2 offset:41472
v_mfma_f32_16x16x32_bf16 v[144:147], v[64:67], a[192:195], v[144:147]
buffer_load_dwordx4 v11, s[8:11], s28 offen offset:3072 lds
v_mfma_f32_16x16x32_bf16 v[144:147], v[68:71], a[208:211], v[144:147]
ds_read_b64_tr_b16 v[48:49], v2 offset:34816
ds_read_b64_tr_b16 v[50:51], v2 offset:35328
s_add_u32 m0, s37, 0
v_mfma_f32_16x16x32_bf16 v[148:151], v[64:67], a[196:199], v[148:151]
ds_read_b64_tr_b16 v[52:53], v2 offset:43008
ds_read_b64_tr_b16 v[54:55], v2 offset:43520
v_mfma_f32_16x16x32_bf16 v[148:151], v[68:71], a[212:215], v[148:151]
v_mfma_f32_16x16x32_bf16 v[152:155], v[64:67], a[200:203], v[152:155]
buffer_load_dwordx4 v10, s[4:7], s29 offen offset:0 lds
v_mfma_f32_16x16x32_bf16 v[152:155], v[68:71], a[216:219], v[152:155]
v_mfma_f32_16x16x32_bf16 v[156:159], v[64:67], a[204:207], v[156:159]
v_mfma_f32_16x16x32_bf16 v[156:159], v[68:71], a[220:223], v[156:159]
s_waitcnt lgkmcnt(0)
v_mfma_f32_16x16x32_bf16 v[96:99], v[40:43], a[224:227], v[96:99]
buffer_load_dwordx4 v11, s[4:7], s29 offen offset:1024 lds
v_mfma_f32_16x16x32_bf16 v[96:99], v[44:47], a[240:243], v[96:99]
ds_read_b64_tr_b16 v[56:57], v3 offset:32768
v_mfma_f32_16x16x32_bf16 v[100:103], v[40:43], a[228:231], v[100:103]
ds_read_b64_tr_b16 v[58:59], v3 offset:33280
v_mfma_f32_16x16x32_bf16 v[100:103], v[44:47], a[244:247], v[100:103]
ds_read_b64_tr_b16 v[60:61], v3 offset:40960
v_mfma_f32_16x16x32_bf16 v[104:107], v[40:43], a[232:235], v[104:107]
buffer_load_dwordx4 v10, s[8:11], s29 offen offset:2048 lds
v_mfma_f32_16x16x32_bf16 v[104:107], v[44:47], a[248:251], v[104:107]
ds_read_b64_tr_b16 v[62:63], v3 offset:41472
v_mfma_f32_16x16x32_bf16 v[108:111], v[40:43], a[236:239], v[108:111]
ds_read_b64_tr_b16 v[64:65], v3 offset:34816
v_mfma_f32_16x16x32_bf16 v[108:111], v[44:47], a[252:255], v[108:111]
ds_read_b64_tr_b16 v[66:67], v3 offset:35328
v_mfma_f32_16x16x32_bf16 v[112:115], v[48:51], a[224:227], v[112:115]
buffer_load_dwordx4 v11, s[8:11], s29 offen offset:3072 lds
v_mfma_f32_16x16x32_bf16 v[112:115], v[52:55], a[240:243], v[112:115]
ds_read_b64_tr_b16 v[68:69], v3 offset:43008
s_add_u32 m0, s37, 16384
v_mfma_f32_16x16x32_bf16 v[116:119], v[48:51], a[228:231], v[116:119]
ds_read_b64_tr_b16 v[70:71], v3 offset:43520
v_mfma_f32_16x16x32_bf16 v[116:119], v[52:55], a[244:247], v[116:119]
buffer_load_dword v78, v221, s[24:27], 0 offen sc1
v_mfma_f32_16x16x32_bf16 v[120:123], v[48:51], a[232:235], v[120:123]
buffer_load_dwordx4 v10, s[4:7], s30 offen offset:0 lds
v_mfma_f32_16x16x32_bf16 v[120:123], v[52:55], a[248:251], v[120:123]
v_mfma_f32_16x16x32_bf16 v[124:127], v[48:51], a[236:239], v[124:127]
s_waitcnt vmcnt(12) lgkmcnt(0)
v_mfma_f32_16x16x32_bf16 v[124:127], v[52:55], a[252:255], v[124:127]
s_barrier
v_mfma_f32_16x16x32_bf16 v[128:131], v[56:59], a[224:227], v[128:131]
buffer_load_dwordx4 v11, s[4:7], s30 offen offset:1024 lds
v_mfma_f32_16x16x32_bf16 v[128:131], v[60:63], a[240:243], v[128:131]
ds_read_b128 v[224:227], v74 offset:49152
ds_read_b128 v[228:231], v74 offset:51200
v_mfma_f32_16x16x32_bf16 v[132:135], v[56:59], a[228:231], v[132:135]
ds_read_b128 v[232:235], v74 offset:53248
ds_read_b128 v[236:239], v74 offset:55296
v_mfma_f32_16x16x32_bf16 v[132:135], v[60:63], a[244:247], v[132:135]
ds_read_b128 v[240:243], v75 offset:49152
ds_read_b128 v[244:247], v75 offset:51200
v_mfma_f32_16x16x32_bf16 v[136:139], v[56:59], a[232:235], v[136:139]
buffer_load_dwordx4 v10, s[8:11], s30 offen offset:2048 lds
v_mfma_f32_16x16x32_bf16 v[136:139], v[60:63], a[248:251], v[136:139]
ds_read_b128 v[248:251], v75 offset:53248
ds_read_b128 v[252:255], v75 offset:55296
v_mfma_f32_16x16x32_bf16 v[140:143], v[56:59], a[236:239], v[140:143]
ds_read_b64_tr_b16 v[40:41], v2 offset:49152
ds_read_b64_tr_b16 v[42:43], v2 offset:49664
v_mfma_f32_16x16x32_bf16 v[140:143], v[60:63], a[252:255], v[140:143]
ds_read_b64_tr_b16 v[44:45], v2 offset:57344
ds_read_b64_tr_b16 v[46:47], v2 offset:57856
v_mfma_f32_16x16x32_bf16 v[144:147], v[64:67], a[224:227], v[144:147]
buffer_load_dwordx4 v11, s[8:11], s30 offen offset:3072 lds
v_mfma_f32_16x16x32_bf16 v[144:147], v[68:71], a[240:243], v[144:147]
ds_read_b64_tr_b16 v[48:49], v2 offset:51200
ds_read_b64_tr_b16 v[50:51], v2 offset:51712
s_add_u32 m0, s37, 32768
v_mfma_f32_16x16x32_bf16 v[148:151], v[64:67], a[228:231], v[148:151]
ds_read_b64_tr_b16 v[52:53], v2 offset:59392
ds_read_b64_tr_b16 v[54:55], v2 offset:59904
v_mfma_f32_16x16x32_bf16 v[148:151], v[68:71], a[244:247], v[148:151]
v_mfma_f32_16x16x32_bf16 v[152:155], v[64:67], a[232:235], v[152:155]
buffer_load_dwordx4 v10, s[4:7], s31 offen offset:0 lds
v_mfma_f32_16x16x32_bf16 v[152:155], v[68:71], a[248:251], v[152:155]
v_mfma_f32_16x16x32_bf16 v[156:159], v[64:67], a[236:239], v[156:159]
v_mfma_f32_16x16x32_bf16 v[156:159], v[68:71], a[252:255], v[156:159]
s_waitcnt lgkmcnt(0)
v_mfma_f32_16x16x32_bf16 v[96:99], v[40:43], v[224:227], v[96:99]
ds_read_b64_tr_b16 v[56:57], v3 offset:49152
v_mfma_f32_16x16x32_bf16 v[96:99], v[44:47], v[240:243], v[96:99]
ds_read_b64_tr_b16 v[58:59], v3 offset:49664
v_mfma_f32_16x16x32_bf16 v[100:103], v[40:43], v[228:231], v[100:103]
ds_read_b64_tr_b16 v[60:61], v3 offset:57344
v_mfma_f32_16x16x32_bf16 v[100:103], v[44:47], v[244:247], v[100:103]
ds_read_b64_tr_b16 v[62:63], v3 offset:57856
v_mfma_f32_16x16x32_bf16 v[104:107], v[40:43], v[232:235], v[104:107]
ds_read_b64_tr_b16 v[64:65], v3 offset:51200
v_mfma_f32_16x16x32_bf16 v[104:107], v[44:47], v[248:251], v[104:107]
ds_read_b64_tr_b16 v[66:67], v3 offset:51712
v_mfma_f32_16x16x32_bf16 v[108:111], v[40:43], v[236:239], v[108:111]
ds_read_b64_tr_b16 v[68:69], v3 offset:59392
v_mfma_f32_16x16x32_bf16 v[108:111], v[44:47], v[252:255], v[108:111]
ds_read_b64_tr_b16 v[70:71], v3 offset:59904
v_mfma_f32_16x16x32_bf16 v[112:115], v[48:51], v[224:227], v[112:115]
buffer_load_dwordx4 v11, s[4:7], s31 offen offset:1024 lds
v_mfma_f32_16x16x32_bf16 v[112:115], v[52:55], v[240:243], v[112:115]
v_mov_b32 v72, v221
v_mfma_f32_16x16x32_bf16 v[116:119], v[48:51], v[228:231], v[116:119]
buffer_load_dwordx4 v10, s[8:11], s31 offen offset:2048 lds
v_mfma_f32_16x16x32_bf16 v[116:119], v[52:55], v[244:247], v[116:119]
v_mfma_f32_16x16x32_bf16 v[120:123], v[48:51], v[232:235], v[120:123]
buffer_load_dwordx4 v11, s[8:11], s31 offen offset:3072 lds
v_mfma_f32_16x16x32_bf16 v[120:123], v[52:55], v[248:251], v[120:123]
s_add_u32 m0, s43, 131072
v_mfma_f32_16x16x32_bf16 v[124:127], v[48:51], v[236:239], v[124:127]
s_waitcnt vmcnt(13) lgkmcnt(0)
v_mfma_f32_16x16x32_bf16 v[124:127], v[52:55], v[252:255], v[124:127]
s_barrier
v_mfma_f32_16x16x32_bf16 v[128:131], v[56:59], v[224:227], v[128:131]
ds_read_b64_tr_b16 v[40:41], v4 offset:0
v_mfma_f32_16x16x32_bf16 v[128:131], v[60:63], v[240:243], v[128:131]
ds_read_b64_tr_b16 v[42:43], v4 offset:512
v_mfma_f32_16x16x32_bf16 v[132:135], v[56:59], v[228:231], v[132:135]
ds_read_b64_tr_b16 v[44:45], v4 offset:8192
v_mfma_f32_16x16x32_bf16 v[132:135], v[60:63], v[244:247], v[132:135]
ds_read_b64_tr_b16 v[46:47], v4 offset:8704
v_mfma_f32_16x16x32_bf16 v[136:139], v[56:59], v[232:235], v[136:139]
ds_read_b64_tr_b16 v[48:49], v4 offset:2048
v_mfma_f32_16x16x32_bf16 v[136:139], v[60:63], v[248:251], v[136:139]
ds_read_b64_tr_b16 v[50:51], v4 offset:2560
v_mfma_f32_16x16x32_bf16 v[140:143], v[56:59], v[236:239], v[140:143]
ds_read_b64_tr_b16 v[52:53], v4 offset:10240
v_mfma_f32_16x16x32_bf16 v[140:143], v[60:63], v[252:255], v[140:143]
ds_read_b64_tr_b16 v[54:55], v4 offset:10752
v_mfma_f32_16x16x32_bf16 v[144:147], v[64:67], v[224:227], v[144:147]
buffer_load_dwordx4 v83, s[52:55], 0 offen offset:0 lds
v_mfma_f32_16x16x32_bf16 v[144:147], v[68:71], v[240:243], v[144:147]
s_add_u32 m0, s43, 131072
v_mfma_f32_16x16x32_bf16 v[148:151], v[64:67], v[228:231], v[148:151]
buffer_load_dwordx4 v84, s[52:55], 0 offen offset:1024 lds
v_mfma_f32_16x16x32_bf16 v[148:151], v[68:71], v[244:247], v[148:151]
s_add_u32 m0, s37, 49152
v_mfma_f32_16x16x32_bf16 v[152:155], v[64:67], v[232:235], v[152:155]
buffer_load_dwordx4 v10, s[4:7], s32 offen offset:0 lds
v_mfma_f32_16x16x32_bf16 v[152:155], v[68:71], v[248:251], v[152:155]
v_mfma_f32_16x16x32_bf16 v[156:159], v[64:67], v[236:239], v[156:159]
v_mfma_f32_16x16x32_bf16 v[156:159], v[68:71], v[252:255], v[156:159]
s_waitcnt lgkmcnt(0)
v_mfma_f32_16x16x32_bf16 v[160:163], v[40:43], a[0:3], 0
ds_read_b64_tr_b16 v[56:57], v5 offset:0
v_mfma_f32_16x16x32_bf16 v[160:163], v[44:47], a[16:19], v[160:163]
ds_read_b64_tr_b16 v[58:59], v5 offset:512
s_add_u32 s50, s44, 0
v_mfma_f32_16x16x32_bf16 v[164:167], v[40:43], a[4:7], 0
ds_read_b64_tr_b16 v[60:61], v5 offset:8192
v_mul_f32 v24, v96, v96
v_mfma_f32_16x16x32_bf16 v[164:167], v[44:47], a[20:23], v[164:167]
ds_read_b64_tr_b16 v[62:63], v5 offset:8704
v_mul_f32 v25, v97, v97
v_mfma_f32_16x16x32_bf16 v[168:171], v[40:43], a[8:11], 0
ds_read_b64_tr_b16 v[64:65], v5 offset:2048
v_fma_f32 v24, v24, s47, v18
v_fma_f32 v25, v25, s47, v18
v_mfma_f32_16x16x32_bf16 v[168:171], v[44:47], a[24:27], v[168:171]
ds_read_b64_tr_b16 v[66:67], v5 offset:2560
v_mul_f32 v24, v24, v96
v_mfma_f32_16x16x32_bf16 v[172:175], v[40:43], a[12:15], 0
ds_read_b64_tr_b16 v[68:69], v5 offset:10240
v_mul_f32 v25, v25, v97
v_mfma_f32_16x16x32_bf16 v[172:175], v[44:47], a[28:31], v[172:175]
ds_read_b64_tr_b16 v[70:71], v5 offset:10752
v_exp_f32 v24, v24
v_mfma_f32_16x16x32_bf16 v[176:179], v[48:51], a[0:3], 0
buffer_load_dwordx4 v11, s[4:7], s32 offen offset:1024 lds
v_mfma_f32_16x16x32_bf16 v[176:179], v[52:55], a[16:19], v[176:179]
v_exp_f32 v25, v25
v_mfma_f32_16x16x32_bf16 v[180:183], v[48:51], a[4:7], 0
buffer_load_dwordx4 v10, s[8:11], s32 offen offset:2048 lds
v_mfma_f32_16x16x32_bf16 v[180:183], v[52:55], a[20:23], v[180:183]
v_mul_f32 v112, v112, v96
v_mul_f32 v113, v113, v97
v_add_f32 v24, 1.0, v24
v_mfma_f32_16x16x32_bf16 v[184:187], v[48:51], a[8:11], 0
buffer_load_dwordx4 v11, s[8:11], s32 offen offset:3072 lds
v_mfma_f32_16x16x32_bf16 v[184:187], v[52:55], a[24:27], v[184:187]
s_add_u32 m0, s43, 131072
v_add_f32 v25, 1.0, v25
v_mul_f32 v26, v98, v98
v_mfma_f32_16x16x32_bf16 v[188:191], v[48:51], a[12:15], 0
v_mul_f32 v27, v99, v99
s_waitcnt vmcnt(15) lgkmcnt(0)
v_mfma_f32_16x16x32_bf16 v[188:191], v[52:55], a[28:31], v[188:191]
s_barrier
v_mfma_f32_16x16x32_bf16 v[192:195], v[56:59], a[0:3], 0
ds_read_b64_tr_b16 v[40:41], v2 offset:0
v_rcp_f32 v24, v24
v_mfma_f32_16x16x32_bf16 v[192:195], v[60:63], a[16:19], v[192:195]
ds_read_b64_tr_b16 v[42:43], v2 offset:512
v_mul_f32 v112, v112, v24
v_mfma_f32_16x16x32_bf16 v[196:199], v[56:59], a[4:7], 0
ds_read_b64_tr_b16 v[44:45], v2 offset:8192
v_fma_f32 v26, v26, s47, v18
v_mfma_f32_16x16x32_bf16 v[196:199], v[60:63], a[20:23], v[196:199]
ds_read_b64_tr_b16 v[46:47], v2 offset:8704
v_rcp_f32 v25, v25
v_mfma_f32_16x16x32_bf16 v[200:203], v[56:59], a[8:11], 0
ds_read_b64_tr_b16 v[48:49], v2 offset:2048
v_mul_f32 v113, v113, v25
v_mfma_f32_16x16x32_bf16 v[200:203], v[60:63], a[24:27], v[200:203]
ds_read_b64_tr_b16 v[50:51], v2 offset:2560
v_fma_f32 v27, v27, s47, v18
v_mfma_f32_16x16x32_bf16 v[204:207], v[56:59], a[12:15], 0
ds_read_b64_tr_b16 v[52:53], v2 offset:10240
v_mul_f32 v26, v26, v98
v_mul_f32 v27, v27, v99
v_mfma_f32_16x16x32_bf16 v[204:207], v[60:63], a[28:31], v[204:207]
ds_read_b64_tr_b16 v[54:55], v2 offset:10752
v_mul_f32 v114, v114, v98
v_mfma_f32_16x16x32_bf16 v[208:211], v[64:67], a[0:3], 0
buffer_load_dwordx4 v85, s[52:55], 0 offen offset:2048 lds
v_mfma_f32_16x16x32_bf16 v[208:211], v[68:71], a[16:19], v[208:211]
s_mov_b64 s[92:93], s[90:91]
s_movk_i32 s94, 4608
v_mfma_f32_16x16x32_bf16 v[212:215], v[64:67], a[4:7], 0
v_exp_f32 v26, v26
v_mul_f32 v115, v115, v99
v_mfma_f32_16x16x32_bf16 v[212:215], v[68:71], a[20:23], v[212:215]
s_add_u32 m0, s43, 134144
v_add_f32 v26, 1.0, v26
v_mfma_f32_16x16x32_bf16 v[216:219], v[64:67], a[8:11], 0
buffer_load_dwordx4 v86, s[92:95], 0 offen lds
v_mfma_f32_16x16x32_bf16 v[216:219], v[68:71], a[24:27], v[216:219]
s_add_u32 m0, s37, 65536
v_exp_f32 v27, v27
v_mfma_f32_16x16x32_bf16 v[220:223], v[64:67], a[12:15], 0
v_add_f32 v27, 1.0, v27
v_cvt_pk_bf16_f32 v96, v112, v113
v_mfma_f32_16x16x32_bf16 v[220:223], v[68:71], a[28:31], v[220:223]
v_mul_f32 v28, v128, v128
s_waitcnt lgkmcnt(0)
v_mfma_f32_16x16x32_bf16 v[160:163], v[40:43], a[32:35], v[160:163]
ds_read_b64_tr_b16 v[56:57], v3 offset:0
v_rcp_f32 v26, v26
v_mfma_f32_16x16x32_bf16 v[160:163], v[44:47], a[48:51], v[160:163]
ds_read_b64_tr_b16 v[58:59], v3 offset:512
v_mul_f32 v114, v114, v26
v_mfma_f32_16x16x32_bf16 v[164:167], v[40:43], a[36:39], v[164:167]
ds_read_b64_tr_b16 v[60:61], v3 offset:8192
v_mul_f32 v29, v129, v129
v_mfma_f32_16x16x32_bf16 v[164:167], v[44:47], a[52:55], v[164:167]
ds_read_b64_tr_b16 v[62:63], v3 offset:8704
v_rcp_f32 v27, v27
v_mfma_f32_16x16x32_bf16 v[168:171], v[40:43], a[40:43], v[168:171]
ds_read_b64_tr_b16 v[64:65], v3 offset:2048
v_mul_f32 v115, v115, v27
v_mfma_f32_16x16x32_bf16 v[168:171], v[44:47], a[56:59], v[168:171]
ds_read_b64_tr_b16 v[66:67], v3 offset:2560
v_cvt_pk_bf16_f32 v97, v114, v115
v_mfma_f32_16x16x32_bf16 v[172:175], v[40:43], a[44:47], v[172:175]
ds_read_b64_tr_b16 v[68:69], v3 offset:10240
v_fma_f32 v28, v28, s47, v18
v_fma_f32 v29, v29, s47, v18
v_mfma_f32_16x16x32_bf16 v[172:175], v[44:47], a[60:63], v[172:175]
ds_read_b64_tr_b16 v[70:71], v3 offset:10752
v_mul_f32 v28, v28, v128
v_mfma_f32_16x16x32_bf16 v[176:179], v[48:51], a[32:35], v[176:179]
buffer_load_dwordx4 v10, s[4:7], s33 offen offset:0 lds
v_mfma_f32_16x16x32_bf16 v[176:179], v[52:55], a[48:51], v[176:179]
v_mul_f32 v29, v29, v129
v_exp_f32 v28, v28
v_mfma_f32_16x16x32_bf16 v[180:183], v[48:51], a[36:39], v[180:183]
buffer_load_dwordx4 v11, s[4:7], s33 offen offset:1024 lds
v_mfma_f32_16x16x32_bf16 v[180:183], v[52:55], a[52:55], v[180:183]
v_exp_f32 v29, v29
v_mfma_f32_16x16x32_bf16 v[184:187], v[48:51], a[40:43], v[184:187]
buffer_load_dwordx4 v10, s[8:11], s33 offen offset:2048 lds
v_mfma_f32_16x16x32_bf16 v[184:187], v[52:55], a[56:59], v[184:187]
v_mul_f32 v144, v144, v128
v_mul_f32 v145, v145, v129
v_add_f32 v28, 1.0, v28
v_mfma_f32_16x16x32_bf16 v[188:191], v[48:51], a[44:47], v[188:191]
v_add_f32 v29, 1.0, v29
s_waitcnt vmcnt(15) lgkmcnt(0)
v_mfma_f32_16x16x32_bf16 v[188:191], v[52:55], a[60:63], v[188:191]
s_barrier
v_mfma_f32_16x16x32_bf16 v[192:195], v[56:59], a[32:35], v[192:195]
ds_read_b64_tr_b16 v[40:41], v2 offset:16384
v_rcp_f32 v28, v28
v_mfma_f32_16x16x32_bf16 v[192:195], v[60:63], a[48:51], v[192:195]
ds_read_b64_tr_b16 v[42:43], v2 offset:16896
v_mul_f32 v144, v144, v28
v_mfma_f32_16x16x32_bf16 v[196:199], v[56:59], a[36:39], v[196:199]
ds_read_b64_tr_b16 v[44:45], v2 offset:24576
v_rcp_f32 v29, v29
v_mfma_f32_16x16x32_bf16 v[196:199], v[60:63], a[52:55], v[196:199]
ds_read_b64_tr_b16 v[46:47], v2 offset:25088
v_mul_f32 v145, v145, v29
v_mfma_f32_16x16x32_bf16 v[200:203], v[56:59], a[40:43], v[200:203]
ds_read_b64_tr_b16 v[48:49], v2 offset:18432
v_mul_f32 v30, v130, v130
v_mfma_f32_16x16x32_bf16 v[200:203], v[60:63], a[56:59], v[200:203]
ds_read_b64_tr_b16 v[50:51], v2 offset:18944
v_mul_f32 v31, v131, v131
v_mfma_f32_16x16x32_bf16 v[204:207], v[56:59], a[44:47], v[204:207]
ds_read_b64_tr_b16 v[52:53], v2 offset:26624
v_fma_f32 v30, v30, s47, v18
v_fma_f32 v31, v31, s47, v18
v_mfma_f32_16x16x32_bf16 v[204:207], v[60:63], a[60:63], v[204:207]
ds_read_b64_tr_b16 v[54:55], v2 offset:27136
v_mul_f32 v30, v30, v130
v_mfma_f32_16x16x32_bf16 v[208:211], v[64:67], a[32:35], v[208:211]
buffer_load_dwordx4 v11, s[8:11], s33 offen offset:3072 lds
v_mfma_f32_16x16x32_bf16 v[208:211], v[68:71], a[48:51], v[208:211]
s_add_u32 m0, s43, 147520
v_mul_f32 v31, v31, v131
v_mul_f32 v146, v146, v130
v_mfma_f32_16x16x32_bf16 v[212:215], v[64:67], a[36:39], v[212:215]
buffer_load_dwordx4 v80, s[96:99], 0 offen offset:0 lds
v_mfma_f32_16x16x32_bf16 v[212:215], v[68:71], a[52:55], v[212:215]
s_add_u32 m0, s43, 147520
v_mul_f32 v147, v147, v131
v_mfma_f32_16x16x32_bf16 v[216:219], v[64:67], a[40:43], v[216:219]
buffer_load_dwordx4 v81, s[96:99], 0 offen offset:1024 lds
v_mfma_f32_16x16x32_bf16 v[216:219], v[68:71], a[56:59], v[216:219]
s_add_u32 m0, s37, 0
v_exp_f32 v30, v30
v_mfma_f32_16x16x32_bf16 v[220:223], v[64:67], a[44:47], v[220:223]
v_exp_f32 v31, v31
v_mfma_f32_16x16x32_bf16 v[220:223], v[68:71], a[60:63], v[220:223]
v_add_f32 v30, 1.0, v30
v_add_f32 v31, 1.0, v31
s_waitcnt lgkmcnt(0)
v_mfma_f32_16x16x32_bf16 v[160:163], v[40:43], a[64:67], v[160:163]
ds_read_b64_tr_b16 v[56:57], v3 offset:16384
v_cvt_pk_bf16_f32 v98, v144, v145
v_mfma_f32_16x16x32_bf16 v[160:163], v[44:47], a[80:83], v[160:163]
ds_read_b64_tr_b16 v[58:59], v3 offset:16896
v_mul_f32 v32, v100, v100
v_mfma_f32_16x16x32_bf16 v[164:167], v[40:43], a[68:71], v[164:167]
ds_read_b64_tr_b16 v[60:61], v3 offset:24576
v_rcp_f32 v30, v30
v_mfma_f32_16x16x32_bf16 v[164:167], v[44:47], a[84:87], v[164:167]
ds_read_b64_tr_b16 v[62:63], v3 offset:25088
v_mul_f32 v146, v146, v30
v_mfma_f32_16x16x32_bf16 v[168:171], v[40:43], a[72:75], v[168:171]
ds_read_b64_tr_b16 v[64:65], v3 offset:18432
v_mul_f32 v33, v101, v101
v_mfma_f32_16x16x32_bf16 v[168:171], v[44:47], a[88:91], v[168:171]
ds_read_b64_tr_b16 v[66:67], v3 offset:18944
v_rcp_f32 v31, v31
v_mfma_f32_16x16x32_bf16 v[172:175], v[40:43], a[76:79], v[172:175]
ds_read_b64_tr_b16 v[68:69], v3 offset:26624
v_mul_f32 v147, v147, v31
v_mfma_f32_16x16x32_bf16 v[172:175], v[44:47], a[92:95], v[172:175]
ds_read_b64_tr_b16 v[70:71], v3 offset:27136
v_cvt_pk_bf16_f32 v99, v146, v147
v_mfma_f32_16x16x32_bf16 v[176:179], v[48:51], a[64:67], v[176:179]
buffer_load_dwordx4 v10, s[4:7], s34 offen offset:0 lds
v_mfma_f32_16x16x32_bf16 v[176:179], v[52:55], a[80:83], v[176:179]
ds_write_b128 v14, v[96:99] offset:0
v_fma_f32 v32, v32, s47, v18
v_mfma_f32_16x16x32_bf16 v[180:183], v[48:51], a[68:71], v[180:183]
buffer_load_dwordx4 v11, s[4:7], s34 offen offset:1024 lds
v_mfma_f32_16x16x32_bf16 v[180:183], v[52:55], a[84:87], v[180:183]
v_readfirstlane_b32 s58, v78
s_cmp_ge_u32 s58, s101
s_cbranch_scc0 L_spin1
L_back1:
v_mfma_f32_16x16x32_bf16 v[184:187], v[48:51], a[72:75], v[184:187]
buffer_load_dwordx4 v10, s[8:11], s34 offen offset:2048 lds
v_mfma_f32_16x16x32_bf16 v[184:187], v[52:55], a[88:91], v[184:187]
v_fma_f32 v33, v33, s47, v18
v_mul_f32 v32, v32, v100
v_mul_f32 v33, v33, v101
v_mfma_f32_16x16x32_bf16 v[188:191], v[48:51], a[76:79], v[188:191]
v_mul_f32 v116, v116, v100
s_waitcnt vmcnt(17) lgkmcnt(0)
v_mfma_f32_16x16x32_bf16 v[188:191], v[52:55], a[92:95], v[188:191]
s_barrier
v_mfma_f32_16x16x32_bf16 v[192:195], v[56:59], a[64:67], v[192:195]
ds_read_b64_tr_b16 v[40:41], v2 offset:32768
v_exp_f32 v32, v32
v_mfma_f32_16x16x32_bf16 v[192:195], v[60:63], a[80:83], v[192:195]
ds_read_b64_tr_b16 v[42:43], v2 offset:33280
v_mul_f32 v117, v117, v101
v_mfma_f32_16x16x32_bf16 v[196:199], v[56:59], a[68:71], v[196:199]
ds_read_b64_tr_b16 v[44:45], v2 offset:40960
v_exp_f32 v33, v33
v_mfma_f32_16x16x32_bf16 v[196:199], v[60:63], a[84:87], v[196:199]
ds_read_b64_tr_b16 v[46:47], v2 offset:41472
v_add_f32 v32, 1.0, v32
v_mfma_f32_16x16x32_bf16 v[200:203], v[56:59], a[72:75], v[200:203]
ds_read_b64_tr_b16 v[48:49], v2 offset:34816
v_add_f32 v33, 1.0, v33
v_mfma_f32_16x16x32_bf16 v[200:203], v[60:63], a[88:91], v[200:203]
ds_read_b64_tr_b16 v[50:51], v2 offset:35328
v_rcp_f32 v32, v32
v_mfma_f32_16x16x32_bf16 v[204:207], v[56:59], a[76:79], v[204:207]
ds_read_b64_tr_b16 v[52:53], v2 offset:43008
v_mul_f32 v116, v116, v32
v_mfma_f32_16x16x32_bf16 v[204:207], v[60:63], a[92:95], v[204:207]
ds_read_b64_tr_b16 v[54:55], v2 offset:43520
v_mul_f32 v34, v102, v102
v_mfma_f32_16x16x32_bf16 v[208:211], v[64:67], a[64:67], v[208:211]
buffer_load_dwordx4 v11, s[8:11], s34 offen offset:3072 lds
v_mfma_f32_16x16x32_bf16 v[208:211], v[68:71], a[80:83], v[208:211]
s_add_u32 m0, s43, 147520
v_rcp_f32 v33, v33
v_mfma_f32_16x16x32_bf16 v[212:215], v[64:67], a[68:71], v[212:215]
buffer_load_dwordx4 v82, s[96:99], 0 offen offset:2048 lds
v_mfma_f32_16x16x32_bf16 v[212:215], v[68:71], a[84:87], v[212:215]
s_add_u32 m0, s37, 16384
v_mul_f32 v117, v117, v33
v_mfma_f32_16x16x32_bf16 v[216:219], v[64:67], a[72:75], v[216:219]
buffer_load_dwordx4 v10, s[4:7], s35 offen offset:0 lds
v_mfma_f32_16x16x32_bf16 v[216:219], v[68:71], a[88:91], v[216:219]
v_mul_f32 v35, v103, v103
v_fma_f32 v34, v34, s47, v18
v_fma_f32 v35, v35, s47, v18
v_mfma_f32_16x16x32_bf16 v[220:223], v[64:67], a[76:79], v[220:223]
v_mul_f32 v34, v34, v102
v_mul_f32 v35, v35, v103
v_mfma_f32_16x16x32_bf16 v[220:223], v[68:71], a[92:95], v[220:223]
v_exp_f32 v34, v34
s_waitcnt lgkmcnt(0)
v_mfma_f32_16x16x32_bf16 v[160:163], v[40:43], a[96:99], v[160:163]
ds_read_b64_tr_b16 v[56:57], v3 offset:32768
v_mul_f32 v118, v118, v102
v_mfma_f32_16x16x32_bf16 v[160:163], v[44:47], a[112:115], v[160:163]
ds_read_b64_tr_b16 v[58:59], v3 offset:33280
v_mul_f32 v119, v119, v103
v_mfma_f32_16x16x32_bf16 v[164:167], v[40:43], a[100:103], v[164:167]
ds_read_b64_tr_b16 v[60:61], v3 offset:40960
v_exp_f32 v35, v35
v_mfma_f32_16x16x32_bf16 v[164:167], v[44:47], a[116:119], v[164:167]
ds_read_b64_tr_b16 v[62:63], v3 offset:41472
v_add_f32 v34, 1.0, v34
v_mfma_f32_16x16x32_bf16 v[168:171], v[40:43], a[104:107], v[168:171]
ds_read_b64_tr_b16 v[64:65], v3 offset:34816
v_add_f32 v35, 1.0, v35
v_mfma_f32_16x16x32_bf16 v[168:171], v[44:47], a[120:123], v[168:171]
ds_read_b64_tr_b16 v[66:67], v3 offset:35328
v_rcp_f32 v34, v34
v_mfma_f32_16x16x32_bf16 v[172:175], v[40:43], a[108:111], v[172:175]
ds_read_b64_tr_b16 v[68:69], v3 offset:43008
v_mul_f32 v118, v118, v34
v_mfma_f32_16x16x32_bf16 v[172:175], v[44:47], a[124:127], v[172:175]
ds_read_b64_tr_b16 v[70:71], v3 offset:43520
v_cvt_pk_bf16_f32 v100, v116, v117
v_mfma_f32_16x16x32_bf16 v[176:179], v[48:51], a[96:99], v[176:179]
buffer_load_dwordx4 v11, s[4:7], s35 offen offset:1024 lds
v_mfma_f32_16x16x32_bf16 v[176:179], v[52:55], a[112:115], v[176:179]
v_rcp_f32 v35, v35
v_mul_f32 v36, v132, v132
v_mfma_f32_16x16x32_bf16 v[180:183], v[48:51], a[100:103], v[180:183]
buffer_load_dwordx4 v10, s[8:11], s35 offen offset:2048 lds
v_mfma_f32_16x16x32_bf16 v[180:183], v[52:55], a[116:119], v[180:183]
v_mul_f32 v119, v119, v35
v_cvt_pk_bf16_f32 v101, v118, v119
v_mfma_f32_16x16x32_bf16 v[184:187], v[48:51], a[104:107], v[184:187]
buffer_load_dwordx4 v11, s[8:11], s35 offen offset:3072 lds
v_mfma_f32_16x16x32_bf16 v[184:187], v[52:55], a[120:123], v[184:187]
s_add_u32 m0, s37, 32768
v_mul_f32 v37, v133, v133
v_fma_f32 v36, v36, s47, v18
v_mfma_f32_16x16x32_bf16 v[188:191], v[48:51], a[108:111], v[188:191]
v_fma_f32 v37, v37, s47, v18
s_waitcnt vmcnt(17) lgkmcnt(0)
v_mfma_f32_16x16x32_bf16 v[188:191], v[52:55], a[124:127], v[188:191]
s_barrier
v_mfma_f32_16x16x32_bf16 v[192:195], v[56:59], a[96:99], v[192:195]
ds_read_b64_tr_b16 v[40:41], v2 offset:49152
v_mul_f32 v36, v36, v132
v_mul_f32 v37, v37, v133
v_mfma_f32_16x16x32_bf16 v[192:195], v[60:63], a[112:115], v[192:195]
ds_read_b64_tr_b16 v[42:43], v2 offset:49664
v_mul_f32 v148, v148, v132
v_mfma_f32_16x16x32_bf16 v[196:199], v[56:59], a[100:103], v[196:199]
ds_read_b64_tr_b16 v[44:45], v2 offset:57344
v_exp_f32 v36, v36
v_mfma_f32_16x16x32_bf16 v[196:199], v[60:63], a[116:119], v[196:199]
ds_read_b64_tr_b16 v[46:47], v2 offset:57856
v_mul_f32 v149, v149, v133
v_mfma_f32_16x16x32_bf16 v[200:203], v[56:59], a[104:107], v[200:203]
ds_read_b64_tr_b16 v[48:49], v2 offset:51200
v_add_f32 v36, 1.0, v36
v_mfma_f32_16x16x32_bf16 v[200:203], v[60:63], a[120:123], v[200:203]
ds_read_b64_tr_b16 v[50:51], v2 offset:51712
v_exp_f32 v37, v37
v_mfma_f32_16x16x32_bf16 v[204:207], v[56:59], a[108:111], v[204:207]
ds_read_b64_tr_b16 v[52:53], v2 offset:59392
v_add_f32 v37, 1.0, v37
v_mfma_f32_16x16x32_bf16 v[204:207], v[60:63], a[124:127], v[204:207]
ds_read_b64_tr_b16 v[54:55], v2 offset:59904
v_mul_f32 v38, v134, v134
v_mfma_f32_16x16x32_bf16 v[208:211], v[64:67], a[96:99], v[208:211]
buffer_load_dwordx4 v10, s[4:7], s36 offen offset:0 lds
v_mfma_f32_16x16x32_bf16 v[208:211], v[68:71], a[112:115], v[208:211]
v_rcp_f32 v36, v36
v_mul_f32 v39, v135, v135
v_mfma_f32_16x16x32_bf16 v[212:215], v[64:67], a[100:103], v[212:215]
buffer_store_dwordx4 v[96:99], v16, s[20:23], s50 offen offset:0 sc1
v_mfma_f32_16x16x32_bf16 v[212:215], v[68:71], a[116:119], v[212:215]
v_rcp_f32 v37, v37
v_mfma_f32_16x16x32_bf16 v[216:219], v[64:67], a[104:107], v[216:219]
buffer_load_dwordx4 v11, s[4:7], s36 offen offset:1024 lds
v_mfma_f32_16x16x32_bf16 v[216:219], v[68:71], a[120:123], v[216:219]
v_mul_f32 v148, v148, v36
v_mul_f32 v149, v149, v37
v_fma_f32 v38, v38, s47, v18
v_mfma_f32_16x16x32_bf16 v[220:223], v[64:67], a[108:111], v[220:223]
v_fma_f32 v39, v39, s47, v18
v_mul_f32 v38, v38, v134
v_mfma_f32_16x16x32_bf16 v[220:223], v[68:71], a[124:127], v[220:223]
v_mul_f32 v39, v39, v135
v_mul_f32 v150, v150, v134
s_waitcnt lgkmcnt(0)
v_mfma_f32_16x16x32_bf16 v[160:163], v[40:43], a[128:131], v[160:163]
ds_read_b64_tr_b16 v[56:57], v3 offset:49152
v_mul_f32 v151, v151, v135
v_mfma_f32_16x16x32_bf16 v[160:163], v[44:47], a[144:147], v[160:163]
ds_read_b64_tr_b16 v[58:59], v3 offset:49664
v_cvt_pk_bf16_f32 v102, v148, v149
v_mfma_f32_16x16x32_bf16 v[164:167], v[40:43], a[132:135], v[164:167]
ds_read_b64_tr_b16 v[60:61], v3 offset:57344
v_exp_f32 v38, v38
v_mfma_f32_16x16x32_bf16 v[164:167], v[44:47], a[148:151], v[164:167]
ds_read_b64_tr_b16 v[62:63], v3 offset:57856
v_add_f32 v38, 1.0, v38
v_mfma_f32_16x16x32_bf16 v[168:171], v[40:43], a[136:139], v[168:171]
ds_read_b64_tr_b16 v[64:65], v3 offset:51200
v_mul_f32 v24, v104, v104
v_mfma_f32_16x16x32_bf16 v[168:171], v[44:47], a[152:155], v[168:171]
ds_read_b64_tr_b16 v[66:67], v3 offset:51712
v_mul_f32 v25, v105, v105
v_mfma_f32_16x16x32_bf16 v[172:175], v[40:43], a[140:143], v[172:175]
ds_read_b64_tr_b16 v[68:69], v3 offset:59392
v_exp_f32 v39, v39
v_mfma_f32_16x16x32_bf16 v[172:175], v[44:47], a[156:159], v[172:175]
ds_read_b64_tr_b16 v[70:71], v3 offset:59904
v_add_f32 v39, 1.0, v39
v_mfma_f32_16x16x32_bf16 v[176:179], v[48:51], a[128:131], v[176:179]
buffer_load_dwordx4 v10, s[8:11], s36 offen offset:2048 lds
v_mfma_f32_16x16x32_bf16 v[176:179], v[52:55], a[144:147], v[176:179]
v_rcp_f32 v38, v38
v_fma_f32 v24, v24, s47, v18
v_mfma_f32_16x16x32_bf16 v[180:183], v[48:51], a[132:135], v[180:183]
v_rcp_f32 v39, v39
v_mfma_f32_16x16x32_bf16 v[180:183], v[52:55], a[148:151], v[180:183]
v_mul_f32 v150, v150, v38
v_mul_f32 v151, v151, v39
v_mfma_f32_16x16x32_bf16 v[184:187], v[48:51], a[136:139], v[184:187]
buffer_load_dwordx4 v11, s[8:11], s36 offen offset:3072 lds
v_mfma_f32_16x16x32_bf16 v[184:187], v[52:55], a[152:155], v[184:187]
v_add_u32 v10, 128, v10
v_add_u32 v11, 128, v11
v_mfma_f32_16x16x32_bf16 v[188:191], v[48:51], a[140:143], v[188:191]
s_add_u32 m0, s37, 49152
s_waitcnt vmcnt(16) lgkmcnt(0)
v_mfma_f32_16x16x32_bf16 v[188:191], v[52:55], a[156:159], v[188:191]
s_barrier
v_mfma_f32_16x16x32_bf16 v[192:195], v[56:59], a[128:131], v[192:195]
ds_read_b64_tr_b16 v[40:41], v4 offset:0
v_cvt_pk_bf16_f32 v103, v150, v151
v_fma_f32 v25, v25, s47, v18
v_mul_f32 v24, v24, v104
v_mfma_f32_16x16x32_bf16 v[192:195], v[60:63], a[144:147], v[192:195]
ds_read_b64_tr_b16 v[42:43], v4 offset:512
v_mul_f32 v25, v25, v105
v_mfma_f32_16x16x32_bf16 v[196:199], v[56:59], a[132:135], v[196:199]
ds_read_b64_tr_b16 v[44:45], v4 offset:8192
v_mul_f32 v120, v120, v104
v_mfma_f32_16x16x32_bf16 v[196:199], v[60:63], a[148:151], v[196:199]
ds_read_b64_tr_b16 v[46:47], v4 offset:8704
v_exp_f32 v24, v24
v_mfma_f32_16x16x32_bf16 v[200:203], v[56:59], a[136:139], v[200:203]
ds_read_b64_tr_b16 v[48:49], v4 offset:2048
v_mul_f32 v121, v121, v105
v_mfma_f32_16x16x32_bf16 v[200:203], v[60:63], a[152:155], v[200:203]
ds_read_b64_tr_b16 v[50:51], v4 offset:2560
v_add_f32 v24, 1.0, v24
v_mfma_f32_16x16x32_bf16 v[204:207], v[56:59], a[140:143], v[204:207]
ds_read_b64_tr_b16 v[52:53], v4 offset:10240
v_exp_f32 v25, v25
v_mfma_f32_16x16x32_bf16 v[204:207], v[60:63], a[156:159], v[204:207]
ds_read_b64_tr_b16 v[54:55], v4 offset:10752
v_add_f32 v25, 1.0, v25
v_mfma_f32_16x16x32_bf16 v[208:211], v[64:67], a[128:131], v[208:211]
buffer_load_dwordx4 v10, s[4:7], s28 offen offset:0 lds
v_mfma_f32_16x16x32_bf16 v[208:211], v[68:71], a[144:147], v[208:211]
ds_write_b128 v14, v[100:103] offset:1024
v_mul_f32 v26, v106, v106
v_mfma_f32_16x16x32_bf16 v[212:215], v[64:67], a[132:135], v[212:215]
buffer_store_dwordx4 v[100:103], v16, s[20:23], s50 offen offset:1024 sc1
v_mfma_f32_16x16x32_bf16 v[212:215], v[68:71], a[148:151], v[212:215]
v_rcp_f32 v24, v24
v_mfma_f32_16x16x32_bf16 v[216:219], v[64:67], a[136:139], v[216:219]
buffer_load_dwordx4 v11, s[4:7], s28 offen offset:1024 lds
v_mfma_f32_16x16x32_bf16 v[216:219], v[68:71], a[152:155], v[216:219]
v_rcp_f32 v25, v25
v_mul_f32 v120, v120, v24
v_mfma_f32_16x16x32_bf16 v[220:223], v[64:67], a[140:143], v[220:223]
v_mul_f32 v121, v121, v25
v_mul_f32 v27, v107, v107
v_mfma_f32_16x16x32_bf16 v[220:223], v[68:71], a[156:159], v[220:223]
v_fma_f32 v26, v26, s47, v18
s_waitcnt lgkmcnt(0)
v_mfma_f32_16x16x32_bf16 v[160:163], v[40:43], a[160:163], v[160:163]
ds_read_b64_tr_b16 v[56:57], v5 offset:0
v_fma_f32 v27, v27, s47, v18
v_mul_f32 v26, v26, v106
v_mfma_f32_16x16x32_bf16 v[160:163], v[44:47], a[176:179], v[160:163]
ds_read_b64_tr_b16 v[58:59], v5 offset:512
v_mul_f32 v27, v27, v107
v_mfma_f32_16x16x32_bf16 v[164:167], v[40:43], a[164:167], v[164:167]
ds_read_b64_tr_b16 v[60:61], v5 offset:8192
v_mul_f32 v122, v122, v106
v_mfma_f32_16x16x32_bf16 v[164:167], v[44:47], a[180:183], v[164:167]
ds_read_b64_tr_b16 v[62:63], v5 offset:8704
v_mul_f32 v123, v123, v107
v_mfma_f32_16x16x32_bf16 v[168:171], v[40:43], a[168:171], v[168:171]
ds_read_b64_tr_b16 v[64:65], v5 offset:2048
v_exp_f32 v26, v26
v_mfma_f32_16x16x32_bf16 v[168:171], v[44:47], a[184:187], v[168:171]
ds_read_b64_tr_b16 v[66:67], v5 offset:2560
v_add_f32 v26, 1.0, v26
v_mfma_f32_16x16x32_bf16 v[172:175], v[40:43], a[172:175], v[172:175]
ds_read_b64_tr_b16 v[68:69], v5 offset:10240
v_cvt_pk_bf16_f32 v104, v120, v121
v_mfma_f32_16x16x32_bf16 v[172:175], v[44:47], a[188:191], v[172:175]
ds_read_b64_tr_b16 v[70:71], v5 offset:10752
v_exp_f32 v27, v27
v_mfma_f32_16x16x32_bf16 v[176:179], v[48:51], a[160:163], v[176:179]
buffer_load_dwordx4 v10, s[8:11], s28 offen offset:2048 lds
v_mfma_f32_16x16x32_bf16 v[176:179], v[52:55], a[176:179], v[176:179]
v_add_f32 v27, 1.0, v27
v_mul_f32 v28, v136, v136
v_mfma_f32_16x16x32_bf16 v[180:183], v[48:51], a[164:167], v[180:183]
v_rcp_f32 v26, v26
v_mul_f32 v29, v137, v137
v_mfma_f32_16x16x32_bf16 v[180:183], v[52:55], a[180:183], v[180:183]
v_rcp_f32 v27, v27
v_mfma_f32_16x16x32_bf16 v[184:187], v[48:51], a[168:171], v[184:187]
buffer_load_dwordx4 v11, s[8:11], s28 offen offset:3072 lds
v_mfma_f32_16x16x32_bf16 v[184:187], v[52:55], a[184:187], v[184:187]
s_add_u32 m0, s37, 65536
v_mul_f32 v122, v122, v26
v_mfma_f32_16x16x32_bf16 v[188:191], v[48:51], a[172:175], v[188:191]
v_mul_f32 v123, v123, v27
v_cvt_pk_bf16_f32 v105, v122, v123
s_waitcnt vmcnt(15) lgkmcnt(0)
v_mfma_f32_16x16x32_bf16 v[188:191], v[52:55], a[188:191], v[188:191]
s_barrier
v_mfma_f32_16x16x32_bf16 v[192:195], v[56:59], a[160:163], v[192:195]
ds_read_b64_tr_b16 v[40:41], v2 offset:0
v_fma_f32 v28, v28, s47, v18
v_mfma_f32_16x16x32_bf16 v[192:195], v[60:63], a[176:179], v[192:195]
ds_read_b64_tr_b16 v[42:43], v2 offset:512
v_fma_f32 v29, v29, s47, v18
v_mul_f32 v28, v28, v136
v_mfma_f32_16x16x32_bf16 v[196:199], v[56:59], a[164:167], v[196:199]
ds_read_b64_tr_b16 v[44:45], v2 offset:8192
v_mul_f32 v29, v29, v137
v_mfma_f32_16x16x32_bf16 v[196:199], v[60:63], a[180:183], v[196:199]
ds_read_b64_tr_b16 v[46:47], v2 offset:8704
v_mul_f32 v152, v152, v136
v_mfma_f32_16x16x32_bf16 v[200:203], v[56:59], a[168:171], v[200:203]
ds_read_b64_tr_b16 v[48:49], v2 offset:2048
v_exp_f32 v28, v28
v_mfma_f32_16x16x32_bf16 v[200:203], v[60:63], a[184:187], v[200:203]
ds_read_b64_tr_b16 v[50:51], v2 offset:2560
v_mul_f32 v153, v153, v137
v_mfma_f32_16x16x32_bf16 v[204:207], v[56:59], a[172:175], v[204:207]
ds_read_b64_tr_b16 v[52:53], v2 offset:10240
v_add_f32 v28, 1.0, v28
v_mfma_f32_16x16x32_bf16 v[204:207], v[60:63], a[188:191], v[204:207]
ds_read_b64_tr_b16 v[54:55], v2 offset:10752
v_mul_f32 v30, v138, v138
v_mfma_f32_16x16x32_bf16 v[208:211], v[64:67], a[160:163], v[208:211]
buffer_load_dwordx4 v10, s[4:7], s29 offen offset:0 lds
v_mfma_f32_16x16x32_bf16 v[208:211], v[68:71], a[176:179], v[208:211]
v_exp_f32 v29, v29
v_mul_f32 v31, v139, v139
v_mfma_f32_16x16x32_bf16 v[212:215], v[64:67], a[164:167], v[212:215]
v_add_f32 v29, 1.0, v29
v_fma_f32 v30, v30, s47, v18
v_mfma_f32_16x16x32_bf16 v[212:215], v[68:71], a[180:183], v[212:215]
v_rcp_f32 v28, v28
v_fma_f32 v31, v31, s47, v18
v_mfma_f32_16x16x32_bf16 v[216:219], v[64:67], a[168:171], v[216:219]
buffer_load_dwordx4 v11, s[4:7], s29 offen offset:1024 lds
v_mfma_f32_16x16x32_bf16 v[216:219], v[68:71], a[184:187], v[216:219]
v_rcp_f32 v29, v29
v_mfma_f32_16x16x32_bf16 v[220:223], v[64:67], a[172:175], v[220:223]
v_mul_f32 v152, v152, v28
v_mul_f32 v153, v153, v29
v_mfma_f32_16x16x32_bf16 v[220:223], v[68:71], a[188:191], v[220:223]
v_mul_f32 v30, v30, v138
v_mul_f32 v31, v31, v139
s_waitcnt lgkmcnt(0)
v_mfma_f32_16x16x32_bf16 v[160:163], v[40:43], a[192:195], v[160:163]
ds_read_b64_tr_b16 v[56:57], v3 offset:0
v_mul_f32 v154, v154, v138
v_mfma_f32_16x16x32_bf16 v[160:163], v[44:47], a[208:211], v[160:163]
ds_read_b64_tr_b16 v[58:59], v3 offset:512
v_mul_f32 v155, v155, v139
v_mfma_f32_16x16x32_bf16 v[164:167], v[40:43], a[196:199], v[164:167]
ds_read_b64_tr_b16 v[60:61], v3 offset:8192
v_exp_f32 v30, v30
v_mfma_f32_16x16x32_bf16 v[164:167], v[44:47], a[212:215], v[164:167]
ds_read_b64_tr_b16 v[62:63], v3 offset:8704
v_add_f32 v30, 1.0, v30
v_mfma_f32_16x16x32_bf16 v[168:171], v[40:43], a[200:203], v[168:171]
ds_read_b64_tr_b16 v[64:65], v3 offset:2048
v_cvt_pk_bf16_f32 v106, v152, v153
v_mfma_f32_16x16x32_bf16 v[168:171], v[44:47], a[216:219], v[168:171]
ds_read_b64_tr_b16 v[66:67], v3 offset:2560
v_mul_f32 v32, v108, v108
v_mfma_f32_16x16x32_bf16 v[172:175], v[40:43], a[204:207], v[172:175]
ds_read_b64_tr_b16 v[68:69], v3 offset:10240
v_exp_f32 v31, v31
v_mfma_f32_16x16x32_bf16 v[172:175], v[44:47], a[220:223], v[172:175]
ds_read_b64_tr_b16 v[70:71], v3 offset:10752
v_add_f32 v31, 1.0, v31
v_mfma_f32_16x16x32_bf16 v[176:179], v[48:51], a[192:195], v[176:179]
buffer_load_dwordx4 v10, s[8:11], s29 offen offset:2048 lds
v_mfma_f32_16x16x32_bf16 v[176:179], v[52:55], a[208:211], v[176:179]
v_rcp_f32 v30, v30
v_mul_f32 v33, v109, v109
v_mfma_f32_16x16x32_bf16 v[180:183], v[48:51], a[196:199], v[180:183]
v_rcp_f32 v31, v31
v_mfma_f32_16x16x32_bf16 v[180:183], v[52:55], a[212:215], v[180:183]
v_mul_f32 v154, v154, v30
v_mul_f32 v155, v155, v31
v_mfma_f32_16x16x32_bf16 v[184:187], v[48:51], a[200:203], v[184:187]
buffer_load_dwordx4 v11, s[8:11], s29 offen offset:3072 lds
v_mfma_f32_16x16x32_bf16 v[184:187], v[52:55], a[216:219], v[184:187]
s_add_u32 m0, s37, 0
v_cvt_pk_bf16_f32 v107, v154, v155
v_fma_f32 v32, v32, s47, v18
v_mfma_f32_16x16x32_bf16 v[188:191], v[48:51], a[204:207], v[188:191]
v_fma_f32 v33, v33, s47, v18
s_waitcnt vmcnt(14) lgkmcnt(0)
v_mfma_f32_16x16x32_bf16 v[188:191], v[52:55], a[220:223], v[188:191]
s_barrier
v_mfma_f32_16x16x32_bf16 v[192:195], v[56:59], a[192:195], v[192:195]
ds_read_b64_tr_b16 v[40:41], v2 offset:16384
s_lshl2_add_u32 s58, s39, s38
v_mfma_f32_16x16x32_bf16 v[192:195], v[60:63], a[208:211], v[192:195]
ds_read_b64_tr_b16 v[42:43], v2 offset:16896
s_mul_i32 s58, s58, 82944
v_mfma_f32_16x16x32_bf16 v[196:199], v[56:59], a[196:199], v[196:199]
ds_read_b64_tr_b16 v[44:45], v2 offset:24576
v_mul_u32_u24 v74, 128, v1
v_mfma_f32_16x16x32_bf16 v[196:199], v[60:63], a[212:215], v[196:199]
ds_read_b64_tr_b16 v[46:47], v2 offset:25088
v_lshrrev_b32 v74, 8, v74
v_mfma_f32_16x16x32_bf16 v[200:203], v[56:59], a[200:203], v[200:203]
ds_read_b64_tr_b16 v[48:49], v2 offset:18432
v_mul_u32_u24 v74, 8960, v74
v_mfma_f32_16x16x32_bf16 v[200:203], v[60:63], a[216:219], v[200:203]
ds_read_b64_tr_b16 v[50:51], v2 offset:18944
v_lshl_add_u32 v74, v1, 7, v74
v_mfma_f32_16x16x32_bf16 v[204:207], v[56:59], a[204:207], v[204:207]
ds_read_b64_tr_b16 v[52:53], v2 offset:26624
v_add_u32 v75, 46, v1
v_mfma_f32_16x16x32_bf16 v[204:207], v[60:63], a[220:223], v[204:207]
ds_read_b64_tr_b16 v[54:55], v2 offset:27136
v_and_b32 v75, 64, v75
v_mfma_f32_16x16x32_bf16 v[208:211], v[64:67], a[192:195], v[208:211]
buffer_load_dwordx4 v10, s[4:7], s30 offen offset:0 lds
v_mfma_f32_16x16x32_bf16 v[208:211], v[68:71], a[208:211], v[208:211]
v_lshl_add_u32 v74, v75, 22, v74
v_add_u32 v74, s58, v74
v_mfma_f32_16x16x32_bf16 v[212:215], v[64:67], a[196:199], v[212:215]
buffer_store_dwordx4 v[104:107], v16, s[20:23], s50 offen offset:2048 sc1
v_mfma_f32_16x16x32_bf16 v[212:215], v[68:71], a[212:215], v[212:215]
ds_write_b128 v14, v[104:107] offset:2048
v_mul_f32 v32, v32, v108
v_mul_f32 v33, v33, v109
v_exp_f32 v32, v32
v_mfma_f32_16x16x32_bf16 v[216:219], v[64:67], a[200:203], v[216:219]
buffer_load_dwordx4 v11, s[4:7], s30 offen offset:1024 lds
v_mfma_f32_16x16x32_bf16 v[216:219], v[68:71], a[216:219], v[216:219]
v_exp_f32 v33, v33
v_mul_f32 v124, v124, v108
v_mfma_f32_16x16x32_bf16 v[220:223], v[64:67], a[204:207], v[220:223]
v_mul_f32 v125, v125, v109
v_add_f32 v32, 1.0, v32
v_mfma_f32_16x16x32_bf16 v[220:223], v[68:71], a[220:223], v[220:223]
v_add_f32 v33, 1.0, v33
s_waitcnt lgkmcnt(0)
v_mfma_f32_16x16x32_bf16 v[160:163], v[40:43], a[224:227], v[160:163]
ds_read_b64_tr_b16 v[56:57], v3 offset:16384
v_mul_f32 v34, v110, v110
v_mfma_f32_16x16x32_bf16 v[160:163], v[44:47], a[240:243], v[160:163]
ds_read_b64_tr_b16 v[58:59], v3 offset:16896
v_rcp_f32 v32, v32
v_mfma_f32_16x16x32_bf16 v[164:167], v[40:43], a[228:231], v[164:167]
ds_read_b64_tr_b16 v[60:61], v3 offset:24576
v_mul_f32 v124, v124, v32
v_mfma_f32_16x16x32_bf16 v[164:167], v[44:47], a[244:247], v[164:167]
ds_read_b64_tr_b16 v[62:63], v3 offset:25088
v_mul_f32 v35, v111, v111
v_mfma_f32_16x16x32_bf16 v[168:171], v[40:43], a[232:235], v[168:171]
ds_read_b64_tr_b16 v[64:65], v3 offset:18432
v_fma_f32 v34, v34, s47, v18
v_mfma_f32_16x16x32_bf16 v[168:171], v[44:47], a[248:251], v[168:171]
ds_read_b64_tr_b16 v[66:67], v3 offset:18944
v_rcp_f32 v33, v33
v_mfma_f32_16x16x32_bf16 v[172:175], v[40:43], a[236:239], v[172:175]
ds_read_b64_tr_b16 v[68:69], v3 offset:26624
v_mul_f32 v125, v125, v33
v_mfma_f32_16x16x32_bf16 v[172:175], v[44:47], a[252:255], v[172:175]
ds_read_b64_tr_b16 v[70:71], v3 offset:27136
v_fma_f32 v35, v35, s47, v18
v_mfma_f32_16x16x32_bf16 v[176:179], v[48:51], a[224:227], v[176:179]
buffer_load_dwordx4 v10, s[8:11], s30 offen offset:2048 lds
v_mfma_f32_16x16x32_bf16 v[176:179], v[52:55], a[240:243], v[176:179]
v_mul_f32 v34, v34, v110
v_mul_f32 v35, v35, v111
v_mul_f32 v126, v126, v110
v_mfma_f32_16x16x32_bf16 v[180:183], v[48:51], a[228:231], v[180:183]
v_exp_f32 v34, v34
v_mfma_f32_16x16x32_bf16 v[180:183], v[52:55], a[244:247], v[180:183]
v_exp_f32 v35, v35
v_mfma_f32_16x16x32_bf16 v[184:187], v[48:51], a[232:235], v[184:187]
buffer_load_dwordx4 v11, s[8:11], s30 offen offset:3072 lds
v_mfma_f32_16x16x32_bf16 v[184:187], v[52:55], a[248:251], v[184:187]
buffer_load_dword v77, v74, s[4:7], 0 offen offset:384
v_mfma_f32_16x16x32_bf16 v[188:191], v[48:51], a[236:239], v[188:191]
v_mul_f32 v127, v127, v111
v_add_f32 v34, 1.0, v34
s_waitcnt vmcnt(15) lgkmcnt(0)
v_mfma_f32_16x16x32_bf16 v[188:191], v[52:55], a[252:255], v[188:191]
s_barrier
v_mfma_f32_16x16x32_bf16 v[192:195], v[56:59], a[224:227], v[192:195]
ds_read_b64_tr_b16 v[40:41], v2 offset:32768
ds_read_b128 v[96:99], v89 offset:3072
v_add_f32 v35, 1.0, v35
v_mfma_f32_16x16x32_bf16 v[192:195], v[60:63], a[240:243], v[192:195]
ds_read_b64_tr_b16 v[42:43], v2 offset:33280
ds_read_b128 v[100:103], v89 offset:3088
v_cvt_pk_bf16_f32 v108, v124, v125
v_mfma_f32_16x16x32_bf16 v[196:199], v[56:59], a[228:231], v[196:199]
ds_read_b64_tr_b16 v[44:45], v2 offset:40960
ds_read_b128 v[104:107], v89 offset:3104
v_mul_f32 v36, v140, v140
v_mfma_f32_16x16x32_bf16 v[196:199], v[60:63], a[244:247], v[196:199]
ds_read_b64_tr_b16 v[46:47], v2 offset:41472
ds_read2_b32 v[112:113], v87 offset0:0 offset1:1
v_mfma_f32_16x16x32_bf16 v[200:203], v[56:59], a[232:235], v[200:203]
ds_read_b64_tr_b16 v[48:49], v2 offset:34816
ds_read2_b32 v[114:115], v87 offset0:36 offset1:37
v_mul_f32 v37, v141, v141
v_mfma_f32_16x16x32_bf16 v[200:203], v[60:63], a[248:251], v[200:203]
ds_read_b64_tr_b16 v[50:51], v2 offset:35328
ds_read2_b32 v[116:117], v87 offset0:72 offset1:73
v_fma_f32 v36, v36, s47, v18
v_mfma_f32_16x16x32_bf16 v[204:207], v[56:59], a[236:239], v[204:207]
ds_read_b64_tr_b16 v[52:53], v2 offset:43008
ds_read2_b32 v[118:119], v87 offset0:108 offset1:109
v_mfma_f32_16x16x32_bf16 v[204:207], v[60:63], a[252:255], v[204:207]
ds_read_b64_tr_b16 v[54:55], v2 offset:43520
ds_read2_b32 v[120:121], v87 offset0:144 offset1:145
v_fma_f32 v37, v37, s47, v18
v_mfma_f32_16x16x32_bf16 v[208:211], v[64:67], a[224:227], v[208:211]
buffer_load_dword v77, v74, s[8:11], 0 offen offset:2432
v_mfma_f32_16x16x32_bf16 v[208:211], v[68:71], a[240:243], v[208:211]
s_add_u32 m0, s37, 16384
v_rcp_f32 v34, v34
v_mul_f32 v36, v36, v140
v_mfma_f32_16x16x32_bf16 v[212:215], v[64:67], a[228:231], v[212:215]
buffer_load_dwordx4 v10, s[4:7], s31 offen offset:0 lds
v_mfma_f32_16x16x32_bf16 v[212:215], v[68:71], a[244:247], v[212:215]
ds_read2_b32 v[122:123], v87 offset0:180 offset1:181
ds_read2_b32 v[128:129], v87 offset0:216 offset1:217
v_mul_f32 v126, v126, v34
v_mfma_f32_16x16x32_bf16 v[216:219], v[64:67], a[232:235], v[216:219]
buffer_load_dwordx4 v11, s[4:7], s31 offen offset:1024 lds
v_mfma_f32_16x16x32_bf16 v[216:219], v[68:71], a[248:251], v[216:219]
v_rcp_f32 v35, v35
v_mul_f32 v37, v37, v141
v_mfma_f32_16x16x32_bf16 v[220:223], v[64:67], a[236:239], v[220:223]
v_mul_f32 v127, v127, v35
v_cvt_pk_bf16_f32 v109, v126, v127
v_mul_f32 v156, v156, v140
v_mfma_f32_16x16x32_bf16 v[220:223], v[68:71], a[252:255], v[220:223]
v_exp_f32 v36, v36
s_waitcnt lgkmcnt(0)
v_mfma_f32_16x16x32_bf16 v[160:163], v[40:43], v[224:227], v[160:163]
ds_read_b64_tr_b16 v[56:57], v3 offset:32768
s_mov_b32 s52, s88
v_mfma_f32_16x16x32_bf16 v[160:163], v[44:47], v[240:243], v[160:163]
ds_read_b64_tr_b16 v[58:59], v3 offset:33280
s_mov_b32 s53, s89
v_mfma_f32_16x16x32_bf16 v[164:167], v[40:43], v[228:231], v[164:167]
ds_read_b64_tr_b16 v[60:61], v3 offset:40960
ds_read2_b32 v[146:147], v88 offset0:0 offset1:1
v_exp_f32 v37, v37
v_mfma_f32_16x16x32_bf16 v[164:167], v[44:47], v[244:247], v[164:167]
ds_read_b64_tr_b16 v[62:63], v3 offset:41472
ds_read2_b32 v[148:149], v88 offset0:36 offset1:37
v_mul_f32 v157, v157, v141
v_mfma_f32_16x16x32_bf16 v[168:171], v[40:43], v[232:235], v[168:171]
ds_read_b64_tr_b16 v[64:65], v3 offset:34816
ds_read2_b32 v[150:151], v88 offset0:72 offset1:73
v_mfma_f32_16x16x32_bf16 v[168:171], v[44:47], v[248:251], v[168:171]
ds_read_b64_tr_b16 v[66:67], v3 offset:35328
ds_read2_b32 v[152:153], v88 offset0:108 offset1:109
v_add_f32 v36, 1.0, v36
v_mfma_f32_16x16x32_bf16 v[172:175], v[40:43], v[236:239], v[172:175]
ds_read_b64_tr_b16 v[68:69], v3 offset:43008
ds_read2_b32 v[130:131], v87 offset0:2 offset1:38
v_add_f32 v37, 1.0, v37
v_mfma_f32_16x16x32_bf16 v[172:175], v[44:47], v[252:255], v[172:175]
ds_read_b64_tr_b16 v[70:71], v3 offset:43520
ds_read2_b32 v[132:133], v87 offset0:74 offset1:110
v_mfma_f32_16x16x32_bf16 v[176:179], v[48:51], v[224:227], v[176:179]
buffer_load_dwordx4 v10, s[8:11], s31 offen offset:2048 lds
v_mfma_f32_16x16x32_bf16 v[176:179], v[52:55], v[240:243], v[176:179]
ds_read2_b32 v[134:135], v87 offset0:146 offset1:182
ds_read2_b32 v[136:137], v87 offset0:218 offset1:254
v_rcp_f32 v36, v36
v_mfma_f32_16x16x32_bf16 v[180:183], v[48:51], v[228:231], v[180:183]
buffer_load_dwordx4 v11, s[8:11], s31 offen offset:3072 lds
v_mfma_f32_16x16x32_bf16 v[180:183], v[52:55], v[244:247], v[180:183]
s_add_u32 m0, s37, 32768
v_rcp_f32 v37, v37
v_mfma_f32_16x16x32_bf16 v[184:187], v[48:51], v[232:235], v[184:187]
ds_read2_b32 v[138:139], v88 offset0:2 offset1:38
ds_read2_b32 v[144:145], v88 offset0:74 offset1:110
v_mul_f32 v156, v156, v36
v_mfma_f32_16x16x32_bf16 v[184:187], v[52:55], v[248:251], v[184:187]
v_mul_f32 v157, v157, v37
v_mul_f32 v38, v142, v142
v_mfma_f32_16x16x32_bf16 v[188:191], v[48:51], v[236:239], v[188:191]
v_mul_f32 v39, v143, v143
v_fma_f32 v38, v38, s47, v18
s_waitcnt vmcnt(15) lgkmcnt(0)
v_mfma_f32_16x16x32_bf16 v[188:191], v[52:55], v[252:255], v[188:191]
s_barrier
v_mfma_f32_16x16x32_bf16 v[192:195], v[56:59], v[224:227], v[192:195]
ds_read_b64_tr_b16 v[40:41], v2 offset:49152
v_fma_f32 v39, v39, s47, v18
v_mul_f32 v38, v38, v142
v_mul_f32 v39, v39, v143
v_mfma_f32_16x16x32_bf16 v[192:195], v[60:63], v[240:243], v[192:195]
ds_read_b64_tr_b16 v[42:43], v2 offset:49664
v_mul_f32 v158, v158, v142
v_mfma_f32_16x16x32_bf16 v[196:199], v[56:59], v[228:231], v[196:199]
ds_read_b64_tr_b16 v[44:45], v2 offset:57344
v_exp_f32 v38, v38
v_mfma_f32_16x16x32_bf16 v[196:199], v[60:63], v[244:247], v[196:199]
ds_read_b64_tr_b16 v[46:47], v2 offset:57856
v_mul_f32 v159, v159, v143
v_mfma_f32_16x16x32_bf16 v[200:203], v[56:59], v[232:235], v[200:203]
ds_read_b64_tr_b16 v[48:49], v2 offset:51200
v_exp_f32 v39, v39
v_mfma_f32_16x16x32_bf16 v[200:203], v[60:63], v[248:251], v[200:203]
ds_read_b64_tr_b16 v[50:51], v2 offset:51712
v_add_f32 v38, 1.0, v38
v_add_f32 v39, 1.0, v39
v_mfma_f32_16x16x32_bf16 v[204:207], v[56:59], v[236:239], v[204:207]
ds_read_b64_tr_b16 v[52:53], v2 offset:59392
v_cvt_pk_bf16_f32 v110, v156, v157
v_mfma_f32_16x16x32_bf16 v[204:207], v[60:63], v[252:255], v[204:207]
ds_read_b64_tr_b16 v[54:55], v2 offset:59904
v_rcp_f32 v38, v38
v_mfma_f32_16x16x32_bf16 v[208:211], v[64:67], v[224:227], v[208:211]
buffer_load_dwordx4 v10, s[4:7], s32 offen offset:0 lds
v_mfma_f32_16x16x32_bf16 v[208:211], v[68:71], v[240:243], v[208:211]
v_rcp_f32 v39, v39
v_mul_f32 v158, v158, v38
v_mfma_f32_16x16x32_bf16 v[212:215], v[64:67], v[228:231], v[212:215]
v_mul_f32 v159, v159, v39
v_cvt_pk_bf16_f32 v111, v158, v159
v_mfma_f32_16x16x32_bf16 v[212:215], v[68:71], v[244:247], v[212:215]
ds_write_b128 v14, v[108:111] offset:3072
v_mfma_f32_16x16x32_bf16 v[216:219], v[64:67], v[232:235], v[216:219]
buffer_load_dwordx4 v11, s[4:7], s32 offen offset:1024 lds
buffer_store_dwordx4 v[108:111], v16, s[20:23], s50 offen offset:3072 sc1
v_mfma_f32_16x16x32_bf16 v[216:219], v[68:71], v[248:251], v[216:219]
v_mfma_f32_16x16x32_bf16 v[220:223], v[64:67], v[236:239], v[220:223]
v_mfma_f32_16x16x32_bf16 v[220:223], v[68:71], v[252:255], v[220:223]
s_waitcnt lgkmcnt(0)
s_mov_b32 s41, 0x05040100
s_mov_b32 s42, 0x07060302
v_perm_b32 v24, v112, v114, s41
v_perm_b32 v25, v114, v116, s41
v_perm_b32 v26, v116, v118, s41
v_perm_b32 v27, v118, v120, s41
v_perm_b32 v28, v120, v122, s41
v_perm_b32 v29, v122, v128, s41
v_dot2_f32_bf16 v108, v26, v96, 0
v_dot2_f32_bf16 v109, v27, v96, 0
v_dot2_f32_bf16 v110, v28, v96, 0
v_dot2_f32_bf16 v111, v29, v96, 0
v_lshlrev_b32 v32, 16, v146
v_lshlrev_b32 v33, 16, v148
v_lshlrev_b32 v34, 16, v150
v_lshlrev_b32 v35, 16, v152
v_dot2_f32_bf16 v108, v24, v97, v108
v_dot2_f32_bf16 v109, v25, v97, v109
v_dot2_f32_bf16 v110, v26, v97, v110
v_dot2_f32_bf16 v111, v27, v97, v111
s_mov_b32 s50, 67113088
s_nop 1
v_pk_mul_f32 v[108:109], v[108:109], v[32:33]
v_pk_mul_f32 v[110:111], v[110:111], v[34:35]
v_cvt_pk_bf16_f32 v108, v108, v109
v_cvt_pk_bf16_f32 v109, v110, v111
buffer_store_dwordx2 v[108:109], v90, s[20:23], s50 offen sc1
v_perm_b32 v24, v112, v114, s42
v_perm_b32 v25, v114, v116, s42
v_perm_b32 v26, v116, v118, s42
v_perm_b32 v27, v118, v120, s42
v_perm_b32 v28, v120, v122, s42
v_perm_b32 v29, v122, v128, s42
v_dot2_f32_bf16 v124, v26, v98, 0
v_dot2_f32_bf16 v125, v27, v98, 0
v_dot2_f32_bf16 v126, v28, v98, 0
v_dot2_f32_bf16 v127, v29, v98, 0
v_and_b32 v32, 0xffff0000, v146
v_and_b32 v33, 0xffff0000, v148
v_and_b32 v34, 0xffff0000, v150
v_and_b32 v35, 0xffff0000, v152
v_dot2_f32_bf16 v124, v24, v99, v124
v_dot2_f32_bf16 v125, v25, v99, v125
v_dot2_f32_bf16 v126, v26, v99, v126
v_dot2_f32_bf16 v127, v27, v99, v127
s_mov_b32 s50, 67117312
s_nop 1
v_pk_mul_f32 v[124:125], v[124:125], v[32:33]
v_pk_mul_f32 v[126:127], v[126:127], v[34:35]
v_cvt_pk_bf16_f32 v124, v124, v125
v_cvt_pk_bf16_f32 v125, v126, v127
buffer_store_dwordx2 v[124:125], v90, s[20:23], s50 offen sc1
v_perm_b32 v24, v113, v115, s41
v_perm_b32 v25, v115, v117, s41
v_perm_b32 v26, v117, v119, s41
v_perm_b32 v27, v119, v121, s41
v_perm_b32 v28, v121, v123, s41
v_perm_b32 v29, v123, v129, s41
v_dot2_f32_bf16 v140, v26, v100, 0
v_dot2_f32_bf16 v141, v27, v100, 0
v_dot2_f32_bf16 v142, v28, v100, 0
v_dot2_f32_bf16 v143, v29, v100, 0
v_lshlrev_b32 v32, 16, v147
v_lshlrev_b32 v33, 16, v149
v_lshlrev_b32 v34, 16, v151
v_lshlrev_b32 v35, 16, v153
v_dot2_f32_bf16 v140, v24, v101, v140
v_dot2_f32_bf16 v141, v25, v101, v141
v_dot2_f32_bf16 v142, v26, v101, v142
v_dot2_f32_bf16 v143, v27, v101, v143
s_mov_b32 s50, 67121536
s_nop 1
v_pk_mul_f32 v[140:141], v[140:141], v[32:33]
v_pk_mul_f32 v[142:143], v[142:143], v[34:35]
v_cvt_pk_bf16_f32 v140, v140, v141
v_cvt_pk_bf16_f32 v141, v142, v143
buffer_store_dwordx2 v[140:141], v90, s[20:23], s50 offen sc1
v_perm_b32 v24, v113, v115, s42
v_perm_b32 v25, v115, v117, s42
v_perm_b32 v26, v117, v119, s42
v_perm_b32 v27, v119, v121, s42
v_perm_b32 v28, v121, v123, s42
v_perm_b32 v29, v123, v129, s42
v_dot2_f32_bf16 v156, v26, v102, 0
v_dot2_f32_bf16 v157, v27, v102, 0
v_dot2_f32_bf16 v158, v28, v102, 0
v_dot2_f32_bf16 v159, v29, v102, 0
v_and_b32 v32, 0xffff0000, v147
v_and_b32 v33, 0xffff0000, v149
v_and_b32 v34, 0xffff0000, v151
v_and_b32 v35, 0xffff0000, v153
v_dot2_f32_bf16 v156, v24, v103, v156
v_dot2_f32_bf16 v157, v25, v103, v157
v_dot2_f32_bf16 v158, v26, v103, v158
v_dot2_f32_bf16 v159, v27, v103, v159
s_mov_b32 s50, 67125760
s_nop 1
v_pk_mul_f32 v[156:157], v[156:157], v[32:33]
v_pk_mul_f32 v[158:159], v[158:159], v[34:35]
v_cvt_pk_bf16_f32 v156, v156, v157
v_cvt_pk_bf16_f32 v157, v158, v159
buffer_store_dwordx2 v[156:157], v90, s[20:23], s50 offen sc1
v_perm_b32 v24, v130, v131, s41
v_perm_b32 v25, v131, v132, s41
v_perm_b32 v26, v132, v133, s41
v_perm_b32 v27, v133, v134, s41
v_perm_b32 v28, v134, v135, s41
v_perm_b32 v29, v135, v136, s41
v_dot2_f32_bf16 v108, v26, v104, 0
v_dot2_f32_bf16 v109, v27, v104, 0
v_dot2_f32_bf16 v110, v28, v104, 0
v_dot2_f32_bf16 v111, v29, v104, 0
v_lshlrev_b32 v32, 16, v138
v_lshlrev_b32 v33, 16, v139
v_lshlrev_b32 v34, 16, v144
v_lshlrev_b32 v35, 16, v145
v_dot2_f32_bf16 v108, v24, v105, v108
v_dot2_f32_bf16 v109, v25, v105, v109
v_dot2_f32_bf16 v110, v26, v105, v110
v_dot2_f32_bf16 v111, v27, v105, v111
s_mov_b32 s50, 67129984
s_nop 1
v_pk_mul_f32 v[108:109], v[108:109], v[32:33]
v_pk_mul_f32 v[110:111], v[110:111], v[34:35]
v_cvt_pk_bf16_f32 v108, v108, v109
v_cvt_pk_bf16_f32 v109, v110, v111
buffer_store_dwordx2 v[108:109], v90, s[20:23], s50 offen sc1
v_perm_b32 v24, v130, v131, s42
v_perm_b32 v25, v131, v132, s42
v_perm_b32 v26, v132, v133, s42
v_perm_b32 v27, v133, v134, s42
v_perm_b32 v28, v134, v135, s42
v_perm_b32 v29, v135, v136, s42
v_dot2_f32_bf16 v124, v26, v106, 0
v_dot2_f32_bf16 v125, v27, v106, 0
v_dot2_f32_bf16 v126, v28, v106, 0
v_dot2_f32_bf16 v127, v29, v106, 0
v_and_b32 v32, 0xffff0000, v138
v_and_b32 v33, 0xffff0000, v139
v_and_b32 v34, 0xffff0000, v144
v_and_b32 v35, 0xffff0000, v145
v_dot2_f32_bf16 v124, v24, v107, v124
v_dot2_f32_bf16 v125, v25, v107, v125
v_dot2_f32_bf16 v126, v26, v107, v126
v_dot2_f32_bf16 v127, v27, v107, v127
s_mov_b32 s50, 67134208
s_nop 1
v_pk_mul_f32 v[124:125], v[124:125], v[32:33]
v_pk_mul_f32 v[126:127], v[126:127], v[34:35]
v_cvt_pk_bf16_f32 v124, v124, v125
v_cvt_pk_bf16_f32 v125, v126, v127
buffer_store_dwordx2 v[124:125], v90, s[20:23], s50 offen sc1
v_mfma_f32_16x16x32_bf16 v[96:99], v[40:43], a[0:3], 0
ds_read_b64_tr_b16 v[56:57], v3 offset:49152
v_mfma_f32_16x16x32_bf16 v[96:99], v[44:47], a[16:19], v[96:99]
ds_read_b64_tr_b16 v[58:59], v3 offset:49664
s_add_u32 s50, s44, 4194304
v_mfma_f32_16x16x32_bf16 v[100:103], v[40:43], a[4:7], 0
ds_read_b64_tr_b16 v[60:61], v3 offset:57344
v_mul_f32 v24, v160, v160
v_mfma_f32_16x16x32_bf16 v[100:103], v[44:47], a[20:23], v[100:103]
ds_read_b64_tr_b16 v[62:63], v3 offset:57856
v_mul_f32 v25, v161, v161
v_mfma_f32_16x16x32_bf16 v[104:107], v[40:43], a[8:11], 0
ds_read_b64_tr_b16 v[64:65], v3 offset:51200
v_fma_f32 v24, v24, s47, v18
v_mfma_f32_16x16x32_bf16 v[104:107], v[44:47], a[24:27], v[104:107]
ds_read_b64_tr_b16 v[66:67], v3 offset:51712
v_fma_f32 v25, v25, s47, v18
v_mul_f32 v24, v24, v160
v_mfma_f32_16x16x32_bf16 v[108:111], v[40:43], a[12:15], 0
ds_read_b64_tr_b16 v[68:69], v3 offset:59392
v_mul_f32 v25, v25, v161
v_mfma_f32_16x16x32_bf16 v[108:111], v[44:47], a[28:31], v[108:111]
ds_read_b64_tr_b16 v[70:71], v3 offset:59904
v_mul_f32 v176, v176, v160
v_mfma_f32_16x16x32_bf16 v[112:115], v[48:51], a[0:3], 0
buffer_load_dwordx4 v10, s[8:11], s32 offen offset:2048 lds
v_mfma_f32_16x16x32_bf16 v[112:115], v[52:55], a[16:19], v[112:115]
v_exp_f32 v24, v24
v_mfma_f32_16x16x32_bf16 v[116:119], v[48:51], a[4:7], 0
v_exp_f32 v25, v25
v_mul_f32 v177, v177, v161
v_mfma_f32_16x16x32_bf16 v[116:119], v[52:55], a[20:23], v[116:119]
v_add_f32 v24, 1.0, v24
v_add_f32 v25, 1.0, v25
v_mfma_f32_16x16x32_bf16 v[120:123], v[48:51], a[8:11], 0
buffer_load_dwordx4 v11, s[8:11], s32 offen offset:3072 lds
v_mfma_f32_16x16x32_bf16 v[120:123], v[52:55], a[24:27], v[120:123]
s_add_u32 m0, s37, 49152
v_mul_f32 v26, v162, v162
v_mfma_f32_16x16x32_bf16 v[124:127], v[48:51], a[12:15], 0
v_mul_f32 v27, v163, v163
s_waitcnt vmcnt(22) lgkmcnt(0)
v_mfma_f32_16x16x32_bf16 v[124:127], v[52:55], a[28:31], v[124:127]
s_barrier
v_mfma_f32_16x16x32_bf16 v[128:131], v[56:59], a[0:3], 0
ds_read_b64_tr_b16 v[40:41], v4 offset:0
v_rcp_f32 v24, v24
v_mfma_f32_16x16x32_bf16 v[128:131], v[60:63], a[16:19], v[128:131]
ds_read_b64_tr_b16 v[42:43], v4 offset:512
v_mul_f32 v176, v176, v24
v_mfma_f32_16x16x32_bf16 v[132:135], v[56:59], a[4:7], 0
ds_read_b64_tr_b16 v[44:45], v4 offset:8192
v_fma_f32 v26, v26, s47, v18
v_mfma_f32_16x16x32_bf16 v[132:135], v[60:63], a[20:23], v[132:135]
ds_read_b64_tr_b16 v[46:47], v4 offset:8704
v_fma_f32 v27, v27, s47, v18
v_mfma_f32_16x16x32_bf16 v[136:139], v[56:59], a[8:11], 0
ds_read_b64_tr_b16 v[48:49], v4 offset:2048
v_rcp_f32 v25, v25
v_mfma_f32_16x16x32_bf16 v[136:139], v[60:63], a[24:27], v[136:139]
ds_read_b64_tr_b16 v[50:51], v4 offset:2560
v_mul_f32 v177, v177, v25
v_mfma_f32_16x16x32_bf16 v[140:143], v[56:59], a[12:15], 0
ds_read_b64_tr_b16 v[52:53], v4 offset:10240
v_mul_f32 v26, v26, v162
v_mfma_f32_16x16x32_bf16 v[140:143], v[60:63], a[28:31], v[140:143]
ds_read_b64_tr_b16 v[54:55], v4 offset:10752
v_mul_f32 v27, v27, v163
v_mfma_f32_16x16x32_bf16 v[144:147], v[64:67], a[0:3], 0
buffer_load_dwordx4 v10, s[4:7], s33 offen offset:0 lds
v_mfma_f32_16x16x32_bf16 v[144:147], v[68:71], a[16:19], v[144:147]
v_exp_f32 v26, v26
v_mul_f32 v178, v178, v162
v_mfma_f32_16x16x32_bf16 v[148:151], v[64:67], a[4:7], 0
v_exp_f32 v27, v27
v_mfma_f32_16x16x32_bf16 v[148:151], v[68:71], a[20:23], v[148:151]
v_mul_f32 v179, v179, v163
v_add_f32 v26, 1.0, v26
v_mfma_f32_16x16x32_bf16 v[152:155], v[64:67], a[8:11], 0
buffer_load_dwordx4 v11, s[4:7], s33 offen offset:1024 lds
v_mfma_f32_16x16x32_bf16 v[152:155], v[68:71], a[24:27], v[152:155]
v_add_f32 v27, 1.0, v27
v_cvt_pk_bf16_f32 v160, v176, v177
v_mfma_f32_16x16x32_bf16 v[156:159], v[64:67], a[12:15], 0
v_rcp_f32 v26, v26
v_mul_f32 v28, v192, v192
v_mfma_f32_16x16x32_bf16 v[156:159], v[68:71], a[28:31], v[156:159]
v_mul_f32 v178, v178, v26
s_waitcnt lgkmcnt(0)
v_mfma_f32_16x16x32_bf16 v[96:99], v[40:43], a[32:35], v[96:99]
ds_read_b64_tr_b16 v[56:57], v5 offset:0
v_mul_f32 v29, v193, v193
v_mfma_f32_16x16x32_bf16 v[96:99], v[44:47], a[48:51], v[96:99]
ds_read_b64_tr_b16 v[58:59], v5 offset:512
v_fma_f32 v28, v28, s47, v18
v_mfma_f32_16x16x32_bf16 v[100:103], v[40:43], a[36:39], v[100:103]
ds_read_b64_tr_b16 v[60:61], v5 offset:8192
v_fma_f32 v29, v29, s47, v18
v_mfma_f32_16x16x32_bf16 v[100:103], v[44:47], a[52:55], v[100:103]
ds_read_b64_tr_b16 v[62:63], v5 offset:8704
v_rcp_f32 v27, v27
v_mfma_f32_16x16x32_bf16 v[104:107], v[40:43], a[40:43], v[104:107]
ds_read_b64_tr_b16 v[64:65], v5 offset:2048
v_mul_f32 v179, v179, v27
v_mfma_f32_16x16x32_bf16 v[104:107], v[44:47], a[56:59], v[104:107]
ds_read_b64_tr_b16 v[66:67], v5 offset:2560
v_cvt_pk_bf16_f32 v161, v178, v179
v_mfma_f32_16x16x32_bf16 v[108:111], v[40:43], a[44:47], v[108:111]
ds_read_b64_tr_b16 v[68:69], v5 offset:10240
v_mul_f32 v28, v28, v192
v_mfma_f32_16x16x32_bf16 v[108:111], v[44:47], a[60:63], v[108:111]
ds_read_b64_tr_b16 v[70:71], v5 offset:10752
v_mul_f32 v29, v29, v193
v_mfma_f32_16x16x32_bf16 v[112:115], v[48:51], a[32:35], v[112:115]
buffer_load_dwordx4 v10, s[8:11], s33 offen offset:2048 lds
v_mfma_f32_16x16x32_bf16 v[112:115], v[52:55], a[48:51], v[112:115]
v_exp_f32 v28, v28
v_mul_f32 v208, v208, v192
v_mfma_f32_16x16x32_bf16 v[116:119], v[48:51], a[36:39], v[116:119]
v_exp_f32 v29, v29
v_mfma_f32_16x16x32_bf16 v[116:119], v[52:55], a[52:55], v[116:119]
v_mul_f32 v209, v209, v193
v_add_f32 v28, 1.0, v28
v_mfma_f32_16x16x32_bf16 v[120:123], v[48:51], a[40:43], v[120:123]
buffer_load_dwordx4 v11, s[8:11], s33 offen offset:3072 lds
v_mfma_f32_16x16x32_bf16 v[120:123], v[52:55], a[56:59], v[120:123]
s_add_u32 m0, s37, 65536
v_add_f32 v29, 1.0, v29
v_mul_f32 v30, v194, v194
v_mfma_f32_16x16x32_bf16 v[124:127], v[48:51], a[44:47], v[124:127]
v_mul_f32 v31, v195, v195
s_waitcnt vmcnt(21) lgkmcnt(0)
v_mfma_f32_16x16x32_bf16 v[124:127], v[52:55], a[60:63], v[124:127]
s_barrier
v_mfma_f32_16x16x32_bf16 v[128:131], v[56:59], a[32:35], v[128:131]
ds_read_b64_tr_b16 v[40:41], v2 offset:0
v_fma_f32 v30, v30, s47, v18
v_mfma_f32_16x16x32_bf16 v[128:131], v[60:63], a[48:51], v[128:131]
ds_read_b64_tr_b16 v[42:43], v2 offset:512
v_fma_f32 v31, v31, s47, v18
v_mfma_f32_16x16x32_bf16 v[132:135], v[56:59], a[36:39], v[132:135]
ds_read_b64_tr_b16 v[44:45], v2 offset:8192
v_rcp_f32 v28, v28
v_mfma_f32_16x16x32_bf16 v[132:135], v[60:63], a[52:55], v[132:135]
ds_read_b64_tr_b16 v[46:47], v2 offset:8704
v_mul_f32 v208, v208, v28
v_mfma_f32_16x16x32_bf16 v[136:139], v[56:59], a[40:43], v[136:139]
ds_read_b64_tr_b16 v[48:49], v2 offset:2048
v_mul_f32 v30, v30, v194
v_mfma_f32_16x16x32_bf16 v[136:139], v[60:63], a[56:59], v[136:139]
ds_read_b64_tr_b16 v[50:51], v2 offset:2560
v_mul_f32 v31, v31, v195
v_mfma_f32_16x16x32_bf16 v[140:143], v[56:59], a[44:47], v[140:143]
ds_read_b64_tr_b16 v[52:53], v2 offset:10240
v_mul_f32 v210, v210, v194
v_mfma_f32_16x16x32_bf16 v[140:143], v[60:63], a[60:63], v[140:143]
ds_read_b64_tr_b16 v[54:55], v2 offset:10752
v_rcp_f32 v29, v29
v_mfma_f32_16x16x32_bf16 v[144:147], v[64:67], a[32:35], v[144:147]
buffer_load_dwordx4 v10, s[4:7], s34 offen offset:0 lds
v_mfma_f32_16x16x32_bf16 v[144:147], v[68:71], a[48:51], v[144:147]
v_mul_f32 v209, v209, v29
v_mul_f32 v211, v211, v195
v_mfma_f32_16x16x32_bf16 v[148:151], v[64:67], a[36:39], v[148:151]
v_exp_f32 v30, v30
v_mfma_f32_16x16x32_bf16 v[148:151], v[68:71], a[52:55], v[148:151]
v_exp_f32 v31, v31
v_mfma_f32_16x16x32_bf16 v[152:155], v[64:67], a[40:43], v[152:155]
buffer_load_dwordx4 v11, s[4:7], s34 offen offset:1024 lds
v_mfma_f32_16x16x32_bf16 v[152:155], v[68:71], a[56:59], v[152:155]
v_add_f32 v30, 1.0, v30
v_add_f32 v31, 1.0, v31
v_cvt_pk_bf16_f32 v162, v208, v209
v_mfma_f32_16x16x32_bf16 v[156:159], v[64:67], a[44:47], v[156:159]
v_rcp_f32 v30, v30
v_mfma_f32_16x16x32_bf16 v[156:159], v[68:71], a[60:63], v[156:159]
v_mul_f32 v210, v210, v30
s_waitcnt lgkmcnt(0)
v_mfma_f32_16x16x32_bf16 v[96:99], v[40:43], a[64:67], v[96:99]
ds_read_b64_tr_b16 v[56:57], v3 offset:0
v_mul_f32 v32, v164, v164
v_mfma_f32_16x16x32_bf16 v[96:99], v[44:47], a[80:83], v[96:99]
ds_read_b64_tr_b16 v[58:59], v3 offset:512
v_rcp_f32 v31, v31
v_mfma_f32_16x16x32_bf16 v[100:103], v[40:43], a[68:71], v[100:103]
ds_read_b64_tr_b16 v[60:61], v3 offset:8192
v_mul_f32 v211, v211, v31
v_mfma_f32_16x16x32_bf16 v[100:103], v[44:47], a[84:87], v[100:103]
ds_read_b64_tr_b16 v[62:63], v3 offset:8704
v_cvt_pk_bf16_f32 v163, v210, v211
v_mfma_f32_16x16x32_bf16 v[104:107], v[40:43], a[72:75], v[104:107]
ds_read_b64_tr_b16 v[64:65], v3 offset:2048
v_mul_f32 v33, v165, v165
v_mfma_f32_16x16x32_bf16 v[104:107], v[44:47], a[88:91], v[104:107]
ds_read_b64_tr_b16 v[66:67], v3 offset:2560
v_fma_f32 v32, v32, s47, v18
v_mfma_f32_16x16x32_bf16 v[108:111], v[40:43], a[76:79], v[108:111]
ds_read_b64_tr_b16 v[68:69], v3 offset:10240
v_fma_f32 v33, v33, s47, v18
v_mul_f32 v32, v32, v164
v_mfma_f32_16x16x32_bf16 v[108:111], v[44:47], a[92:95], v[108:111]
ds_read_b64_tr_b16 v[70:71], v3 offset:10752
v_mul_f32 v33, v33, v165
v_mfma_f32_16x16x32_bf16 v[112:115], v[48:51], a[64:67], v[112:115]
buffer_load_dwordx4 v10, s[8:11], s34 offen offset:2048 lds
v_mfma_f32_16x16x32_bf16 v[112:115], v[52:55], a[80:83], v[112:115]
ds_write_b128 v14, v[160:163] offset:16384
v_mfma_f32_16x16x32_bf16 v[116:119], v[48:51], a[68:71], v[116:119]
buffer_store_dwordx4 v[160:163], v16, s[20:23], s50 offen offset:0 sc1
v_mfma_f32_16x16x32_bf16 v[116:119], v[52:55], a[84:87], v[116:119]
v_exp_f32 v32, v32
v_mul_f32 v180, v180, v164
v_mfma_f32_16x16x32_bf16 v[120:123], v[48:51], a[72:75], v[120:123]
buffer_load_dwordx4 v11, s[8:11], s34 offen offset:3072 lds
v_mfma_f32_16x16x32_bf16 v[120:123], v[52:55], a[88:91], v[120:123]
s_add_u32 m0, s37, 0
v_mul_f32 v181, v181, v165
v_mfma_f32_16x16x32_bf16 v[124:127], v[48:51], a[76:79], v[124:127]
v_add_f32 v32, 1.0, v32
s_waitcnt vmcnt(20) lgkmcnt(0)
v_mfma_f32_16x16x32_bf16 v[124:127], v[52:55], a[92:95], v[124:127]
s_barrier
v_mfma_f32_16x16x32_bf16 v[128:131], v[56:59], a[64:67], v[128:131]
ds_read_b64_tr_b16 v[40:41], v2 offset:16384
v_exp_f32 v33, v33
v_mfma_f32_16x16x32_bf16 v[128:131], v[60:63], a[80:83], v[128:131]
ds_read_b64_tr_b16 v[42:43], v2 offset:16896
v_add_f32 v33, 1.0, v33
v_mfma_f32_16x16x32_bf16 v[132:135], v[56:59], a[68:71], v[132:135]
ds_read_b64_tr_b16 v[44:45], v2 offset:24576
v_mul_f32 v34, v166, v166
v_mfma_f32_16x16x32_bf16 v[132:135], v[60:63], a[84:87], v[132:135]
ds_read_b64_tr_b16 v[46:47], v2 offset:25088
v_mul_f32 v35, v167, v167
v_mfma_f32_16x16x32_bf16 v[136:139], v[56:59], a[72:75], v[136:139]
ds_read_b64_tr_b16 v[48:49], v2 offset:18432
v_fma_f32 v34, v34, s47, v18
v_mfma_f32_16x16x32_bf16 v[136:139], v[60:63], a[88:91], v[136:139]
ds_read_b64_tr_b16 v[50:51], v2 offset:18944
v_rcp_f32 v32, v32
v_mfma_f32_16x16x32_bf16 v[140:143], v[56:59], a[76:79], v[140:143]
ds_read_b64_tr_b16 v[52:53], v2 offset:26624
v_mul_f32 v180, v180, v32
v_mfma_f32_16x16x32_bf16 v[140:143], v[60:63], a[92:95], v[140:143]
ds_read_b64_tr_b16 v[54:55], v2 offset:27136
v_fma_f32 v35, v35, s47, v18
v_mfma_f32_16x16x32_bf16 v[144:147], v[64:67], a[64:67], v[144:147]
buffer_load_dwordx4 v10, s[4:7], s35 offen offset:0 lds
v_mfma_f32_16x16x32_bf16 v[144:147], v[68:71], a[80:83], v[144:147]
v_rcp_f32 v33, v33
v_mfma_f32_16x16x32_bf16 v[148:151], v[64:67], a[68:71], v[148:151]
v_mul_f32 v181, v181, v33
v_mul_f32 v34, v34, v166
v_mul_f32 v35, v35, v167
v_mfma_f32_16x16x32_bf16 v[148:151], v[68:71], a[84:87], v[148:151]
v_exp_f32 v34, v34
v_mfma_f32_16x16x32_bf16 v[152:155], v[64:67], a[72:75], v[152:155]
buffer_load_dwordx4 v11, s[4:7], s35 offen offset:1024 lds
v_mfma_f32_16x16x32_bf16 v[152:155], v[68:71], a[88:91], v[152:155]
v_exp_f32 v35, v35
v_mfma_f32_16x16x32_bf16 v[156:159], v[64:67], a[76:79], v[156:159]
v_mul_f32 v182, v182, v166
v_mul_f32 v183, v183, v167
v_mfma_f32_16x16x32_bf16 v[156:159], v[68:71], a[92:95], v[156:159]
v_add_f32 v34, 1.0, v34
v_add_f32 v35, 1.0, v35
s_waitcnt lgkmcnt(0)
v_mfma_f32_16x16x32_bf16 v[96:99], v[40:43], a[96:99], v[96:99]
ds_read_b64_tr_b16 v[56:57], v3 offset:16384
v_cvt_pk_bf16_f32 v164, v180, v181
v_mfma_f32_16x16x32_bf16 v[96:99], v[44:47], a[112:115], v[96:99]
ds_read_b64_tr_b16 v[58:59], v3 offset:16896
v_mul_f32 v36, v196, v196
v_mfma_f32_16x16x32_bf16 v[100:103], v[40:43], a[100:103], v[100:103]
ds_read_b64_tr_b16 v[60:61], v3 offset:24576
v_mul_f32 v37, v197, v197
v_mfma_f32_16x16x32_bf16 v[100:103], v[44:47], a[116:119], v[100:103]
ds_read_b64_tr_b16 v[62:63], v3 offset:25088
v_fma_f32 v36, v36, s47, v18
v_mfma_f32_16x16x32_bf16 v[104:107], v[40:43], a[104:107], v[104:107]
ds_read_b64_tr_b16 v[64:65], v3 offset:18432
v_rcp_f32 v34, v34
v_mfma_f32_16x16x32_bf16 v[104:107], v[44:47], a[120:123], v[104:107]
ds_read_b64_tr_b16 v[66:67], v3 offset:18944
v_mul_f32 v182, v182, v34
v_mfma_f32_16x16x32_bf16 v[108:111], v[40:43], a[108:111], v[108:111]
ds_read_b64_tr_b16 v[68:69], v3 offset:26624
v_fma_f32 v37, v37, s47, v18
v_mfma_f32_16x16x32_bf16 v[108:111], v[44:47], a[124:127], v[108:111]
ds_read_b64_tr_b16 v[70:71], v3 offset:27136
v_mul_f32 v36, v36, v196
v_mfma_f32_16x16x32_bf16 v[112:115], v[48:51], a[96:99], v[112:115]
buffer_load_dwordx4 v10, s[8:11], s35 offen offset:2048 lds
v_mfma_f32_16x16x32_bf16 v[112:115], v[52:55], a[112:115], v[112:115]
v_rcp_f32 v35, v35
v_mfma_f32_16x16x32_bf16 v[116:119], v[48:51], a[100:103], v[116:119]
v_mul_f32 v183, v183, v35
v_cvt_pk_bf16_f32 v165, v182, v183
v_mul_f32 v37, v37, v197
v_mfma_f32_16x16x32_bf16 v[116:119], v[52:55], a[116:119], v[116:119]
v_exp_f32 v36, v36
v_mfma_f32_16x16x32_bf16 v[120:123], v[48:51], a[104:107], v[120:123]
buffer_load_dwordx4 v11, s[8:11], s35 offen offset:3072 lds
v_mfma_f32_16x16x32_bf16 v[120:123], v[52:55], a[120:123], v[120:123]
s_add_u32 m0, s37, 16384
v_mul_f32 v212, v212, v196
v_mfma_f32_16x16x32_bf16 v[124:127], v[48:51], a[108:111], v[124:127]
v_mul_f32 v213, v213, v197
s_waitcnt vmcnt(13) lgkmcnt(0)
v_mfma_f32_16x16x32_bf16 v[124:127], v[52:55], a[124:127], v[124:127]
s_barrier
v_mfma_f32_16x16x32_bf16 v[128:131], v[56:59], a[96:99], v[128:131]
ds_read_b64_tr_b16 v[40:41], v2 offset:32768
v_exp_f32 v37, v37
v_mfma_f32_16x16x32_bf16 v[128:131], v[60:63], a[112:115], v[128:131]
ds_read_b64_tr_b16 v[42:43], v2 offset:33280
v_add_f32 v36, 1.0, v36
v_mfma_f32_16x16x32_bf16 v[132:135], v[56:59], a[100:103], v[132:135]
ds_read_b64_tr_b16 v[44:45], v2 offset:40960
v_add_f32 v37, 1.0, v37
v_mfma_f32_16x16x32_bf16 v[132:135], v[60:63], a[116:119], v[132:135]
ds_read_b64_tr_b16 v[46:47], v2 offset:41472
v_mul_f32 v38, v198, v198
v_mfma_f32_16x16x32_bf16 v[136:139], v[56:59], a[104:107], v[136:139]
ds_read_b64_tr_b16 v[48:49], v2 offset:34816
v_rcp_f32 v36, v36
v_mfma_f32_16x16x32_bf16 v[136:139], v[60:63], a[120:123], v[136:139]
ds_read_b64_tr_b16 v[50:51], v2 offset:35328
v_mul_f32 v212, v212, v36
v_mfma_f32_16x16x32_bf16 v[140:143], v[56:59], a[108:111], v[140:143]
ds_read_b64_tr_b16 v[52:53], v2 offset:43008
v_mov_b32 v20, 1
v_mfma_f32_16x16x32_bf16 v[140:143], v[60:63], a[124:127], v[140:143]
ds_read_b64_tr_b16 v[54:55], v2 offset:43520
v_mul_f32 v39, v199, v199
v_mfma_f32_16x16x32_bf16 v[144:147], v[64:67], a[96:99], v[144:147]
buffer_load_dwordx4 v10, s[4:7], s36 offen offset:0 lds
v_mfma_f32_16x16x32_bf16 v[144:147], v[68:71], a[112:115], v[144:147]
v_rcp_f32 v37, v37
v_fma_f32 v38, v38, s47, v18
v_mfma_f32_16x16x32_bf16 v[148:151], v[64:67], a[100:103], v[148:151]
buffer_store_dword v20, v19, s[20:23], 0 offen sc1
v_mfma_f32_16x16x32_bf16 v[148:151], v[68:71], a[116:119], v[148:151]
v_mul_f32 v213, v213, v37
v_fma_f32 v39, v39, s47, v18
v_mfma_f32_16x16x32_bf16 v[152:155], v[64:67], a[104:107], v[152:155]
buffer_load_dwordx4 v11, s[4:7], s36 offen offset:1024 lds
v_mfma_f32_16x16x32_bf16 v[152:155], v[68:71], a[120:123], v[152:155]
v_mul_f32 v38, v38, v198
v_mul_f32 v39, v39, v199
v_mfma_f32_16x16x32_bf16 v[156:159], v[64:67], a[108:111], v[156:159]
v_exp_f32 v38, v38
v_mfma_f32_16x16x32_bf16 v[156:159], v[68:71], a[124:127], v[156:159]
v_exp_f32 v39, v39
s_waitcnt lgkmcnt(0)
v_mfma_f32_16x16x32_bf16 v[96:99], v[40:43], a[128:131], v[96:99]
ds_read_b64_tr_b16 v[56:57], v3 offset:32768
v_mul_f32 v214, v214, v198
v_mfma_f32_16x16x32_bf16 v[96:99], v[44:47], a[144:147], v[96:99]
ds_read_b64_tr_b16 v[58:59], v3 offset:33280
v_mul_f32 v215, v215, v199
v_mfma_f32_16x16x32_bf16 v[100:103], v[40:43], a[132:135], v[100:103]
ds_read_b64_tr_b16 v[60:61], v3 offset:40960
v_add_f32 v38, 1.0, v38
v_mfma_f32_16x16x32_bf16 v[100:103], v[44:47], a[148:151], v[100:103]
ds_read_b64_tr_b16 v[62:63], v3 offset:41472
v_add_f32 v39, 1.0, v39
v_mfma_f32_16x16x32_bf16 v[104:107], v[40:43], a[136:139], v[104:107]
ds_read_b64_tr_b16 v[64:65], v3 offset:34816
v_rcp_f32 v38, v38
v_mfma_f32_16x16x32_bf16 v[104:107], v[44:47], a[152:155], v[104:107]
ds_read_b64_tr_b16 v[66:67], v3 offset:35328
v_mul_f32 v214, v214, v38
v_mfma_f32_16x16x32_bf16 v[108:111], v[40:43], a[140:143], v[108:111]
ds_read_b64_tr_b16 v[68:69], v3 offset:43008
v_cvt_pk_bf16_f32 v166, v212, v213
v_mfma_f32_16x16x32_bf16 v[108:111], v[44:47], a[156:159], v[108:111]
ds_read_b64_tr_b16 v[70:71], v3 offset:43520
v_mul_f32 v24, v168, v168
v_mfma_f32_16x16x32_bf16 v[112:115], v[48:51], a[128:131], v[112:115]
buffer_load_dwordx4 v10, s[8:11], s36 offen offset:2048 lds
v_mfma_f32_16x16x32_bf16 v[112:115], v[52:55], a[144:147], v[112:115]
v_rcp_f32 v39, v39
v_mul_f32 v25, v169, v169
v_mfma_f32_16x16x32_bf16 v[116:119], v[48:51], a[132:135], v[116:119]
v_mul_f32 v215, v215, v39
v_cvt_pk_bf16_f32 v167, v214, v215
v_mfma_f32_16x16x32_bf16 v[116:119], v[52:55], a[148:151], v[116:119]
ds_write_b128 v14, v[164:167] offset:17408
v_mfma_f32_16x16x32_bf16 v[120:123], v[48:51], a[136:139], v[120:123]
buffer_load_dwordx4 v11, s[8:11], s36 offen offset:3072 lds
v_mfma_f32_16x16x32_bf16 v[120:123], v[52:55], a[152:155], v[120:123]
v_add_u32 v10, 128, v10
v_add_u32 v11, 128, v11
v_mfma_f32_16x16x32_bf16 v[124:127], v[48:51], a[140:143], v[124:127]
s_add_u32 m0, s37, 32768
s_waitcnt vmcnt(14) lgkmcnt(0)
v_mfma_f32_16x16x32_bf16 v[124:127], v[52:55], a[156:159], v[124:127]
s_barrier
v_mfma_f32_16x16x32_bf16 v[128:131], v[56:59], a[128:131], v[128:131]
ds_read_b64_tr_b16 v[40:41], v2 offset:49152
v_fma_f32 v24, v24, s47, v18
v_fma_f32 v25, v25, s47, v18
v_mfma_f32_16x16x32_bf16 v[128:131], v[60:63], a[144:147], v[128:131]
ds_read_b64_tr_b16 v[42:43], v2 offset:49664
v_mul_f32 v24, v24, v168
v_mfma_f32_16x16x32_bf16 v[132:135], v[56:59], a[132:135], v[132:135]
ds_read_b64_tr_b16 v[44:45], v2 offset:57344
v_mul_f32 v25, v25, v169
v_mfma_f32_16x16x32_bf16 v[132:135], v[60:63], a[148:151], v[132:135]
ds_read_b64_tr_b16 v[46:47], v2 offset:57856
v_mul_f32 v184, v184, v168
v_mfma_f32_16x16x32_bf16 v[136:139], v[56:59], a[136:139], v[136:139]
ds_read_b64_tr_b16 v[48:49], v2 offset:51200
v_exp_f32 v24, v24
v_mfma_f32_16x16x32_bf16 v[136:139], v[60:63], a[152:155], v[136:139]
ds_read_b64_tr_b16 v[50:51], v2 offset:51712
v_mul_f32 v185, v185, v169
v_mfma_f32_16x16x32_bf16 v[140:143], v[56:59], a[140:143], v[140:143]
ds_read_b64_tr_b16 v[52:53], v2 offset:59392
v_add_f32 v24, 1.0, v24
v_mfma_f32_16x16x32_bf16 v[140:143], v[60:63], a[156:159], v[140:143]
ds_read_b64_tr_b16 v[54:55], v2 offset:59904
v_mul_f32 v26, v170, v170
v_mfma_f32_16x16x32_bf16 v[144:147], v[64:67], a[128:131], v[144:147]
buffer_load_dwordx4 v10, s[4:7], s28 offen offset:0 lds
v_mfma_f32_16x16x32_bf16 v[144:147], v[68:71], a[144:147], v[144:147]
v_exp_f32 v25, v25
v_mfma_f32_16x16x32_bf16 v[148:151], v[64:67], a[132:135], v[148:151]
buffer_store_dwordx4 v[164:167], v16, s[20:23], s50 offen offset:1024 sc1
v_mfma_f32_16x16x32_bf16 v[148:151], v[68:71], a[148:151], v[148:151]
v_add_f32 v25, 1.0, v25
v_rcp_f32 v24, v24
v_mfma_f32_16x16x32_bf16 v[152:155], v[64:67], a[136:139], v[152:155]
buffer_load_dwordx4 v11, s[4:7], s28 offen offset:1024 lds
v_mfma_f32_16x16x32_bf16 v[152:155], v[68:71], a[152:155], v[152:155]
v_rcp_f32 v25, v25
v_mfma_f32_16x16x32_bf16 v[156:159], v[64:67], a[140:143], v[156:159]
v_mul_f32 v184, v184, v24
v_mul_f32 v185, v185, v25
v_mfma_f32_16x16x32_bf16 v[156:159], v[68:71], a[156:159], v[156:159]
v_mul_f32 v27, v171, v171
v_fma_f32 v26, v26, s47, v18
s_waitcnt lgkmcnt(0)
v_mfma_f32_16x16x32_bf16 v[96:99], v[40:43], a[160:163], v[96:99]
ds_read_b64_tr_b16 v[56:57], v3 offset:49152
v_fma_f32 v27, v27, s47, v18
v_mfma_f32_16x16x32_bf16 v[96:99], v[44:47], a[176:179], v[96:99]
ds_read_b64_tr_b16 v[58:59], v3 offset:49664
v_mul_f32 v26, v26, v170
v_mfma_f32_16x16x32_bf16 v[100:103], v[40:43], a[164:167], v[100:103]
ds_read_b64_tr_b16 v[60:61], v3 offset:57344
v_mul_f32 v27, v27, v171
v_mfma_f32_16x16x32_bf16 v[100:103], v[44:47], a[180:183], v[100:103]
ds_read_b64_tr_b16 v[62:63], v3 offset:57856
v_mul_f32 v186, v186, v170
v_mfma_f32_16x16x32_bf16 v[104:107], v[40:43], a[168:171], v[104:107]
ds_read_b64_tr_b16 v[64:65], v3 offset:51200
v_mul_f32 v187, v187, v171
v_mfma_f32_16x16x32_bf16 v[104:107], v[44:47], a[184:187], v[104:107]
ds_read_b64_tr_b16 v[66:67], v3 offset:51712
v_exp_f32 v26, v26
v_mfma_f32_16x16x32_bf16 v[108:111], v[40:43], a[172:175], v[108:111]
ds_read_b64_tr_b16 v[68:69], v3 offset:59392
v_add_f32 v26, 1.0, v26
v_mfma_f32_16x16x32_bf16 v[108:111], v[44:47], a[188:191], v[108:111]
ds_read_b64_tr_b16 v[70:71], v3 offset:59904
v_cvt_pk_bf16_f32 v168, v184, v185
v_mfma_f32_16x16x32_bf16 v[112:115], v[48:51], a[160:163], v[112:115]
buffer_load_dwordx4 v10, s[8:11], s28 offen offset:2048 lds
v_mfma_f32_16x16x32_bf16 v[112:115], v[52:55], a[176:179], v[112:115]
v_exp_f32 v27, v27
v_mfma_f32_16x16x32_bf16 v[116:119], v[48:51], a[164:167], v[116:119]
v_add_f32 v27, 1.0, v27
v_rcp_f32 v26, v26
v_mfma_f32_16x16x32_bf16 v[116:119], v[52:55], a[180:183], v[116:119]
v_rcp_f32 v27, v27
v_mfma_f32_16x16x32_bf16 v[120:123], v[48:51], a[168:171], v[120:123]
buffer_load_dwordx4 v11, s[8:11], s28 offen offset:3072 lds
v_mfma_f32_16x16x32_bf16 v[120:123], v[52:55], a[184:187], v[120:123]
s_add_u32 m0, s37, 49152
v_mul_f32 v186, v186, v26
v_mfma_f32_16x16x32_bf16 v[124:127], v[48:51], a[172:175], v[124:127]
v_mul_f32 v187, v187, v27
s_waitcnt vmcnt(14) lgkmcnt(0)
v_mfma_f32_16x16x32_bf16 v[124:127], v[52:55], a[188:191], v[124:127]
s_barrier
v_mfma_f32_16x16x32_bf16 v[128:131], v[56:59], a[160:163], v[128:131]
ds_read_b64_tr_b16 v[40:41], v4 offset:0
v_cvt_pk_bf16_f32 v169, v186, v187
v_mul_f32 v28, v200, v200
v_mfma_f32_16x16x32_bf16 v[128:131], v[60:63], a[176:179], v[128:131]
ds_read_b64_tr_b16 v[42:43], v4 offset:512
v_mul_f32 v29, v201, v201
v_mfma_f32_16x16x32_bf16 v[132:135], v[56:59], a[164:167], v[132:135]
ds_read_b64_tr_b16 v[44:45], v4 offset:8192
v_fma_f32 v28, v28, s47, v18
v_mfma_f32_16x16x32_bf16 v[132:135], v[60:63], a[180:183], v[132:135]
ds_read_b64_tr_b16 v[46:47], v4 offset:8704
v_fma_f32 v29, v29, s47, v18
v_mfma_f32_16x16x32_bf16 v[136:139], v[56:59], a[168:171], v[136:139]
ds_read_b64_tr_b16 v[48:49], v4 offset:2048
v_mul_f32 v28, v28, v200
v_mfma_f32_16x16x32_bf16 v[136:139], v[60:63], a[184:187], v[136:139]
ds_read_b64_tr_b16 v[50:51], v4 offset:2560
v_mul_f32 v29, v29, v201
v_mfma_f32_16x16x32_bf16 v[140:143], v[56:59], a[172:175], v[140:143]
ds_read_b64_tr_b16 v[52:53], v4 offset:10240
v_exp_f32 v28, v28
v_mfma_f32_16x16x32_bf16 v[140:143], v[60:63], a[188:191], v[140:143]
ds_read_b64_tr_b16 v[54:55], v4 offset:10752
v_mul_f32 v216, v216, v200
v_mfma_f32_16x16x32_bf16 v[144:147], v[64:67], a[160:163], v[144:147]
buffer_load_dwordx4 v10, s[4:7], s29 offen offset:0 lds
v_mfma_f32_16x16x32_bf16 v[144:147], v[68:71], a[176:179], v[144:147]
v_exp_f32 v29, v29
v_mfma_f32_16x16x32_bf16 v[148:151], v[64:67], a[164:167], v[148:151]
v_mul_f32 v217, v217, v201
v_add_f32 v28, 1.0, v28
v_mfma_f32_16x16x32_bf16 v[148:151], v[68:71], a[180:183], v[148:151]
v_add_f32 v29, 1.0, v29
v_mul_f32 v30, v202, v202
v_mfma_f32_16x16x32_bf16 v[152:155], v[64:67], a[168:171], v[152:155]
buffer_load_dwordx4 v11, s[4:7], s29 offen offset:1024 lds
v_mfma_f32_16x16x32_bf16 v[152:155], v[68:71], a[184:187], v[152:155]
v_rcp_f32 v28, v28
v_mul_f32 v31, v203, v203
v_mfma_f32_16x16x32_bf16 v[156:159], v[64:67], a[172:175], v[156:159]
v_rcp_f32 v29, v29
v_mfma_f32_16x16x32_bf16 v[156:159], v[68:71], a[188:191], v[156:159]
v_mul_f32 v216, v216, v28
s_waitcnt lgkmcnt(0)
v_mfma_f32_16x16x32_bf16 v[96:99], v[40:43], a[192:195], v[96:99]
ds_read_b64_tr_b16 v[56:57], v5 offset:0
v_mul_f32 v217, v217, v29
v_mfma_f32_16x16x32_bf16 v[96:99], v[44:47], a[208:211], v[96:99]
ds_read_b64_tr_b16 v[58:59], v5 offset:512
v_fma_f32 v30, v30, s47, v18
v_fma_f32 v31, v31, s47, v18
v_mfma_f32_16x16x32_bf16 v[100:103], v[40:43], a[196:199], v[100:103]
ds_read_b64_tr_b16 v[60:61], v5 offset:8192
v_mul_f32 v30, v30, v202
v_mfma_f32_16x16x32_bf16 v[100:103], v[44:47], a[212:215], v[100:103]
ds_read_b64_tr_b16 v[62:63], v5 offset:8704
v_mul_f32 v31, v31, v203
v_mfma_f32_16x16x32_bf16 v[104:107], v[40:43], a[200:203], v[104:107]
ds_read_b64_tr_b16 v[64:65], v5 offset:2048
v_mul_f32 v218, v218, v202
v_mfma_f32_16x16x32_bf16 v[104:107], v[44:47], a[216:219], v[104:107]
ds_read_b64_tr_b16 v[66:67], v5 offset:2560
v_mul_f32 v219, v219, v203
v_mfma_f32_16x16x32_bf16 v[108:111], v[40:43], a[204:207], v[108:111]
ds_read_b64_tr_b16 v[68:69], v5 offset:10240
v_cvt_pk_bf16_f32 v170, v216, v217
v_mfma_f32_16x16x32_bf16 v[108:111], v[44:47], a[220:223], v[108:111]
ds_read_b64_tr_b16 v[70:71], v5 offset:10752
v_exp_f32 v30, v30
v_mfma_f32_16x16x32_bf16 v[112:115], v[48:51], a[192:195], v[112:115]
buffer_load_dwordx4 v10, s[8:11], s29 offen offset:2048 lds
v_mfma_f32_16x16x32_bf16 v[112:115], v[52:55], a[208:211], v[112:115]
v_exp_f32 v31, v31
v_mfma_f32_16x16x32_bf16 v[116:119], v[48:51], a[196:199], v[116:119]
v_add_f32 v30, 1.0, v30
v_add_f32 v31, 1.0, v31
v_mfma_f32_16x16x32_bf16 v[116:119], v[52:55], a[212:215], v[116:119]
v_rcp_f32 v30, v30
v_mfma_f32_16x16x32_bf16 v[120:123], v[48:51], a[200:203], v[120:123]
buffer_load_dwordx4 v11, s[8:11], s29 offen offset:3072 lds
v_mfma_f32_16x16x32_bf16 v[120:123], v[52:55], a[216:219], v[120:123]
s_add_u32 m0, s37, 65536
v_rcp_f32 v31, v31
v_mfma_f32_16x16x32_bf16 v[124:127], v[48:51], a[204:207], v[124:127]
v_mul_f32 v218, v218, v30
s_waitcnt vmcnt(14) lgkmcnt(0)
v_mfma_f32_16x16x32_bf16 v[124:127], v[52:55], a[220:223], v[124:127]
s_barrier
v_mfma_f32_16x16x32_bf16 v[128:131], v[56:59], a[192:195], v[128:131]
ds_read_b64_tr_b16 v[40:41], v2 offset:0
v_mul_f32 v219, v219, v31
v_mfma_f32_16x16x32_bf16 v[128:131], v[60:63], a[208:211], v[128:131]
ds_read_b64_tr_b16 v[42:43], v2 offset:512
v_cvt_pk_bf16_f32 v171, v218, v219
v_mfma_f32_16x16x32_bf16 v[132:135], v[56:59], a[196:199], v[132:135]
ds_read_b64_tr_b16 v[44:45], v2 offset:8192
v_mul_f32 v32, v172, v172
v_mfma_f32_16x16x32_bf16 v[132:135], v[60:63], a[212:215], v[132:135]
ds_read_b64_tr_b16 v[46:47], v2 offset:8704
v_mul_f32 v33, v173, v173
v_fma_f32 v32, v32, s47, v18
v_mfma_f32_16x16x32_bf16 v[136:139], v[56:59], a[200:203], v[136:139]
ds_read_b64_tr_b16 v[48:49], v2 offset:2048
v_fma_f32 v33, v33, s47, v18
v_mfma_f32_16x16x32_bf16 v[136:139], v[60:63], a[216:219], v[136:139]
ds_read_b64_tr_b16 v[50:51], v2 offset:2560
v_mul_f32 v32, v32, v172
v_mfma_f32_16x16x32_bf16 v[140:143], v[56:59], a[204:207], v[140:143]
ds_read_b64_tr_b16 v[52:53], v2 offset:10240
v_mul_f32 v33, v33, v173
v_mfma_f32_16x16x32_bf16 v[140:143], v[60:63], a[220:223], v[140:143]
ds_read_b64_tr_b16 v[54:55], v2 offset:10752
v_mul_f32 v188, v188, v172
v_mfma_f32_16x16x32_bf16 v[144:147], v[64:67], a[192:195], v[144:147]
buffer_load_dwordx4 v10, s[4:7], s30 offen offset:0 lds
v_mfma_f32_16x16x32_bf16 v[144:147], v[68:71], a[208:211], v[144:147]
ds_write_b128 v14, v[168:171] offset:18432
v_mfma_f32_16x16x32_bf16 v[148:151], v[64:67], a[196:199], v[148:151]
buffer_store_dwordx4 v[168:171], v16, s[20:23], s50 offen offset:2048 sc1
v_mfma_f32_16x16x32_bf16 v[148:151], v[68:71], a[212:215], v[148:151]
v_exp_f32 v32, v32
v_mul_f32 v189, v189, v173
v_mfma_f32_16x16x32_bf16 v[152:155], v[64:67], a[200:203], v[152:155]
buffer_load_dwordx4 v11, s[4:7], s30 offen offset:1024 lds
v_mfma_f32_16x16x32_bf16 v[152:155], v[68:71], a[216:219], v[152:155]
v_exp_f32 v33, v33
v_mfma_f32_16x16x32_bf16 v[156:159], v[64:67], a[204:207], v[156:159]
v_add_f32 v32, 1.0, v32
v_add_f32 v33, 1.0, v33
v_mfma_f32_16x16x32_bf16 v[156:159], v[68:71], a[220:223], v[156:159]
v_mul_f32 v34, v174, v174
s_waitcnt lgkmcnt(0)
v_mfma_f32_16x16x32_bf16 v[96:99], v[40:43], a[224:227], v[96:99]
ds_read_b64_tr_b16 v[56:57], v3 offset:0
v_rcp_f32 v32, v32
v_mfma_f32_16x16x32_bf16 v[96:99], v[44:47], a[240:243], v[96:99]
ds_read_b64_tr_b16 v[58:59], v3 offset:512
v_mul_f32 v188, v188, v32
v_mfma_f32_16x16x32_bf16 v[100:103], v[40:43], a[228:231], v[100:103]
ds_read_b64_tr_b16 v[60:61], v3 offset:8192
v_mul_f32 v35, v175, v175
v_mfma_f32_16x16x32_bf16 v[100:103], v[44:47], a[244:247], v[100:103]
ds_read_b64_tr_b16 v[62:63], v3 offset:8704
v_fma_f32 v34, v34, s47, v18
v_mfma_f32_16x16x32_bf16 v[104:107], v[40:43], a[232:235], v[104:107]
ds_read_b64_tr_b16 v[64:65], v3 offset:2048
v_fma_f32 v35, v35, s47, v18
v_mfma_f32_16x16x32_bf16 v[104:107], v[44:47], a[248:251], v[104:107]
ds_read_b64_tr_b16 v[66:67], v3 offset:2560
v_mul_f32 v34, v34, v174
v_mfma_f32_16x16x32_bf16 v[108:111], v[40:43], a[236:239], v[108:111]
ds_read_b64_tr_b16 v[68:69], v3 offset:10240
v_rcp_f32 v33, v33
v_mfma_f32_16x16x32_bf16 v[108:111], v[44:47], a[252:255], v[108:111]
ds_read_b64_tr_b16 v[70:71], v3 offset:10752
v_mul_f32 v189, v189, v33
v_mfma_f32_16x16x32_bf16 v[112:115], v[48:51], a[224:227], v[112:115]
buffer_load_dwordx4 v10, s[8:11], s30 offen offset:2048 lds
v_mfma_f32_16x16x32_bf16 v[112:115], v[52:55], a[240:243], v[112:115]
v_mul_f32 v35, v35, v175
v_mul_f32 v190, v190, v174
v_mfma_f32_16x16x32_bf16 v[116:119], v[48:51], a[228:231], v[116:119]
v_exp_f32 v34, v34
v_mfma_f32_16x16x32_bf16 v[116:119], v[52:55], a[244:247], v[116:119]
v_exp_f32 v35, v35
v_mfma_f32_16x16x32_bf16 v[120:123], v[48:51], a[232:235], v[120:123]
buffer_load_dwordx4 v11, s[8:11], s30 offen offset:3072 lds
v_mfma_f32_16x16x32_bf16 v[120:123], v[52:55], a[248:251], v[120:123]
s_add_u32 m0, s37, 0
v_mul_f32 v191, v191, v175
v_add_f32 v34, 1.0, v34
v_mfma_f32_16x16x32_bf16 v[124:127], v[48:51], a[236:239], v[124:127]
v_add_f32 v35, 1.0, v35
s_waitcnt vmcnt(14) lgkmcnt(0)
v_mfma_f32_16x16x32_bf16 v[124:127], v[52:55], a[252:255], v[124:127]
s_barrier
v_mfma_f32_16x16x32_bf16 v[128:131], v[56:59], a[224:227], v[128:131]
ds_read_b64_tr_b16 v[40:41], v2 offset:16384
v_cvt_pk_bf16_f32 v172, v188, v189
v_mfma_f32_16x16x32_bf16 v[128:131], v[60:63], a[240:243], v[128:131]
ds_read_b64_tr_b16 v[42:43], v2 offset:16896
v_mul_f32 v36, v204, v204
v_mfma_f32_16x16x32_bf16 v[132:135], v[56:59], a[228:231], v[132:135]
ds_read_b64_tr_b16 v[44:45], v2 offset:24576
v_mul_f32 v37, v205, v205
v_mfma_f32_16x16x32_bf16 v[132:135], v[60:63], a[244:247], v[132:135]
ds_read_b64_tr_b16 v[46:47], v2 offset:25088
v_fma_f32 v36, v36, s47, v18
v_mfma_f32_16x16x32_bf16 v[136:139], v[56:59], a[232:235], v[136:139]
ds_read_b64_tr_b16 v[48:49], v2 offset:18432
v_rcp_f32 v34, v34
v_mfma_f32_16x16x32_bf16 v[136:139], v[60:63], a[248:251], v[136:139]
ds_read_b64_tr_b16 v[50:51], v2 offset:18944
v_mul_f32 v190, v190, v34
v_mfma_f32_16x16x32_bf16 v[140:143], v[56:59], a[236:239], v[140:143]
ds_read_b64_tr_b16 v[52:53], v2 offset:26624
v_fma_f32 v37, v37, s47, v18
v_mfma_f32_16x16x32_bf16 v[140:143], v[60:63], a[252:255], v[140:143]
ds_read_b64_tr_b16 v[54:55], v2 offset:27136
v_mul_f32 v36, v36, v204
v_mfma_f32_16x16x32_bf16 v[144:147], v[64:67], a[224:227], v[144:147]
buffer_load_dwordx4 v10, s[4:7], s31 offen offset:0 lds
v_mfma_f32_16x16x32_bf16 v[144:147], v[68:71], a[240:243], v[144:147]
v_rcp_f32 v35, v35
v_mfma_f32_16x16x32_bf16 v[148:151], v[64:67], a[228:231], v[148:151]
v_mul_f32 v191, v191, v35
v_cvt_pk_bf16_f32 v173, v190, v191
v_mfma_f32_16x16x32_bf16 v[148:151], v[68:71], a[244:247], v[148:151]
v_mul_f32 v37, v37, v205
v_exp_f32 v36, v36
v_mfma_f32_16x16x32_bf16 v[152:155], v[64:67], a[232:235], v[152:155]
buffer_load_dwordx4 v11, s[4:7], s31 offen offset:1024 lds
v_mfma_f32_16x16x32_bf16 v[152:155], v[68:71], a[248:251], v[152:155]
v_exp_f32 v37, v37
v_mfma_f32_16x16x32_bf16 v[156:159], v[64:67], a[236:239], v[156:159]
v_mul_f32 v220, v220, v204
v_mul_f32 v221, v221, v205
v_mfma_f32_16x16x32_bf16 v[156:159], v[68:71], a[252:255], v[156:159]
v_add_f32 v36, 1.0, v36
s_waitcnt lgkmcnt(0)
v_mfma_f32_16x16x32_bf16 v[96:99], v[40:43], v[224:227], v[96:99]
ds_read_b64_tr_b16 v[56:57], v3 offset:16384
v_add_f32 v37, 1.0, v37
v_mfma_f32_16x16x32_bf16 v[96:99], v[44:47], v[240:243], v[96:99]
ds_read_b64_tr_b16 v[58:59], v3 offset:16896
v_mul_f32 v38, v206, v206
v_mfma_f32_16x16x32_bf16 v[100:103], v[40:43], v[228:231], v[100:103]
ds_read_b64_tr_b16 v[60:61], v3 offset:24576
v_rcp_f32 v36, v36
v_mfma_f32_16x16x32_bf16 v[100:103], v[44:47], v[244:247], v[100:103]
ds_read_b64_tr_b16 v[62:63], v3 offset:25088
v_mul_f32 v220, v220, v36
v_mfma_f32_16x16x32_bf16 v[104:107], v[40:43], v[232:235], v[104:107]
ds_read_b64_tr_b16 v[64:65], v3 offset:18432
v_mul_f32 v39, v207, v207
v_mfma_f32_16x16x32_bf16 v[104:107], v[44:47], v[248:251], v[104:107]
ds_read_b64_tr_b16 v[66:67], v3 offset:18944
v_fma_f32 v38, v38, s47, v18
v_mfma_f32_16x16x32_bf16 v[108:111], v[40:43], v[236:239], v[108:111]
ds_read_b64_tr_b16 v[68:69], v3 offset:26624
v_fma_f32 v39, v39, s47, v18
v_mfma_f32_16x16x32_bf16 v[108:111], v[44:47], v[252:255], v[108:111]
ds_read_b64_tr_b16 v[70:71], v3 offset:27136
v_mul_f32 v38, v38, v206
v_mfma_f32_16x16x32_bf16 v[112:115], v[48:51], v[224:227], v[112:115]
buffer_load_dwordx4 v10, s[8:11], s31 offen offset:2048 lds
v_mfma_f32_16x16x32_bf16 v[112:115], v[52:55], v[240:243], v[112:115]
v_rcp_f32 v37, v37
v_mfma_f32_16x16x32_bf16 v[116:119], v[48:51], v[228:231], v[116:119]
v_mul_f32 v221, v221, v37
v_mul_f32 v39, v39, v207
v_mfma_f32_16x16x32_bf16 v[116:119], v[52:55], v[244:247], v[116:119]
v_exp_f32 v38, v38
v_mul_f32 v222, v222, v206
v_mfma_f32_16x16x32_bf16 v[120:123], v[48:51], v[232:235], v[120:123]
buffer_load_dwordx4 v11, s[8:11], s31 offen offset:3072 lds
v_mfma_f32_16x16x32_bf16 v[120:123], v[52:55], v[248:251], v[120:123]
s_add_u32 m0, s37, 16384
v_mul_f32 v223, v223, v207
v_mfma_f32_16x16x32_bf16 v[124:127], v[48:51], v[236:239], v[124:127]
v_add_f32 v38, 1.0, v38
s_waitcnt vmcnt(13) lgkmcnt(0)
v_mfma_f32_16x16x32_bf16 v[124:127], v[52:55], v[252:255], v[124:127]
s_barrier
v_mfma_f32_16x16x32_bf16 v[128:131], v[56:59], v[224:227], v[128:131]
ds_read_b64_tr_b16 v[40:41], v2 offset:32768
v_cvt_pk_bf16_f32 v174, v220, v221
v_mfma_f32_16x16x32_bf16 v[128:131], v[60:63], v[240:243], v[128:131]
ds_read_b64_tr_b16 v[42:43], v2 offset:33280
v_mfma_f32_16x16x32_bf16 v[132:135], v[56:59], v[228:231], v[132:135]
ds_read_b64_tr_b16 v[44:45], v2 offset:40960
v_mfma_f32_16x16x32_bf16 v[132:135], v[60:63], v[244:247], v[132:135]
ds_read_b64_tr_b16 v[46:47], v2 offset:41472
v_exp_f32 v39, v39
v_mfma_f32_16x16x32_bf16 v[136:139], v[56:59], v[232:235], v[136:139]
ds_read_b64_tr_b16 v[48:49], v2 offset:34816
v_add_f32 v39, 1.0, v39
v_mfma_f32_16x16x32_bf16 v[136:139], v[60:63], v[248:251], v[136:139]
ds_read_b64_tr_b16 v[50:51], v2 offset:35328
v_mfma_f32_16x16x32_bf16 v[140:143], v[56:59], v[236:239], v[140:143]
ds_read_b64_tr_b16 v[52:53], v2 offset:43008
v_rcp_f32 v38, v38
v_mfma_f32_16x16x32_bf16 v[140:143], v[60:63], v[252:255], v[140:143]
ds_read_b64_tr_b16 v[54:55], v2 offset:43520
v_mul_f32 v222, v222, v38
v_mfma_f32_16x16x32_bf16 v[144:147], v[64:67], v[224:227], v[144:147]
buffer_load_dwordx4 v10, s[4:7], s32 offen offset:0 lds
v_mfma_f32_16x16x32_bf16 v[144:147], v[68:71], v[240:243], v[144:147]
v_rcp_f32 v39, v39
v_mfma_f32_16x16x32_bf16 v[148:151], v[64:67], v[228:231], v[148:151]
v_mul_f32 v223, v223, v39
v_cvt_pk_bf16_f32 v175, v222, v223
v_mfma_f32_16x16x32_bf16 v[148:151], v[68:71], v[244:247], v[148:151]
ds_write_b128 v14, v[172:175] offset:19456
v_mfma_f32_16x16x32_bf16 v[152:155], v[64:67], v[232:235], v[152:155]
buffer_load_dwordx4 v11, s[4:7], s32 offen offset:1024 lds
buffer_store_dwordx4 v[172:175], v16, s[20:23], s50 offen offset:3072 sc1
v_mfma_f32_16x16x32_bf16 v[152:155], v[68:71], v[248:251], v[152:155]
v_mfma_f32_16x16x32_bf16 v[156:159], v[64:67], v[236:239], v[156:159]
v_mfma_f32_16x16x32_bf16 v[156:159], v[68:71], v[252:255], v[156:159]
s_waitcnt lgkmcnt(0)
v_mfma_f32_16x16x32_bf16 v[160:163], v[40:43], a[0:3], 0
ds_read_b64_tr_b16 v[56:57], v3 offset:32768
v_mfma_f32_16x16x32_bf16 v[160:163], v[44:47], a[16:19], v[160:163]
ds_read_b64_tr_b16 v[58:59], v3 offset:33280
s_add_u32 s50, s44, 8388608
v_mfma_f32_16x16x32_bf16 v[164:167], v[40:43], a[4:7], 0
ds_read_b64_tr_b16 v[60:61], v3 offset:40960
v_mul_f32 v24, v96, v96
v_mfma_f32_16x16x32_bf16 v[164:167], v[44:47], a[20:23], v[164:167]
ds_read_b64_tr_b16 v[62:63], v3 offset:41472
v_mul_f32 v25, v97, v97
v_mfma_f32_16x16x32_bf16 v[168:171], v[40:43], a[8:11], 0
ds_read_b64_tr_b16 v[64:65], v3 offset:34816
v_fma_f32 v24, v24, s47, v18
v_mfma_f32_16x16x32_bf16 v[168:171], v[44:47], a[24:27], v[168:171]
ds_read_b64_tr_b16 v[66:67], v3 offset:35328
v_fma_f32 v25, v25, s47, v18
v_mul_f32 v24, v24, v96
v_mfma_f32_16x16x32_bf16 v[172:175], v[40:43], a[12:15], 0
ds_read_b64_tr_b16 v[68:69], v3 offset:43008
v_mul_f32 v25, v25, v97
v_mfma_f32_16x16x32_bf16 v[172:175], v[44:47], a[28:31], v[172:175]
ds_read_b64_tr_b16 v[70:71], v3 offset:43520
v_mul_f32 v112, v112, v96
v_mfma_f32_16x16x32_bf16 v[176:179], v[48:51], a[0:3], 0
buffer_load_dwordx4 v10, s[8:11], s32 offen offset:2048 lds
v_mfma_f32_16x16x32_bf16 v[176:179], v[52:55], a[16:19], v[176:179]
v_exp_f32 v24, v24
v_mul_f32 v113, v113, v97
v_mfma_f32_16x16x32_bf16 v[180:183], v[48:51], a[4:7], 0
v_exp_f32 v25, v25
v_mfma_f32_16x16x32_bf16 v[180:183], v[52:55], a[20:23], v[180:183]
v_add_f32 v24, 1.0, v24
v_add_f32 v25, 1.0, v25
v_mfma_f32_16x16x32_bf16 v[184:187], v[48:51], a[8:11], 0
buffer_load_dwordx4 v11, s[8:11], s32 offen offset:3072 lds
v_mfma_f32_16x16x32_bf16 v[184:187], v[52:55], a[24:27], v[184:187]
s_add_u32 m0, s37, 32768
v_rcp_f32 v24, v24
v_mfma_f32_16x16x32_bf16 v[188:191], v[48:51], a[12:15], 0
v_mul_f32 v112, v112, v24
s_waitcnt vmcnt(14) lgkmcnt(0)
v_mfma_f32_16x16x32_bf16 v[188:191], v[52:55], a[28:31], v[188:191]
s_barrier
v_mfma_f32_16x16x32_bf16 v[192:195], v[56:59], a[0:3], 0
ds_read_b64_tr_b16 v[40:41], v2 offset:49152
v_mul_f32 v26, v98, v98
v_mfma_f32_16x16x32_bf16 v[192:195], v[60:63], a[16:19], v[192:195]
ds_read_b64_tr_b16 v[42:43], v2 offset:49664
v_rcp_f32 v25, v25
v_mfma_f32_16x16x32_bf16 v[196:199], v[56:59], a[4:7], 0
ds_read_b64_tr_b16 v[44:45], v2 offset:57344
v_mul_f32 v113, v113, v25
v_mfma_f32_16x16x32_bf16 v[196:199], v[60:63], a[20:23], v[196:199]
ds_read_b64_tr_b16 v[46:47], v2 offset:57856
v_mul_f32 v27, v99, v99
v_mfma_f32_16x16x32_bf16 v[200:203], v[56:59], a[8:11], 0
ds_read_b64_tr_b16 v[48:49], v2 offset:51200
v_fma_f32 v26, v26, s47, v18
v_mfma_f32_16x16x32_bf16 v[200:203], v[60:63], a[24:27], v[200:203]
ds_read_b64_tr_b16 v[50:51], v2 offset:51712
v_fma_f32 v27, v27, s47, v18
v_mul_f32 v26, v26, v98
v_mfma_f32_16x16x32_bf16 v[204:207], v[56:59], a[12:15], 0
ds_read_b64_tr_b16 v[52:53], v2 offset:59392
v_mul_f32 v27, v27, v99
v_mfma_f32_16x16x32_bf16 v[204:207], v[60:63], a[28:31], v[204:207]
ds_read_b64_tr_b16 v[54:55], v2 offset:59904
v_mul_f32 v114, v114, v98
v_mfma_f32_16x16x32_bf16 v[208:211], v[64:67], a[0:3], 0
buffer_load_dwordx4 v10, s[4:7], s33 offen offset:0 lds
v_mfma_f32_16x16x32_bf16 v[208:211], v[68:71], a[16:19], v[208:211]
v_exp_f32 v26, v26
v_mul_f32 v115, v115, v99
v_mfma_f32_16x16x32_bf16 v[212:215], v[64:67], a[4:7], 0
v_exp_f32 v27, v27
v_mfma_f32_16x16x32_bf16 v[212:215], v[68:71], a[20:23], v[212:215]
v_add_f32 v26, 1.0, v26
v_add_f32 v27, 1.0, v27
v_mfma_f32_16x16x32_bf16 v[216:219], v[64:67], a[8:11], 0
buffer_load_dwordx4 v11, s[4:7], s33 offen offset:1024 lds
v_mfma_f32_16x16x32_bf16 v[216:219], v[68:71], a[24:27], v[216:219]
v_rcp_f32 v26, v26
v_cvt_pk_bf16_f32 v96, v112, v113
v_mfma_f32_16x16x32_bf16 v[220:223], v[64:67], a[12:15], 0
v_rcp_f32 v27, v27
v_mfma_f32_16x16x32_bf16 v[220:223], v[68:71], a[28:31], v[220:223]
v_mul_f32 v114, v114, v26
s_waitcnt lgkmcnt(0)
v_mfma_f32_16x16x32_bf16 v[160:163], v[40:43], a[32:35], v[160:163]
ds_read_b64_tr_b16 v[56:57], v3 offset:49152
v_mul_f32 v115, v115, v27
v_mfma_f32_16x16x32_bf16 v[160:163], v[44:47], a[48:51], v[160:163]
ds_read_b64_tr_b16 v[58:59], v3 offset:49664
v_cvt_pk_bf16_f32 v97, v114, v115
v_mfma_f32_16x16x32_bf16 v[164:167], v[40:43], a[36:39], v[164:167]
ds_read_b64_tr_b16 v[60:61], v3 offset:57344
v_mul_f32 v28, v128, v128
v_mul_f32 v29, v129, v129
v_mfma_f32_16x16x32_bf16 v[164:167], v[44:47], a[52:55], v[164:167]
ds_read_b64_tr_b16 v[62:63], v3 offset:57856
v_fma_f32 v28, v28, s47, v18
v_mfma_f32_16x16x32_bf16 v[168:171], v[40:43], a[40:43], v[168:171]
ds_read_b64_tr_b16 v[64:65], v3 offset:51200
v_fma_f32 v29, v29, s47, v18
v_mfma_f32_16x16x32_bf16 v[168:171], v[44:47], a[56:59], v[168:171]
ds_read_b64_tr_b16 v[66:67], v3 offset:51712
v_mul_f32 v28, v28, v128
v_mfma_f32_16x16x32_bf16 v[172:175], v[40:43], a[44:47], v[172:175]
ds_read_b64_tr_b16 v[68:69], v3 offset:59392
v_mul_f32 v29, v29, v129
v_mul_f32 v144, v144, v128
v_mfma_f32_16x16x32_bf16 v[172:175], v[44:47], a[60:63], v[172:175]
ds_read_b64_tr_b16 v[70:71], v3 offset:59904
v_mul_f32 v145, v145, v129
v_mfma_f32_16x16x32_bf16 v[176:179], v[48:51], a[32:35], v[176:179]
buffer_load_dwordx4 v10, s[8:11], s33 offen offset:2048 lds
v_mfma_f32_16x16x32_bf16 v[176:179], v[52:55], a[48:51], v[176:179]
v_exp_f32 v28, v28
v_mfma_f32_16x16x32_bf16 v[180:183], v[48:51], a[36:39], v[180:183]
v_exp_f32 v29, v29
v_add_f32 v28, 1.0, v28
v_mfma_f32_16x16x32_bf16 v[180:183], v[52:55], a[52:55], v[180:183]
v_add_f32 v29, 1.0, v29
v_mul_f32 v30, v130, v130
v_mfma_f32_16x16x32_bf16 v[184:187], v[48:51], a[40:43], v[184:187]
buffer_load_dwordx4 v11, s[8:11], s33 offen offset:3072 lds
v_mfma_f32_16x16x32_bf16 v[184:187], v[52:55], a[56:59], v[184:187]
s_add_u32 m0, s37, 49152
v_mul_f32 v31, v131, v131
v_mfma_f32_16x16x32_bf16 v[188:191], v[48:51], a[44:47], v[188:191]
v_rcp_f32 v28, v28
s_waitcnt vmcnt(13) lgkmcnt(0)
v_mfma_f32_16x16x32_bf16 v[188:191], v[52:55], a[60:63], v[188:191]
s_barrier
v_mfma_f32_16x16x32_bf16 v[192:195], v[56:59], a[32:35], v[192:195]
ds_read_b64_tr_b16 v[40:41], v4 offset:0
v_mul_f32 v144, v144, v28
v_mfma_f32_16x16x32_bf16 v[192:195], v[60:63], a[48:51], v[192:195]
ds_read_b64_tr_b16 v[42:43], v4 offset:512
v_fma_f32 v30, v30, s47, v18
v_mfma_f32_16x16x32_bf16 v[196:199], v[56:59], a[36:39], v[196:199]
ds_read_b64_tr_b16 v[44:45], v4 offset:8192
v_rcp_f32 v29, v29
v_mfma_f32_16x16x32_bf16 v[196:199], v[60:63], a[52:55], v[196:199]
ds_read_b64_tr_b16 v[46:47], v4 offset:8704
v_mul_f32 v145, v145, v29
v_mfma_f32_16x16x32_bf16 v[200:203], v[56:59], a[40:43], v[200:203]
ds_read_b64_tr_b16 v[48:49], v4 offset:2048
v_fma_f32 v31, v31, s47, v18
v_mfma_f32_16x16x32_bf16 v[200:203], v[60:63], a[56:59], v[200:203]
ds_read_b64_tr_b16 v[50:51], v4 offset:2560
v_mul_f32 v30, v30, v130
v_mfma_f32_16x16x32_bf16 v[204:207], v[56:59], a[44:47], v[204:207]
ds_read_b64_tr_b16 v[52:53], v4 offset:10240
v_mul_f32 v31, v31, v131
v_mul_f32 v146, v146, v130
v_mfma_f32_16x16x32_bf16 v[204:207], v[60:63], a[60:63], v[204:207]
ds_read_b64_tr_b16 v[54:55], v4 offset:10752
v_mul_f32 v147, v147, v131
v_mfma_f32_16x16x32_bf16 v[208:211], v[64:67], a[32:35], v[208:211]
buffer_load_dwordx4 v10, s[4:7], s34 offen offset:0 lds
v_mfma_f32_16x16x32_bf16 v[208:211], v[68:71], a[48:51], v[208:211]
v_exp_f32 v30, v30
v_mfma_f32_16x16x32_bf16 v[212:215], v[64:67], a[36:39], v[212:215]
v_exp_f32 v31, v31
v_mfma_f32_16x16x32_bf16 v[212:215], v[68:71], a[52:55], v[212:215]
v_add_f32 v30, 1.0, v30
v_add_f32 v31, 1.0, v31
v_cvt_pk_bf16_f32 v98, v144, v145
v_mfma_f32_16x16x32_bf16 v[216:219], v[64:67], a[40:43], v[216:219]
buffer_load_dwordx4 v11, s[4:7], s34 offen offset:1024 lds
v_mfma_f32_16x16x32_bf16 v[216:219], v[68:71], a[56:59], v[216:219]
v_rcp_f32 v30, v30
v_mfma_f32_16x16x32_bf16 v[220:223], v[64:67], a[44:47], v[220:223]
v_rcp_f32 v31, v31
v_mfma_f32_16x16x32_bf16 v[220:223], v[68:71], a[60:63], v[220:223]
v_mul_f32 v146, v146, v30
v_mul_f32 v147, v147, v31
s_waitcnt lgkmcnt(0)
v_mfma_f32_16x16x32_bf16 v[160:163], v[40:43], a[64:67], v[160:163]
ds_read_b64_tr_b16 v[56:57], v5 offset:0
v_cvt_pk_bf16_f32 v99, v146, v147
v_mfma_f32_16x16x32_bf16 v[160:163], v[44:47], a[80:83], v[160:163]
ds_read_b64_tr_b16 v[58:59], v5 offset:512
v_mul_f32 v32, v100, v100
v_mfma_f32_16x16x32_bf16 v[164:167], v[40:43], a[68:71], v[164:167]
ds_read_b64_tr_b16 v[60:61], v5 offset:8192
v_mul_f32 v33, v101, v101
v_mfma_f32_16x16x32_bf16 v[164:167], v[44:47], a[84:87], v[164:167]
ds_read_b64_tr_b16 v[62:63], v5 offset:8704
v_fma_f32 v32, v32, s47, v18
v_fma_f32 v33, v33, s47, v18
v_mfma_f32_16x16x32_bf16 v[168:171], v[40:43], a[72:75], v[168:171]
ds_read_b64_tr_b16 v[64:65], v5 offset:2048
v_mul_f32 v32, v32, v100
v_mfma_f32_16x16x32_bf16 v[168:171], v[44:47], a[88:91], v[168:171]
ds_read_b64_tr_b16 v[66:67], v5 offset:2560
v_mul_f32 v33, v33, v101
v_mfma_f32_16x16x32_bf16 v[172:175], v[40:43], a[76:79], v[172:175]
ds_read_b64_tr_b16 v[68:69], v5 offset:10240
v_mul_f32 v116, v116, v100
v_mfma_f32_16x16x32_bf16 v[172:175], v[44:47], a[92:95], v[172:175]
ds_read_b64_tr_b16 v[70:71], v5 offset:10752
v_exp_f32 v32, v32
v_mfma_f32_16x16x32_bf16 v[176:179], v[48:51], a[64:67], v[176:179]
buffer_load_dwordx4 v10, s[8:11], s34 offen offset:2048 lds
v_mfma_f32_16x16x32_bf16 v[176:179], v[52:55], a[80:83], v[176:179]
ds_write_b128 v14, v[96:99] offset:32768
v_mfma_f32_16x16x32_bf16 v[180:183], v[48:51], a[68:71], v[180:183]
buffer_store_dwordx4 v[96:99], v16, s[20:23], s50 offen offset:0 sc1
v_mfma_f32_16x16x32_bf16 v[180:183], v[52:55], a[84:87], v[180:183]
v_exp_f32 v33, v33
v_mfma_f32_16x16x32_bf16 v[184:187], v[48:51], a[72:75], v[184:187]
buffer_load_dwordx4 v11, s[8:11], s34 offen offset:3072 lds
v_mfma_f32_16x16x32_bf16 v[184:187], v[52:55], a[88:91], v[184:187]
s_add_u32 m0, s37, 65536
v_mul_f32 v117, v117, v101
v_add_f32 v32, 1.0, v32
v_mfma_f32_16x16x32_bf16 v[188:191], v[48:51], a[76:79], v[188:191]
v_add_f32 v33, 1.0, v33
s_waitcnt vmcnt(14) lgkmcnt(0)
v_mfma_f32_16x16x32_bf16 v[188:191], v[52:55], a[92:95], v[188:191]
s_barrier
v_mfma_f32_16x16x32_bf16 v[192:195], v[56:59], a[64:67], v[192:195]
ds_read_b64_tr_b16 v[40:41], v2 offset:0
s_lshl2_add_u32 s58, s39, s38
v_mfma_f32_16x16x32_bf16 v[192:195], v[60:63], a[80:83], v[192:195]
ds_read_b64_tr_b16 v[42:43], v2 offset:512
s_mul_i32 s58, s58, 10368
v_mfma_f32_16x16x32_bf16 v[196:199], v[56:59], a[68:71], v[196:199]
ds_read_b64_tr_b16 v[44:45], v2 offset:8192
v_mul_u32_u24 v74, 52, v1
v_mfma_f32_16x16x32_bf16 v[196:199], v[60:63], a[84:87], v[196:199]
ds_read_b64_tr_b16 v[46:47], v2 offset:8704
v_lshrrev_b32 v74, 8, v74
v_mfma_f32_16x16x32_bf16 v[200:203], v[56:59], a[72:75], v[200:203]
ds_read_b64_tr_b16 v[48:49], v2 offset:2048
v_mul_u32_u24 v74, 512, v74
v_mfma_f32_16x16x32_bf16 v[200:203], v[60:63], a[88:91], v[200:203]
ds_read_b64_tr_b16 v[50:51], v2 offset:2560
v_lshl_add_u32 v74, v1, 7, v74
v_mfma_f32_16x16x32_bf16 v[204:207], v[56:59], a[76:79], v[204:207]
ds_read_b64_tr_b16 v[52:53], v2 offset:10240
v_add_u32 v75, 19, v1
v_mfma_f32_16x16x32_bf16 v[204:207], v[60:63], a[92:95], v[204:207]
ds_read_b64_tr_b16 v[54:55], v2 offset:10752
v_and_b32 v75, 64, v75
v_mfma_f32_16x16x32_bf16 v[208:211], v[64:67], a[64:67], v[208:211]
buffer_load_dwordx4 v10, s[4:7], s35 offen offset:0 lds
v_mfma_f32_16x16x32_bf16 v[208:211], v[68:71], a[80:83], v[208:211]
v_lshl_add_u32 v74, v75, 22, v74
v_add_u32 v74, s58, v74
v_mfma_f32_16x16x32_bf16 v[212:215], v[64:67], a[68:71], v[212:215]
v_rcp_f32 v32, v32
v_rcp_f32 v33, v33
v_mul_f32 v34, v102, v102
v_mfma_f32_16x16x32_bf16 v[212:215], v[68:71], a[84:87], v[212:215]
v_mul_f32 v116, v116, v32
v_mul_f32 v117, v117, v33
v_mfma_f32_16x16x32_bf16 v[216:219], v[64:67], a[72:75], v[216:219]
buffer_load_dwordx4 v11, s[4:7], s35 offen offset:1024 lds
v_mfma_f32_16x16x32_bf16 v[216:219], v[68:71], a[88:91], v[216:219]
v_mul_f32 v35, v103, v103
v_fma_f32 v34, v34, s47, v18
v_fma_f32 v35, v35, s47, v18
v_mfma_f32_16x16x32_bf16 v[220:223], v[64:67], a[76:79], v[220:223]
v_mul_f32 v34, v34, v102
v_mul_f32 v35, v35, v103
v_mfma_f32_16x16x32_bf16 v[220:223], v[68:71], a[92:95], v[220:223]
v_mul_f32 v118, v118, v102
s_waitcnt lgkmcnt(0)
v_mfma_f32_16x16x32_bf16 v[160:163], v[40:43], a[96:99], v[160:163]
ds_read_b64_tr_b16 v[56:57], v3 offset:0
v_mul_f32 v119, v119, v103
v_mfma_f32_16x16x32_bf16 v[160:163], v[44:47], a[112:115], v[160:163]
ds_read_b64_tr_b16 v[58:59], v3 offset:512
v_exp_f32 v34, v34
v_mfma_f32_16x16x32_bf16 v[164:167], v[40:43], a[100:103], v[164:167]
ds_read_b64_tr_b16 v[60:61], v3 offset:8192
v_add_f32 v34, 1.0, v34
v_mfma_f32_16x16x32_bf16 v[164:167], v[44:47], a[116:119], v[164:167]
ds_read_b64_tr_b16 v[62:63], v3 offset:8704
v_cvt_pk_bf16_f32 v100, v116, v117
v_mfma_f32_16x16x32_bf16 v[168:171], v[40:43], a[104:107], v[168:171]
ds_read_b64_tr_b16 v[64:65], v3 offset:2048
v_mul_f32 v36, v132, v132
v_mfma_f32_16x16x32_bf16 v[168:171], v[44:47], a[120:123], v[168:171]
ds_read_b64_tr_b16 v[66:67], v3 offset:2560
v_exp_f32 v35, v35
v_mfma_f32_16x16x32_bf16 v[172:175], v[40:43], a[108:111], v[172:175]
ds_read_b64_tr_b16 v[68:69], v3 offset:10240
v_add_f32 v35, 1.0, v35
v_mfma_f32_16x16x32_bf16 v[172:175], v[44:47], a[124:127], v[172:175]
ds_read_b64_tr_b16 v[70:71], v3 offset:10752
v_mul_f32 v37, v133, v133
v_mfma_f32_16x16x32_bf16 v[176:179], v[48:51], a[96:99], v[176:179]
buffer_load_dwordx4 v10, s[8:11], s35 offen offset:2048 lds
v_mfma_f32_16x16x32_bf16 v[176:179], v[52:55], a[112:115], v[176:179]
v_rcp_f32 v34, v34
v_fma_f32 v36, v36, s47, v18
v_mfma_f32_16x16x32_bf16 v[180:183], v[48:51], a[100:103], v[180:183]
v_rcp_f32 v35, v35
v_mfma_f32_16x16x32_bf16 v[180:183], v[52:55], a[116:119], v[180:183]
v_mul_f32 v118, v118, v34
v_mul_f32 v119, v119, v35
v_mfma_f32_16x16x32_bf16 v[184:187], v[48:51], a[104:107], v[184:187]
buffer_load_dwordx4 v11, s[8:11], s35 offen offset:3072 lds
v_mfma_f32_16x16x32_bf16 v[184:187], v[52:55], a[120:123], v[184:187]
buffer_load_dword v77, v74, s[16:19], 0 offen offset:2048
v_mfma_f32_16x16x32_bf16 v[188:191], v[48:51], a[108:111], v[188:191]
s_add_u32 m0, s37, 0
s_waitcnt vmcnt(14) lgkmcnt(0)
v_mfma_f32_16x16x32_bf16 v[188:191], v[52:55], a[124:127], v[188:191]
s_barrier
v_mfma_f32_16x16x32_bf16 v[192:195], v[56:59], a[96:99], v[192:195]
ds_read_b64_tr_b16 v[40:41], v2 offset:16384
v_cvt_pk_bf16_f32 v101, v118, v119
v_fma_f32 v37, v37, s47, v18
v_mfma_f32_16x16x32_bf16 v[192:195], v[60:63], a[112:115], v[192:195]
ds_read_b64_tr_b16 v[42:43], v2 offset:16896
v_mul_f32 v36, v36, v132
v_mfma_f32_16x16x32_bf16 v[196:199], v[56:59], a[100:103], v[196:199]
ds_read_b64_tr_b16 v[44:45], v2 offset:24576
v_mul_f32 v37, v37, v133
v_mul_f32 v148, v148, v132
v_mfma_f32_16x16x32_bf16 v[196:199], v[60:63], a[116:119], v[196:199]
ds_read_b64_tr_b16 v[46:47], v2 offset:25088
v_mul_f32 v149, v149, v133
v_mfma_f32_16x16x32_bf16 v[200:203], v[56:59], a[104:107], v[200:203]
ds_read_b64_tr_b16 v[48:49], v2 offset:18432
v_mul_f32 v38, v134, v134
v_mfma_f32_16x16x32_bf16 v[200:203], v[60:63], a[120:123], v[200:203]
ds_read_b64_tr_b16 v[50:51], v2 offset:18944
v_mul_f32 v39, v135, v135
v_mfma_f32_16x16x32_bf16 v[204:207], v[56:59], a[108:111], v[204:207]
ds_read_b64_tr_b16 v[52:53], v2 offset:26624
v_exp_f32 v36, v36
v_mfma_f32_16x16x32_bf16 v[204:207], v[60:63], a[124:127], v[204:207]
ds_read_b64_tr_b16 v[54:55], v2 offset:27136
v_add_f32 v36, 1.0, v36
v_mfma_f32_16x16x32_bf16 v[208:211], v[64:67], a[96:99], v[208:211]
buffer_load_dwordx4 v10, s[4:7], s36 offen offset:0 lds
v_mfma_f32_16x16x32_bf16 v[208:211], v[68:71], a[112:115], v[208:211]
v_exp_f32 v37, v37
v_mfma_f32_16x16x32_bf16 v[212:215], v[64:67], a[100:103], v[212:215]
v_add_f32 v37, 1.0, v37
v_fma_f32 v38, v38, s47, v18
v_mfma_f32_16x16x32_bf16 v[212:215], v[68:71], a[116:119], v[212:215]
v_rcp_f32 v36, v36
v_fma_f32 v39, v39, s47, v18
v_mfma_f32_16x16x32_bf16 v[216:219], v[64:67], a[104:107], v[216:219]
buffer_load_dwordx4 v11, s[4:7], s36 offen offset:1024 lds
v_mfma_f32_16x16x32_bf16 v[216:219], v[68:71], a[120:123], v[216:219]
v_rcp_f32 v37, v37
v_mfma_f32_16x16x32_bf16 v[220:223], v[64:67], a[108:111], v[220:223]
v_mul_f32 v148, v148, v36
v_mul_f32 v149, v149, v37
v_mfma_f32_16x16x32_bf16 v[220:223], v[68:71], a[124:127], v[220:223]
v_mul_f32 v38, v38, v134
v_mul_f32 v39, v39, v135
s_waitcnt lgkmcnt(0)
v_mfma_f32_16x16x32_bf16 v[160:163], v[40:43], a[128:131], v[160:163]
ds_read_b64_tr_b16 v[56:57], v3 offset:16384
v_mul_f32 v150, v150, v134
v_mfma_f32_16x16x32_bf16 v[160:163], v[44:47], a[144:147], v[160:163]
ds_read_b64_tr_b16 v[58:59], v3 offset:16896
v_mul_f32 v151, v151, v135
v_mfma_f32_16x16x32_bf16 v[164:167], v[40:43], a[132:135], v[164:167]
ds_read_b64_tr_b16 v[60:61], v3 offset:24576
v_cvt_pk_bf16_f32 v102, v148, v149
v_mfma_f32_16x16x32_bf16 v[164:167], v[44:47], a[148:151], v[164:167]
ds_read_b64_tr_b16 v[62:63], v3 offset:25088
v_mul_f32 v24, v104, v104
v_mfma_f32_16x16x32_bf16 v[168:171], v[40:43], a[136:139], v[168:171]
ds_read_b64_tr_b16 v[64:65], v3 offset:18432
v_exp_f32 v38, v38
v_mfma_f32_16x16x32_bf16 v[168:171], v[44:47], a[152:155], v[168:171]
ds_read_b64_tr_b16 v[66:67], v3 offset:18944
v_add_f32 v38, 1.0, v38
v_mfma_f32_16x16x32_bf16 v[172:175], v[40:43], a[140:143], v[172:175]
ds_read_b64_tr_b16 v[68:69], v3 offset:26624
v_mul_f32 v25, v105, v105
v_mfma_f32_16x16x32_bf16 v[172:175], v[44:47], a[156:159], v[172:175]
ds_read_b64_tr_b16 v[70:71], v3 offset:27136
v_fma_f32 v24, v24, s47, v18
v_mfma_f32_16x16x32_bf16 v[176:179], v[48:51], a[128:131], v[176:179]
buffer_load_dwordx4 v10, s[8:11], s36 offen offset:2048 lds
v_mfma_f32_16x16x32_bf16 v[176:179], v[52:55], a[144:147], v[176:179]
v_exp_f32 v39, v39
v_fma_f32 v25, v25, s47, v18
v_mfma_f32_16x16x32_bf16 v[180:183], v[48:51], a[132:135], v[180:183]
v_add_f32 v39, 1.0, v39
v_mul_f32 v24, v24, v104
v_mfma_f32_16x16x32_bf16 v[180:183], v[52:55], a[148:151], v[180:183]
v_rcp_f32 v38, v38
v_mfma_f32_16x16x32_bf16 v[184:187], v[48:51], a[136:139], v[184:187]
buffer_load_dwordx4 v11, s[8:11], s36 offen offset:3072 lds
v_mfma_f32_16x16x32_bf16 v[184:187], v[52:55], a[152:155], v[184:187]
v_add_u32 v10, 128, v10
v_add_u32 v11, 128, v11
v_mfma_f32_16x16x32_bf16 v[188:191], v[48:51], a[140:143], v[188:191]
s_add_u32 m0, s37, 16384
s_waitcnt vmcnt(14) lgkmcnt(0)
v_mfma_f32_16x16x32_bf16 v[188:191], v[52:55], a[156:159], v[188:191]
s_barrier
v_mfma_f32_16x16x32_bf16 v[192:195], v[56:59], a[128:131], v[192:195]
ds_read_b64_tr_b16 v[40:41], v2 offset:32768
v_rcp_f32 v39, v39
v_mfma_f32_16x16x32_bf16 v[192:195], v[60:63], a[144:147], v[192:195]
ds_read_b64_tr_b16 v[42:43], v2 offset:33280
v_mul_f32 v150, v150, v38
v_mul_f32 v151, v151, v39
v_mfma_f32_16x16x32_bf16 v[196:199], v[56:59], a[132:135], v[196:199]
ds_read_b64_tr_b16 v[44:45], v2 offset:40960
v_cvt_pk_bf16_f32 v103, v150, v151
v_mfma_f32_16x16x32_bf16 v[196:199], v[60:63], a[148:151], v[196:199]
ds_read_b64_tr_b16 v[46:47], v2 offset:41472
v_mul_f32 v25, v25, v105
v_mfma_f32_16x16x32_bf16 v[200:203], v[56:59], a[136:139], v[200:203]
ds_read_b64_tr_b16 v[48:49], v2 offset:34816
v_mul_f32 v120, v120, v104
v_mfma_f32_16x16x32_bf16 v[200:203], v[60:63], a[152:155], v[200:203]
ds_read_b64_tr_b16 v[50:51], v2 offset:35328
v_mul_f32 v121, v121, v105
v_mfma_f32_16x16x32_bf16 v[204:207], v[56:59], a[140:143], v[204:207]
ds_read_b64_tr_b16 v[52:53], v2 offset:43008
v_exp_f32 v24, v24
v_mfma_f32_16x16x32_bf16 v[204:207], v[60:63], a[156:159], v[204:207]
ds_read_b64_tr_b16 v[54:55], v2 offset:43520
v_add_f32 v24, 1.0, v24
v_mfma_f32_16x16x32_bf16 v[208:211], v[64:67], a[128:131], v[208:211]
buffer_load_dwordx4 v10, s[4:7], s28 offen offset:0 lds
v_mfma_f32_16x16x32_bf16 v[208:211], v[68:71], a[144:147], v[208:211]
ds_write_b128 v14, v[100:103] offset:33792
v_mfma_f32_16x16x32_bf16 v[212:215], v[64:67], a[132:135], v[212:215]
buffer_store_dwordx4 v[100:103], v16, s[20:23], s50 offen offset:1024 sc1
v_mfma_f32_16x16x32_bf16 v[212:215], v[68:71], a[148:151], v[212:215]
v_exp_f32 v25, v25
v_mul_f32 v26, v106, v106
v_mfma_f32_16x16x32_bf16 v[216:219], v[64:67], a[136:139], v[216:219]
buffer_load_dwordx4 v11, s[4:7], s28 offen offset:1024 lds
v_mfma_f32_16x16x32_bf16 v[216:219], v[68:71], a[152:155], v[216:219]
v_add_f32 v25, 1.0, v25
v_mul_f32 v27, v107, v107
v_mfma_f32_16x16x32_bf16 v[220:223], v[64:67], a[140:143], v[220:223]
v_rcp_f32 v24, v24
v_mfma_f32_16x16x32_bf16 v[220:223], v[68:71], a[156:159], v[220:223]
v_rcp_f32 v25, v25
s_waitcnt lgkmcnt(0)
v_mfma_f32_16x16x32_bf16 v[160:163], v[40:43], a[160:163], v[160:163]
ds_read_b64_tr_b16 v[56:57], v3 offset:32768
v_mul_f32 v120, v120, v24
v_mfma_f32_16x16x32_bf16 v[160:163], v[44:47], a[176:179], v[160:163]
ds_read_b64_tr_b16 v[58:59], v3 offset:33280
v_mul_f32 v121, v121, v25
v_mfma_f32_16x16x32_bf16 v[164:167], v[40:43], a[164:167], v[164:167]
ds_read_b64_tr_b16 v[60:61], v3 offset:40960
v_fma_f32 v26, v26, s47, v18
v_mfma_f32_16x16x32_bf16 v[164:167], v[44:47], a[180:183], v[164:167]
ds_read_b64_tr_b16 v[62:63], v3 offset:41472
v_fma_f32 v27, v27, s47, v18
v_mul_f32 v26, v26, v106
v_mfma_f32_16x16x32_bf16 v[168:171], v[40:43], a[168:171], v[168:171]
ds_read_b64_tr_b16 v[64:65], v3 offset:34816
v_mul_f32 v27, v27, v107
v_mfma_f32_16x16x32_bf16 v[168:171], v[44:47], a[184:187], v[168:171]
ds_read_b64_tr_b16 v[66:67], v3 offset:35328
v_mul_f32 v122, v122, v106
v_mfma_f32_16x16x32_bf16 v[172:175], v[40:43], a[172:175], v[172:175]
ds_read_b64_tr_b16 v[68:69], v3 offset:43008
v_mul_f32 v123, v123, v107
v_mfma_f32_16x16x32_bf16 v[172:175], v[44:47], a[188:191], v[172:175]
ds_read_b64_tr_b16 v[70:71], v3 offset:43520
v_cvt_pk_bf16_f32 v104, v120, v121
v_mfma_f32_16x16x32_bf16 v[176:179], v[48:51], a[160:163], v[176:179]
buffer_load_dwordx4 v10, s[8:11], s28 offen offset:2048 lds
v_mfma_f32_16x16x32_bf16 v[176:179], v[52:55], a[176:179], v[176:179]
v_exp_f32 v26, v26
v_mul_f32 v28, v136, v136
v_mfma_f32_16x16x32_bf16 v[180:183], v[48:51], a[164:167], v[180:183]
v_exp_f32 v27, v27
v_mfma_f32_16x16x32_bf16 v[180:183], v[52:55], a[180:183], v[180:183]
v_add_f32 v26, 1.0, v26
v_add_f32 v27, 1.0, v27
v_mfma_f32_16x16x32_bf16 v[184:187], v[48:51], a[168:171], v[184:187]
buffer_load_dwordx4 v11, s[8:11], s28 offen offset:3072 lds
v_mfma_f32_16x16x32_bf16 v[184:187], v[52:55], a[184:187], v[184:187]
s_add_u32 m0, s37, 32768
v_rcp_f32 v26, v26
v_mfma_f32_16x16x32_bf16 v[188:191], v[48:51], a[172:175], v[188:191]
v_mul_f32 v122, v122, v26
s_waitcnt vmcnt(14) lgkmcnt(0)
v_mfma_f32_16x16x32_bf16 v[188:191], v[52:55], a[188:191], v[188:191]
s_barrier
v_mfma_f32_16x16x32_bf16 v[192:195], v[56:59], a[160:163], v[192:195]
ds_read_b64_tr_b16 v[40:41], v2 offset:49152
v_mul_f32 v29, v137, v137
v_mfma_f32_16x16x32_bf16 v[192:195], v[60:63], a[176:179], v[192:195]
ds_read_b64_tr_b16 v[42:43], v2 offset:49664
v_rcp_f32 v27, v27
v_mfma_f32_16x16x32_bf16 v[196:199], v[56:59], a[164:167], v[196:199]
ds_read_b64_tr_b16 v[44:45], v2 offset:57344
v_mul_f32 v123, v123, v27
v_mfma_f32_16x16x32_bf16 v[196:199], v[60:63], a[180:183], v[196:199]
ds_read_b64_tr_b16 v[46:47], v2 offset:57856
v_cvt_pk_bf16_f32 v105, v122, v123
v_mfma_f32_16x16x32_bf16 v[200:203], v[56:59], a[168:171], v[200:203]
ds_read_b64_tr_b16 v[48:49], v2 offset:51200
v_fma_f32 v28, v28, s47, v18
v_mfma_f32_16x16x32_bf16 v[200:203], v[60:63], a[184:187], v[200:203]
ds_read_b64_tr_b16 v[50:51], v2 offset:51712
v_fma_f32 v29, v29, s47, v18
v_mfma_f32_16x16x32_bf16 v[204:207], v[56:59], a[172:175], v[204:207]
ds_read_b64_tr_b16 v[52:53], v2 offset:59392
v_mul_f32 v28, v28, v136
v_mul_f32 v29, v29, v137
v_mfma_f32_16x16x32_bf16 v[204:207], v[60:63], a[188:191], v[204:207]
ds_read_b64_tr_b16 v[54:55], v2 offset:59904
v_mul_f32 v152, v152, v136
v_mfma_f32_16x16x32_bf16 v[208:211], v[64:67], a[160:163], v[208:211]
buffer_load_dwordx4 v10, s[4:7], s29 offen offset:0 lds
v_mfma_f32_16x16x32_bf16 v[208:211], v[68:71], a[176:179], v[208:211]
v_exp_f32 v28, v28
v_mfma_f32_16x16x32_bf16 v[212:215], v[64:67], a[164:167], v[212:215]
v_exp_f32 v29, v29
v_mul_f32 v153, v153, v137
v_mfma_f32_16x16x32_bf16 v[212:215], v[68:71], a[180:183], v[212:215]
v_add_f32 v28, 1.0, v28
v_add_f32 v29, 1.0, v29
v_mfma_f32_16x16x32_bf16 v[216:219], v[64:67], a[168:171], v[216:219]
buffer_load_dwordx4 v11, s[4:7], s29 offen offset:1024 lds
v_mfma_f32_16x16x32_bf16 v[216:219], v[68:71], a[184:187], v[216:219]
v_rcp_f32 v28, v28
v_mfma_f32_16x16x32_bf16 v[220:223], v[64:67], a[172:175], v[220:223]
v_rcp_f32 v29, v29
v_mfma_f32_16x16x32_bf16 v[220:223], v[68:71], a[188:191], v[220:223]
v_mul_f32 v152, v152, v28
v_mul_f32 v153, v153, v29
s_waitcnt lgkmcnt(0)
v_mfma_f32_16x16x32_bf16 v[160:163], v[40:43], a[192:195], v[160:163]
ds_read_b64_tr_b16 v[56:57], v3 offset:49152
v_mul_f32 v30, v138, v138
v_mfma_f32_16x16x32_bf16 v[160:163], v[44:47], a[208:211], v[160:163]
ds_read_b64_tr_b16 v[58:59], v3 offset:49664
v_mul_f32 v31, v139, v139
v_mfma_f32_16x16x32_bf16 v[164:167], v[40:43], a[196:199], v[164:167]
ds_read_b64_tr_b16 v[60:61], v3 offset:57344
v_fma_f32 v30, v30, s47, v18
v_mfma_f32_16x16x32_bf16 v[164:167], v[44:47], a[212:215], v[164:167]
ds_read_b64_tr_b16 v[62:63], v3 offset:57856
v_fma_f32 v31, v31, s47, v18
v_mfma_f32_16x16x32_bf16 v[168:171], v[40:43], a[200:203], v[168:171]
ds_read_b64_tr_b16 v[64:65], v3 offset:51200
v_mul_f32 v30, v30, v138
v_mul_f32 v31, v31, v139
v_mfma_f32_16x16x32_bf16 v[168:171], v[44:47], a[216:219], v[168:171]
ds_read_b64_tr_b16 v[66:67], v3 offset:51712
v_mul_f32 v154, v154, v138
v_mfma_f32_16x16x32_bf16 v[172:175], v[40:43], a[204:207], v[172:175]
ds_read_b64_tr_b16 v[68:69], v3 offset:59392
v_mul_f32 v155, v155, v139
v_mfma_f32_16x16x32_bf16 v[172:175], v[44:47], a[220:223], v[172:175]
ds_read_b64_tr_b16 v[70:71], v3 offset:59904
v_cvt_pk_bf16_f32 v106, v152, v153
v_mfma_f32_16x16x32_bf16 v[176:179], v[48:51], a[192:195], v[176:179]
buffer_load_dwordx4 v10, s[8:11], s29 offen offset:2048 lds
v_mfma_f32_16x16x32_bf16 v[176:179], v[52:55], a[208:211], v[176:179]
v_exp_f32 v30, v30
v_mul_f32 v32, v108, v108
v_mfma_f32_16x16x32_bf16 v[180:183], v[48:51], a[196:199], v[180:183]
v_exp_f32 v31, v31
v_mfma_f32_16x16x32_bf16 v[180:183], v[52:55], a[212:215], v[180:183]
v_add_f32 v30, 1.0, v30
v_add_f32 v31, 1.0, v31
v_mfma_f32_16x16x32_bf16 v[184:187], v[48:51], a[200:203], v[184:187]
buffer_load_dwordx4 v11, s[8:11], s29 offen offset:3072 lds
v_mfma_f32_16x16x32_bf16 v[184:187], v[52:55], a[216:219], v[184:187]
s_add_u32 m0, s37, 49152
v_mul_f32 v33, v109, v109
v_mfma_f32_16x16x32_bf16 v[188:191], v[48:51], a[204:207], v[188:191]
v_rcp_f32 v30, v30
s_waitcnt vmcnt(14) lgkmcnt(0)
v_mfma_f32_16x16x32_bf16 v[188:191], v[52:55], a[220:223], v[188:191]
s_barrier
v_mfma_f32_16x16x32_bf16 v[192:195], v[56:59], a[192:195], v[192:195]
ds_read_b64_tr_b16 v[40:41], v4 offset:0
v_mul_f32 v154, v154, v30
v_mfma_f32_16x16x32_bf16 v[192:195], v[60:63], a[208:211], v[192:195]
ds_read_b64_tr_b16 v[42:43], v4 offset:512
v_fma_f32 v32, v32, s47, v18
v_mfma_f32_16x16x32_bf16 v[196:199], v[56:59], a[196:199], v[196:199]
ds_read_b64_tr_b16 v[44:45], v4 offset:8192
v_fma_f32 v33, v33, s47, v18
v_mfma_f32_16x16x32_bf16 v[196:199], v[60:63], a[212:215], v[196:199]
ds_read_b64_tr_b16 v[46:47], v4 offset:8704
v_rcp_f32 v31, v31
v_mfma_f32_16x16x32_bf16 v[200:203], v[56:59], a[200:203], v[200:203]
ds_read_b64_tr_b16 v[48:49], v4 offset:2048
v_mul_f32 v155, v155, v31
v_mfma_f32_16x16x32_bf16 v[200:203], v[60:63], a[216:219], v[200:203]
ds_read_b64_tr_b16 v[50:51], v4 offset:2560
v_cvt_pk_bf16_f32 v107, v154, v155
v_mfma_f32_16x16x32_bf16 v[204:207], v[56:59], a[204:207], v[204:207]
ds_read_b64_tr_b16 v[52:53], v4 offset:10240
v_mul_f32 v32, v32, v108
v_mfma_f32_16x16x32_bf16 v[204:207], v[60:63], a[220:223], v[204:207]
ds_read_b64_tr_b16 v[54:55], v4 offset:10752
v_mul_f32 v33, v33, v109
v_mfma_f32_16x16x32_bf16 v[208:211], v[64:67], a[192:195], v[208:211]
buffer_load_dwordx4 v10, s[4:7], s30 offen offset:0 lds
v_mfma_f32_16x16x32_bf16 v[208:211], v[68:71], a[208:211], v[208:211]
ds_write_b128 v14, v[104:107] offset:34816
v_mul_f32 v124, v124, v108
v_mfma_f32_16x16x32_bf16 v[212:215], v[64:67], a[196:199], v[212:215]
buffer_store_dwordx4 v[104:107], v16, s[20:23], s50 offen offset:2048 sc1
v_mfma_f32_16x16x32_bf16 v[212:215], v[68:71], a[212:215], v[212:215]
v_exp_f32 v32, v32
v_mfma_f32_16x16x32_bf16 v[216:219], v[64:67], a[200:203], v[216:219]
buffer_load_dwordx4 v11, s[4:7], s30 offen offset:1024 lds
v_mfma_f32_16x16x32_bf16 v[216:219], v[68:71], a[216:219], v[216:219]
v_exp_f32 v33, v33
v_mul_f32 v125, v125, v109
v_mfma_f32_16x16x32_bf16 v[220:223], v[64:67], a[204:207], v[220:223]
v_add_f32 v32, 1.0, v32
v_add_f32 v33, 1.0, v33
v_mfma_f32_16x16x32_bf16 v[220:223], v[68:71], a[220:223], v[220:223]
v_mul_f32 v34, v110, v110
s_waitcnt lgkmcnt(0)
v_mfma_f32_16x16x32_bf16 v[160:163], v[40:43], a[224:227], v[160:163]
ds_read_b64_tr_b16 v[56:57], v5 offset:0
v_mul_f32 v35, v111, v111
v_mfma_f32_16x16x32_bf16 v[160:163], v[44:47], a[240:243], v[160:163]
ds_read_b64_tr_b16 v[58:59], v5 offset:512
v_fma_f32 v34, v34, s47, v18
v_mfma_f32_16x16x32_bf16 v[164:167], v[40:43], a[228:231], v[164:167]
ds_read_b64_tr_b16 v[60:61], v5 offset:8192
v_rcp_f32 v32, v32
v_mfma_f32_16x16x32_bf16 v[164:167], v[44:47], a[244:247], v[164:167]
ds_read_b64_tr_b16 v[62:63], v5 offset:8704
v_mul_f32 v124, v124, v32
v_mfma_f32_16x16x32_bf16 v[168:171], v[40:43], a[232:235], v[168:171]
ds_read_b64_tr_b16 v[64:65], v5 offset:2048
v_fma_f32 v35, v35, s47, v18
v_mfma_f32_16x16x32_bf16 v[168:171], v[44:47], a[248:251], v[168:171]
ds_read_b64_tr_b16 v[66:67], v5 offset:2560
v_mul_f32 v34, v34, v110
v_mfma_f32_16x16x32_bf16 v[172:175], v[40:43], a[236:239], v[172:175]
ds_read_b64_tr_b16 v[68:69], v5 offset:10240
v_mul_f32 v35, v35, v111
v_mfma_f32_16x16x32_bf16 v[172:175], v[44:47], a[252:255], v[172:175]
ds_read_b64_tr_b16 v[70:71], v5 offset:10752
v_rcp_f32 v33, v33
v_mfma_f32_16x16x32_bf16 v[176:179], v[48:51], a[224:227], v[176:179]
buffer_load_dwordx4 v10, s[8:11], s30 offen offset:2048 lds
v_mfma_f32_16x16x32_bf16 v[176:179], v[52:55], a[240:243], v[176:179]
v_mul_f32 v125, v125, v33
v_mul_f32 v126, v126, v110
v_mfma_f32_16x16x32_bf16 v[180:183], v[48:51], a[228:231], v[180:183]
buffer_load_dword v78, v79, s[20:23], 0 offen sc1
v_mfma_f32_16x16x32_bf16 v[180:183], v[52:55], a[244:247], v[180:183]
v_exp_f32 v34, v34
v_mfma_f32_16x16x32_bf16 v[184:187], v[48:51], a[232:235], v[184:187]
buffer_load_dwordx4 v11, s[8:11], s30 offen offset:3072 lds
v_mfma_f32_16x16x32_bf16 v[184:187], v[52:55], a[248:251], v[184:187]
s_add_u32 m0, s37, 65536
v_exp_f32 v35, v35
v_mfma_f32_16x16x32_bf16 v[188:191], v[48:51], a[236:239], v[188:191]
v_mul_f32 v127, v127, v111
s_waitcnt vmcnt(15) lgkmcnt(0)
v_mfma_f32_16x16x32_bf16 v[188:191], v[52:55], a[252:255], v[188:191]
s_barrier
v_mfma_f32_16x16x32_bf16 v[192:195], v[56:59], a[224:227], v[192:195]
ds_read_b64_tr_b16 v[40:41], v2 offset:0
v_add_f32 v34, 1.0, v34
v_mfma_f32_16x16x32_bf16 v[192:195], v[60:63], a[240:243], v[192:195]
ds_read_b64_tr_b16 v[42:43], v2 offset:512
v_add_f32 v35, 1.0, v35
v_cvt_pk_bf16_f32 v108, v124, v125
v_mfma_f32_16x16x32_bf16 v[196:199], v[56:59], a[228:231], v[196:199]
ds_read_b64_tr_b16 v[44:45], v2 offset:8192
v_mul_f32 v36, v140, v140
v_mfma_f32_16x16x32_bf16 v[196:199], v[60:63], a[244:247], v[196:199]
ds_read_b64_tr_b16 v[46:47], v2 offset:8704
v_mul_f32 v37, v141, v141
v_mfma_f32_16x16x32_bf16 v[200:203], v[56:59], a[232:235], v[200:203]
ds_read_b64_tr_b16 v[48:49], v2 offset:2048
v_fma_f32 v36, v36, s47, v18
v_mfma_f32_16x16x32_bf16 v[200:203], v[60:63], a[248:251], v[200:203]
ds_read_b64_tr_b16 v[50:51], v2 offset:2560
v_fma_f32 v37, v37, s47, v18
v_mfma_f32_16x16x32_bf16 v[204:207], v[56:59], a[236:239], v[204:207]
ds_read_b64_tr_b16 v[52:53], v2 offset:10240
v_mul_f32 v36, v36, v140
v_mfma_f32_16x16x32_bf16 v[204:207], v[60:63], a[252:255], v[204:207]
ds_read_b64_tr_b16 v[54:55], v2 offset:10752
v_rcp_f32 v34, v34
v_mfma_f32_16x16x32_bf16 v[208:211], v[64:67], a[224:227], v[208:211]
buffer_load_dwordx4 v10, s[4:7], s31 offen offset:0 lds
v_mfma_f32_16x16x32_bf16 v[208:211], v[68:71], a[240:243], v[208:211]
v_rcp_f32 v35, v35
v_mfma_f32_16x16x32_bf16 v[212:215], v[64:67], a[228:231], v[212:215]
v_mul_f32 v126, v126, v34
v_mul_f32 v127, v127, v35
v_mfma_f32_16x16x32_bf16 v[212:215], v[68:71], a[244:247], v[212:215]
v_cvt_pk_bf16_f32 v109, v126, v127
v_mul_f32 v37, v37, v141
v_mfma_f32_16x16x32_bf16 v[216:219], v[64:67], a[232:235], v[216:219]
buffer_load_dwordx4 v11, s[4:7], s31 offen offset:1024 lds
v_mfma_f32_16x16x32_bf16 v[216:219], v[68:71], a[248:251], v[216:219]
v_exp_f32 v36, v36
v_mul_f32 v156, v156, v140
v_mfma_f32_16x16x32_bf16 v[220:223], v[64:67], a[236:239], v[220:223]
v_exp_f32 v37, v37
v_mfma_f32_16x16x32_bf16 v[220:223], v[68:71], a[252:255], v[220:223]
v_mul_f32 v157, v157, v141
s_waitcnt lgkmcnt(0)
v_mfma_f32_16x16x32_bf16 v[160:163], v[40:43], v[224:227], v[160:163]
ds_read_b64_tr_b16 v[56:57], v3 offset:0
v_add_f32 v36, 1.0, v36
v_mfma_f32_16x16x32_bf16 v[160:163], v[44:47], v[240:243], v[160:163]
ds_read_b64_tr_b16 v[58:59], v3 offset:512
v_add_f32 v37, 1.0, v37
v_mfma_f32_16x16x32_bf16 v[164:167], v[40:43], v[228:231], v[164:167]
ds_read_b64_tr_b16 v[60:61], v3 offset:8192
v_rcp_f32 v36, v36
v_mfma_f32_16x16x32_bf16 v[164:167], v[44:47], v[244:247], v[164:167]
ds_read_b64_tr_b16 v[62:63], v3 offset:8704
v_mul_f32 v156, v156, v36
v_mfma_f32_16x16x32_bf16 v[168:171], v[40:43], v[232:235], v[168:171]
ds_read_b64_tr_b16 v[64:65], v3 offset:2048
v_mul_f32 v38, v142, v142
v_mfma_f32_16x16x32_bf16 v[168:171], v[44:47], v[248:251], v[168:171]
ds_read_b64_tr_b16 v[66:67], v3 offset:2560
v_mul_f32 v39, v143, v143
v_mfma_f32_16x16x32_bf16 v[172:175], v[40:43], v[236:239], v[172:175]
ds_read_b64_tr_b16 v[68:69], v3 offset:10240
v_fma_f32 v38, v38, s47, v18
v_mfma_f32_16x16x32_bf16 v[172:175], v[44:47], v[252:255], v[172:175]
ds_read_b64_tr_b16 v[70:71], v3 offset:10752
v_fma_f32 v39, v39, s47, v18
v_mfma_f32_16x16x32_bf16 v[176:179], v[48:51], v[224:227], v[176:179]
buffer_load_dwordx4 v10, s[8:11], s31 offen offset:2048 lds
v_mfma_f32_16x16x32_bf16 v[176:179], v[52:55], v[240:243], v[176:179]
v_rcp_f32 v37, v37
v_mul_f32 v38, v38, v142
v_mfma_f32_16x16x32_bf16 v[180:183], v[48:51], v[228:231], v[180:183]
v_mul_f32 v157, v157, v37
v_mul_f32 v39, v39, v143
v_mfma_f32_16x16x32_bf16 v[180:183], v[52:55], v[244:247], v[180:183]
v_exp_f32 v38, v38
v_mfma_f32_16x16x32_bf16 v[184:187], v[48:51], v[232:235], v[184:187]
buffer_load_dwordx4 v11, s[8:11], s31 offen offset:3072 lds
v_mfma_f32_16x16x32_bf16 v[184:187], v[52:55], v[248:251], v[184:187]
s_add_u32 m0, s37, 0
v_mul_f32 v158, v158, v142
v_mfma_f32_16x16x32_bf16 v[188:191], v[48:51], v[236:239], v[188:191]
v_mul_f32 v159, v159, v143
s_waitcnt vmcnt(14) lgkmcnt(0)
v_mfma_f32_16x16x32_bf16 v[188:191], v[52:55], v[252:255], v[188:191]
s_barrier
v_mfma_f32_16x16x32_bf16 v[192:195], v[56:59], v[224:227], v[192:195]
ds_read_b64_tr_b16 v[40:41], v2 offset:16384
v_exp_f32 v39, v39
v_mfma_f32_16x16x32_bf16 v[192:195], v[60:63], v[240:243], v[192:195]
ds_read_b64_tr_b16 v[42:43], v2 offset:16896
v_add_f32 v38, 1.0, v38
v_mfma_f32_16x16x32_bf16 v[196:199], v[56:59], v[228:231], v[196:199]
ds_read_b64_tr_b16 v[44:45], v2 offset:24576
v_add_f32 v39, 1.0, v39
v_mfma_f32_16x16x32_bf16 v[196:199], v[60:63], v[244:247], v[196:199]
ds_read_b64_tr_b16 v[46:47], v2 offset:25088
v_cvt_pk_bf16_f32 v110, v156, v157
v_mfma_f32_16x16x32_bf16 v[200:203], v[56:59], v[232:235], v[200:203]
ds_read_b64_tr_b16 v[48:49], v2 offset:18432
v_mfma_f32_16x16x32_bf16 v[200:203], v[60:63], v[248:251], v[200:203]
ds_read_b64_tr_b16 v[50:51], v2 offset:18944
v_rcp_f32 v38, v38
v_mfma_f32_16x16x32_bf16 v[204:207], v[56:59], v[236:239], v[204:207]
ds_read_b64_tr_b16 v[52:53], v2 offset:26624
v_mul_f32 v158, v158, v38
v_mfma_f32_16x16x32_bf16 v[204:207], v[60:63], v[252:255], v[204:207]
ds_read_b64_tr_b16 v[54:55], v2 offset:27136
v_mfma_f32_16x16x32_bf16 v[208:211], v[64:67], v[224:227], v[208:211]
buffer_load_dwordx4 v10, s[4:7], s32 offen offset:0 lds
v_mfma_f32_16x16x32_bf16 v[208:211], v[68:71], v[240:243], v[208:211]
v_rcp_f32 v39, v39
v_mfma_f32_16x16x32_bf16 v[212:215], v[64:67], v[228:231], v[212:215]
v_mul_f32 v159, v159, v39
v_cvt_pk_bf16_f32 v111, v158, v159
v_mfma_f32_16x16x32_bf16 v[212:215], v[68:71], v[244:247], v[212:215]
ds_write_b128 v14, v[108:111] offset:35840
v_mfma_f32_16x16x32_bf16 v[216:219], v[64:67], v[232:235], v[216:219]
buffer_load_dwordx4 v11, s[4:7], s32 offen offset:1024 lds
buffer_store_dwordx4 v[108:111], v16, s[20:23], s50 offen offset:3072 sc1
v_mfma_f32_16x16x32_bf16 v[216:219], v[68:71], v[248:251], v[216:219]
v_mfma_f32_16x16x32_bf16 v[220:223], v[64:67], v[236:239], v[220:223]
v_mfma_f32_16x16x32_bf16 v[220:223], v[68:71], v[252:255], v[220:223]
s_waitcnt lgkmcnt(0)
v_mfma_f32_16x16x32_bf16 v[96:99], v[40:43], a[0:3], 0
ds_read_b64_tr_b16 v[56:57], v3 offset:16384
v_mfma_f32_16x16x32_bf16 v[96:99], v[44:47], a[16:19], v[96:99]
ds_read_b64_tr_b16 v[58:59], v3 offset:16896
s_add_u32 s50, s44, 12582912
v_mfma_f32_16x16x32_bf16 v[100:103], v[40:43], a[4:7], 0
ds_read_b64_tr_b16 v[60:61], v3 offset:24576
v_mul_f32 v24, v160, v160
v_mfma_f32_16x16x32_bf16 v[100:103], v[44:47], a[20:23], v[100:103]
ds_read_b64_tr_b16 v[62:63], v3 offset:25088
v_mul_f32 v25, v161, v161
v_mfma_f32_16x16x32_bf16 v[104:107], v[40:43], a[8:11], 0
ds_read_b64_tr_b16 v[64:65], v3 offset:18432
v_fma_f32 v24, v24, s47, v18
v_mfma_f32_16x16x32_bf16 v[104:107], v[44:47], a[24:27], v[104:107]
ds_read_b64_tr_b16 v[66:67], v3 offset:18944
v_fma_f32 v25, v25, s47, v18
v_mul_f32 v24, v24, v160
v_mfma_f32_16x16x32_bf16 v[108:111], v[40:43], a[12:15], 0
ds_read_b64_tr_b16 v[68:69], v3 offset:26624
v_mul_f32 v25, v25, v161
v_mfma_f32_16x16x32_bf16 v[108:111], v[44:47], a[28:31], v[108:111]
ds_read_b64_tr_b16 v[70:71], v3 offset:27136
v_mul_f32 v176, v176, v160
v_mfma_f32_16x16x32_bf16 v[112:115], v[48:51], a[0:3], 0
buffer_load_dwordx4 v10, s[8:11], s32 offen offset:2048 lds
v_mfma_f32_16x16x32_bf16 v[112:115], v[52:55], a[16:19], v[112:115]
v_exp_f32 v24, v24
v_mul_f32 v177, v177, v161
v_mfma_f32_16x16x32_bf16 v[116:119], v[48:51], a[4:7], 0
v_exp_f32 v25, v25
v_mfma_f32_16x16x32_bf16 v[116:119], v[52:55], a[20:23], v[116:119]
v_add_f32 v24, 1.0, v24
v_add_f32 v25, 1.0, v25
v_mfma_f32_16x16x32_bf16 v[120:123], v[48:51], a[8:11], 0
buffer_load_dwordx4 v11, s[8:11], s32 offen offset:3072 lds
v_mfma_f32_16x16x32_bf16 v[120:123], v[52:55], a[24:27], v[120:123]
s_add_u32 m0, s37, 16384
v_rcp_f32 v24, v24
v_mfma_f32_16x16x32_bf16 v[124:127], v[48:51], a[12:15], 0
v_mul_f32 v176, v176, v24
s_waitcnt vmcnt(15) lgkmcnt(0)
v_mfma_f32_16x16x32_bf16 v[124:127], v[52:55], a[28:31], v[124:127]
s_barrier
v_mfma_f32_16x16x32_bf16 v[128:131], v[56:59], a[0:3], 0
ds_read_b64_tr_b16 v[40:41], v2 offset:32768
v_mul_f32 v26, v162, v162
v_mfma_f32_16x16x32_bf16 v[128:131], v[60:63], a[16:19], v[128:131]
ds_read_b64_tr_b16 v[42:43], v2 offset:33280
v_rcp_f32 v25, v25
v_mfma_f32_16x16x32_bf16 v[132:135], v[56:59], a[4:7], 0
ds_read_b64_tr_b16 v[44:45], v2 offset:40960
v_mul_f32 v177, v177, v25
v_mfma_f32_16x16x32_bf16 v[132:135], v[60:63], a[20:23], v[132:135]
ds_read_b64_tr_b16 v[46:47], v2 offset:41472
v_mul_f32 v27, v163, v163
v_mfma_f32_16x16x32_bf16 v[136:139], v[56:59], a[8:11], 0
ds_read_b64_tr_b16 v[48:49], v2 offset:34816
v_fma_f32 v26, v26, s47, v18
v_mfma_f32_16x16x32_bf16 v[136:139], v[60:63], a[24:27], v[136:139]
ds_read_b64_tr_b16 v[50:51], v2 offset:35328
v_fma_f32 v27, v27, s47, v18
v_mul_f32 v26, v26, v162
v_mfma_f32_16x16x32_bf16 v[140:143], v[56:59], a[12:15], 0
ds_read_b64_tr_b16 v[52:53], v2 offset:43008
v_mul_f32 v27, v27, v163
v_mfma_f32_16x16x32_bf16 v[140:143], v[60:63], a[28:31], v[140:143]
ds_read_b64_tr_b16 v[54:55], v2 offset:43520
v_mul_f32 v178, v178, v162
v_mfma_f32_16x16x32_bf16 v[144:147], v[64:67], a[0:3], 0
buffer_load_dwordx4 v10, s[4:7], s33 offen offset:0 lds
v_mfma_f32_16x16x32_bf16 v[144:147], v[68:71], a[16:19], v[144:147]
v_exp_f32 v26, v26
v_mul_f32 v179, v179, v163
v_mfma_f32_16x16x32_bf16 v[148:151], v[64:67], a[4:7], 0
v_exp_f32 v27, v27
v_mfma_f32_16x16x32_bf16 v[148:151], v[68:71], a[20:23], v[148:151]
s_waitcnt vmcnt(11)
v_readfirstlane_b32 s58, v78
s_cmp_ge_u32 s58, 2
s_cbranch_scc0 L_spin2
L_back2:
v_mfma_f32_16x16x32_bf16 v[152:155], v[64:67], a[8:11], 0
buffer_load_dwordx4 v11, s[4:7], s33 offen offset:1024 lds
v_mfma_f32_16x16x32_bf16 v[152:155], v[68:71], a[24:27], v[152:155]
v_add_f32 v26, 1.0, v26
v_add_f32 v27, 1.0, v27
v_cvt_pk_bf16_f32 v160, v176, v177
v_mfma_f32_16x16x32_bf16 v[156:159], v[64:67], a[12:15], 0
v_rcp_f32 v26, v26
v_mfma_f32_16x16x32_bf16 v[156:159], v[68:71], a[28:31], v[156:159]
v_mul_f32 v178, v178, v26
s_waitcnt lgkmcnt(0)
v_mfma_f32_16x16x32_bf16 v[96:99], v[40:43], a[32:35], v[96:99]
s_add_u32 s51, s45, 0
v_mul_f32 v28, v192, v192
v_mfma_f32_16x16x32_bf16 v[96:99], v[44:47], a[48:51], v[96:99]
ds_read_b64_tr_b16 v[56:57], v3 offset:32768
v_rcp_f32 v27, v27
v_mfma_f32_16x16x32_bf16 v[100:103], v[40:43], a[36:39], v[100:103]
ds_read_b64_tr_b16 v[58:59], v3 offset:33280
v_mul_f32 v179, v179, v27
v_mfma_f32_16x16x32_bf16 v[100:103], v[44:47], a[52:55], v[100:103]
ds_read_b64_tr_b16 v[60:61], v3 offset:40960
v_cvt_pk_bf16_f32 v161, v178, v179
v_mfma_f32_16x16x32_bf16 v[104:107], v[40:43], a[40:43], v[104:107]
buffer_load_dwordx4 v10, s[8:11], s33 offen offset:2048 lds
v_mfma_f32_16x16x32_bf16 v[104:107], v[44:47], a[56:59], v[104:107]
ds_read_b64_tr_b16 v[62:63], v3 offset:41472
v_mul_f32 v29, v193, v193
v_fma_f32 v28, v28, s47, v18
v_mfma_f32_16x16x32_bf16 v[108:111], v[40:43], a[44:47], v[108:111]
ds_read_b64_tr_b16 v[64:65], v3 offset:34816
v_fma_f32 v29, v29, s47, v18
v_mfma_f32_16x16x32_bf16 v[108:111], v[44:47], a[60:63], v[108:111]
ds_read_b64_tr_b16 v[66:67], v3 offset:35328
v_mul_f32 v28, v28, v192
v_mul_f32 v29, v29, v193
v_mfma_f32_16x16x32_bf16 v[112:115], v[48:51], a[32:35], v[112:115]
buffer_load_dwordx4 a[0:3], v17, s[20:23], s51 offen offset:0
v_mfma_f32_16x16x32_bf16 v[112:115], v[52:55], a[48:51], v[112:115]
ds_read_b64_tr_b16 v[68:69], v3 offset:43008
v_mul_f32 v208, v208, v192
v_mfma_f32_16x16x32_bf16 v[116:119], v[48:51], a[36:39], v[116:119]
ds_read_b64_tr_b16 v[70:71], v3 offset:43520
v_mul_f32 v209, v209, v193
v_mfma_f32_16x16x32_bf16 v[116:119], v[52:55], a[52:55], v[116:119]
v_exp_f32 v28, v28
v_mul_f32 v30, v194, v194
v_mfma_f32_16x16x32_bf16 v[120:123], v[48:51], a[40:43], v[120:123]
buffer_load_dwordx4 v11, s[8:11], s33 offen offset:3072 lds
v_mfma_f32_16x16x32_bf16 v[120:123], v[52:55], a[56:59], v[120:123]
s_add_u32 m0, s37, 32768
v_add_f32 v28, 1.0, v28
v_mfma_f32_16x16x32_bf16 v[124:127], v[48:51], a[44:47], v[124:127]
v_exp_f32 v29, v29
s_waitcnt vmcnt(14) lgkmcnt(0)
v_mfma_f32_16x16x32_bf16 v[124:127], v[52:55], a[60:63], v[124:127]
s_barrier
v_mfma_f32_16x16x32_bf16 v[128:131], v[56:59], a[32:35], v[128:131]
buffer_load_dwordx4 a[4:7], v17, s[20:23], s51 offen offset:1024
v_mfma_f32_16x16x32_bf16 v[128:131], v[60:63], a[48:51], v[128:131]
ds_read_b64_tr_b16 v[40:41], v2 offset:49152
v_add_f32 v29, 1.0, v29
v_mul_f32 v31, v195, v195
v_mfma_f32_16x16x32_bf16 v[132:135], v[56:59], a[36:39], v[132:135]
ds_read_b64_tr_b16 v[42:43], v2 offset:49664
v_fma_f32 v30, v30, s47, v18
v_mfma_f32_16x16x32_bf16 v[132:135], v[60:63], a[52:55], v[132:135]
ds_read_b64_tr_b16 v[44:45], v2 offset:57344
v_fma_f32 v31, v31, s47, v18
v_mfma_f32_16x16x32_bf16 v[136:139], v[56:59], a[40:43], v[136:139]
buffer_load_dwordx4 v10, s[4:7], s34 offen offset:0 lds
v_mfma_f32_16x16x32_bf16 v[136:139], v[60:63], a[56:59], v[136:139]
ds_read_b64_tr_b16 v[46:47], v2 offset:57856
v_rcp_f32 v28, v28
v_mfma_f32_16x16x32_bf16 v[140:143], v[56:59], a[44:47], v[140:143]
ds_read_b64_tr_b16 v[48:49], v2 offset:51200
v_mul_f32 v208, v208, v28
v_mfma_f32_16x16x32_bf16 v[140:143], v[60:63], a[60:63], v[140:143]
ds_read_b64_tr_b16 v[50:51], v2 offset:51712
v_mul_f32 v30, v30, v194
v_mfma_f32_16x16x32_bf16 v[144:147], v[64:67], a[32:35], v[144:147]
buffer_load_dwordx4 a[8:11], v17, s[20:23], s51 offen offset:2048
v_mfma_f32_16x16x32_bf16 v[144:147], v[68:71], a[48:51], v[144:147]
ds_read_b64_tr_b16 v[52:53], v2 offset:59392
v_rcp_f32 v29, v29
v_mfma_f32_16x16x32_bf16 v[148:151], v[64:67], a[36:39], v[148:151]
ds_read_b64_tr_b16 v[54:55], v2 offset:59904
v_mul_f32 v209, v209, v29
v_mfma_f32_16x16x32_bf16 v[148:151], v[68:71], a[52:55], v[148:151]
v_mul_f32 v31, v31, v195
v_exp_f32 v30, v30
v_mfma_f32_16x16x32_bf16 v[152:155], v[64:67], a[40:43], v[152:155]
buffer_load_dwordx4 v11, s[4:7], s34 offen offset:1024 lds
v_mfma_f32_16x16x32_bf16 v[152:155], v[68:71], a[56:59], v[152:155]
v_exp_f32 v31, v31
v_mfma_f32_16x16x32_bf16 v[156:159], v[64:67], a[44:47], v[156:159]
v_mul_f32 v210, v210, v194
v_mul_f32 v211, v211, v195
v_add_f32 v30, 1.0, v30
v_mfma_f32_16x16x32_bf16 v[156:159], v[68:71], a[60:63], v[156:159]
v_add_f32 v31, 1.0, v31
s_waitcnt lgkmcnt(0)
v_mfma_f32_16x16x32_bf16 v[96:99], v[40:43], a[64:67], v[96:99]
buffer_load_dwordx4 a[12:15], v17, s[20:23], s51 offen offset:3072
v_mfma_f32_16x16x32_bf16 v[96:99], v[44:47], a[80:83], v[96:99]
ds_read_b64_tr_b16 v[56:57], v3 offset:49152
s_add_u32 s51, s45, 8192
v_cvt_pk_bf16_f32 v162, v208, v209
v_mfma_f32_16x16x32_bf16 v[100:103], v[40:43], a[68:71], v[100:103]
ds_read_b64_tr_b16 v[58:59], v3 offset:49664
v_mul_f32 v32, v164, v164
v_mfma_f32_16x16x32_bf16 v[100:103], v[44:47], a[84:87], v[100:103]
ds_read_b64_tr_b16 v[60:61], v3 offset:57344
v_mul_f32 v33, v165, v165
v_mfma_f32_16x16x32_bf16 v[104:107], v[40:43], a[72:75], v[104:107]
buffer_load_dwordx4 v10, s[8:11], s34 offen offset:2048 lds
v_mfma_f32_16x16x32_bf16 v[104:107], v[44:47], a[88:91], v[104:107]
ds_read_b64_tr_b16 v[62:63], v3 offset:57856
v_rcp_f32 v30, v30
v_mfma_f32_16x16x32_bf16 v[108:111], v[40:43], a[76:79], v[108:111]
ds_read_b64_tr_b16 v[64:65], v3 offset:51200
v_rcp_f32 v31, v31
v_mfma_f32_16x16x32_bf16 v[108:111], v[44:47], a[92:95], v[108:111]
ds_read_b64_tr_b16 v[66:67], v3 offset:51712
v_mul_f32 v210, v210, v30
v_mfma_f32_16x16x32_bf16 v[112:115], v[48:51], a[64:67], v[112:115]
buffer_load_dwordx4 a[16:19], v17, s[20:23], s51 offen offset:0
v_mfma_f32_16x16x32_bf16 v[112:115], v[52:55], a[80:83], v[112:115]
ds_read_b64_tr_b16 v[68:69], v3 offset:59392
v_mul_f32 v211, v211, v31
v_cvt_pk_bf16_f32 v163, v210, v211
v_mfma_f32_16x16x32_bf16 v[116:119], v[48:51], a[68:71], v[116:119]
ds_read_b64_tr_b16 v[70:71], v3 offset:59904
v_fma_f32 v32, v32, s47, v18
v_mfma_f32_16x16x32_bf16 v[116:119], v[52:55], a[84:87], v[116:119]
ds_write_b128 v14, v[160:163] offset:49152
v_fma_f32 v33, v33, s47, v18
v_mfma_f32_16x16x32_bf16 v[120:123], v[48:51], a[72:75], v[120:123]
buffer_load_dwordx4 v11, s[8:11], s34 offen offset:3072 lds
v_mfma_f32_16x16x32_bf16 v[120:123], v[52:55], a[88:91], v[120:123]
s_add_u32 m0, s37, 49152
v_mul_f32 v32, v32, v164
v_mfma_f32_16x16x32_bf16 v[124:127], v[48:51], a[76:79], v[124:127]
v_mul_f32 v33, v33, v165
v_mul_f32 v180, v180, v164
s_waitcnt vmcnt(15) lgkmcnt(0)
v_mfma_f32_16x16x32_bf16 v[124:127], v[52:55], a[92:95], v[124:127]
s_barrier
v_mfma_f32_16x16x32_bf16 v[128:131], v[56:59], a[64:67], v[128:131]
buffer_load_dwordx4 a[20:23], v17, s[20:23], s51 offen offset:1024
v_mfma_f32_16x16x32_bf16 v[128:131], v[60:63], a[80:83], v[128:131]
ds_read_b64_tr_b16 v[40:41], v4 offset:0
v_exp_f32 v32, v32
v_mfma_f32_16x16x32_bf16 v[132:135], v[56:59], a[68:71], v[132:135]
ds_read_b64_tr_b16 v[42:43], v4 offset:512
v_mul_f32 v181, v181, v165
v_mfma_f32_16x16x32_bf16 v[132:135], v[60:63], a[84:87], v[132:135]
ds_read_b64_tr_b16 v[44:45], v4 offset:8192
v_exp_f32 v33, v33
v_mfma_f32_16x16x32_bf16 v[136:139], v[56:59], a[72:75], v[136:139]
buffer_load_dwordx4 v10, s[4:7], s35 offen offset:0 lds
v_mfma_f32_16x16x32_bf16 v[136:139], v[60:63], a[88:91], v[136:139]
ds_read_b64_tr_b16 v[46:47], v4 offset:8704
v_add_f32 v32, 1.0, v32
v_mfma_f32_16x16x32_bf16 v[140:143], v[56:59], a[76:79], v[140:143]
ds_read_b64_tr_b16 v[48:49], v4 offset:2048
v_mov_b32 v20, 2
v_mfma_f32_16x16x32_bf16 v[140:143], v[60:63], a[92:95], v[140:143]
ds_read_b64_tr_b16 v[50:51], v4 offset:2560
v_add_f32 v33, 1.0, v33
v_mul_f32 v34, v166, v166
v_mfma_f32_16x16x32_bf16 v[144:147], v[64:67], a[64:67], v[144:147]
buffer_store_dword v20, v19, s[20:23], 0 offen sc1
v_mfma_f32_16x16x32_bf16 v[144:147], v[68:71], a[80:83], v[144:147]
ds_read_b64_tr_b16 v[52:53], v4 offset:10240
v_rcp_f32 v32, v32
v_mfma_f32_16x16x32_bf16 v[148:151], v[64:67], a[68:71], v[148:151]
ds_read_b64_tr_b16 v[54:55], v4 offset:10752
v_mul_f32 v180, v180, v32
v_mfma_f32_16x16x32_bf16 v[148:151], v[68:71], a[84:87], v[148:151]
v_rcp_f32 v33, v33
v_mul_f32 v35, v167, v167
v_mfma_f32_16x16x32_bf16 v[152:155], v[64:67], a[72:75], v[152:155]
buffer_load_dwordx4 v11, s[4:7], s35 offen offset:1024 lds
v_mfma_f32_16x16x32_bf16 v[152:155], v[68:71], a[88:91], v[152:155]
v_mul_f32 v181, v181, v33
v_fma_f32 v34, v34, s47, v18
v_fma_f32 v35, v35, s47, v18
v_mfma_f32_16x16x32_bf16 v[156:159], v[64:67], a[76:79], v[156:159]
v_mul_f32 v34, v34, v166
v_mul_f32 v35, v35, v167
v_mfma_f32_16x16x32_bf16 v[156:159], v[68:71], a[92:95], v[156:159]
v_mul_f32 v182, v182, v166
s_waitcnt lgkmcnt(0)
v_mfma_f32_16x16x32_bf16 v[96:99], v[40:43], a[96:99], v[96:99]
buffer_load_dwordx4 a[24:27], v17, s[20:23], s51 offen offset:2048
v_mfma_f32_16x16x32_bf16 v[96:99], v[44:47], a[112:115], v[96:99]
ds_read_b64_tr_b16 v[56:57], v5 offset:0
v_exp_f32 v34, v34
v_mfma_f32_16x16x32_bf16 v[100:103], v[40:43], a[100:103], v[100:103]
ds_read_b64_tr_b16 v[58:59], v5 offset:512
ds_read_b128 a[64:67], v15 offset:0
v_mul_f32 v183, v183, v167
v_mfma_f32_16x16x32_bf16 v[100:103], v[44:47], a[116:119], v[100:103]
ds_read_b64_tr_b16 v[60:61], v5 offset:8192
v_add_f32 v34, 1.0, v34
v_mfma_f32_16x16x32_bf16 v[104:107], v[40:43], a[104:107], v[104:107]
buffer_load_dwordx4 v10, s[8:11], s35 offen offset:2048 lds
v_mfma_f32_16x16x32_bf16 v[104:107], v[44:47], a[120:123], v[104:107]
ds_read_b64_tr_b16 v[62:63], v5 offset:8704
v_exp_f32 v35, v35
v_mfma_f32_16x16x32_bf16 v[108:111], v[40:43], a[108:111], v[108:111]
ds_read_b64_tr_b16 v[64:65], v5 offset:2048
ds_read_b128 a[68:71], v15 offset:1024
v_mfma_f32_16x16x32_bf16 v[108:111], v[44:47], a[124:127], v[108:111]
ds_read_b64_tr_b16 v[66:67], v5 offset:2560
v_add_f32 v35, 1.0, v35
v_cvt_pk_bf16_f32 v164, v180, v181
v_mfma_f32_16x16x32_bf16 v[112:115], v[48:51], a[96:99], v[112:115]
buffer_load_dwordx4 a[28:31], v17, s[20:23], s51 offen offset:3072
v_mfma_f32_16x16x32_bf16 v[112:115], v[52:55], a[112:115], v[112:115]
ds_read_b64_tr_b16 v[68:69], v5 offset:10240
s_add_u32 s51, s45, 4194304
v_mul_f32 v36, v196, v196
v_mfma_f32_16x16x32_bf16 v[116:119], v[48:51], a[100:103], v[116:119]
ds_read_b64_tr_b16 v[70:71], v5 offset:10752
ds_read_b128 a[72:75], v15 offset:2048
v_mfma_f32_16x16x32_bf16 v[116:119], v[52:55], a[116:119], v[116:119]
ds_read_b128 a[76:79], v15 offset:3072
v_mul_f32 v37, v197, v197
v_mfma_f32_16x16x32_bf16 v[120:123], v[48:51], a[104:107], v[120:123]
buffer_load_dwordx4 v11, s[8:11], s35 offen offset:3072 lds
v_mfma_f32_16x16x32_bf16 v[120:123], v[52:55], a[120:123], v[120:123]
s_add_u32 m0, s37, 65536
v_rcp_f32 v34, v34
v_mfma_f32_16x16x32_bf16 v[124:127], v[48:51], a[108:111], v[124:127]
v_rcp_f32 v35, v35
s_waitcnt vmcnt(21) lgkmcnt(0)
v_mfma_f32_16x16x32_bf16 v[124:127], v[52:55], a[124:127], v[124:127]
s_barrier
v_mfma_f32_16x16x32_bf16 v[128:131], v[56:59], a[96:99], v[128:131]
buffer_load_dwordx4 a[32:35], v17, s[20:23], s51 offen offset:0
v_mfma_f32_16x16x32_bf16 v[128:131], v[60:63], a[112:115], v[128:131]
ds_read_b64_tr_b16 v[40:41], v2 offset:0
v_mul_f32 v182, v182, v34
v_mul_f32 v183, v183, v35
v_mfma_f32_16x16x32_bf16 v[132:135], v[56:59], a[100:103], v[132:135]
ds_read_b64_tr_b16 v[42:43], v2 offset:512
ds_read_b128 a[80:83], v15 offset:8192
v_mfma_f32_16x16x32_bf16 v[132:135], v[60:63], a[116:119], v[132:135]
ds_read_b64_tr_b16 v[44:45], v2 offset:8192
v_cvt_pk_bf16_f32 v165, v182, v183
v_fma_f32 v36, v36, s47, v18
v_mfma_f32_16x16x32_bf16 v[136:139], v[56:59], a[104:107], v[136:139]
buffer_load_dwordx4 v10, s[4:7], s36 offen offset:0 lds
v_mfma_f32_16x16x32_bf16 v[136:139], v[60:63], a[120:123], v[136:139]
ds_read_b64_tr_b16 v[46:47], v2 offset:8704
v_fma_f32 v37, v37, s47, v18
v_mul_f32 v36, v36, v196
v_mfma_f32_16x16x32_bf16 v[140:143], v[56:59], a[108:111], v[140:143]
ds_read_b64_tr_b16 v[48:49], v2 offset:2048
ds_read_b128 a[84:87], v15 offset:9216
v_mfma_f32_16x16x32_bf16 v[140:143], v[60:63], a[124:127], v[140:143]
ds_read_b64_tr_b16 v[50:51], v2 offset:2560
v_mul_f32 v37, v37, v197
v_mfma_f32_16x16x32_bf16 v[144:147], v[64:67], a[96:99], v[144:147]
buffer_load_dwordx4 a[36:39], v17, s[20:23], s51 offen offset:1024
v_mfma_f32_16x16x32_bf16 v[144:147], v[68:71], a[112:115], v[144:147]
ds_read_b64_tr_b16 v[52:53], v2 offset:10240
v_exp_f32 v36, v36
v_mfma_f32_16x16x32_bf16 v[148:151], v[64:67], a[100:103], v[148:151]
ds_read_b64_tr_b16 v[54:55], v2 offset:10752
ds_read_b128 a[88:91], v15 offset:10240
v_mul_f32 v212, v212, v196
v_mfma_f32_16x16x32_bf16 v[148:151], v[68:71], a[116:119], v[148:151]
ds_read_b128 a[92:95], v15 offset:11264
v_mul_f32 v213, v213, v197
v_mfma_f32_16x16x32_bf16 v[152:155], v[64:67], a[104:107], v[152:155]
buffer_load_dwordx4 v11, s[4:7], s36 offen offset:1024 lds
v_mfma_f32_16x16x32_bf16 v[152:155], v[68:71], a[120:123], v[152:155]
v_exp_f32 v37, v37
v_add_f32 v36, 1.0, v36
v_mfma_f32_16x16x32_bf16 v[156:159], v[64:67], a[108:111], v[156:159]
v_add_f32 v37, 1.0, v37
v_mul_f32 v38, v198, v198
v_mfma_f32_16x16x32_bf16 v[156:159], v[68:71], a[124:127], v[156:159]
v_rcp_f32 v36, v36
s_waitcnt lgkmcnt(0)
v_mfma_f32_16x16x32_bf16 v[96:99], v[40:43], a[128:131], v[96:99]
buffer_load_dwordx4 a[40:43], v17, s[20:23], s51 offen offset:2048
v_mfma_f32_16x16x32_bf16 v[96:99], v[44:47], a[144:147], v[96:99]
ds_read_b64_tr_b16 v[56:57], v3 offset:0
v_rcp_f32 v37, v37
v_mfma_f32_16x16x32_bf16 v[100:103], v[40:43], a[132:135], v[100:103]
ds_read_b64_tr_b16 v[58:59], v3 offset:512
v_mul_f32 v212, v212, v36
v_mfma_f32_16x16x32_bf16 v[100:103], v[44:47], a[148:151], v[100:103]
ds_read_b64_tr_b16 v[60:61], v3 offset:8192
v_mul_f32 v213, v213, v37
v_mul_f32 v39, v199, v199
v_mfma_f32_16x16x32_bf16 v[104:107], v[40:43], a[136:139], v[104:107]
buffer_load_dwordx4 v10, s[8:11], s36 offen offset:2048 lds
v_mfma_f32_16x16x32_bf16 v[104:107], v[44:47], a[152:155], v[104:107]
ds_read_b64_tr_b16 v[62:63], v3 offset:8704
v_fma_f32 v38, v38, s47, v18
v_mfma_f32_16x16x32_bf16 v[108:111], v[40:43], a[140:143], v[108:111]
ds_read_b64_tr_b16 v[64:65], v3 offset:2048
v_fma_f32 v39, v39, s47, v18
v_mul_f32 v38, v38, v198
v_mfma_f32_16x16x32_bf16 v[108:111], v[44:47], a[156:159], v[108:111]
ds_read_b64_tr_b16 v[66:67], v3 offset:2560
v_mul_f32 v39, v39, v199
v_mfma_f32_16x16x32_bf16 v[112:115], v[48:51], a[128:131], v[112:115]
buffer_load_dwordx4 a[44:47], v17, s[20:23], s51 offen offset:3072
v_mfma_f32_16x16x32_bf16 v[112:115], v[52:55], a[144:147], v[112:115]
ds_read_b64_tr_b16 v[68:69], v3 offset:10240
s_add_u32 s51, s45, 4202496
v_mul_f32 v214, v214, v198
v_mfma_f32_16x16x32_bf16 v[116:119], v[48:51], a[132:135], v[116:119]
ds_read_b64_tr_b16 v[70:71], v3 offset:10752
v_mul_f32 v215, v215, v199
v_mfma_f32_16x16x32_bf16 v[116:119], v[52:55], a[148:151], v[116:119]
v_exp_f32 v38, v38
v_cvt_pk_bf16_f32 v166, v212, v213
v_mfma_f32_16x16x32_bf16 v[120:123], v[48:51], a[136:139], v[120:123]
buffer_load_dwordx4 v11, s[8:11], s36 offen offset:3072 lds
v_mfma_f32_16x16x32_bf16 v[120:123], v[52:55], a[152:155], v[120:123]
s_add_u32 m0, s37, 0
v_exp_f32 v39, v39
v_mfma_f32_16x16x32_bf16 v[124:127], v[48:51], a[140:143], v[124:127]
s_mov_b32 s48, 370688
s_waitcnt vmcnt(24) lgkmcnt(0)
v_mfma_f32_16x16x32_bf16 v[124:127], v[52:55], a[156:159], v[124:127]
s_barrier
v_mfma_f32_16x16x32_bf16 v[128:131], v[56:59], a[128:131], v[128:131]
buffer_load_dwordx4 a[48:51], v17, s[20:23], s51 offen offset:0
v_mfma_f32_16x16x32_bf16 v[128:131], v[60:63], a[144:147], v[128:131]
ds_read_b64_tr_b16 v[40:41], v2 offset:16384
v_add_f32 v38, 1.0, v38
v_add_f32 v39, 1.0, v39
v_mfma_f32_16x16x32_bf16 v[132:135], v[56:59], a[132:135], v[132:135]
ds_read_b64_tr_b16 v[42:43], v2 offset:16896
v_rcp_f32 v38, v38
v_mfma_f32_16x16x32_bf16 v[132:135], v[60:63], a[148:151], v[132:135]
ds_read_b64_tr_b16 v[44:45], v2 offset:24576
v_mul_f32 v214, v214, v38
v_mfma_f32_16x16x32_bf16 v[136:139], v[56:59], a[136:139], v[136:139]
buffer_load_dwordx4 v12, s[16:19], s48 offen offset:0 lds
v_mfma_f32_16x16x32_bf16 v[136:139], v[60:63], a[152:155], v[136:139]
ds_read_b64_tr_b16 v[46:47], v2 offset:25088
v_rcp_f32 v39, v39
v_mfma_f32_16x16x32_bf16 v[140:143], v[56:59], a[140:143], v[140:143]
ds_read_b64_tr_b16 v[48:49], v2 offset:18432
v_mul_f32 v215, v215, v39
v_cvt_pk_bf16_f32 v167, v214, v215
v_mfma_f32_16x16x32_bf16 v[140:143], v[60:63], a[156:159], v[140:143]
ds_read_b64_tr_b16 v[50:51], v2 offset:18944
v_mul_f32 v24, v168, v168
v_mfma_f32_16x16x32_bf16 v[144:147], v[64:67], a[128:131], v[144:147]
buffer_load_dwordx4 a[52:55], v17, s[20:23], s51 offen offset:1024
v_mfma_f32_16x16x32_bf16 v[144:147], v[68:71], a[144:147], v[144:147]
ds_read_b64_tr_b16 v[52:53], v2 offset:26624
v_mul_f32 v25, v169, v169
v_fma_f32 v24, v24, s47, v18
v_mfma_f32_16x16x32_bf16 v[148:151], v[64:67], a[132:135], v[148:151]
ds_read_b64_tr_b16 v[54:55], v2 offset:27136
v_fma_f32 v25, v25, s47, v18
v_mfma_f32_16x16x32_bf16 v[148:151], v[68:71], a[148:151], v[148:151]
ds_write_b128 v14, v[164:167] offset:50176
v_mul_f32 v24, v24, v168
v_mfma_f32_16x16x32_bf16 v[152:155], v[64:67], a[136:139], v[152:155]
buffer_load_dwordx4 v13, s[16:19], s48 offen offset:1024 lds
v_mfma_f32_16x16x32_bf16 v[152:155], v[68:71], a[152:155], v[152:155]
s_mov_b32 s49, 368768
v_mul_f32 v25, v25, v169
v_mfma_f32_16x16x32_bf16 v[156:159], v[64:67], a[140:143], v[156:159]
v_exp_f32 v24, v24
v_mul_f32 v184, v184, v168
v_mfma_f32_16x16x32_bf16 v[156:159], v[68:71], a[156:159], v[156:159]
v_mul_f32 v185, v185, v169
s_waitcnt lgkmcnt(0)
v_mfma_f32_16x16x32_bf16 v[96:99], v[40:43], a[160:163], v[96:99]
buffer_load_dwordx4 a[56:59], v17, s[20:23], s51 offen offset:2048
v_mfma_f32_16x16x32_bf16 v[96:99], v[44:47], a[176:179], v[96:99]
ds_read_b64_tr_b16 v[56:57], v3 offset:16384
v_exp_f32 v25, v25
v_mfma_f32_16x16x32_bf16 v[100:103], v[40:43], a[164:167], v[100:103]
ds_read_b64_tr_b16 v[58:59], v3 offset:16896
ds_read_b128 a[96:99], v15 offset:16384
v_add_f32 v24, 1.0, v24
v_mfma_f32_16x16x32_bf16 v[100:103], v[44:47], a[180:183], v[100:103]
ds_read_b64_tr_b16 v[60:61], v3 offset:24576
v_add_f32 v25, 1.0, v25
v_mfma_f32_16x16x32_bf16 v[104:107], v[40:43], a[168:171], v[104:107]
buffer_load_dwordx4 v12, s[16:19], s49 offen offset:2048 lds
v_mfma_f32_16x16x32_bf16 v[104:107], v[44:47], a[184:187], v[104:107]
ds_read_b64_tr_b16 v[62:63], v3 offset:25088
v_rcp_f32 v24, v24
v_mfma_f32_16x16x32_bf16 v[108:111], v[40:43], a[172:175], v[108:111]
ds_read_b64_tr_b16 v[64:65], v3 offset:18432
ds_read_b128 a[100:103], v15 offset:17408
v_mul_f32 v184, v184, v24
v_mfma_f32_16x16x32_bf16 v[108:111], v[44:47], a[188:191], v[108:111]
ds_read_b64_tr_b16 v[66:67], v3 offset:18944
v_mul_f32 v26, v170, v170
v_mfma_f32_16x16x32_bf16 v[112:115], v[48:51], a[160:163], v[112:115]
buffer_load_dwordx4 a[60:63], v17, s[20:23], s51 offen offset:3072
v_mfma_f32_16x16x32_bf16 v[112:115], v[52:55], a[176:179], v[112:115]
ds_read_b64_tr_b16 v[68:69], v3 offset:26624
v_rcp_f32 v25, v25
v_mfma_f32_16x16x32_bf16 v[116:119], v[48:51], a[164:167], v[116:119]
ds_read_b64_tr_b16 v[70:71], v3 offset:27136
ds_read_b128 a[104:107], v15 offset:18432
v_mfma_f32_16x16x32_bf16 v[116:119], v[52:55], a[180:183], v[116:119]
ds_read_b128 a[108:111], v15 offset:19456
v_mul_f32 v185, v185, v25
v_mul_f32 v27, v171, v171
v_mfma_f32_16x16x32_bf16 v[120:123], v[48:51], a[168:171], v[120:123]
buffer_load_dwordx4 v13, s[16:19], s49 offen offset:3072 lds
v_mfma_f32_16x16x32_bf16 v[120:123], v[52:55], a[184:187], v[120:123]
s_add_u32 m0, s37, 16384
v_fma_f32 v26, v26, s47, v18
v_fma_f32 v27, v27, s47, v18
v_mfma_f32_16x16x32_bf16 v[124:127], v[48:51], a[172:175], v[124:127]
s_mov_b32 s48, 444416
s_waitcnt vmcnt(24) lgkmcnt(0)
v_mfma_f32_16x16x32_bf16 v[124:127], v[52:55], a[188:191], v[124:127]
s_barrier
v_mfma_f32_16x16x32_bf16 v[128:131], v[56:59], a[160:163], v[128:131]
buffer_store_dwordx4 v[160:163], v16, s[20:23], s50 offen offset:0 sc1
v_mfma_f32_16x16x32_bf16 v[128:131], v[60:63], a[176:179], v[128:131]
ds_read_b64_tr_b16 v[40:41], v2 offset:32768
v_mul_f32 v26, v26, v170
v_mul_f32 v27, v27, v171
v_mul_f32 v186, v186, v170
v_mfma_f32_16x16x32_bf16 v[132:135], v[56:59], a[164:167], v[132:135]
ds_read_b64_tr_b16 v[42:43], v2 offset:33280
ds_read_b128 a[112:115], v15 offset:24576
v_mfma_f32_16x16x32_bf16 v[132:135], v[60:63], a[180:183], v[132:135]
ds_read_b64_tr_b16 v[44:45], v2 offset:40960
v_exp_f32 v26, v26
v_mfma_f32_16x16x32_bf16 v[136:139], v[56:59], a[168:171], v[136:139]
buffer_load_dwordx4 v12, s[16:19], s48 offen offset:0 lds
v_mfma_f32_16x16x32_bf16 v[136:139], v[60:63], a[184:187], v[136:139]
ds_read_b64_tr_b16 v[46:47], v2 offset:41472
v_exp_f32 v27, v27
v_mfma_f32_16x16x32_bf16 v[140:143], v[56:59], a[172:175], v[140:143]
ds_read_b64_tr_b16 v[48:49], v2 offset:34816
ds_read_b128 a[116:119], v15 offset:25600
v_mfma_f32_16x16x32_bf16 v[140:143], v[60:63], a[188:191], v[140:143]
ds_read_b64_tr_b16 v[50:51], v2 offset:35328
v_mul_f32 v187, v187, v171
v_add_f32 v26, 1.0, v26
v_mfma_f32_16x16x32_bf16 v[144:147], v[64:67], a[160:163], v[144:147]
buffer_store_dwordx4 v[164:167], v16, s[20:23], s50 offen offset:1024 sc1
v_mfma_f32_16x16x32_bf16 v[144:147], v[68:71], a[176:179], v[144:147]
ds_read_b64_tr_b16 v[52:53], v2 offset:43008
v_add_f32 v27, 1.0, v27
v_cvt_pk_bf16_f32 v168, v184, v185
v_mfma_f32_16x16x32_bf16 v[148:151], v[64:67], a[164:167], v[148:151]
ds_read_b64_tr_b16 v[54:55], v2 offset:43520
ds_read_b128 a[120:123], v15 offset:26624
v_mfma_f32_16x16x32_bf16 v[148:151], v[68:71], a[180:183], v[148:151]
ds_read_b128 a[124:127], v15 offset:27648
v_mul_f32 v28, v200, v200
v_mfma_f32_16x16x32_bf16 v[152:155], v[64:67], a[168:171], v[152:155]
buffer_load_dwordx4 v13, s[16:19], s48 offen offset:1024 lds
v_mfma_f32_16x16x32_bf16 v[152:155], v[68:71], a[184:187], v[152:155]
s_mov_b32 s49, 442496
v_rcp_f32 v26, v26
v_mfma_f32_16x16x32_bf16 v[156:159], v[64:67], a[172:175], v[156:159]
v_rcp_f32 v27, v27
v_mul_f32 v186, v186, v26
v_mfma_f32_16x16x32_bf16 v[156:159], v[68:71], a[188:191], v[156:159]
v_mul_f32 v187, v187, v27
s_waitcnt lgkmcnt(0)
v_mfma_f32_16x16x32_bf16 v[96:99], v[40:43], a[192:195], v[96:99]
v_cvt_pk_bf16_f32 v169, v186, v187
v_mul_f32 v29, v201, v201
v_fma_f32 v28, v28, s47, v18
v_mfma_f32_16x16x32_bf16 v[96:99], v[44:47], a[208:211], v[96:99]
ds_read_b64_tr_b16 v[56:57], v3 offset:32768
v_fma_f32 v29, v29, s47, v18
v_mfma_f32_16x16x32_bf16 v[100:103], v[40:43], a[196:199], v[100:103]
ds_read_b64_tr_b16 v[58:59], v3 offset:33280
v_mul_f32 v28, v28, v200
v_mul_f32 v29, v29, v201
v_mfma_f32_16x16x32_bf16 v[100:103], v[44:47], a[212:215], v[100:103]
ds_read_b64_tr_b16 v[60:61], v3 offset:40960
v_mul_f32 v216, v216, v200
v_mfma_f32_16x16x32_bf16 v[104:107], v[40:43], a[200:203], v[104:107]
buffer_load_dwordx4 v12, s[16:19], s49 offen offset:2048 lds
v_mfma_f32_16x16x32_bf16 v[104:107], v[44:47], a[216:219], v[104:107]
ds_read_b64_tr_b16 v[62:63], v3 offset:41472
v_exp_f32 v28, v28
v_mfma_f32_16x16x32_bf16 v[108:111], v[40:43], a[204:207], v[108:111]
ds_read_b64_tr_b16 v[64:65], v3 offset:34816
v_exp_f32 v29, v29
v_mfma_f32_16x16x32_bf16 v[108:111], v[44:47], a[220:223], v[108:111]
ds_read_b64_tr_b16 v[66:67], v3 offset:35328
v_mul_f32 v217, v217, v201
v_mfma_f32_16x16x32_bf16 v[112:115], v[48:51], a[192:195], v[112:115]
v_add_f32 v28, 1.0, v28
v_add_f32 v29, 1.0, v29
v_mul_f32 v30, v202, v202
v_mfma_f32_16x16x32_bf16 v[112:115], v[52:55], a[208:211], v[112:115]
ds_read_b64_tr_b16 v[68:69], v3 offset:43008
v_mul_f32 v31, v203, v203
v_mfma_f32_16x16x32_bf16 v[116:119], v[48:51], a[196:199], v[116:119]
ds_read_b64_tr_b16 v[70:71], v3 offset:43520
v_rcp_f32 v28, v28
v_mfma_f32_16x16x32_bf16 v[116:119], v[52:55], a[212:215], v[116:119]
v_rcp_f32 v29, v29
v_mfma_f32_16x16x32_bf16 v[120:123], v[48:51], a[200:203], v[120:123]
buffer_load_dwordx4 v13, s[16:19], s49 offen offset:3072 lds
v_mfma_f32_16x16x32_bf16 v[120:123], v[52:55], a[216:219], v[120:123]
s_add_u32 m0, s37, 32768
v_mul_f32 v216, v216, v28
v_mul_f32 v217, v217, v29
v_mfma_f32_16x16x32_bf16 v[124:127], v[48:51], a[204:207], v[124:127]
s_mov_b32 s48, 2048
s_waitcnt vmcnt(22) lgkmcnt(0)
v_mfma_f32_16x16x32_bf16 v[124:127], v[52:55], a[220:223], v[124:127]
s_barrier
v_mfma_f32_16x16x32_bf16 v[128:131], v[56:59], a[192:195], v[128:131]
v_fma_f32 v30, v30, s47, v18
v_fma_f32 v31, v31, s47, v18
v_mul_f32 v30, v30, v202
v_mfma_f32_16x16x32_bf16 v[128:131], v[60:63], a[208:211], v[128:131]
ds_read_b64_tr_b16 v[40:41], v2 offset:49152
v_mul_f32 v31, v31, v203
v_mul_f32 v218, v218, v202
v_mfma_f32_16x16x32_bf16 v[132:135], v[56:59], a[196:199], v[132:135]
ds_read_b64_tr_b16 v[42:43], v2 offset:49664
v_mul_f32 v219, v219, v203
v_mfma_f32_16x16x32_bf16 v[132:135], v[60:63], a[212:215], v[132:135]
ds_read_b64_tr_b16 v[44:45], v2 offset:57344
v_exp_f32 v30, v30
v_mfma_f32_16x16x32_bf16 v[136:139], v[56:59], a[200:203], v[136:139]
buffer_load_dwordx4 v12, s[16:19], s48 offen offset:0 lds
v_mfma_f32_16x16x32_bf16 v[136:139], v[60:63], a[216:219], v[136:139]
ds_read_b64_tr_b16 v[46:47], v2 offset:57856
v_exp_f32 v31, v31
v_mfma_f32_16x16x32_bf16 v[140:143], v[56:59], a[204:207], v[140:143]
ds_read_b64_tr_b16 v[48:49], v2 offset:51200
v_add_f32 v30, 1.0, v30
v_mfma_f32_16x16x32_bf16 v[140:143], v[60:63], a[220:223], v[140:143]
ds_read_b64_tr_b16 v[50:51], v2 offset:51712
v_add_f32 v31, 1.0, v31
v_cvt_pk_bf16_f32 v170, v216, v217
v_mfma_f32_16x16x32_bf16 v[144:147], v[64:67], a[192:195], v[144:147]
v_rcp_f32 v30, v30
v_mfma_f32_16x16x32_bf16 v[144:147], v[68:71], a[208:211], v[144:147]
ds_read_b64_tr_b16 v[52:53], v2 offset:59392
v_mul_f32 v218, v218, v30
v_mfma_f32_16x16x32_bf16 v[148:151], v[64:67], a[196:199], v[148:151]
ds_read_b64_tr_b16 v[54:55], v2 offset:59904
v_rcp_f32 v31, v31
v_mfma_f32_16x16x32_bf16 v[148:151], v[68:71], a[212:215], v[148:151]
v_mul_f32 v219, v219, v31
v_cvt_pk_bf16_f32 v171, v218, v219
v_mfma_f32_16x16x32_bf16 v[152:155], v[64:67], a[200:203], v[152:155]
buffer_load_dwordx4 v13, s[16:19], s48 offen offset:1024 lds
v_mfma_f32_16x16x32_bf16 v[152:155], v[68:71], a[216:219], v[152:155]
s_mov_b32 s49, 128
v_mul_f32 v32, v172, v172
v_mul_f32 v33, v173, v173
v_mfma_f32_16x16x32_bf16 v[156:159], v[64:67], a[204:207], v[156:159]
v_fma_f32 v32, v32, s47, v18
v_fma_f32 v33, v33, s47, v18
v_mul_f32 v32, v32, v172
v_mfma_f32_16x16x32_bf16 v[156:159], v[68:71], a[220:223], v[156:159]
v_mul_f32 v33, v33, v173
s_waitcnt lgkmcnt(0)
v_mfma_f32_16x16x32_bf16 v[96:99], v[40:43], a[224:227], v[96:99]
buffer_store_dwordx4 v[168:171], v16, s[20:23], s50 offen offset:2048 sc1
v_mfma_f32_16x16x32_bf16 v[96:99], v[44:47], a[240:243], v[96:99]
ds_read_b64_tr_b16 v[56:57], v3 offset:49152
v_exp_f32 v32, v32
v_mfma_f32_16x16x32_bf16 v[100:103], v[40:43], a[228:231], v[100:103]
ds_read_b64_tr_b16 v[58:59], v3 offset:49664
ds_read_b128 a[128:131], v15 offset:32768
v_mul_f32 v188, v188, v172
v_mfma_f32_16x16x32_bf16 v[100:103], v[44:47], a[244:247], v[100:103]
ds_read_b64_tr_b16 v[60:61], v3 offset:57344
v_mul_f32 v189, v189, v173
v_mfma_f32_16x16x32_bf16 v[104:107], v[40:43], a[232:235], v[104:107]
buffer_load_dwordx4 v12, s[16:19], s49 offen offset:2048 lds
v_mfma_f32_16x16x32_bf16 v[104:107], v[44:47], a[248:251], v[104:107]
ds_read_b64_tr_b16 v[62:63], v3 offset:57856
v_exp_f32 v33, v33
v_mfma_f32_16x16x32_bf16 v[108:111], v[40:43], a[236:239], v[108:111]
ds_read_b64_tr_b16 v[64:65], v3 offset:51200
ds_read_b128 a[132:135], v15 offset:33792
v_add_f32 v32, 1.0, v32
v_mfma_f32_16x16x32_bf16 v[108:111], v[44:47], a[252:255], v[108:111]
ds_read_b64_tr_b16 v[66:67], v3 offset:51712
v_add_f32 v33, 1.0, v33
v_mfma_f32_16x16x32_bf16 v[112:115], v[48:51], a[224:227], v[112:115]
ds_write_b128 v14, v[168:171] offset:51200
ds_read_b128 a[136:139], v15 offset:34816
v_mfma_f32_16x16x32_bf16 v[112:115], v[52:55], a[240:243], v[112:115]
ds_read_b64_tr_b16 v[68:69], v3 offset:59392
v_mul_f32 v34, v174, v174
v_mfma_f32_16x16x32_bf16 v[116:119], v[48:51], a[228:231], v[116:119]
ds_read_b64_tr_b16 v[70:71], v3 offset:59904
ds_read_b128 a[140:143], v15 offset:35840
v_mul_f32 v35, v175, v175
v_mfma_f32_16x16x32_bf16 v[116:119], v[52:55], a[244:247], v[116:119]
ds_read_b128 a[144:147], v15 offset:40960
v_fma_f32 v34, v34, s47, v18
v_mfma_f32_16x16x32_bf16 v[120:123], v[48:51], a[232:235], v[120:123]
buffer_load_dwordx4 v13, s[16:19], s49 offen offset:3072 lds
v_mfma_f32_16x16x32_bf16 v[120:123], v[52:55], a[248:251], v[120:123]
s_add_u32 m0, s37, 49152
v_rcp_f32 v32, v32
v_mfma_f32_16x16x32_bf16 v[124:127], v[48:51], a[236:239], v[124:127]
s_mov_b32 s48, 75776
s_waitcnt vmcnt(19) lgkmcnt(0)
v_mfma_f32_16x16x32_bf16 v[124:127], v[52:55], a[252:255], v[124:127]
s_barrier
v_mfma_f32_16x16x32_bf16 v[128:131], v[56:59], a[224:227], v[128:131]
ds_read_b128 a[148:151], v15 offset:41984
ds_read_b128 a[152:155], v15 offset:43008
v_rcp_f32 v33, v33
v_mfma_f32_16x16x32_bf16 v[128:131], v[60:63], a[240:243], v[128:131]
ds_read_b64_tr_b16 v[40:41], v4 offset:0
v_mul_f32 v188, v188, v32
v_mfma_f32_16x16x32_bf16 v[132:135], v[56:59], a[228:231], v[132:135]
ds_read_b64_tr_b16 v[42:43], v4 offset:512
ds_read_b128 a[156:159], v15 offset:44032
v_mul_f32 v189, v189, v33
v_mfma_f32_16x16x32_bf16 v[132:135], v[60:63], a[244:247], v[132:135]
ds_read_b64_tr_b16 v[44:45], v4 offset:8192
v_fma_f32 v35, v35, s47, v18
v_mul_f32 v34, v34, v174
v_mfma_f32_16x16x32_bf16 v[136:139], v[56:59], a[232:235], v[136:139]
buffer_load_dwordx4 v12, s[16:19], s48 offen offset:0 lds
v_mfma_f32_16x16x32_bf16 v[136:139], v[60:63], a[248:251], v[136:139]
ds_read_b64_tr_b16 v[46:47], v4 offset:8704
v_mul_f32 v35, v35, v175
v_mul_f32 v190, v190, v174
v_mfma_f32_16x16x32_bf16 v[140:143], v[56:59], a[236:239], v[140:143]
ds_read_b64_tr_b16 v[48:49], v4 offset:2048
v_mul_f32 v191, v191, v175
v_mfma_f32_16x16x32_bf16 v[140:143], v[60:63], a[252:255], v[140:143]
ds_read_b64_tr_b16 v[50:51], v4 offset:2560
v_exp_f32 v34, v34
v_mfma_f32_16x16x32_bf16 v[144:147], v[64:67], a[224:227], v[144:147]
buffer_load_dword v78, v79, s[20:23], 0 offen sc1
v_mfma_f32_16x16x32_bf16 v[144:147], v[68:71], a[240:243], v[144:147]
ds_read_b64_tr_b16 v[52:53], v4 offset:10240
v_exp_f32 v35, v35
v_mfma_f32_16x16x32_bf16 v[148:151], v[64:67], a[228:231], v[148:151]
ds_read_b64_tr_b16 v[54:55], v4 offset:10752
v_add_f32 v34, 1.0, v34
v_add_f32 v35, 1.0, v35
v_mfma_f32_16x16x32_bf16 v[148:151], v[68:71], a[244:247], v[148:151]
v_rcp_f32 v34, v34
v_mfma_f32_16x16x32_bf16 v[152:155], v[64:67], a[232:235], v[152:155]
buffer_load_dwordx4 v13, s[16:19], s48 offen offset:1024 lds
v_mfma_f32_16x16x32_bf16 v[152:155], v[68:71], a[248:251], v[152:155]
s_mov_b32 s49, 73856
v_rcp_f32 v35, v35
v_mul_f32 v190, v190, v34
v_mfma_f32_16x16x32_bf16 v[156:159], v[64:67], a[236:239], v[156:159]
v_mul_f32 v191, v191, v35
v_cvt_pk_bf16_f32 v172, v188, v189
v_mfma_f32_16x16x32_bf16 v[156:159], v[68:71], a[252:255], v[156:159]
v_cvt_pk_bf16_f32 v173, v190, v191
v_mul_f32 v36, v204, v204
s_waitcnt lgkmcnt(0)
v_mfma_f32_16x16x32_bf16 v[96:99], v[40:43], v[224:227], v[96:99]
v_mul_f32 v37, v205, v205
v_fma_f32 v36, v36, s47, v18
v_mfma_f32_16x16x32_bf16 v[96:99], v[44:47], v[240:243], v[96:99]
ds_read_b64_tr_b16 v[56:57], v5 offset:0
v_fma_f32 v37, v37, s47, v18
v_mul_f32 v36, v36, v204
v_mfma_f32_16x16x32_bf16 v[100:103], v[40:43], v[228:231], v[100:103]
ds_read_b64_tr_b16 v[58:59], v5 offset:512
v_mul_f32 v37, v37, v205
v_mul_f32 v220, v220, v204
v_mfma_f32_16x16x32_bf16 v[100:103], v[44:47], v[244:247], v[100:103]
ds_read_b64_tr_b16 v[60:61], v5 offset:8192
v_mul_f32 v221, v221, v205
v_mfma_f32_16x16x32_bf16 v[104:107], v[40:43], v[232:235], v[104:107]
buffer_load_dwordx4 v12, s[16:19], s49 offen offset:2048 lds
v_mfma_f32_16x16x32_bf16 v[104:107], v[44:47], v[248:251], v[104:107]
ds_read_b64_tr_b16 v[62:63], v5 offset:8704
v_exp_f32 v36, v36
v_mfma_f32_16x16x32_bf16 v[108:111], v[40:43], v[236:239], v[108:111]
ds_read_b64_tr_b16 v[64:65], v5 offset:2048
v_exp_f32 v37, v37
v_mfma_f32_16x16x32_bf16 v[108:111], v[44:47], v[252:255], v[108:111]
ds_read_b64_tr_b16 v[66:67], v5 offset:2560
v_add_f32 v36, 1.0, v36
v_add_f32 v37, 1.0, v37
v_mfma_f32_16x16x32_bf16 v[112:115], v[48:51], v[224:227], v[112:115]
v_rcp_f32 v36, v36
v_mfma_f32_16x16x32_bf16 v[112:115], v[52:55], v[240:243], v[112:115]
ds_read_b64_tr_b16 v[68:69], v5 offset:10240
v_rcp_f32 v37, v37
v_mfma_f32_16x16x32_bf16 v[116:119], v[48:51], v[228:231], v[116:119]
ds_read_b64_tr_b16 v[70:71], v5 offset:10752
v_mul_f32 v220, v220, v36
v_mfma_f32_16x16x32_bf16 v[116:119], v[52:55], v[244:247], v[116:119]
v_mul_f32 v221, v221, v37
v_mul_f32 v38, v206, v206
v_mul_f32 v39, v207, v207
v_mfma_f32_16x16x32_bf16 v[120:123], v[48:51], v[232:235], v[120:123]
buffer_load_dwordx4 v13, s[16:19], s49 offen offset:3072 lds
v_mfma_f32_16x16x32_bf16 v[120:123], v[52:55], v[248:251], v[120:123]
s_add_u32 m0, s37, 65536
v_fma_f32 v38, v38, s47, v18
v_fma_f32 v39, v39, s47, v18
v_mfma_f32_16x16x32_bf16 v[124:127], v[48:51], v[236:239], v[124:127]
s_mov_b32 s48, 149504
s_waitcnt vmcnt(16) lgkmcnt(0)
v_mfma_f32_16x16x32_bf16 v[124:127], v[52:55], v[252:255], v[124:127]
s_barrier
v_mfma_f32_16x16x32_bf16 v[128:131], v[56:59], v[224:227], v[128:131]
v_mul_f32 v38, v38, v206
v_mul_f32 v39, v39, v207
v_exp_f32 v38, v38
v_mfma_f32_16x16x32_bf16 v[128:131], v[60:63], v[240:243], v[128:131]
ds_read_b64_tr_b16 v[40:41], v6 offset:0
v_mul_f32 v222, v222, v206
v_mfma_f32_16x16x32_bf16 v[132:135], v[56:59], v[228:231], v[132:135]
ds_read_b64_tr_b16 v[42:43], v6 offset:4096
v_exp_f32 v39, v39
v_mfma_f32_16x16x32_bf16 v[132:135], v[60:63], v[244:247], v[132:135]
ds_read_b64_tr_b16 v[44:45], v6 offset:8192
v_mul_f32 v223, v223, v207
v_mfma_f32_16x16x32_bf16 v[136:139], v[56:59], v[232:235], v[136:139]
buffer_load_dwordx4 v12, s[16:19], s48 offen offset:0 lds
v_mfma_f32_16x16x32_bf16 v[136:139], v[60:63], v[248:251], v[136:139]
ds_read_b64_tr_b16 v[46:47], v6 offset:12288
v_add_f32 v38, 1.0, v38
v_add_f32 v39, 1.0, v39
v_cvt_pk_bf16_f32 v174, v220, v221
v_mfma_f32_16x16x32_bf16 v[140:143], v[56:59], v[236:239], v[140:143]
ds_read_b64_tr_b16 v[48:49], v7 offset:0
v_mfma_f32_16x16x32_bf16 v[140:143], v[60:63], v[252:255], v[140:143]
ds_read_b64_tr_b16 v[50:51], v7 offset:4096
v_rcp_f32 v38, v38
v_mfma_f32_16x16x32_bf16 v[144:147], v[64:67], v[224:227], v[144:147]
v_rcp_f32 v39, v39
v_mfma_f32_16x16x32_bf16 v[144:147], v[68:71], v[240:243], v[144:147]
ds_read_b64_tr_b16 v[52:53], v7 offset:8192
v_mul_f32 v222, v222, v38
v_mul_f32 v223, v223, v39
v_mfma_f32_16x16x32_bf16 v[148:151], v[64:67], v[228:231], v[148:151]
ds_read_b64_tr_b16 v[54:55], v7 offset:12288
v_cvt_pk_bf16_f32 v175, v222, v223
v_mfma_f32_16x16x32_bf16 v[148:151], v[68:71], v[244:247], v[148:151]
ds_write_b128 v14, v[172:175] offset:52224
v_mfma_f32_16x16x32_bf16 v[152:155], v[64:67], v[232:235], v[152:155]
buffer_load_dwordx4 v13, s[16:19], s48 offen offset:1024 lds
buffer_store_dwordx4 v[172:175], v16, s[20:23], s50 offen offset:3072 sc1
v_mfma_f32_16x16x32_bf16 v[152:155], v[68:71], v[248:251], v[152:155]
s_mov_b32 s49, 147584
v_mfma_f32_16x16x32_bf16 v[156:159], v[64:67], v[236:239], v[156:159]
v_mfma_f32_16x16x32_bf16 v[156:159], v[68:71], v[252:255], v[156:159]
s_waitcnt lgkmcnt(0)
v_mfma_f32_16x16x32_bf16 v[160:163], v[40:43], a[0:3], 0
v_mfma_f32_16x16x32_bf16 v[160:163], v[44:47], a[16:19], v[160:163]
ds_read_b64_tr_b16 v[56:57], v6 offset:2048
s_add_u32 s50, s44, 16777216
v_mfma_f32_16x16x32_bf16 v[164:167], v[40:43], a[4:7], 0
ds_read_b64_tr_b16 v[58:59], v6 offset:6144
v_mul_f32 v24, v96, v96
v_mul_f32 v25, v97, v97
v_mfma_f32_16x16x32_bf16 v[164:167], v[44:47], a[20:23], v[164:167]
ds_read_b64_tr_b16 v[60:61], v6 offset:10240
v_fma_f32 v24, v24, s47, v18
v_mfma_f32_16x16x32_bf16 v[168:171], v[40:43], a[8:11], 0
buffer_load_dwordx4 v12, s[16:19], s49 offen offset:2048 lds
v_mfma_f32_16x16x32_bf16 v[168:171], v[44:47], a[24:27], v[168:171]
ds_read_b64_tr_b16 v[62:63], v6 offset:14336
v_fma_f32 v25, v25, s47, v18
v_mul_f32 v24, v24, v96
v_mfma_f32_16x16x32_bf16 v[172:175], v[40:43], a[12:15], 0
ds_read_b64_tr_b16 v[64:65], v7 offset:2048
v_mul_f32 v25, v25, v97
v_mul_f32 v112, v112, v96
v_mfma_f32_16x16x32_bf16 v[172:175], v[44:47], a[28:31], v[172:175]
ds_read_b64_tr_b16 v[66:67], v7 offset:6144
v_mul_f32 v113, v113, v97
v_mfma_f32_16x16x32_bf16 v[176:179], v[48:51], a[0:3], 0
v_exp_f32 v24, v24
v_mul_f32 v26, v98, v98
v_mfma_f32_16x16x32_bf16 v[176:179], v[52:55], a[16:19], v[176:179]
ds_read_b64_tr_b16 v[68:69], v7 offset:10240
v_add_f32 v24, 1.0, v24
v_mfma_f32_16x16x32_bf16 v[180:183], v[48:51], a[4:7], 0
ds_read_b64_tr_b16 v[70:71], v7 offset:14336
v_exp_f32 v25, v25
v_mfma_f32_16x16x32_bf16 v[180:183], v[52:55], a[20:23], v[180:183]
s_waitcnt vmcnt(7)
v_readfirstlane_b32 s58, v78
s_cmp_ge_u32 s58, 3
s_cbranch_scc0 L_spin3
L_back3:
v_mfma_f32_16x16x32_bf16 v[184:187], v[48:51], a[8:11], 0
buffer_load_dwordx4 v13, s[16:19], s49 offen offset:3072 lds
v_mfma_f32_16x16x32_bf16 v[184:187], v[52:55], a[24:27], v[184:187]
s_add_u32 m0, s37, 0
v_add_f32 v25, 1.0, v25
v_mul_f32 v27, v99, v99
v_mfma_f32_16x16x32_bf16 v[188:191], v[48:51], a[12:15], 0
s_mov_b32 s48, 223232
s_waitcnt lgkmcnt(0)
v_mfma_f32_16x16x32_bf16 v[188:191], v[52:55], a[28:31], v[188:191]
s_barrier
v_mfma_f32_16x16x32_bf16 v[192:195], v[56:59], a[0:3], 0
ds_read_b128 a[160:163], v15 offset:49152
ds_read_b128 a[164:167], v15 offset:50176
s_add_u32 s51, s45, 8388608
v_fma_f32 v26, v26, s47, v18
v_mfma_f32_16x16x32_bf16 v[192:195], v[60:63], a[16:19], v[192:195]
ds_read_b64_tr_b16 v[40:41], v6 offset:16384
v_rcp_f32 v24, v24
v_mfma_f32_16x16x32_bf16 v[196:199], v[56:59], a[4:7], 0
ds_read_b64_tr_b16 v[42:43], v6 offset:20480
ds_read_b128 a[168:171], v15 offset:51200
v_mul_f32 v112, v112, v24
v_mfma_f32_16x16x32_bf16 v[196:199], v[60:63], a[20:23], v[196:199]
ds_read_b64_tr_b16 v[44:45], v6 offset:24576
v_fma_f32 v27, v27, s47, v18
v_mfma_f32_16x16x32_bf16 v[200:203], v[56:59], a[8:11], 0
buffer_load_dwordx4 v12, s[16:19], s48 offen offset:0 lds
v_mfma_f32_16x16x32_bf16 v[200:203], v[60:63], a[24:27], v[200:203]
ds_read_b64_tr_b16 v[46:47], v6 offset:28672
v_rcp_f32 v25, v25
v_mfma_f32_16x16x32_bf16 v[204:207], v[56:59], a[12:15], 0
ds_read_b64_tr_b16 v[48:49], v7 offset:16384
ds_read_b128 a[172:175], v15 offset:52224
v_mul_f32 v113, v113, v25
v_mfma_f32_16x16x32_bf16 v[204:207], v[60:63], a[28:31], v[204:207]
ds_read_b64_tr_b16 v[50:51], v7 offset:20480
v_mul_f32 v26, v26, v98
v_mul_f32 v27, v27, v99
v_mfma_f32_16x16x32_bf16 v[208:211], v[64:67], a[0:3], 0
buffer_load_dwordx4 a[192:195], v17, s[20:23], s51 offen offset:0
v_mfma_f32_16x16x32_bf16 v[208:211], v[68:71], a[16:19], v[208:211]
ds_read_b64_tr_b16 v[52:53], v7 offset:24576
v_exp_f32 v26, v26
v_mfma_f32_16x16x32_bf16 v[212:215], v[64:67], a[4:7], 0
ds_read_b64_tr_b16 v[54:55], v7 offset:28672
ds_read_b128 a[176:179], v15 offset:57344
v_mul_f32 v114, v114, v98
v_mfma_f32_16x16x32_bf16 v[212:215], v[68:71], a[20:23], v[212:215]
ds_read_b128 a[180:183], v15 offset:58368
v_mul_f32 v115, v115, v99
v_mfma_f32_16x16x32_bf16 v[216:219], v[64:67], a[8:11], 0
buffer_load_dwordx4 v13, s[16:19], s48 offen offset:1024 lds
v_mfma_f32_16x16x32_bf16 v[216:219], v[68:71], a[24:27], v[216:219]
s_mov_b32 s49, 221312
v_exp_f32 v27, v27
v_add_f32 v26, 1.0, v26
v_mfma_f32_16x16x32_bf16 v[220:223], v[64:67], a[12:15], 0
v_add_f32 v27, 1.0, v27
v_cvt_pk_bf16_f32 v96, v112, v113
v_mfma_f32_16x16x32_bf16 v[220:223], v[68:71], a[28:31], v[220:223]
v_rcp_f32 v26, v26
s_waitcnt lgkmcnt(0)
v_mfma_f32_16x16x32_bf16 v[160:163], v[40:43], a[32:35], v[160:163]
buffer_load_dwordx4 a[196:199], v17, s[20:23], s51 offen offset:1024
v_mfma_f32_16x16x32_bf16 v[160:163], v[44:47], a[48:51], v[160:163]
ds_read_b64_tr_b16 v[56:57], v6 offset:18432
v_rcp_f32 v27, v27
v_mfma_f32_16x16x32_bf16 v[164:167], v[40:43], a[36:39], v[164:167]
ds_read_b64_tr_b16 v[58:59], v6 offset:22528
ds_read_b128 a[184:187], v15 offset:59392
v_mul_f32 v114, v114, v26
v_mfma_f32_16x16x32_bf16 v[164:167], v[44:47], a[52:55], v[164:167]
ds_read_b64_tr_b16 v[60:61], v6 offset:26624
v_mul_f32 v115, v115, v27
v_cvt_pk_bf16_f32 v97, v114, v115
v_mfma_f32_16x16x32_bf16 v[168:171], v[40:43], a[40:43], v[168:171]
buffer_load_dwordx4 v12, s[16:19], s49 offen offset:2048 lds
v_mfma_f32_16x16x32_bf16 v[168:171], v[44:47], a[56:59], v[168:171]
ds_read_b64_tr_b16 v[62:63], v6 offset:30720
v_mul_f32 v28, v128, v128
v_mul_f32 v29, v129, v129
v_mfma_f32_16x16x32_bf16 v[172:175], v[40:43], a[44:47], v[172:175]
ds_read_b64_tr_b16 v[64:65], v7 offset:18432
ds_read_b128 a[188:191], v15 offset:60416
v_fma_f32 v28, v28, s47, v18
v_mfma_f32_16x16x32_bf16 v[172:175], v[44:47], a[60:63], v[172:175]
ds_read_b64_tr_b16 v[66:67], v7 offset:22528
v_fma_f32 v29, v29, s47, v18
v_mfma_f32_16x16x32_bf16 v[176:179], v[48:51], a[32:35], v[176:179]
buffer_load_dword v78, v79, s[20:23], 0 offen sc1
v_mfma_f32_16x16x32_bf16 v[176:179], v[52:55], a[48:51], v[176:179]
ds_read_b64_tr_b16 v[68:69], v7 offset:26624
v_mul_f32 v28, v28, v128
v_mul_f32 v29, v29, v129
v_mfma_f32_16x16x32_bf16 v[180:183], v[48:51], a[36:39], v[180:183]
ds_read_b64_tr_b16 v[70:71], v7 offset:30720
v_exp_f32 v28, v28
v_mfma_f32_16x16x32_bf16 v[180:183], v[52:55], a[52:55], v[180:183]
v_exp_f32 v29, v29
v_mul_f32 v144, v144, v128
v_mfma_f32_16x16x32_bf16 v[184:187], v[48:51], a[40:43], v[184:187]
buffer_load_dwordx4 v13, s[16:19], s49 offen offset:3072 lds
v_mfma_f32_16x16x32_bf16 v[184:187], v[52:55], a[56:59], v[184:187]
s_add_u32 m0, s37, 16384
v_mul_f32 v145, v145, v129
v_add_f32 v28, 1.0, v28
v_mfma_f32_16x16x32_bf16 v[188:191], v[48:51], a[44:47], v[188:191]
s_mov_b32 s48, 518144
s_waitcnt lgkmcnt(0)
v_mfma_f32_16x16x32_bf16 v[188:191], v[52:55], a[60:63], v[188:191]
s_barrier
v_mfma_f32_16x16x32_bf16 v[192:195], v[56:59], a[32:35], v[192:195]
buffer_load_dwordx4 a[200:203], v17, s[20:23], s51 offen offset:2048
v_mfma_f32_16x16x32_bf16 v[192:195], v[60:63], a[48:51], v[192:195]
ds_read_b64_tr_b16 v[40:41], v6 offset:32768
v_add_f32 v29, 1.0, v29
v_rcp_f32 v28, v28
v_mul_f32 v30, v130, v130
v_mfma_f32_16x16x32_bf16 v[196:199], v[56:59], a[36:39], v[196:199]
ds_read_b64_tr_b16 v[42:43], v6 offset:36864
v_mul_f32 v144, v144, v28
v_mfma_f32_16x16x32_bf16 v[196:199], v[60:63], a[52:55], v[196:199]
ds_read_b64_tr_b16 v[44:45], v6 offset:40960
v_rcp_f32 v29, v29
v_mfma_f32_16x16x32_bf16 v[200:203], v[56:59], a[40:43], v[200:203]
buffer_load_dwordx4 v12, s[16:19], s48 offen offset:0 lds
v_mfma_f32_16x16x32_bf16 v[200:203], v[60:63], a[56:59], v[200:203]
ds_read_b64_tr_b16 v[46:47], v6 offset:45056
v_mul_f32 v145, v145, v29
v_mul_f32 v31, v131, v131
v_mfma_f32_16x16x32_bf16 v[204:207], v[56:59], a[44:47], v[204:207]
ds_read_b64_tr_b16 v[48:49], v7 offset:32768
v_fma_f32 v30, v30, s47, v18
v_fma_f32 v31, v31, s47, v18
v_mfma_f32_16x16x32_bf16 v[204:207], v[60:63], a[60:63], v[204:207]
ds_read_b64_tr_b16 v[50:51], v7 offset:36864
v_mul_f32 v30, v30, v130
v_mul_f32 v31, v31, v131
v_mfma_f32_16x16x32_bf16 v[208:211], v[64:67], a[32:35], v[208:211]
buffer_load_dwordx4 a[204:207], v17, s[20:23], s51 offen offset:3072
v_mfma_f32_16x16x32_bf16 v[208:211], v[68:71], a[48:51], v[208:211]
ds_read_b64_tr_b16 v[52:53], v7 offset:40960
s_add_u32 s51, s45, 8396800
v_mul_f32 v146, v146, v130
v_mfma_f32_16x16x32_bf16 v[212:215], v[64:67], a[36:39], v[212:215]
ds_read_b64_tr_b16 v[54:55], v7 offset:45056
v_mul_f32 v147, v147, v131
v_mfma_f32_16x16x32_bf16 v[212:215], v[68:71], a[52:55], v[212:215]
v_exp_f32 v30, v30
v_cvt_pk_bf16_f32 v98, v144, v145
v_mfma_f32_16x16x32_bf16 v[216:219], v[64:67], a[40:43], v[216:219]
buffer_load_dwordx4 v13, s[16:19], s48 offen offset:1024 lds
v_mfma_f32_16x16x32_bf16 v[216:219], v[68:71], a[56:59], v[216:219]
s_mov_b32 s49, 516224
v_exp_f32 v31, v31
v_mfma_f32_16x16x32_bf16 v[220:223], v[64:67], a[44:47], v[220:223]
v_add_f32 v30, 1.0, v30
v_add_f32 v31, 1.0, v31
v_mul_f32 v32, v100, v100
v_mfma_f32_16x16x32_bf16 v[220:223], v[68:71], a[60:63], v[220:223]
v_rcp_f32 v30, v30
s_waitcnt lgkmcnt(0)
v_mfma_f32_16x16x32_bf16 v[160:163], v[40:43], a[64:67], v[160:163]
buffer_load_dwordx4 a[208:211], v17, s[20:23], s51 offen offset:0
v_mfma_f32_16x16x32_bf16 v[160:163], v[44:47], a[80:83], v[160:163]
ds_read_b64_tr_b16 v[56:57], v6 offset:34816
v_rcp_f32 v31, v31
v_mfma_f32_16x16x32_bf16 v[164:167], v[40:43], a[68:71], v[164:167]
ds_read_b64_tr_b16 v[58:59], v6 offset:38912
v_mul_f32 v146, v146, v30
v_mul_f32 v147, v147, v31
v_mfma_f32_16x16x32_bf16 v[164:167], v[44:47], a[84:87], v[164:167]
ds_read_b64_tr_b16 v[60:61], v6 offset:43008
v_cvt_pk_bf16_f32 v99, v146, v147
v_mfma_f32_16x16x32_bf16 v[168:171], v[40:43], a[72:75], v[168:171]
buffer_load_dwordx4 v12, s[16:19], s49 offen offset:2048 lds
v_mfma_f32_16x16x32_bf16 v[168:171], v[44:47], a[88:91], v[168:171]
ds_read_b64_tr_b16 v[62:63], v6 offset:47104
v_mul_f32 v33, v101, v101
v_fma_f32 v32, v32, s47, v18
v_fma_f32 v33, v33, s47, v18
v_mfma_f32_16x16x32_bf16 v[172:175], v[40:43], a[76:79], v[172:175]
ds_read_b64_tr_b16 v[64:65], v7 offset:34816
v_mul_f32 v32, v32, v100
v_mfma_f32_16x16x32_bf16 v[172:175], v[44:47], a[92:95], v[172:175]
ds_read_b64_tr_b16 v[66:67], v7 offset:38912
v_mul_f32 v33, v33, v101
v_mul_f32 v116, v116, v100
v_mfma_f32_16x16x32_bf16 v[176:179], v[48:51], a[64:67], v[176:179]
buffer_load_dwordx4 a[212:215], v17, s[20:23], s51 offen offset:1024
v_mfma_f32_16x16x32_bf16 v[176:179], v[52:55], a[80:83], v[176:179]
ds_read_b64_tr_b16 v[68:69], v7 offset:43008
v_exp_f32 v32, v32
v_mfma_f32_16x16x32_bf16 v[180:183], v[48:51], a[68:71], v[180:183]
ds_read_b64_tr_b16 v[70:71], v7 offset:47104
v_exp_f32 v33, v33
v_mfma_f32_16x16x32_bf16 v[180:183], v[52:55], a[84:87], v[180:183]
ds_write_b128 v22, v[96:99] offset:0
v_mfma_f32_16x16x32_bf16 v[184:187], v[48:51], a[72:75], v[184:187]
buffer_load_dwordx4 v13, s[16:19], s49 offen offset:3072 lds
v_mfma_f32_16x16x32_bf16 v[184:187], v[52:55], a[88:91], v[184:187]
s_add_u32 m0, s37, 32768
v_mul_f32 v117, v117, v101
v_add_f32 v32, 1.0, v32
v_add_f32 v33, 1.0, v33
v_mfma_f32_16x16x32_bf16 v[188:191], v[48:51], a[76:79], v[188:191]
s_mov_b32 s48, 591872
s_waitcnt vmcnt(17) lgkmcnt(0)
v_mfma_f32_16x16x32_bf16 v[188:191], v[52:55], a[92:95], v[188:191]
s_barrier
v_mfma_f32_16x16x32_bf16 v[192:195], v[56:59], a[64:67], v[192:195]
buffer_load_dwordx4 a[216:219], v17, s[20:23], s51 offen offset:2048
v_mfma_f32_16x16x32_bf16 v[192:195], v[60:63], a[80:83], v[192:195]
ds_read_b64_tr_b16 v[40:41], v6 offset:49152
v_rcp_f32 v32, v32
v_mul_f32 v34, v102, v102
v_mfma_f32_16x16x32_bf16 v[196:199], v[56:59], a[68:71], v[196:199]
ds_read_b64_tr_b16 v[42:43], v6 offset:53248
v_rcp_f32 v33, v33
v_mfma_f32_16x16x32_bf16 v[196:199], v[60:63], a[84:87], v[196:199]
ds_read_b64_tr_b16 v[44:45], v6 offset:57344
v_mul_f32 v116, v116, v32
v_mul_f32 v117, v117, v33
v_mfma_f32_16x16x32_bf16 v[200:203], v[56:59], a[72:75], v[200:203]
buffer_load_dwordx4 v12, s[16:19], s48 offen offset:0 lds
v_mfma_f32_16x16x32_bf16 v[200:203], v[60:63], a[88:91], v[200:203]
ds_read_b64_tr_b16 v[46:47], v6 offset:61440
v_mul_f32 v35, v103, v103
v_fma_f32 v34, v34, s47, v18
v_mfma_f32_16x16x32_bf16 v[204:207], v[56:59], a[76:79], v[204:207]
ds_read_b64_tr_b16 v[48:49], v7 offset:49152
v_mov_b32 v20, 3
v_mfma_f32_16x16x32_bf16 v[204:207], v[60:63], a[92:95], v[204:207]
ds_read_b64_tr_b16 v[50:51], v7 offset:53248
v_fma_f32 v35, v35, s47, v18
v_mul_f32 v34, v34, v102
v_mfma_f32_16x16x32_bf16 v[208:211], v[64:67], a[64:67], v[208:211]
buffer_store_dword v20, v19, s[20:23], 0 offen sc1
v_mfma_f32_16x16x32_bf16 v[208:211], v[68:71], a[80:83], v[208:211]
ds_read_b64_tr_b16 v[52:53], v7 offset:57344
v_mul_f32 v35, v35, v103
v_mul_f32 v118, v118, v102
v_mfma_f32_16x16x32_bf16 v[212:215], v[64:67], a[68:71], v[212:215]
ds_read_b64_tr_b16 v[54:55], v7 offset:61440
v_exp_f32 v34, v34
v_mfma_f32_16x16x32_bf16 v[212:215], v[68:71], a[84:87], v[212:215]
s_waitcnt vmcnt(12)
v_readfirstlane_b32 s58, v78
s_cmp_ge_u32 s58, 4
s_cbranch_scc0 L_spin4
L_back4:
v_mfma_f32_16x16x32_bf16 v[216:219], v[64:67], a[72:75], v[216:219]
buffer_load_dwordx4 v13, s[16:19], s48 offen offset:1024 lds
v_mfma_f32_16x16x32_bf16 v[216:219], v[68:71], a[88:91], v[216:219]
s_mov_b32 s49, 589952
v_exp_f32 v35, v35
v_mul_f32 v119, v119, v103
v_mfma_f32_16x16x32_bf16 v[220:223], v[64:67], a[76:79], v[220:223]
v_add_f32 v34, 1.0, v34
v_add_f32 v35, 1.0, v35
v_cvt_pk_bf16_f32 v100, v116, v117
v_mfma_f32_16x16x32_bf16 v[220:223], v[68:71], a[92:95], v[220:223]
v_rcp_f32 v34, v34
buffer_load_dwordx4 a[220:223], v17, s[20:23], s51 offen offset:3072
s_waitcnt lgkmcnt(0)
v_mfma_f32_16x16x32_bf16 v[160:163], v[40:43], a[96:99], v[160:163]
buffer_store_dwordx4 v[96:99], v16, s[20:23], s50 offen offset:0 sc1
v_mfma_f32_16x16x32_bf16 v[160:163], v[44:47], a[112:115], v[160:163]
ds_read_b64_tr_b16 v[56:57], v6 offset:51200
s_add_u32 s51, s45, 12582912
v_mul_f32 v118, v118, v34
v_mfma_f32_16x16x32_bf16 v[164:167], v[40:43], a[100:103], v[164:167]
ds_read_b64_tr_b16 v[58:59], v6 offset:55296
v_rcp_f32 v35, v35
v_mfma_f32_16x16x32_bf16 v[164:167], v[44:47], a[116:119], v[164:167]
ds_read_b64_tr_b16 v[60:61], v6 offset:59392
v_mul_f32 v119, v119, v35
v_cvt_pk_bf16_f32 v101, v118, v119
v_mfma_f32_16x16x32_bf16 v[168:171], v[40:43], a[104:107], v[168:171]
buffer_load_dwordx4 v12, s[16:19], s49 offen offset:2048 lds
v_mfma_f32_16x16x32_bf16 v[168:171], v[44:47], a[120:123], v[168:171]
ds_read_b64_tr_b16 v[62:63], v6 offset:63488
v_mul_f32 v36, v132, v132
v_mul_f32 v37, v133, v133
v_mfma_f32_16x16x32_bf16 v[172:175], v[40:43], a[108:111], v[172:175]
ds_read_b64_tr_b16 v[64:65], v7 offset:51200
v_fma_f32 v36, v36, s47, v18
v_fma_f32 v37, v37, s47, v18
v_mfma_f32_16x16x32_bf16 v[172:175], v[44:47], a[124:127], v[172:175]
ds_read_b64_tr_b16 v[66:67], v7 offset:55296
v_mul_f32 v36, v36, v132
v_mul_f32 v37, v37, v133
v_mfma_f32_16x16x32_bf16 v[176:179], v[48:51], a[96:99], v[176:179]
buffer_load_dwordx4 a[224:227], v17, s[20:23], s51 offen offset:0
v_mfma_f32_16x16x32_bf16 v[176:179], v[52:55], a[112:115], v[176:179]
ds_read_b64_tr_b16 v[68:69], v7 offset:59392
v_exp_f32 v36, v36
v_mfma_f32_16x16x32_bf16 v[180:183], v[48:51], a[100:103], v[180:183]
ds_read_b64_tr_b16 v[70:71], v7 offset:63488
v_exp_f32 v37, v37
v_mfma_f32_16x16x32_bf16 v[180:183], v[52:55], a[116:119], v[180:183]
v_mul_f32 v148, v148, v132
v_mul_f32 v149, v149, v133
v_add_f32 v36, 1.0, v36
v_mfma_f32_16x16x32_bf16 v[184:187], v[48:51], a[104:107], v[184:187]
buffer_load_dwordx4 v13, s[16:19], s49 offen offset:3072 lds
v_mfma_f32_16x16x32_bf16 v[184:187], v[52:55], a[120:123], v[184:187]
s_add_u32 m0, s37, 49152
v_add_f32 v37, 1.0, v37
v_mul_f32 v38, v134, v134
v_mfma_f32_16x16x32_bf16 v[188:191], v[48:51], a[108:111], v[188:191]
s_mov_b32 s48, 296960
s_waitcnt lgkmcnt(0)
v_mfma_f32_16x16x32_bf16 v[188:191], v[52:55], a[124:127], v[188:191]
s_barrier
v_mfma_f32_16x16x32_bf16 v[192:195], v[56:59], a[96:99], v[192:195]
buffer_load_dwordx4 a[228:231], v17, s[20:23], s51 offen offset:1024
v_mfma_f32_16x16x32_bf16 v[192:195], v[60:63], a[112:115], v[192:195]
ds_read_b64_tr_b16 v[40:41], v8 offset:0
v_rcp_f32 v36, v36
v_rcp_f32 v37, v37
v_mfma_f32_16x16x32_bf16 v[196:199], v[56:59], a[100:103], v[196:199]
ds_read_b64_tr_b16 v[42:43], v8 offset:4096
v_mul_f32 v148, v148, v36
v_mul_f32 v149, v149, v37
v_mfma_f32_16x16x32_bf16 v[196:199], v[60:63], a[116:119], v[196:199]
ds_read_b64_tr_b16 v[44:45], v8 offset:8192
v_mul_f32 v39, v135, v135
v_fma_f32 v38, v38, s47, v18
v_mfma_f32_16x16x32_bf16 v[200:203], v[56:59], a[104:107], v[200:203]
buffer_load_dwordx4 v12, s[16:19], s48 offen offset:0 lds
v_mfma_f32_16x16x32_bf16 v[200:203], v[60:63], a[120:123], v[200:203]
ds_read_b64_tr_b16 v[46:47], v8 offset:12288
v_fma_f32 v39, v39, s47, v18
v_mul_f32 v38, v38, v134
v_mfma_f32_16x16x32_bf16 v[204:207], v[56:59], a[108:111], v[204:207]
ds_read_b64_tr_b16 v[48:49], v9 offset:0
v_mul_f32 v39, v39, v135
v_mul_f32 v150, v150, v134
v_mfma_f32_16x16x32_bf16 v[204:207], v[60:63], a[124:127], v[204:207]
ds_read_b64_tr_b16 v[50:51], v9 offset:4096
v_exp_f32 v38, v38
v_mfma_f32_16x16x32_bf16 v[208:211], v[64:67], a[96:99], v[208:211]
buffer_load_dwordx4 a[232:235], v17, s[20:23], s51 offen offset:2048
v_mfma_f32_16x16x32_bf16 v[208:211], v[68:71], a[112:115], v[208:211]
ds_read_b64_tr_b16 v[52:53], v9 offset:8192
v_exp_f32 v39, v39
v_mfma_f32_16x16x32_bf16 v[212:215], v[64:67], a[100:103], v[212:215]
ds_read_b64_tr_b16 v[54:55], v9 offset:12288
v_mul_f32 v151, v151, v135
v_add_f32 v38, 1.0, v38
v_mfma_f32_16x16x32_bf16 v[212:215], v[68:71], a[116:119], v[212:215]
v_add_f32 v39, 1.0, v39
v_rcp_f32 v38, v38
v_mfma_f32_16x16x32_bf16 v[216:219], v[64:67], a[104:107], v[216:219]
buffer_load_dwordx4 v13, s[16:19], s48 offen offset:1024 lds
v_mfma_f32_16x16x32_bf16 v[216:219], v[68:71], a[120:123], v[216:219]
s_mov_b32 s49, 295040
v_rcp_f32 v39, v39
v_mfma_f32_16x16x32_bf16 v[220:223], v[64:67], a[108:111], v[220:223]
v_mul_f32 v150, v150, v38
v_mul_f32 v151, v151, v39
v_cvt_pk_bf16_f32 v102, v148, v149
v_mfma_f32_16x16x32_bf16 v[220:223], v[68:71], a[124:127], v[220:223]
v_cvt_pk_bf16_f32 v103, v150, v151
v_mul_f32 v24, v104, v104
s_waitcnt lgkmcnt(0)
v_mfma_f32_16x16x32_bf16 v[160:163], v[40:43], a[128:131], v[160:163]
buffer_load_dwordx4 a[236:239], v17, s[20:23], s51 offen offset:3072
v_mfma_f32_16x16x32_bf16 v[160:163], v[44:47], a[144:147], v[160:163]
ds_read_b64_tr_b16 v[56:57], v8 offset:2048
s_add_u32 s51, s45, 12591104
v_mul_f32 v25, v105, v105
v_mfma_f32_16x16x32_bf16 v[164:167], v[40:43], a[132:135], v[164:167]
ds_read_b64_tr_b16 v[58:59], v8 offset:6144
v_fma_f32 v24, v24, s47, v18
v_fma_f32 v25, v25, s47, v18
v_mfma_f32_16x16x32_bf16 v[164:167], v[44:47], a[148:151], v[164:167]
ds_read_b64_tr_b16 v[60:61], v8 offset:10240
v_mul_f32 v24, v24, v104
v_mul_f32 v25, v25, v105
v_mfma_f32_16x16x32_bf16 v[168:171], v[40:43], a[136:139], v[168:171]
buffer_load_dwordx4 v12, s[16:19], s49 offen offset:2048 lds
v_mfma_f32_16x16x32_bf16 v[168:171], v[44:47], a[152:155], v[168:171]
ds_read_b64_tr_b16 v[62:63], v8 offset:14336
v_exp_f32 v24, v24
v_mfma_f32_16x16x32_bf16 v[172:175], v[40:43], a[140:143], v[172:175]
ds_read_b64_tr_b16 v[64:65], v9 offset:2048
v_exp_f32 v25, v25
v_mfma_f32_16x16x32_bf16 v[172:175], v[44:47], a[156:159], v[172:175]
ds_read_b64_tr_b16 v[66:67], v9 offset:6144
v_mul_f32 v120, v120, v104
v_mul_f32 v121, v121, v105
v_mfma_f32_16x16x32_bf16 v[176:179], v[48:51], a[128:131], v[176:179]
buffer_load_dwordx4 a[240:243], v17, s[20:23], s51 offen offset:0
v_mfma_f32_16x16x32_bf16 v[176:179], v[52:55], a[144:147], v[176:179]
ds_read_b64_tr_b16 v[68:69], v9 offset:10240
v_add_f32 v24, 1.0, v24
v_add_f32 v25, 1.0, v25
v_mfma_f32_16x16x32_bf16 v[180:183], v[48:51], a[132:135], v[180:183]
ds_read_b64_tr_b16 v[70:71], v9 offset:14336
v_rcp_f32 v24, v24
v_mfma_f32_16x16x32_bf16 v[180:183], v[52:55], a[148:151], v[180:183]
ds_write_b128 v22, v[100:103] offset:1024
v_mul_f32 v120, v120, v24
v_mfma_f32_16x16x32_bf16 v[184:187], v[48:51], a[136:139], v[184:187]
buffer_load_dwordx4 v13, s[16:19], s49 offen offset:3072 lds
v_mfma_f32_16x16x32_bf16 v[184:187], v[52:55], a[152:155], v[184:187]
s_add_u32 m0, s37, 65536
v_rcp_f32 v25, v25
v_mfma_f32_16x16x32_bf16 v[188:191], v[48:51], a[140:143], v[188:191]
s_mov_b32 s48, 370944
s_waitcnt vmcnt(25) lgkmcnt(0)
v_mfma_f32_16x16x32_bf16 v[188:191], v[52:55], a[156:159], v[188:191]
s_barrier
v_mfma_f32_16x16x32_bf16 v[192:195], v[56:59], a[128:131], v[192:195]
buffer_load_dwordx4 a[244:247], v17, s[20:23], s51 offen offset:1024
v_mfma_f32_16x16x32_bf16 v[192:195], v[60:63], a[144:147], v[192:195]
ds_read_b64_tr_b16 v[40:41], v6 offset:0
v_mul_f32 v121, v121, v25
v_mul_f32 v26, v106, v106
v_mul_f32 v27, v107, v107
v_fma_f32 v26, v26, s47, v18
v_mfma_f32_16x16x32_bf16 v[196:199], v[56:59], a[132:135], v[196:199]
ds_read_b64_tr_b16 v[42:43], v6 offset:4096
v_fma_f32 v27, v27, s47, v18
v_mul_f32 v26, v26, v106
v_mfma_f32_16x16x32_bf16 v[196:199], v[60:63], a[148:151], v[196:199]
ds_read_b64_tr_b16 v[44:45], v6 offset:8192
v_mul_f32 v27, v27, v107
v_mfma_f32_16x16x32_bf16 v[200:203], v[56:59], a[136:139], v[200:203]
buffer_load_dwordx4 v12, s[16:19], s48 offen offset:0 lds
v_mfma_f32_16x16x32_bf16 v[200:203], v[60:63], a[152:155], v[200:203]
ds_read_b64_tr_b16 v[46:47], v6 offset:12288
v_exp_f32 v26, v26
v_mul_f32 v122, v122, v106
v_mfma_f32_16x16x32_bf16 v[204:207], v[56:59], a[140:143], v[204:207]
ds_read_b64_tr_b16 v[48:49], v7 offset:0
v_exp_f32 v27, v27
v_mfma_f32_16x16x32_bf16 v[204:207], v[60:63], a[156:159], v[204:207]
ds_read_b64_tr_b16 v[50:51], v7 offset:4096
v_mul_f32 v123, v123, v107
v_mfma_f32_16x16x32_bf16 v[208:211], v[64:67], a[128:131], v[208:211]
buffer_load_dwordx4 a[248:251], v17, s[20:23], s51 offen offset:2048
v_mfma_f32_16x16x32_bf16 v[208:211], v[68:71], a[144:147], v[208:211]
ds_read_b64_tr_b16 v[52:53], v7 offset:8192
v_add_f32 v26, 1.0, v26
v_add_f32 v27, 1.0, v27
v_cvt_pk_bf16_f32 v104, v120, v121
v_mfma_f32_16x16x32_bf16 v[212:215], v[64:67], a[132:135], v[212:215]
ds_read_b64_tr_b16 v[54:55], v7 offset:12288
v_rcp_f32 v26, v26
v_mfma_f32_16x16x32_bf16 v[212:215], v[68:71], a[148:151], v[212:215]
v_rcp_f32 v27, v27
v_mfma_f32_16x16x32_bf16 v[216:219], v[64:67], a[136:139], v[216:219]
buffer_load_dwordx4 v13, s[16:19], s48 offen offset:1024 lds
v_mfma_f32_16x16x32_bf16 v[216:219], v[68:71], a[152:155], v[216:219]
s_mov_b32 s49, 442624
v_mul_f32 v122, v122, v26
v_mul_f32 v123, v123, v27
v_cvt_pk_bf16_f32 v105, v122, v123
v_mfma_f32_16x16x32_bf16 v[220:223], v[64:67], a[140:143], v[220:223]
v_mul_f32 v28, v136, v136
v_mul_f32 v29, v137, v137
v_fma_f32 v28, v28, s47, v18
v_mfma_f32_16x16x32_bf16 v[220:223], v[68:71], a[156:159], v[220:223]
v_fma_f32 v29, v29, s47, v18
s_waitcnt lgkmcnt(0)
v_mfma_f32_16x16x32_bf16 v[160:163], v[40:43], a[160:163], v[160:163]
buffer_load_dwordx4 a[252:255], v17, s[20:23], s51 offen offset:3072
v_mfma_f32_16x16x32_bf16 v[160:163], v[44:47], a[176:179], v[160:163]
ds_read_b64_tr_b16 v[56:57], v6 offset:2048
v_mul_f32 v28, v28, v136
v_mul_f32 v29, v29, v137
v_mul_f32 v152, v152, v136
v_mfma_f32_16x16x32_bf16 v[164:167], v[40:43], a[164:167], v[164:167]
ds_read_b64_tr_b16 v[58:59], v6 offset:6144
v_mul_f32 v153, v153, v137
v_mfma_f32_16x16x32_bf16 v[164:167], v[44:47], a[180:183], v[164:167]
ds_read_b64_tr_b16 v[60:61], v6 offset:10240
v_exp_f32 v28, v28
v_mfma_f32_16x16x32_bf16 v[168:171], v[40:43], a[168:171], v[168:171]
buffer_load_dwordx4 v12, s[16:19], s49 offen offset:2048 lds
v_mfma_f32_16x16x32_bf16 v[168:171], v[44:47], a[184:187], v[168:171]
ds_read_b64_tr_b16 v[62:63], v6 offset:14336
v_exp_f32 v29, v29
v_add_f32 v28, 1.0, v28
v_mfma_f32_16x16x32_bf16 v[172:175], v[40:43], a[172:175], v[172:175]
ds_read_b64_tr_b16 v[64:65], v7 offset:2048
v_add_f32 v29, 1.0, v29
v_mfma_f32_16x16x32_bf16 v[172:175], v[44:47], a[188:191], v[172:175]
ds_read_b64_tr_b16 v[66:67], v7 offset:6144
v_rcp_f32 v28, v28
v_mfma_f32_16x16x32_bf16 v[176:179], v[48:51], a[160:163], v[176:179]
buffer_store_dwordx4 v[100:103], v16, s[20:23], s50 offen offset:1024 sc1
v_mfma_f32_16x16x32_bf16 v[176:179], v[52:55], a[176:179], v[176:179]
ds_read_b64_tr_b16 v[68:69], v7 offset:10240
v_rcp_f32 v29, v29
v_mul_f32 v152, v152, v28
v_mfma_f32_16x16x32_bf16 v[180:183], v[48:51], a[164:167], v[180:183]
ds_read_b64_tr_b16 v[70:71], v7 offset:14336
v_mul_f32 v153, v153, v29
v_mfma_f32_16x16x32_bf16 v[180:183], v[52:55], a[180:183], v[180:183]
v_mul_f32 v30, v138, v138
v_mul_f32 v31, v139, v139
v_fma_f32 v30, v30, s47, v18
v_mfma_f32_16x16x32_bf16 v[184:187], v[48:51], a[168:171], v[184:187]
buffer_load_dwordx4 v13, s[16:19], s49 offen offset:3072 lds
v_mfma_f32_16x16x32_bf16 v[184:187], v[52:55], a[184:187], v[184:187]
s_add_u32 m0, s37, 0
v_fma_f32 v31, v31, s47, v18
v_mul_f32 v30, v30, v138
v_mfma_f32_16x16x32_bf16 v[188:191], v[48:51], a[172:175], v[188:191]
s_mov_b32 s48, 2304
s_waitcnt vmcnt(25) lgkmcnt(0)
v_mfma_f32_16x16x32_bf16 v[188:191], v[52:55], a[188:191], v[188:191]
s_barrier
v_mfma_f32_16x16x32_bf16 v[192:195], v[56:59], a[160:163], v[192:195]
v_mul_f32 v31, v31, v139
v_exp_f32 v30, v30
v_exp_f32 v31, v31
v_mfma_f32_16x16x32_bf16 v[192:195], v[60:63], a[176:179], v[192:195]
ds_read_b64_tr_b16 v[40:41], v6 offset:16384
v_mul_f32 v154, v154, v138
v_mfma_f32_16x16x32_bf16 v[196:199], v[56:59], a[164:167], v[196:199]
ds_read_b64_tr_b16 v[42:43], v6 offset:20480
v_mul_f32 v155, v155, v139
v_add_f32 v30, 1.0, v30
v_mfma_f32_16x16x32_bf16 v[196:199], v[60:63], a[180:183], v[196:199]
ds_read_b64_tr_b16 v[44:45], v6 offset:24576
v_add_f32 v31, 1.0, v31
v_cvt_pk_bf16_f32 v106, v152, v153
v_mfma_f32_16x16x32_bf16 v[200:203], v[56:59], a[168:171], v[200:203]
buffer_load_dwordx4 v12, s[16:19], s48 offen offset:0 lds
v_mfma_f32_16x16x32_bf16 v[200:203], v[60:63], a[184:187], v[200:203]
ds_read_b64_tr_b16 v[46:47], v6 offset:28672
v_rcp_f32 v30, v30
v_mfma_f32_16x16x32_bf16 v[204:207], v[56:59], a[172:175], v[204:207]
ds_read_b64_tr_b16 v[48:49], v7 offset:16384
v_rcp_f32 v31, v31
v_mfma_f32_16x16x32_bf16 v[204:207], v[60:63], a[188:191], v[204:207]
ds_read_b64_tr_b16 v[50:51], v7 offset:20480
v_mul_f32 v154, v154, v30
v_mul_f32 v155, v155, v31
v_mfma_f32_16x16x32_bf16 v[208:211], v[64:67], a[160:163], v[208:211]
v_cvt_pk_bf16_f32 v107, v154, v155
v_mul_f32 v32, v108, v108
v_mfma_f32_16x16x32_bf16 v[208:211], v[68:71], a[176:179], v[208:211]
ds_read_b64_tr_b16 v[52:53], v7 offset:24576
v_mul_f32 v33, v109, v109
v_fma_f32 v32, v32, s47, v18
v_mfma_f32_16x16x32_bf16 v[212:215], v[64:67], a[164:167], v[212:215]
ds_read_b64_tr_b16 v[54:55], v7 offset:28672
v_fma_f32 v33, v33, s47, v18
v_mul_f32 v32, v32, v108
v_mfma_f32_16x16x32_bf16 v[212:215], v[68:71], a[180:183], v[212:215]
ds_write_b128 v22, v[104:107] offset:2048
v_mul_f32 v33, v33, v109
v_mfma_f32_16x16x32_bf16 v[216:219], v[64:67], a[168:171], v[216:219]
buffer_load_dwordx4 v13, s[16:19], s48 offen offset:1024 lds
v_mfma_f32_16x16x32_bf16 v[216:219], v[68:71], a[184:187], v[216:219]
s_mov_b32 s49, 73984
v_exp_f32 v32, v32
v_mfma_f32_16x16x32_bf16 v[220:223], v[64:67], a[172:175], v[220:223]
v_exp_f32 v33, v33
v_mul_f32 v124, v124, v108
v_mfma_f32_16x16x32_bf16 v[220:223], v[68:71], a[188:191], v[220:223]
v_mul_f32 v125, v125, v109
s_waitcnt vmcnt(22) lgkmcnt(0)
v_mfma_f32_16x16x32_bf16 v[160:163], v[40:43], a[192:195], v[160:163]
buffer_store_dwordx4 v[104:107], v16, s[20:23], s50 offen offset:2048 sc1
v_mfma_f32_16x16x32_bf16 v[160:163], v[44:47], a[208:211], v[160:163]
ds_read_b64_tr_b16 v[56:57], v6 offset:18432
v_add_f32 v32, 1.0, v32
v_add_f32 v33, 1.0, v33
v_mul_f32 v34, v110, v110
v_mfma_f32_16x16x32_bf16 v[164:167], v[40:43], a[196:199], v[164:167]
ds_read_b64_tr_b16 v[58:59], v6 offset:22528
v_rcp_f32 v32, v32
v_mfma_f32_16x16x32_bf16 v[164:167], v[44:47], a[212:215], v[164:167]
ds_read_b64_tr_b16 v[60:61], v6 offset:26624
v_mul_f32 v124, v124, v32
v_mfma_f32_16x16x32_bf16 v[168:171], v[40:43], a[200:203], v[168:171]
buffer_load_dwordx4 v12, s[16:19], s49 offen offset:2048 lds
v_mfma_f32_16x16x32_bf16 v[168:171], v[44:47], a[216:219], v[168:171]
ds_read_b64_tr_b16 v[62:63], v6 offset:30720
v_rcp_f32 v33, v33
v_mul_f32 v35, v111, v111
v_mfma_f32_16x16x32_bf16 v[172:175], v[40:43], a[204:207], v[172:175]
ds_read_b64_tr_b16 v[64:65], v7 offset:18432
v_mul_f32 v125, v125, v33
v_mfma_f32_16x16x32_bf16 v[172:175], v[44:47], a[220:223], v[172:175]
ds_read_b64_tr_b16 v[66:67], v7 offset:22528
v_fma_f32 v34, v34, s47, v18
v_fma_f32 v35, v35, s47, v18
v_mfma_f32_16x16x32_bf16 v[176:179], v[48:51], a[192:195], v[176:179]
v_mul_f32 v34, v34, v110
v_mul_f32 v35, v35, v111
v_mul_f32 v126, v126, v110
v_mfma_f32_16x16x32_bf16 v[176:179], v[52:55], a[208:211], v[176:179]
ds_read_b64_tr_b16 v[68:69], v7 offset:26624
v_exp_f32 v34, v34
v_mfma_f32_16x16x32_bf16 v[180:183], v[48:51], a[196:199], v[180:183]
ds_read_b64_tr_b16 v[70:71], v7 offset:30720
v_mul_f32 v127, v127, v111
v_mfma_f32_16x16x32_bf16 v[180:183], v[52:55], a[212:215], v[180:183]
v_exp_f32 v35, v35
v_add_f32 v34, 1.0, v34
v_mfma_f32_16x16x32_bf16 v[184:187], v[48:51], a[200:203], v[184:187]
buffer_load_dwordx4 v13, s[16:19], s49 offen offset:3072 lds
v_mfma_f32_16x16x32_bf16 v[184:187], v[52:55], a[216:219], v[184:187]
s_add_u32 m0, s37, 16384
v_add_f32 v35, 1.0, v35
v_cvt_pk_bf16_f32 v108, v124, v125
v_mfma_f32_16x16x32_bf16 v[188:191], v[48:51], a[204:207], v[188:191]
s_mov_b32 s48, 149760
s_waitcnt vmcnt(21) lgkmcnt(0)
v_mfma_f32_16x16x32_bf16 v[188:191], v[52:55], a[220:223], v[188:191]
s_barrier
v_mfma_f32_16x16x32_bf16 v[192:195], v[56:59], a[192:195], v[192:195]
v_rcp_f32 v34, v34
v_rcp_f32 v35, v35
v_mul_f32 v36, v140, v140
v_mfma_f32_16x16x32_bf16 v[192:195], v[60:63], a[208:211], v[192:195]
ds_read_b64_tr_b16 v[40:41], v6 offset:32768
v_mul_f32 v126, v126, v34
v_mfma_f32_16x16x32_bf16 v[196:199], v[56:59], a[196:199], v[196:199]
ds_read_b64_tr_b16 v[42:43], v6 offset:36864
v_mul_f32 v127, v127, v35
v_cvt_pk_bf16_f32 v109, v126, v127
v_mfma_f32_16x16x32_bf16 v[196:199], v[60:63], a[212:215], v[196:199]
ds_read_b64_tr_b16 v[44:45], v6 offset:40960
v_mul_f32 v37, v141, v141
v_fma_f32 v36, v36, s47, v18
v_mfma_f32_16x16x32_bf16 v[200:203], v[56:59], a[200:203], v[200:203]
buffer_load_dwordx4 v12, s[16:19], s48 offen offset:0 lds
v_mfma_f32_16x16x32_bf16 v[200:203], v[60:63], a[216:219], v[200:203]
ds_read_b64_tr_b16 v[46:47], v6 offset:45056
v_fma_f32 v37, v37, s47, v18
v_mul_f32 v36, v36, v140
v_mfma_f32_16x16x32_bf16 v[204:207], v[56:59], a[204:207], v[204:207]
ds_read_b64_tr_b16 v[48:49], v7 offset:32768
v_mul_f32 v37, v37, v141
v_mul_f32 v156, v156, v140
v_mfma_f32_16x16x32_bf16 v[204:207], v[60:63], a[220:223], v[204:207]
ds_read_b64_tr_b16 v[50:51], v7 offset:36864
v_mul_f32 v157, v157, v141
v_mfma_f32_16x16x32_bf16 v[208:211], v[64:67], a[192:195], v[208:211]
v_exp_f32 v36, v36
v_mul_f32 v38, v142, v142
v_mfma_f32_16x16x32_bf16 v[208:211], v[68:71], a[208:211], v[208:211]
ds_read_b64_tr_b16 v[52:53], v7 offset:40960
v_exp_f32 v37, v37
v_mfma_f32_16x16x32_bf16 v[212:215], v[64:67], a[196:199], v[212:215]
ds_read_b64_tr_b16 v[54:55], v7 offset:45056
v_add_f32 v36, 1.0, v36
v_mfma_f32_16x16x32_bf16 v[212:215], v[68:71], a[212:215], v[212:215]
v_add_f32 v37, 1.0, v37
v_rcp_f32 v36, v36
v_mfma_f32_16x16x32_bf16 v[216:219], v[64:67], a[200:203], v[216:219]
buffer_load_dwordx4 v13, s[16:19], s48 offen offset:1024 lds
v_mfma_f32_16x16x32_bf16 v[216:219], v[68:71], a[216:219], v[216:219]
s_mov_b32 s49, 221440
v_rcp_f32 v37, v37
v_mul_f32 v156, v156, v36
v_mfma_f32_16x16x32_bf16 v[220:223], v[64:67], a[204:207], v[220:223]
v_mul_f32 v157, v157, v37
v_mul_f32 v39, v143, v143
v_mfma_f32_16x16x32_bf16 v[220:223], v[68:71], a[220:223], v[220:223]
v_fma_f32 v38, v38, s47, v18
v_fma_f32 v39, v39, s47, v18
s_waitcnt vmcnt(10) lgkmcnt(0)
v_mfma_f32_16x16x32_bf16 v[160:163], v[40:43], a[224:227], v[160:163]
v_mul_f32 v38, v38, v142
v_mul_f32 v39, v39, v143
v_mfma_f32_16x16x32_bf16 v[160:163], v[44:47], a[240:243], v[160:163]
ds_read_b64_tr_b16 v[56:57], v6 offset:34816
v_exp_f32 v38, v38
v_mfma_f32_16x16x32_bf16 v[164:167], v[40:43], a[228:231], v[164:167]
ds_read_b64_tr_b16 v[58:59], v6 offset:38912
v_exp_f32 v39, v39
v_mfma_f32_16x16x32_bf16 v[164:167], v[44:47], a[244:247], v[164:167]
ds_read_b64_tr_b16 v[60:61], v6 offset:43008
v_mul_f32 v158, v158, v142
v_mfma_f32_16x16x32_bf16 v[168:171], v[40:43], a[232:235], v[168:171]
buffer_load_dwordx4 v12, s[16:19], s49 offen offset:2048 lds
v_mfma_f32_16x16x32_bf16 v[168:171], v[44:47], a[248:251], v[168:171]
ds_read_b64_tr_b16 v[62:63], v6 offset:47104
v_mul_f32 v159, v159, v143
v_add_f32 v38, 1.0, v38
v_add_f32 v39, 1.0, v39
v_mfma_f32_16x16x32_bf16 v[172:175], v[40:43], a[236:239], v[172:175]
ds_read_b64_tr_b16 v[64:65], v7 offset:34816
v_rcp_f32 v38, v38
v_mfma_f32_16x16x32_bf16 v[172:175], v[44:47], a[252:255], v[172:175]
ds_read_b64_tr_b16 v[66:67], v7 offset:38912
v_mul_f32 v158, v158, v38
v_mfma_f32_16x16x32_bf16 v[176:179], v[48:51], a[224:227], v[176:179]
v_rcp_f32 v39, v39
v_cvt_pk_bf16_f32 v110, v156, v157
v_mfma_f32_16x16x32_bf16 v[176:179], v[52:55], a[240:243], v[176:179]
ds_read_b64_tr_b16 v[68:69], v7 offset:43008
v_mul_f32 v159, v159, v39
v_mfma_f32_16x16x32_bf16 v[180:183], v[48:51], a[228:231], v[180:183]
ds_read_b64_tr_b16 v[70:71], v7 offset:47104
v_cvt_pk_bf16_f32 v111, v158, v159
v_mfma_f32_16x16x32_bf16 v[180:183], v[52:55], a[244:247], v[180:183]
ds_write_b128 v22, v[108:111] offset:3072
v_mfma_f32_16x16x32_bf16 v[184:187], v[48:51], a[232:235], v[184:187]
buffer_load_dwordx4 v13, s[16:19], s49 offen offset:3072 lds
buffer_store_dwordx4 v[108:111], v16, s[20:23], s50 offen offset:3072 sc1
v_mfma_f32_16x16x32_bf16 v[184:187], v[52:55], a[248:251], v[184:187]
s_add_u32 m0, s37, 32768
v_mfma_f32_16x16x32_bf16 v[188:191], v[48:51], a[236:239], v[188:191]
s_mov_b32 s48, 518400
s_waitcnt lgkmcnt(0)
v_mfma_f32_16x16x32_bf16 v[188:191], v[52:55], a[252:255], v[188:191]
s_barrier
v_mfma_f32_16x16x32_bf16 v[192:195], v[56:59], a[224:227], v[192:195]
v_mfma_f32_16x16x32_bf16 v[192:195], v[60:63], a[240:243], v[192:195]
ds_read_b64_tr_b16 v[40:41], v6 offset:49152
ds_read_b128 v[224:227], v23 offset:0
v_mfma_f32_16x16x32_bf16 v[196:199], v[56:59], a[228:231], v[196:199]
ds_read_b64_tr_b16 v[42:43], v6 offset:53248
ds_read_b128 v[228:231], v23 offset:1024
v_mfma_f32_16x16x32_bf16 v[196:199], v[60:63], a[244:247], v[196:199]
ds_read_b64_tr_b16 v[44:45], v6 offset:57344
ds_read_b128 v[232:235], v23 offset:2048
v_mfma_f32_16x16x32_bf16 v[200:203], v[56:59], a[232:235], v[200:203]
buffer_load_dwordx4 v12, s[16:19], s48 offen offset:0 lds
v_mfma_f32_16x16x32_bf16 v[200:203], v[60:63], a[248:251], v[200:203]
ds_read_b64_tr_b16 v[46:47], v6 offset:61440
ds_read_b128 v[236:239], v23 offset:3072
v_mfma_f32_16x16x32_bf16 v[204:207], v[56:59], a[236:239], v[204:207]
ds_read_b64_tr_b16 v[48:49], v7 offset:49152
ds_read_b128 v[240:243], v23 offset:8192
v_mfma_f32_16x16x32_bf16 v[204:207], v[60:63], a[252:255], v[204:207]
ds_read_b64_tr_b16 v[50:51], v7 offset:53248
ds_read_b128 v[244:247], v23 offset:9216
v_mfma_f32_16x16x32_bf16 v[208:211], v[64:67], a[224:227], v[208:211]
v_mfma_f32_16x16x32_bf16 v[208:211], v[68:71], a[240:243], v[208:211]
ds_read_b64_tr_b16 v[52:53], v7 offset:57344
ds_read_b128 v[248:251], v23 offset:10240
v_mfma_f32_16x16x32_bf16 v[212:215], v[64:67], a[228:231], v[212:215]
ds_read_b64_tr_b16 v[54:55], v7 offset:61440
ds_read_b128 v[252:255], v23 offset:11264
v_mfma_f32_16x16x32_bf16 v[212:215], v[68:71], a[244:247], v[212:215]
v_mfma_f32_16x16x32_bf16 v[216:219], v[64:67], a[232:235], v[216:219]
buffer_load_dwordx4 v13, s[16:19], s48 offen offset:1024 lds
v_mfma_f32_16x16x32_bf16 v[216:219], v[68:71], a[248:251], v[216:219]
s_mov_b32 s49, 590080
v_mfma_f32_16x16x32_bf16 v[220:223], v[64:67], a[236:239], v[220:223]
v_mfma_f32_16x16x32_bf16 v[220:223], v[68:71], a[252:255], v[220:223]
s_waitcnt lgkmcnt(0)
v_mfma_f32_16x16x32_bf16 v[160:163], v[40:43], v[224:227], v[160:163]
v_mfma_f32_16x16x32_bf16 v[160:163], v[44:47], v[240:243], v[160:163]
ds_read_b64_tr_b16 v[56:57], v6 offset:51200
s_bfe_u32 s36, s46, 0x1000c
v_mfma_f32_16x16x32_bf16 v[164:167], v[40:43], v[228:231], v[164:167]
ds_read_b64_tr_b16 v[58:59], v6 offset:55296
s_xor_b32 s36, s36, 1
v_mfma_f32_16x16x32_bf16 v[164:167], v[44:47], v[244:247], v[164:167]
ds_read_b64_tr_b16 v[60:61], v6 offset:59392
s_lshl_b32 s36, s36, 28
v_mfma_f32_16x16x32_bf16 v[168:171], v[40:43], v[232:235], v[168:171]
buffer_load_dwordx4 v12, s[16:19], s49 offen offset:2048 lds
v_mfma_f32_16x16x32_bf16 v[168:171], v[44:47], v[248:251], v[168:171]
ds_read_b64_tr_b16 v[62:63], v6 offset:63488
v_add_u32 v14, s36, v21
v_mfma_f32_16x16x32_bf16 v[172:175], v[40:43], v[236:239], v[172:175]
ds_read_b64_tr_b16 v[64:65], v7 offset:51200
v_lshlrev_b32 v16, 4, v0
v_mfma_f32_16x16x32_bf16 v[172:175], v[44:47], v[252:255], v[172:175]
ds_read_b64_tr_b16 v[66:67], v7 offset:55296
v_add_u32 v16, 131072, v16
v_mfma_f32_16x16x32_bf16 v[176:179], v[48:51], v[224:227], v[176:179]
v_mfma_f32_16x16x32_bf16 v[176:179], v[52:55], v[240:243], v[176:179]
ds_read_b64_tr_b16 v[68:69], v7 offset:59392
v_mfma_f32_16x16x32_bf16 v[180:183], v[48:51], v[228:231], v[180:183]
ds_read_b64_tr_b16 v[70:71], v7 offset:63488
v_mfma_f32_16x16x32_bf16 v[180:183], v[52:55], v[244:247], v[180:183]
v_mfma_f32_16x16x32_bf16 v[184:187], v[48:51], v[232:235], v[184:187]
buffer_load_dwordx4 v13, s[16:19], s49 offen offset:3072 lds
v_mfma_f32_16x16x32_bf16 v[184:187], v[52:55], v[248:251], v[184:187]
s_add_u32 m0, s37, 49152
v_mfma_f32_16x16x32_bf16 v[188:191], v[48:51], v[236:239], v[188:191]
s_mov_b32 s48, 297216
s_waitcnt vmcnt(14) lgkmcnt(0)
v_mfma_f32_16x16x32_bf16 v[188:191], v[52:55], v[252:255], v[188:191]
s_barrier
v_mfma_f32_16x16x32_bf16 v[192:195], v[56:59], v[224:227], v[192:195]
v_mfma_f32_16x16x32_bf16 v[192:195], v[60:63], v[240:243], v[192:195]
ds_read_b64_tr_b16 v[40:41], v8 offset:0
v_mfma_f32_16x16x32_bf16 v[196:199], v[56:59], v[228:231], v[196:199]
ds_read_b64_tr_b16 v[42:43], v8 offset:4096
v_mfma_f32_16x16x32_bf16 v[196:199], v[60:63], v[244:247], v[196:199]
ds_read_b64_tr_b16 v[44:45], v8 offset:8192
v_mfma_f32_16x16x32_bf16 v[200:203], v[56:59], v[232:235], v[200:203]
buffer_load_dwordx4 v12, s[16:19], s48 offen offset:0 lds
v_mfma_f32_16x16x32_bf16 v[200:203], v[60:63], v[248:251], v[200:203]
ds_read_b64_tr_b16 v[46:47], v8 offset:12288
v_mfma_f32_16x16x32_bf16 v[204:207], v[56:59], v[236:239], v[204:207]
ds_read_b64_tr_b16 v[48:49], v9 offset:0
v_mfma_f32_16x16x32_bf16 v[204:207], v[60:63], v[252:255], v[204:207]
ds_read_b64_tr_b16 v[50:51], v9 offset:4096
v_mfma_f32_16x16x32_bf16 v[208:211], v[64:67], v[224:227], v[208:211]
v_mfma_f32_16x16x32_bf16 v[208:211], v[68:71], v[240:243], v[208:211]
ds_read_b64_tr_b16 v[52:53], v9 offset:8192
v_mfma_f32_16x16x32_bf16 v[212:215], v[64:67], v[228:231], v[212:215]
ds_read_b64_tr_b16 v[54:55], v9 offset:12288
v_mfma_f32_16x16x32_bf16 v[212:215], v[68:71], v[244:247], v[212:215]
v_mfma_f32_16x16x32_bf16 v[216:219], v[64:67], v[232:235], v[216:219]
buffer_load_dwordx4 v13, s[16:19], s48 offen offset:1024 lds
v_mfma_f32_16x16x32_bf16 v[216:219], v[68:71], v[248:251], v[216:219]
s_mov_b32 s49, 369024
v_mfma_f32_16x16x32_bf16 v[220:223], v[64:67], v[236:239], v[220:223]
v_mfma_f32_16x16x32_bf16 v[220:223], v[68:71], v[252:255], v[220:223]
s_waitcnt lgkmcnt(0)
v_mfma_f32_16x16x32_bf16 v[96:99], v[40:43], a[0:3], 0
v_mfma_f32_16x16x32_bf16 v[96:99], v[44:47], a[16:19], v[96:99]
ds_read_b64_tr_b16 v[56:57], v8 offset:2048
v_mfma_f32_16x16x32_bf16 v[100:103], v[40:43], a[4:7], 0
ds_read_b64_tr_b16 v[58:59], v8 offset:6144
v_mfma_f32_16x16x32_bf16 v[100:103], v[44:47], a[20:23], v[100:103]
ds_read_b64_tr_b16 v[60:61], v8 offset:10240
v_mfma_f32_16x16x32_bf16 v[104:107], v[40:43], a[8:11], 0
buffer_load_dwordx4 v12, s[16:19], s49 offen offset:2048 lds
v_mfma_f32_16x16x32_bf16 v[104:107], v[44:47], a[24:27], v[104:107]
ds_read_b64_tr_b16 v[62:63], v8 offset:14336
v_mfma_f32_16x16x32_bf16 v[108:111], v[40:43], a[12:15], 0
ds_read_b64_tr_b16 v[64:65], v9 offset:2048
v_mfma_f32_16x16x32_bf16 v[108:111], v[44:47], a[28:31], v[108:111]
ds_read_b64_tr_b16 v[66:67], v9 offset:6144
v_mfma_f32_16x16x32_bf16 v[112:115], v[48:51], a[0:3], 0
v_cvt_pk_bf16_f32 v160, v160, v161
v_cvt_pk_bf16_f32 v161, v162, v163
v_mfma_f32_16x16x32_bf16 v[112:115], v[52:55], a[16:19], v[112:115]
ds_read_b64_tr_b16 v[68:69], v9 offset:10240
v_cvt_pk_bf16_f32 v162, v176, v177
v_mfma_f32_16x16x32_bf16 v[116:119], v[48:51], a[4:7], 0
ds_read_b64_tr_b16 v[70:71], v9 offset:14336
v_cvt_pk_bf16_f32 v163, v178, v179
v_mfma_f32_16x16x32_bf16 v[116:119], v[52:55], a[20:23], v[116:119]
ds_write_b128 v16, v[160:163] offset:0
v_mfma_f32_16x16x32_bf16 v[120:123], v[48:51], a[8:11], 0
buffer_load_dwordx4 v13, s[16:19], s49 offen offset:3072 lds
v_mfma_f32_16x16x32_bf16 v[120:123], v[52:55], a[24:27], v[120:123]
s_add_u32 m0, s37, 65536
s_xor_b32 s50, s46, 0
v_mfma_f32_16x16x32_bf16 v[124:127], v[48:51], a[12:15], 0
s_mov_b32 s48, 444800
s_waitcnt vmcnt(8) lgkmcnt(0)
v_mfma_f32_16x16x32_bf16 v[124:127], v[52:55], a[28:31], v[124:127]
s_barrier
v_mfma_f32_16x16x32_bf16 v[96:99], v[56:59], a[32:35], v[96:99]
buffer_store_dwordx4 v[160:163], v14, s[20:23], s50 offen sc1
v_mfma_f32_16x16x32_bf16 v[96:99], v[60:63], a[48:51], v[96:99]
ds_read_b64_tr_b16 v[40:41], v6 offset:0
v_cvt_pk_bf16_f32 v164, v164, v165
v_mfma_f32_16x16x32_bf16 v[100:103], v[56:59], a[36:39], v[100:103]
ds_read_b64_tr_b16 v[42:43], v6 offset:4096
v_cvt_pk_bf16_f32 v165, v166, v167
v_mfma_f32_16x16x32_bf16 v[100:103], v[60:63], a[52:55], v[100:103]
ds_read_b64_tr_b16 v[44:45], v6 offset:8192
v_cvt_pk_bf16_f32 v166, v180, v181
v_mfma_f32_16x16x32_bf16 v[104:107], v[56:59], a[40:43], v[104:107]
buffer_load_dwordx4 v12, s[16:19], s48 offen offset:0 lds
v_mfma_f32_16x16x32_bf16 v[104:107], v[60:63], a[56:59], v[104:107]
ds_read_b64_tr_b16 v[46:47], v6 offset:12288
v_cvt_pk_bf16_f32 v167, v182, v183
v_mfma_f32_16x16x32_bf16 v[108:111], v[56:59], a[44:47], v[108:111]
ds_read_b64_tr_b16 v[48:49], v7 offset:0
v_mov_b32 v20, 4
v_mfma_f32_16x16x32_bf16 v[108:111], v[60:63], a[60:63], v[108:111]
ds_read_b64_tr_b16 v[50:51], v7 offset:4096
s_xor_b32 s50, s46, 9216
v_mfma_f32_16x16x32_bf16 v[112:115], v[64:67], a[32:35], v[112:115]
buffer_store_dword v20, v19, s[20:23], 0 offen sc1
v_mfma_f32_16x16x32_bf16 v[112:115], v[68:71], a[48:51], v[112:115]
ds_read_b64_tr_b16 v[52:53], v7 offset:8192
v_cvt_pk_bf16_f32 v168, v168, v169
v_mfma_f32_16x16x32_bf16 v[116:119], v[64:67], a[36:39], v[116:119]
ds_read_b64_tr_b16 v[54:55], v7 offset:12288
v_cvt_pk_bf16_f32 v169, v170, v171
v_mfma_f32_16x16x32_bf16 v[116:119], v[68:71], a[52:55], v[116:119]
v_cvt_pk_bf16_f32 v170, v184, v185
v_cvt_pk_bf16_f32 v171, v186, v187
v_mfma_f32_16x16x32_bf16 v[120:123], v[64:67], a[40:43], v[120:123]
buffer_load_dwordx4 v13, s[16:19], s48 offen offset:1024 lds
v_mfma_f32_16x16x32_bf16 v[120:123], v[68:71], a[56:59], v[120:123]
s_mov_b32 s49, 384
v_cvt_pk_bf16_f32 v172, v172, v173
v_mfma_f32_16x16x32_bf16 v[124:127], v[64:67], a[44:47], v[124:127]
v_cvt_pk_bf16_f32 v173, v174, v175
v_cvt_pk_bf16_f32 v174, v188, v189
v_mfma_f32_16x16x32_bf16 v[124:127], v[68:71], a[60:63], v[124:127]
v_cvt_pk_bf16_f32 v175, v190, v191
s_waitcnt lgkmcnt(0)
v_mfma_f32_16x16x32_bf16 v[96:99], v[40:43], a[64:67], v[96:99]
buffer_store_dwordx4 v[164:167], v21, s[20:23], s50 offen sc1
v_mfma_f32_16x16x32_bf16 v[96:99], v[44:47], a[80:83], v[96:99]
ds_read_b64_tr_b16 v[56:57], v6 offset:2048
s_bfe_u32 s36, s2, 0x30003
v_mfma_f32_16x16x32_bf16 v[100:103], v[40:43], a[68:71], v[100:103]
ds_read_b64_tr_b16 v[58:59], v6 offset:6144
s_and_b32 s35, s2, 1
v_mfma_f32_16x16x32_bf16 v[100:103], v[44:47], a[84:87], v[100:103]
ds_read_b64_tr_b16 v[60:61], v6 offset:10240
s_lshl3_add_u32 s36, s36, s35
v_mfma_f32_16x16x32_bf16 v[104:107], v[40:43], a[72:75], v[104:107]
buffer_load_dwordx4 v12, s[16:19], s49 offen offset:2048 lds
v_mfma_f32_16x16x32_bf16 v[104:107], v[44:47], a[88:91], v[104:107]
ds_read_b64_tr_b16 v[62:63], v6 offset:14336
s_lshl_b32 s36, s36, 10
v_mfma_f32_16x16x32_bf16 v[108:111], v[40:43], a[76:79], v[108:111]
ds_read_b64_tr_b16 v[64:65], v7 offset:2048
s_add_u32 s36, s36, 76546048
v_mfma_f32_16x16x32_bf16 v[108:111], v[44:47], a[92:95], v[108:111]
ds_read_b64_tr_b16 v[66:67], v7 offset:6144
s_lshr_b32 s59, s40, 1
v_mfma_f32_16x16x32_bf16 v[112:115], v[48:51], a[64:67], v[112:115]
s_and_b32 s35, s40, 1
s_lshl3_add_u32 s59, s59, s35
v_mfma_f32_16x16x32_bf16 v[112:115], v[52:55], a[80:83], v[112:115]
ds_read_b64_tr_b16 v[68:69], v7 offset:10240
s_and_b32 s35, s38, 1
v_mfma_f32_16x16x32_bf16 v[116:119], v[48:51], a[68:71], v[116:119]
ds_read_b64_tr_b16 v[70:71], v7 offset:14336
s_lshl3_add_u32 s59, s59, s35
v_mfma_f32_16x16x32_bf16 v[116:119], v[52:55], a[84:87], v[116:119]
s_lshl_b32 s59, s59, 5
s_add_u32 s59, s59, s36
v_mfma_f32_16x16x32_bf16 v[120:123], v[48:51], a[72:75], v[120:123]
buffer_load_dwordx4 v13, s[16:19], s49 offen offset:3072 lds
v_mfma_f32_16x16x32_bf16 v[120:123], v[52:55], a[88:91], v[120:123]
s_add_u32 m0, s37, 0
s_add_u32 s59, s59, 128
v_mfma_f32_16x16x32_bf16 v[124:127], v[48:51], a[76:79], v[124:127]
s_mov_b32 s48, 76160
s_waitcnt lgkmcnt(0)
v_mfma_f32_16x16x32_bf16 v[124:127], v[52:55], a[92:95], v[124:127]
s_barrier
v_mfma_f32_16x16x32_bf16 v[96:99], v[56:59], a[96:99], v[96:99]
v_and_b32 v72, 7, v0
v_lshl_add_u32 v94, v72, 2, s59
v_mfma_f32_16x16x32_bf16 v[96:99], v[60:63], a[112:115], v[96:99]
ds_read_b64_tr_b16 v[40:41], v6 offset:16384
s_lshl3_add_u32 s35, s35, s40
v_mfma_f32_16x16x32_bf16 v[100:103], v[56:59], a[100:103], v[100:103]
ds_read_b64_tr_b16 v[42:43], v6 offset:20480
s_lshl2_add_u32 s35, s35, s36
v_mfma_f32_16x16x32_bf16 v[100:103], v[60:63], a[116:119], v[100:103]
ds_read_b64_tr_b16 v[44:45], v6 offset:24576
s_and_b32 s34, s38, 2
v_mfma_f32_16x16x32_bf16 v[104:107], v[56:59], a[104:107], v[104:107]
buffer_load_dwordx4 v12, s[16:19], s48 offen offset:0 lds
v_mfma_f32_16x16x32_bf16 v[104:107], v[60:63], a[120:123], v[104:107]
ds_read_b64_tr_b16 v[46:47], v6 offset:28672
s_lshl_b32 s34, s34, 11
v_mfma_f32_16x16x32_bf16 v[108:111], v[56:59], a[108:111], v[108:111]
ds_read_b64_tr_b16 v[48:49], v7 offset:16384
s_add_u32 s35, s35, s34
v_mfma_f32_16x16x32_bf16 v[108:111], v[60:63], a[124:127], v[108:111]
ds_read_b64_tr_b16 v[50:51], v7 offset:20480
v_and_b32 v72, 2, v1
v_mfma_f32_16x16x32_bf16 v[112:115], v[64:67], a[96:99], v[112:115]
v_mad_u32_u24 v72, v72, 3, v1
v_lshl_add_u32 v75, v72, 8, s35
v_mfma_f32_16x16x32_bf16 v[112:115], v[68:71], a[112:115], v[112:115]
ds_read_b64_tr_b16 v[52:53], v7 offset:24576
v_and_b32 v72, 60, v1
v_mfma_f32_16x16x32_bf16 v[116:119], v[64:67], a[100:103], v[116:119]
ds_read_b64_tr_b16 v[54:55], v7 offset:28672
v_lshl_add_u32 v75, v72, 26, v75
v_mfma_f32_16x16x32_bf16 v[116:119], v[68:71], a[116:119], v[116:119]
s_mul_i32 s34, s38, 20
v_min_u32 v73, 19, v1
v_mfma_f32_16x16x32_bf16 v[120:123], v[64:67], a[104:107], v[120:123]
buffer_load_dwordx4 v13, s[16:19], s48 offen offset:1024 lds
v_mfma_f32_16x16x32_bf16 v[120:123], v[68:71], a[120:123], v[120:123]
s_mov_b32 s49, 147840
v_add_u32 v73, s34, v73
v_mfma_f32_16x16x32_bf16 v[124:127], v[64:67], a[108:111], v[124:127]
v_and_b32 v72, 1, v73
v_lshrrev_b32 v73, 1, v73
v_mfma_f32_16x16x32_bf16 v[124:127], v[68:71], a[124:127], v[124:127]
v_lshl_add_u32 v73, v73, 2, v72
s_waitcnt lgkmcnt(0)
v_mfma_f32_16x16x32_bf16 v[96:99], v[40:43], a[128:131], v[96:99]
v_lshlrev_b32 v73, 8, v73
v_add_u32 v10, 76546560, v73
v_mfma_f32_16x16x32_bf16 v[96:99], v[44:47], a[144:147], v[96:99]
ds_read_b64_tr_b16 v[56:57], v6 offset:18432
v_lshlrev_b32 v2, 4, v1
v_mfma_f32_16x16x32_bf16 v[100:103], v[40:43], a[132:135], v[100:103]
ds_read_b64_tr_b16 v[58:59], v6 offset:22528
s_xor_b32 s50, s46, 18432
v_mfma_f32_16x16x32_bf16 v[100:103], v[44:47], a[148:151], v[100:103]
ds_read_b64_tr_b16 v[60:61], v6 offset:26624
v_cvt_pk_bf16_f32 v192, v192, v193
v_mfma_f32_16x16x32_bf16 v[104:107], v[40:43], a[136:139], v[104:107]
buffer_load_dwordx4 v12, s[16:19], s49 offen offset:2048 lds
v_mfma_f32_16x16x32_bf16 v[104:107], v[44:47], a[152:155], v[104:107]
ds_read_b64_tr_b16 v[62:63], v6 offset:30720
v_cvt_pk_bf16_f32 v193, v194, v195
v_mfma_f32_16x16x32_bf16 v[108:111], v[40:43], a[140:143], v[108:111]
ds_read_b64_tr_b16 v[64:65], v7 offset:18432
v_cvt_pk_bf16_f32 v194, v208, v209
v_mfma_f32_16x16x32_bf16 v[108:111], v[44:47], a[156:159], v[108:111]
ds_read_b64_tr_b16 v[66:67], v7 offset:22528
v_cvt_pk_bf16_f32 v195, v210, v211
v_mfma_f32_16x16x32_bf16 v[112:115], v[48:51], a[128:131], v[112:115]
buffer_store_dwordx4 v[168:171], v21, s[20:23], s50 offen sc1
v_mfma_f32_16x16x32_bf16 v[112:115], v[52:55], a[144:147], v[112:115]
ds_read_b64_tr_b16 v[68:69], v7 offset:26624
s_xor_b32 s50, s46, 27648
v_mfma_f32_16x16x32_bf16 v[116:119], v[48:51], a[132:135], v[116:119]
ds_read_b64_tr_b16 v[70:71], v7 offset:30720
v_cvt_pk_bf16_f32 v196, v196, v197
v_mfma_f32_16x16x32_bf16 v[116:119], v[52:55], a[148:151], v[116:119]
ds_write_b128 v16, v[192:195] offset:4096
v_mfma_f32_16x16x32_bf16 v[120:123], v[48:51], a[136:139], v[120:123]
buffer_load_dwordx4 v13, s[16:19], s49 offen offset:3072 lds
v_mfma_f32_16x16x32_bf16 v[120:123], v[52:55], a[152:155], v[120:123]
s_add_u32 m0, s37, 16384
v_cvt_pk_bf16_f32 v197, v198, v199
v_mfma_f32_16x16x32_bf16 v[124:127], v[48:51], a[140:143], v[124:127]
s_mov_b32 s48, 223616
s_waitcnt vmcnt(16) lgkmcnt(0)
v_mfma_f32_16x16x32_bf16 v[124:127], v[52:55], a[156:159], v[124:127]
s_barrier
v_mfma_f32_16x16x32_bf16 v[96:99], v[56:59], a[160:163], v[96:99]
buffer_store_dwordx4 v[172:175], v21, s[20:23], s50 offen sc1
v_mfma_f32_16x16x32_bf16 v[96:99], v[60:63], a[176:179], v[96:99]
ds_read_b64_tr_b16 v[40:41], v6 offset:32768
s_xor_b32 s50, s46, 2097152
v_mfma_f32_16x16x32_bf16 v[100:103], v[56:59], a[164:167], v[100:103]
ds_read_b64_tr_b16 v[42:43], v6 offset:36864
v_cvt_pk_bf16_f32 v198, v212, v213
v_mfma_f32_16x16x32_bf16 v[100:103], v[60:63], a[180:183], v[100:103]
ds_read_b64_tr_b16 v[44:45], v6 offset:40960
v_cvt_pk_bf16_f32 v199, v214, v215
v_mfma_f32_16x16x32_bf16 v[104:107], v[56:59], a[168:171], v[104:107]
buffer_load_dwordx4 v12, s[16:19], s48 offen offset:0 lds
v_mfma_f32_16x16x32_bf16 v[104:107], v[60:63], a[184:187], v[104:107]
ds_read_b64_tr_b16 v[46:47], v6 offset:45056
v_cvt_pk_bf16_f32 v200, v200, v201
v_mfma_f32_16x16x32_bf16 v[108:111], v[56:59], a[172:175], v[108:111]
ds_read_b64_tr_b16 v[48:49], v7 offset:32768
v_cvt_pk_bf16_f32 v201, v202, v203
v_mfma_f32_16x16x32_bf16 v[108:111], v[60:63], a[188:191], v[108:111]
ds_read_b64_tr_b16 v[50:51], v7 offset:36864
v_cvt_pk_bf16_f32 v202, v216, v217
v_mfma_f32_16x16x32_bf16 v[112:115], v[64:67], a[160:163], v[112:115]
buffer_store_dwordx4 v[192:195], v14, s[20:23], s50 offen sc1
v_mfma_f32_16x16x32_bf16 v[112:115], v[68:71], a[176:179], v[112:115]
ds_read_b64_tr_b16 v[52:53], v7 offset:40960
s_xor_b32 s50, s46, 2106368
v_mfma_f32_16x16x32_bf16 v[116:119], v[64:67], a[164:167], v[116:119]
ds_read_b64_tr_b16 v[54:55], v7 offset:45056
v_cvt_pk_bf16_f32 v203, v218, v219
v_mfma_f32_16x16x32_bf16 v[116:119], v[68:71], a[180:183], v[116:119]
v_cvt_pk_bf16_f32 v204, v204, v205
v_cvt_pk_bf16_f32 v205, v206, v207
v_mfma_f32_16x16x32_bf16 v[120:123], v[64:67], a[168:171], v[120:123]
buffer_load_dwordx4 v13, s[16:19], s48 offen offset:1024 lds
v_mfma_f32_16x16x32_bf16 v[120:123], v[68:71], a[184:187], v[120:123]
s_mov_b32 s49, 516480
v_cvt_pk_bf16_f32 v206, v220, v221
v_mfma_f32_16x16x32_bf16 v[124:127], v[64:67], a[172:175], v[124:127]
v_cvt_pk_bf16_f32 v207, v222, v223
v_mfma_f32_16x16x32_bf16 v[124:127], v[68:71], a[188:191], v[124:127]
s_waitcnt lgkmcnt(0)
v_mfma_f32_16x16x32_bf16 v[96:99], v[40:43], a[192:195], v[96:99]
buffer_store_dwordx4 v[196:199], v21, s[20:23], s50 offen sc1
v_mfma_f32_16x16x32_bf16 v[96:99], v[44:47], a[208:211], v[96:99]
ds_read_b64_tr_b16 v[56:57], v6 offset:34816
s_xor_b32 s50, s46, 2115584
v_mfma_f32_16x16x32_bf16 v[100:103], v[40:43], a[196:199], v[100:103]
ds_read_b64_tr_b16 v[58:59], v6 offset:38912
s_mov_b64 s[4:5], s[0:1]
v_mfma_f32_16x16x32_bf16 v[100:103], v[44:47], a[212:215], v[100:103]
ds_read_b64_tr_b16 v[60:61], v6 offset:43008
s_mov_b32 s6, 2359296
v_mfma_f32_16x16x32_bf16 v[104:107], v[40:43], a[200:203], v[104:107]
buffer_load_dwordx4 v12, s[16:19], s49 offen offset:2048 lds
v_mfma_f32_16x16x32_bf16 v[104:107], v[44:47], a[216:219], v[104:107]
ds_read_b64_tr_b16 v[62:63], v6 offset:47104
s_lshr_b32 s28, s40, 2
v_mfma_f32_16x16x32_bf16 v[108:111], v[40:43], a[204:207], v[108:111]
ds_read_b64_tr_b16 v[64:65], v7 offset:34816
s_and_b32 s29, s40, 3
v_mfma_f32_16x16x32_bf16 v[108:111], v[44:47], a[220:223], v[108:111]
ds_read_b64_tr_b16 v[66:67], v7 offset:38912
s_lshl3_add_u32 s28, s28, s29
v_mfma_f32_16x16x32_bf16 v[112:115], v[48:51], a[192:195], v[112:115]
buffer_store_dwordx4 v[200:203], v21, s[20:23], s50 offen sc1
v_mfma_f32_16x16x32_bf16 v[112:115], v[52:55], a[208:211], v[112:115]
ds_read_b64_tr_b16 v[68:69], v7 offset:43008
s_xor_b32 s50, s46, 2124800
v_mfma_f32_16x16x32_bf16 v[116:119], v[48:51], a[196:199], v[116:119]
ds_read_b64_tr_b16 v[70:71], v7 offset:47104
s_and_b32 s29, s38, 1
v_mfma_f32_16x16x32_bf16 v[116:119], v[52:55], a[212:215], v[116:119]
s_lshl2_add_u32 s28, s29, s28
s_lshr_b32 s29, s38, 1
v_mfma_f32_16x16x32_bf16 v[120:123], v[48:51], a[200:203], v[120:123]
buffer_load_dwordx4 v13, s[16:19], s49 offen offset:3072 lds
v_mfma_f32_16x16x32_bf16 v[120:123], v[52:55], a[216:219], v[120:123]
s_add_u32 m0, s37, 32768
s_lshl_b32 s28, s28, 13
v_mfma_f32_16x16x32_bf16 v[124:127], v[48:51], a[204:207], v[124:127]
s_mov_b32 s48, 592256
s_waitcnt vmcnt(20) lgkmcnt(0)
v_mfma_f32_16x16x32_bf16 v[124:127], v[52:55], a[220:223], v[124:127]
s_barrier
v_mfma_f32_16x16x32_bf16 v[96:99], v[56:59], a[224:227], v[96:99]
buffer_store_dwordx4 v[204:207], v21, s[20:23], s50 offen sc1
v_mfma_f32_16x16x32_bf16 v[96:99], v[60:63], a[240:243], v[96:99]
ds_read_b64_tr_b16 v[40:41], v6 offset:49152
s_mul_i32 s29, s29, 2097152
v_mfma_f32_16x16x32_bf16 v[100:103], v[56:59], a[228:231], v[100:103]
ds_read_b64_tr_b16 v[42:43], v6 offset:53248
s_add_u32 s28, s28, s29
v_mfma_f32_16x16x32_bf16 v[100:103], v[60:63], a[244:247], v[100:103]
ds_read_b64_tr_b16 v[44:45], v6 offset:57344
s_mul_i32 s29, s39, 131072
v_mfma_f32_16x16x32_bf16 v[104:107], v[56:59], a[232:235], v[104:107]
buffer_load_dwordx4 v12, s[16:19], s48 offen offset:0 lds
v_mfma_f32_16x16x32_bf16 v[104:107], v[60:63], a[248:251], v[104:107]
ds_read_b64_tr_b16 v[46:47], v6 offset:61440
s_add_u32 s28, s28, s29
v_mfma_f32_16x16x32_bf16 v[108:111], v[56:59], a[236:239], v[108:111]
ds_read_b64_tr_b16 v[48:49], v7 offset:49152
s_add_u32 s28, s28, 33554432
v_mfma_f32_16x16x32_bf16 v[108:111], v[60:63], a[252:255], v[108:111]
ds_read_b64_tr_b16 v[50:51], v7 offset:53248
s_mul_i32 s8, s40, 288
v_mfma_f32_16x16x32_bf16 v[112:115], v[64:67], a[224:227], v[112:115]
s_add_u32 s8, s8, s38
s_lshl_b32 s8, s8, 6
v_mfma_f32_16x16x32_bf16 v[112:115], v[68:71], a[240:243], v[112:115]
ds_read_b64_tr_b16 v[52:53], v7 offset:57344
s_mul_i32 s9, s39, 147456
v_mfma_f32_16x16x32_bf16 v[116:119], v[64:67], a[228:231], v[116:119]
ds_read_b64_tr_b16 v[54:55], v7 offset:61440
s_add_u32 s9, s9, s8
v_mfma_f32_16x16x32_bf16 v[116:119], v[68:71], a[244:247], v[116:119]
s_lshl3_add_u32 s36, s39, s40
s_lshl_b32 s11, s36, 7
v_mfma_f32_16x16x32_bf16 v[120:123], v[64:67], a[232:235], v[120:123]
buffer_load_dwordx4 v13, s[16:19], s48 offen offset:1024 lds
v_mfma_f32_16x16x32_bf16 v[120:123], v[68:71], a[248:251], v[120:123]
s_mov_b32 s49, 295296
s_add_u32 s11, s11, 75497472
v_mfma_f32_16x16x32_bf16 v[124:127], v[64:67], a[236:239], v[124:127]
s_mul_i32 s10, s38, 4224
s_add_u32 s10, s10, s36
v_mfma_f32_16x16x32_bf16 v[124:127], v[68:71], a[252:255], v[124:127]
s_lshl_b32 s10, s10, 5
s_waitcnt lgkmcnt(0)
v_mfma_f32_16x16x32_bf16 v[96:99], v[40:43], v[224:227], v[96:99]
s_add_u32 s10, s10, 71303168
s_lshr_b32 s36, s40, 2
v_mfma_f32_16x16x32_bf16 v[96:99], v[44:47], v[240:243], v[96:99]
ds_read_b64_tr_b16 v[56:57], v6 offset:51200
s_and_b32 s29, s38, 2
v_mfma_f32_16x16x32_bf16 v[100:103], v[40:43], v[228:231], v[100:103]
ds_read_b64_tr_b16 v[58:59], v6 offset:55296
s_add_u32 s36, s36, s29
v_mfma_f32_16x16x32_bf16 v[100:103], v[44:47], v[244:247], v[100:103]
ds_read_b64_tr_b16 v[60:61], v6 offset:59392
s_and_b32 s29, s38, 1
v_mfma_f32_16x16x32_bf16 v[104:107], v[40:43], v[232:235], v[104:107]
buffer_load_dwordx4 v12, s[16:19], s49 offen offset:2048 lds
v_mfma_f32_16x16x32_bf16 v[104:107], v[44:47], v[248:251], v[104:107]
ds_read_b64_tr_b16 v[62:63], v6 offset:63488
s_lshl1_add_u32 s36, s36, s29
v_mfma_f32_16x16x32_bf16 v[108:111], v[40:43], v[236:239], v[108:111]
ds_read_b64_tr_b16 v[64:65], v7 offset:51200
s_lshl_b32 s36, s36, 10
v_mfma_f32_16x16x32_bf16 v[108:111], v[44:47], v[252:255], v[108:111]
ds_read_b64_tr_b16 v[66:67], v7 offset:55296
s_add_u32 s36, s36, 131072
v_mfma_f32_16x16x32_bf16 v[112:115], v[48:51], v[224:227], v[112:115]
v_add_u32 v22, s36, v2
s_add_u32 s29, s28, 4096
v_mfma_f32_16x16x32_bf16 v[112:115], v[52:55], v[240:243], v[112:115]
ds_read_b64_tr_b16 v[68:69], v7 offset:59392
s_add_u32 s30, s28, 4194304
v_mfma_f32_16x16x32_bf16 v[116:119], v[48:51], v[228:231], v[116:119]
ds_read_b64_tr_b16 v[70:71], v7 offset:63488
s_add_u32 s31, s28, 4198400
v_mfma_f32_16x16x32_bf16 v[116:119], v[52:55], v[244:247], v[116:119]
s_add_u32 s32, s28, 8388608
s_add_u32 s33, s28, 8392704
v_mfma_f32_16x16x32_bf16 v[120:123], v[48:51], v[232:235], v[120:123]
buffer_load_dwordx4 v13, s[16:19], s49 offen offset:3072 lds
v_mfma_f32_16x16x32_bf16 v[120:123], v[52:55], v[248:251], v[120:123]
s_add_u32 m0, s37, 49152
v_and_b32 v72, 15, v1
v_mfma_f32_16x16x32_bf16 v[124:127], v[48:51], v[236:239], v[124:127]
s_mov_b32 s48, 371200
s_waitcnt vmcnt(18) lgkmcnt(0)
v_mfma_f32_16x16x32_bf16 v[124:127], v[52:55], v[252:255], v[124:127]
s_barrier
v_mfma_f32_16x16x32_bf16 v[128:131], v[56:59], a[0:3], 0
v_lshrrev_b32 v73, 4, v1
v_lshlrev_b32 v5, 3, v72
v_mfma_f32_16x16x32_bf16 v[128:131], v[60:63], a[16:19], v[128:131]
ds_read_b64_tr_b16 v[40:41], v8 offset:0
v_mul_u32_u24 v3, 0x480, v72
v_mfma_f32_16x16x32_bf16 v[132:135], v[56:59], a[4:7], 0
ds_read_b64_tr_b16 v[42:43], v8 offset:4096
v_lshl_add_u32 v3, v73, 4, v3
v_mfma_f32_16x16x32_bf16 v[132:135], v[60:63], a[20:23], v[132:135]
ds_read_b64_tr_b16 v[44:45], v8 offset:8192
v_and_b32 v74, 12, v72
v_mfma_f32_16x16x32_bf16 v[136:139], v[56:59], a[8:11], 0
buffer_load_dwordx4 v12, s[16:19], s48 offen offset:0 lds
v_mfma_f32_16x16x32_bf16 v[136:139], v[60:63], a[24:27], v[136:139]
ds_read_b64_tr_b16 v[46:47], v8 offset:12288
v_add_u32 v74, v74, v72
v_mfma_f32_16x16x32_bf16 v[140:143], v[56:59], a[12:15], 0
ds_read_b64_tr_b16 v[48:49], v9 offset:0
v_bfe_u32 v76, v1, 5, 1
v_mfma_f32_16x16x32_bf16 v[140:143], v[60:63], a[28:31], v[140:143]
ds_read_b64_tr_b16 v[50:51], v9 offset:4096
v_lshl_add_u32 v74, v76, 2, v74
v_mfma_f32_16x16x32_bf16 v[144:147], v[64:67], a[0:3], 0
buffer_load_dwordx2 v[92:93], v5, s[20:23], s11 offen sc1
v_mfma_f32_16x16x32_bf16 v[144:147], v[68:71], a[16:19], v[144:147]
ds_read_b64_tr_b16 v[52:53], v9 offset:8192
v_cvt_pk_bf16_f32 v96, v96, v97
v_mfma_f32_16x16x32_bf16 v[148:151], v[64:67], a[4:7], 0
ds_read_b64_tr_b16 v[54:55], v9 offset:12288
v_cvt_pk_bf16_f32 v97, v98, v99
v_mfma_f32_16x16x32_bf16 v[148:151], v[68:71], a[20:23], v[148:151]
v_cvt_pk_bf16_f32 v98, v112, v113
v_cvt_pk_bf16_f32 v99, v114, v115
v_mfma_f32_16x16x32_bf16 v[152:155], v[64:67], a[8:11], 0
buffer_load_dwordx4 v13, s[16:19], s48 offen offset:1024 lds
v_mfma_f32_16x16x32_bf16 v[152:155], v[68:71], a[24:27], v[152:155]
s_mov_b32 s49, 442880
s_xor_b32 s50, s46, 4194304
v_mfma_f32_16x16x32_bf16 v[156:159], v[64:67], a[12:15], 0
v_cvt_pk_bf16_f32 v100, v100, v101
v_cvt_pk_bf16_f32 v101, v102, v103
v_mfma_f32_16x16x32_bf16 v[156:159], v[68:71], a[28:31], v[156:159]
v_cvt_pk_bf16_f32 v102, v116, v117
s_waitcnt lgkmcnt(0)
v_mfma_f32_16x16x32_bf16 v[128:131], v[40:43], a[32:35], v[128:131]
buffer_store_dwordx4 v[96:99], v14, s[20:23], s50 offen sc1
v_mfma_f32_16x16x32_bf16 v[128:131], v[44:47], a[48:51], v[128:131]
ds_read_b64_tr_b16 v[56:57], v8 offset:2048
v_cvt_pk_bf16_f32 v103, v118, v119
v_mfma_f32_16x16x32_bf16 v[132:135], v[40:43], a[36:39], v[132:135]
ds_read_b64_tr_b16 v[58:59], v8 offset:6144
s_xor_b32 s50, s46, 4203520
v_mfma_f32_16x16x32_bf16 v[132:135], v[44:47], a[52:55], v[132:135]
ds_read_b64_tr_b16 v[60:61], v8 offset:10240
v_cvt_pk_bf16_f32 v104, v104, v105
v_mfma_f32_16x16x32_bf16 v[136:139], v[40:43], a[40:43], v[136:139]
buffer_load_dwordx4 v12, s[16:19], s49 offen offset:2048 lds
v_mfma_f32_16x16x32_bf16 v[136:139], v[44:47], a[56:59], v[136:139]
ds_read_b64_tr_b16 v[62:63], v8 offset:14336
v_cvt_pk_bf16_f32 v105, v106, v107
v_mfma_f32_16x16x32_bf16 v[140:143], v[40:43], a[44:47], v[140:143]
ds_read_b64_tr_b16 v[64:65], v9 offset:2048
v_cvt_pk_bf16_f32 v106, v120, v121
v_mfma_f32_16x16x32_bf16 v[140:143], v[44:47], a[60:63], v[140:143]
ds_read_b64_tr_b16 v[66:67], v9 offset:6144
v_cvt_pk_bf16_f32 v107, v122, v123
v_mfma_f32_16x16x32_bf16 v[144:147], v[48:51], a[32:35], v[144:147]
buffer_store_dwordx4 v[100:103], v21, s[20:23], s50 offen sc1
v_mfma_f32_16x16x32_bf16 v[144:147], v[52:55], a[48:51], v[144:147]
ds_read_b64_tr_b16 v[68:69], v9 offset:10240
s_xor_b32 s50, s46, 4212736
v_mfma_f32_16x16x32_bf16 v[148:151], v[48:51], a[36:39], v[148:151]
ds_read_b64_tr_b16 v[70:71], v9 offset:14336
v_cvt_pk_bf16_f32 v108, v108, v109
v_mfma_f32_16x16x32_bf16 v[148:151], v[52:55], a[52:55], v[148:151]
ds_write_b128 v16, v[96:99] offset:8192
v_mfma_f32_16x16x32_bf16 v[152:155], v[48:51], a[40:43], v[152:155]
buffer_load_dwordx4 v13, s[16:19], s49 offen offset:3072 lds
v_mfma_f32_16x16x32_bf16 v[152:155], v[52:55], a[56:59], v[152:155]
s_add_u32 m0, s37, 65536
v_cvt_pk_bf16_f32 v109, v110, v111
v_mfma_f32_16x16x32_bf16 v[156:159], v[48:51], a[44:47], v[156:159]
s_mov_b32 s48, 2560
s_waitcnt vmcnt(20) lgkmcnt(0)
v_mfma_f32_16x16x32_bf16 v[156:159], v[52:55], a[60:63], v[156:159]
s_barrier
v_mfma_f32_16x16x32_bf16 v[128:131], v[56:59], a[64:67], v[128:131]
buffer_store_dwordx4 v[104:107], v21, s[20:23], s50 offen sc1
v_mfma_f32_16x16x32_bf16 v[128:131], v[60:63], a[80:83], v[128:131]
ds_read_b64_tr_b16 v[40:41], v6 offset:0
v_cvt_pk_bf16_f32 v110, v124, v125
v_mfma_f32_16x16x32_bf16 v[132:135], v[56:59], a[68:71], v[132:135]
ds_read_b64_tr_b16 v[42:43], v6 offset:4096
v_cvt_pk_bf16_f32 v111, v126, v127
v_mfma_f32_16x16x32_bf16 v[132:135], v[60:63], a[84:87], v[132:135]
ds_read_b64_tr_b16 v[44:45], v6 offset:8192
s_xor_b32 s50, s46, 4221952
v_mfma_f32_16x16x32_bf16 v[136:139], v[56:59], a[72:75], v[136:139]
buffer_load_dwordx4 v12, s[16:19], s48 offen offset:0 lds
v_mfma_f32_16x16x32_bf16 v[136:139], v[60:63], a[88:91], v[136:139]
ds_read_b64_tr_b16 v[46:47], v6 offset:12288
v_mul_u32_u24 v74, 4224, v74
v_mfma_f32_16x16x32_bf16 v[140:143], v[56:59], a[76:79], v[140:143]
ds_read_b64_tr_b16 v[48:49], v7 offset:0
v_and_b32 v76, 16, v1
v_mfma_f32_16x16x32_bf16 v[140:143], v[60:63], a[92:95], v[140:143]
ds_read_b64_tr_b16 v[50:51], v7 offset:4096
v_add_u32 v4, v76, v74
v_mfma_f32_16x16x32_bf16 v[144:147], v[64:67], a[64:67], v[144:147]
buffer_store_dwordx4 v[108:111], v21, s[20:23], s50 offen sc1
v_mfma_f32_16x16x32_bf16 v[144:147], v[68:71], a[80:83], v[144:147]
ds_read_b64_tr_b16 v[52:53], v7 offset:8192
v_and_b32 v74, 1, v72
v_mfma_f32_16x16x32_bf16 v[148:151], v[64:67], a[68:71], v[148:151]
ds_read_b64_tr_b16 v[54:55], v7 offset:12288
v_lshlrev_b32 v74, 4, v74
v_mfma_f32_16x16x32_bf16 v[148:151], v[68:71], a[84:87], v[148:151]
v_mov_b32 v77, 0x3f80
v_lshlrev_b32 v77, v74, v77
v_mfma_f32_16x16x32_bf16 v[152:155], v[64:67], a[72:75], v[152:155]
buffer_load_dwordx4 v13, s[16:19], s48 offen offset:1024 lds
v_mfma_f32_16x16x32_bf16 v[152:155], v[68:71], a[88:91], v[152:155]
s_mov_b32 s49, 74240
v_lshrrev_b32 v74, 1, v72
v_mfma_f32_16x16x32_bf16 v[156:159], v[64:67], a[76:79], v[156:159]
v_and_b32 v76, 2, v74
v_xor_b32 v76, v76, v73
v_mfma_f32_16x16x32_bf16 v[156:159], v[68:71], a[92:95], v[156:159]
v_lshrrev_b32 v72, 3, v72
s_waitcnt lgkmcnt(0)
v_mfma_f32_16x16x32_bf16 v[128:131], v[40:43], a[96:99], v[128:131]
buffer_load_dwordx4 v[80:83], v3, s[12:15], s8 offen offset:2048
v_mfma_f32_16x16x32_bf16 v[128:131], v[44:47], a[112:115], v[128:131]
ds_read_b64_tr_b16 v[56:57], v6 offset:2048
v_xor_b32 v73, v73, v72
v_mfma_f32_16x16x32_bf16 v[132:135], v[40:43], a[100:103], v[132:135]
ds_read_b64_tr_b16 v[58:59], v6 offset:6144
v_lshl_add_u32 v76, v76, 1, v72
v_mfma_f32_16x16x32_bf16 v[132:135], v[44:47], a[116:119], v[132:135]
ds_read_b64_tr_b16 v[60:61], v6 offset:10240
v_and_b32 v72, 1, v74
v_mfma_f32_16x16x32_bf16 v[136:139], v[40:43], a[104:107], v[136:139]
buffer_load_dwordx4 v12, s[16:19], s49 offen offset:2048 lds
v_mfma_f32_16x16x32_bf16 v[136:139], v[44:47], a[120:123], v[136:139]
ds_read_b64_tr_b16 v[62:63], v6 offset:14336
v_lshl_add_u32 v76, v76, 1, v72
v_mfma_f32_16x16x32_bf16 v[140:143], v[40:43], a[108:111], v[140:143]
ds_read_b64_tr_b16 v[64:65], v7 offset:2048
v_and_b32 v74, 3, v74
v_mfma_f32_16x16x32_bf16 v[140:143], v[44:47], a[124:127], v[140:143]
ds_read_b64_tr_b16 v[66:67], v7 offset:6144
v_lshl_add_u32 v73, v73, 2, v74
v_mfma_f32_16x16x32_bf16 v[144:147], v[48:51], a[96:99], v[144:147]
buffer_load_dwordx4 v[84:87], v3, s[12:15], s8 offen offset:2304
v_mfma_f32_16x16x32_bf16 v[144:147], v[52:55], a[112:115], v[144:147]
ds_read_b64_tr_b16 v[68:69], v7 offset:10240
v_lshlrev_b32 v76, v76, 1
v_mfma_f32_16x16x32_bf16 v[148:151], v[48:51], a[100:103], v[148:151]
ds_read_b64_tr_b16 v[70:71], v7 offset:14336
v_lshlrev_b32 v73, v73, 1
v_mfma_f32_16x16x32_bf16 v[148:151], v[52:55], a[116:119], v[148:151]
v_bfe_i32 v24, v76, 0, 1
v_bfe_i32 v32, v73, 0, 1
v_mfma_f32_16x16x32_bf16 v[152:155], v[48:51], a[104:107], v[152:155]
buffer_load_dwordx4 v13, s[16:19], s49 offen offset:3072 lds
v_mfma_f32_16x16x32_bf16 v[152:155], v[52:55], a[120:123], v[152:155]
s_add_u32 m0, s37, 0
v_bfe_i32 v25, v76, 1, 1
v_mfma_f32_16x16x32_bf16 v[156:159], v[48:51], a[108:111], v[156:159]
s_mov_b32 s48, 150016
s_waitcnt vmcnt(20) lgkmcnt(0)
v_mfma_f32_16x16x32_bf16 v[156:159], v[52:55], a[124:127], v[156:159]
s_barrier
v_mfma_f32_16x16x32_bf16 v[128:131], v[56:59], a[128:131], v[128:131]
buffer_load_dwordx4 v[88:91], v3, s[12:15], s8 offen offset:2560
v_mfma_f32_16x16x32_bf16 v[128:131], v[60:63], a[144:147], v[128:131]
ds_read_b64_tr_b16 v[40:41], v6 offset:16384
v_bfe_i32 v33, v73, 1, 1
v_mfma_f32_16x16x32_bf16 v[132:135], v[56:59], a[132:135], v[132:135]
ds_read_b64_tr_b16 v[42:43], v6 offset:20480
v_bfe_i32 v26, v76, 2, 1
v_mfma_f32_16x16x32_bf16 v[132:135], v[60:63], a[148:151], v[132:135]
ds_read_b64_tr_b16 v[44:45], v6 offset:24576
v_bfe_i32 v34, v73, 2, 1
v_mfma_f32_16x16x32_bf16 v[136:139], v[56:59], a[136:139], v[136:139]
buffer_load_dwordx4 v12, s[16:19], s48 offen offset:0 lds
v_mfma_f32_16x16x32_bf16 v[136:139], v[60:63], a[152:155], v[136:139]
ds_read_b64_tr_b16 v[46:47], v6 offset:28672
v_bfe_i32 v27, v76, 3, 1
v_mfma_f32_16x16x32_bf16 v[140:143], v[56:59], a[140:143], v[140:143]
ds_read_b64_tr_b16 v[48:49], v7 offset:16384
v_bfe_i32 v35, v73, 3, 1
v_mfma_f32_16x16x32_bf16 v[140:143], v[60:63], a[156:159], v[140:143]
ds_read_b64_tr_b16 v[50:51], v7 offset:20480
v_bfe_i32 v28, v76, 4, 1
v_mfma_f32_16x16x32_bf16 v[144:147], v[64:67], a[128:131], v[144:147]
v_bfe_i32 v36, v73, 8, 1
v_bfe_i32 v29, v76, 5, 1
v_mfma_f32_16x16x32_bf16 v[144:147], v[68:71], a[144:147], v[144:147]
ds_read_b64_tr_b16 v[52:53], v7 offset:24576
v_bfe_i32 v37, v73, 9, 1
v_mfma_f32_16x16x32_bf16 v[148:151], v[64:67], a[132:135], v[148:151]
ds_read_b64_tr_b16 v[54:55], v7 offset:28672
v_bfe_i32 v30, v76, 6, 1
v_mfma_f32_16x16x32_bf16 v[148:151], v[68:71], a[148:151], v[148:151]
v_bfe_i32 v38, v73, 10, 1
v_bfe_i32 v31, v76, 7, 1
v_mfma_f32_16x16x32_bf16 v[152:155], v[64:67], a[136:139], v[152:155]
buffer_load_dwordx4 v13, s[16:19], s48 offen offset:1024 lds
v_mfma_f32_16x16x32_bf16 v[152:155], v[68:71], a[152:155], v[152:155]
s_mov_b32 s49, 221696
v_bfe_i32 v39, v73, 11, 1
v_mfma_f32_16x16x32_bf16 v[156:159], v[64:67], a[140:143], v[156:159]
v_and_b32 v24, v77, v24
v_and_b32 v25, v77, v25
v_mfma_f32_16x16x32_bf16 v[156:159], v[68:71], a[156:159], v[156:159]
v_and_b32 v26, v77, v26
s_waitcnt lgkmcnt(0)
v_mfma_f32_16x16x32_bf16 v[128:131], v[40:43], a[160:163], v[128:131]
v_and_b32 v27, v77, v27
v_and_b32 v28, v77, v28
v_mfma_f32_16x16x32_bf16 v[128:131], v[44:47], a[176:179], v[128:131]
ds_read_b64_tr_b16 v[56:57], v6 offset:18432
v_and_b32 v29, v77, v29
v_mfma_f32_16x16x32_bf16 v[132:135], v[40:43], a[164:167], v[132:135]
ds_read_b64_tr_b16 v[58:59], v6 offset:22528
v_and_b32 v30, v77, v30
v_mfma_f32_16x16x32_bf16 v[132:135], v[44:47], a[180:183], v[132:135]
ds_read_b64_tr_b16 v[60:61], v6 offset:26624
v_and_b32 v31, v77, v31
v_mfma_f32_16x16x32_bf16 v[136:139], v[40:43], a[168:171], v[136:139]
buffer_load_dwordx4 v12, s[16:19], s49 offen offset:2048 lds
v_mfma_f32_16x16x32_bf16 v[136:139], v[44:47], a[184:187], v[136:139]
ds_read_b64_tr_b16 v[62:63], v6 offset:30720
v_and_b32 v32, v77, v32
v_mfma_f32_16x16x32_bf16 v[140:143], v[40:43], a[172:175], v[140:143]
ds_read_b64_tr_b16 v[64:65], v7 offset:18432
v_and_b32 v33, v77, v33
v_mfma_f32_16x16x32_bf16 v[140:143], v[44:47], a[188:191], v[140:143]
ds_read_b64_tr_b16 v[66:67], v7 offset:22528
v_and_b32 v34, v77, v34
v_mfma_f32_16x16x32_bf16 v[144:147], v[48:51], a[160:163], v[144:147]
v_and_b32 v35, v77, v35
v_and_b32 v36, v77, v36
v_mfma_f32_16x16x32_bf16 v[144:147], v[52:55], a[176:179], v[144:147]
ds_read_b64_tr_b16 v[68:69], v7 offset:26624
v_and_b32 v37, v77, v37
v_mfma_f32_16x16x32_bf16 v[148:151], v[48:51], a[164:167], v[148:151]
ds_read_b64_tr_b16 v[70:71], v7 offset:30720
v_and_b32 v38, v77, v38
v_mfma_f32_16x16x32_bf16 v[148:151], v[52:55], a[180:183], v[148:151]
v_and_b32 v39, v77, v39
v_mfma_f32_16x16x32_bf16 v[152:155], v[48:51], a[168:171], v[152:155]
buffer_load_dwordx4 v13, s[16:19], s49 offen offset:3072 lds
v_mfma_f32_16x16x32_bf16 v[152:155], v[52:55], a[184:187], v[152:155]
s_add_u32 m0, s37, 16384
v_mfma_f32_16x16x32_bf16 v[156:159], v[48:51], a[172:175], v[156:159]
s_mov_b32 s48, 518656
s_waitcnt vmcnt(20) lgkmcnt(0)
v_mfma_f32_16x16x32_bf16 v[156:159], v[52:55], a[188:191], v[156:159]
s_barrier
v_mfma_f32_16x16x32_bf16 v[128:131], v[56:59], a[192:195], v[128:131]
v_mfma_f32_16x16x32_bf16 v[128:131], v[60:63], a[208:211], v[128:131]
ds_read_b64_tr_b16 v[40:41], v6 offset:32768
v_mfma_f32_16x16x32_bf16 v[132:135], v[56:59], a[196:199], v[132:135]
ds_read_b64_tr_b16 v[42:43], v6 offset:36864
v_mfma_f32_16x16x32_bf16 v[132:135], v[60:63], a[212:215], v[132:135]
ds_read_b64_tr_b16 v[44:45], v6 offset:40960
v_mfma_f32_16x16x32_bf16 v[136:139], v[56:59], a[200:203], v[136:139]
buffer_load_dwordx4 v12, s[16:19], s48 offen offset:0 lds
v_mfma_f32_16x16x32_bf16 v[136:139], v[60:63], a[216:219], v[136:139]
ds_read_b64_tr_b16 v[46:47], v6 offset:45056
v_mfma_f32_16x16x32_bf16 v[140:143], v[56:59], a[204:207], v[140:143]
ds_read_b64_tr_b16 v[48:49], v7 offset:32768
v_mfma_f32_16x16x32_bf16 v[140:143], v[60:63], a[220:223], v[140:143]
ds_read_b64_tr_b16 v[50:51], v7 offset:36864
v_mfma_f32_16x16x32_bf16 v[144:147], v[64:67], a[192:195], v[144:147]
v_mfma_f32_16x16x32_bf16 v[144:147], v[68:71], a[208:211], v[144:147]
ds_read_b64_tr_b16 v[52:53], v7 offset:40960
v_mfma_f32_16x16x32_bf16 v[148:151], v[64:67], a[196:199], v[148:151]
ds_read_b64_tr_b16 v[54:55], v7 offset:45056
v_mfma_f32_16x16x32_bf16 v[148:151], v[68:71], a[212:215], v[148:151]
v_mfma_f32_16x16x32_bf16 v[152:155], v[64:67], a[200:203], v[152:155]
buffer_load_dwordx4 v13, s[16:19], s48 offen offset:1024 lds
v_mfma_f32_16x16x32_bf16 v[152:155], v[68:71], a[216:219], v[152:155]
s_mov_b32 s49, 590336
v_mfma_f32_16x16x32_bf16 v[156:159], v[64:67], a[204:207], v[156:159]
v_mfma_f32_16x16x32_bf16 v[156:159], v[68:71], a[220:223], v[156:159]
s_waitcnt lgkmcnt(0)
v_mfma_f32_16x16x32_bf16 v[128:131], v[40:43], a[224:227], v[128:131]
v_mfma_f32_16x16x32_bf16 v[128:131], v[44:47], a[240:243], v[128:131]
ds_read_b64_tr_b16 v[56:57], v6 offset:34816
v_mfma_f32_16x16x32_bf16 v[132:135], v[40:43], a[228:231], v[132:135]
ds_read_b64_tr_b16 v[58:59], v6 offset:38912
v_mfma_f32_16x16x32_bf16 v[132:135], v[44:47], a[244:247], v[132:135]
ds_read_b64_tr_b16 v[60:61], v6 offset:43008
v_mfma_f32_16x16x32_bf16 v[136:139], v[40:43], a[232:235], v[136:139]
buffer_load_dwordx4 v12, s[16:19], s49 offen offset:2048 lds
v_mfma_f32_16x16x32_bf16 v[136:139], v[44:47], a[248:251], v[136:139]
ds_read_b64_tr_b16 v[62:63], v6 offset:47104
v_mfma_f32_16x16x32_bf16 v[140:143], v[40:43], a[236:239], v[140:143]
ds_read_b64_tr_b16 v[64:65], v7 offset:34816
v_mfma_f32_16x16x32_bf16 v[140:143], v[44:47], a[252:255], v[140:143]
ds_read_b64_tr_b16 v[66:67], v7 offset:38912
v_mfma_f32_16x16x32_bf16 v[144:147], v[48:51], a[224:227], v[144:147]
v_mfma_f32_16x16x32_bf16 v[144:147], v[52:55], a[240:243], v[144:147]
ds_read_b64_tr_b16 v[68:69], v7 offset:43008
v_mfma_f32_16x16x32_bf16 v[148:151], v[48:51], a[228:231], v[148:151]
ds_read_b64_tr_b16 v[70:71], v7 offset:47104
v_mfma_f32_16x16x32_bf16 v[148:151], v[52:55], a[244:247], v[148:151]
v_mfma_f32_16x16x32_bf16 v[152:155], v[48:51], a[232:235], v[152:155]
buffer_load_dwordx4 v13, s[16:19], s49 offen offset:3072 lds
v_mfma_f32_16x16x32_bf16 v[152:155], v[52:55], a[248:251], v[152:155]
s_add_u32 m0, s37, 32768
v_mfma_f32_16x16x32_bf16 v[156:159], v[48:51], a[236:239], v[156:159]
s_mov_b32 s48, 297472
s_waitcnt vmcnt(17) lgkmcnt(0)
v_mfma_f32_16x16x32_bf16 v[156:159], v[52:55], a[252:255], v[156:159]
s_barrier
v_mfma_f32_16x16x32_bf16 v[128:131], v[56:59], v[224:227], v[128:131]
v_mfma_f32_16x16x32_bf16 v[128:131], v[60:63], v[240:243], v[128:131]
ds_read_b64_tr_b16 v[40:41], v6 offset:49152
v_mfma_f32_16x16x32_bf16 v[132:135], v[56:59], v[228:231], v[132:135]
ds_read_b64_tr_b16 v[42:43], v6 offset:53248
v_mfma_f32_16x16x32_bf16 v[132:135], v[60:63], v[244:247], v[132:135]
ds_read_b64_tr_b16 v[44:45], v6 offset:57344
v_mfma_f32_16x16x32_bf16 v[136:139], v[56:59], v[232:235], v[136:139]
buffer_load_dwordx4 v12, s[16:19], s48 offen offset:0 lds
v_mfma_f32_16x16x32_bf16 v[136:139], v[60:63], v[248:251], v[136:139]
ds_read_b64_tr_b16 v[46:47], v6 offset:61440
v_mfma_f32_16x16x32_bf16 v[140:143], v[56:59], v[236:239], v[140:143]
ds_read_b64_tr_b16 v[48:49], v7 offset:49152
v_mfma_f32_16x16x32_bf16 v[140:143], v[60:63], v[252:255], v[140:143]
ds_read_b64_tr_b16 v[50:51], v7 offset:53248
v_mfma_f32_16x16x32_bf16 v[144:147], v[64:67], v[224:227], v[144:147]
v_mfma_f32_16x16x32_bf16 v[144:147], v[68:71], v[240:243], v[144:147]
ds_read_b64_tr_b16 v[52:53], v7 offset:57344
v_mfma_f32_16x16x32_bf16 v[148:151], v[64:67], v[228:231], v[148:151]
ds_read_b64_tr_b16 v[54:55], v7 offset:61440
v_mfma_f32_16x16x32_bf16 v[148:151], v[68:71], v[244:247], v[148:151]
v_mfma_f32_16x16x32_bf16 v[152:155], v[64:67], v[232:235], v[152:155]
buffer_load_dwordx4 v13, s[16:19], s48 offen offset:1024 lds
v_mfma_f32_16x16x32_bf16 v[152:155], v[68:71], v[248:251], v[152:155]
v_mfma_f32_16x16x32_bf16 v[156:159], v[64:67], v[236:239], v[156:159]
v_mfma_f32_16x16x32_bf16 v[156:159], v[68:71], v[252:255], v[156:159]
s_waitcnt lgkmcnt(0)
v_mfma_f32_16x16x32_bf16 v[160:163], v[40:43], a[0:3], 0
v_mfma_f32_16x16x32_bf16 v[160:163], v[44:47], a[16:19], v[160:163]
ds_read_b64_tr_b16 v[56:57], v6 offset:51200
v_mfma_f32_16x16x32_bf16 v[164:167], v[40:43], a[4:7], 0
ds_read_b64_tr_b16 v[58:59], v6 offset:55296
v_mfma_f32_16x16x32_bf16 v[164:167], v[44:47], a[20:23], v[164:167]
ds_read_b64_tr_b16 v[60:61], v6 offset:59392
v_mfma_f32_16x16x32_bf16 v[168:171], v[40:43], a[8:11], 0
v_mfma_f32_16x16x32_bf16 v[168:171], v[44:47], a[24:27], v[168:171]
ds_read_b64_tr_b16 v[62:63], v6 offset:63488
v_mfma_f32_16x16x32_bf16 v[172:175], v[40:43], a[12:15], 0
ds_read_b64_tr_b16 v[64:65], v7 offset:51200
v_mfma_f32_16x16x32_bf16 v[172:175], v[44:47], a[28:31], v[172:175]
ds_read_b64_tr_b16 v[66:67], v7 offset:55296
v_mfma_f32_16x16x32_bf16 v[176:179], v[48:51], a[0:3], 0
buffer_load_dword v95, v10, s[20:23], 0 offen sc1
v_mfma_f32_16x16x32_bf16 v[176:179], v[52:55], a[16:19], v[176:179]
ds_read_b64_tr_b16 v[68:69], v7 offset:59392
v_cvt_pk_bf16_f32 v128, v128, v129
v_mfma_f32_16x16x32_bf16 v[180:183], v[48:51], a[4:7], 0
ds_read_b64_tr_b16 v[70:71], v7 offset:63488
v_cvt_pk_bf16_f32 v129, v130, v131
v_mfma_f32_16x16x32_bf16 v[180:183], v[52:55], a[20:23], v[180:183]
v_cvt_pk_bf16_f32 v130, v144, v145
v_cvt_pk_bf16_f32 v131, v146, v147
v_mfma_f32_16x16x32_bf16 v[184:187], v[48:51], a[8:11], 0
ds_write_b128 v16, v[128:131] offset:12288
v_mfma_f32_16x16x32_bf16 v[184:187], v[52:55], a[24:27], v[184:187]
s_xor_b32 s50, s46, 6291456
v_cvt_pk_bf16_f32 v132, v132, v133
v_mfma_f32_16x16x32_bf16 v[188:191], v[48:51], a[12:15], 0
v_cvt_pk_bf16_f32 v133, v134, v135
s_waitcnt vmcnt(12) lgkmcnt(0)
v_mfma_f32_16x16x32_bf16 v[188:191], v[52:55], a[28:31], v[188:191]
s_barrier
v_mfma_f32_16x16x32_bf16 v[160:163], v[56:59], a[32:35], v[160:163]
buffer_store_dwordx4 v[128:131], v14, s[20:23], s50 offen sc1
v_mfma_f32_16x16x32_bf16 v[160:163], v[60:63], a[48:51], v[160:163]
ds_read_b64_tr_b16 v[40:41], v8 offset:0
v_cvt_pk_bf16_f32 v134, v148, v149
v_mfma_f32_16x16x32_bf16 v[164:167], v[56:59], a[36:39], v[164:167]
ds_read_b64_tr_b16 v[42:43], v8 offset:4096
v_cvt_pk_bf16_f32 v135, v150, v151
v_mfma_f32_16x16x32_bf16 v[164:167], v[60:63], a[52:55], v[164:167]
ds_read_b64_tr_b16 v[44:45], v8 offset:8192
s_xor_b32 s50, s46, 6300672
v_mfma_f32_16x16x32_bf16 v[168:171], v[56:59], a[40:43], v[168:171]
buffer_store_dwordx4 v[132:135], v21, s[20:23], s50 offen sc1
v_mfma_f32_16x16x32_bf16 v[168:171], v[60:63], a[56:59], v[168:171]
ds_read_b64_tr_b16 v[46:47], v8 offset:12288
v_cvt_pk_bf16_f32 v136, v136, v137
v_mfma_f32_16x16x32_bf16 v[172:175], v[56:59], a[44:47], v[172:175]
ds_read_b64_tr_b16 v[48:49], v9 offset:0
v_cvt_pk_bf16_f32 v137, v138, v139
v_mfma_f32_16x16x32_bf16 v[172:175], v[60:63], a[60:63], v[172:175]
ds_read_b64_tr_b16 v[50:51], v9 offset:4096
v_cvt_pk_bf16_f32 v138, v152, v153
v_mfma_f32_16x16x32_bf16 v[176:179], v[64:67], a[32:35], v[176:179]
v_cvt_pk_bf16_f32 v139, v154, v155
s_xor_b32 s50, s46, 6309888
v_mfma_f32_16x16x32_bf16 v[176:179], v[68:71], a[48:51], v[176:179]
ds_read_b64_tr_b16 v[52:53], v9 offset:8192
v_cvt_pk_bf16_f32 v140, v140, v141
v_mfma_f32_16x16x32_bf16 v[180:183], v[64:67], a[36:39], v[180:183]
ds_read_b64_tr_b16 v[54:55], v9 offset:12288
v_cvt_pk_bf16_f32 v141, v142, v143
v_mfma_f32_16x16x32_bf16 v[180:183], v[68:71], a[52:55], v[180:183]
v_cvt_pk_bf16_f32 v142, v156, v157
v_cvt_pk_bf16_f32 v143, v158, v159
v_mfma_f32_16x16x32_bf16 v[184:187], v[64:67], a[40:43], v[184:187]
buffer_store_dwordx4 v[136:139], v21, s[20:23], s50 offen sc1
v_mfma_f32_16x16x32_bf16 v[184:187], v[68:71], a[56:59], v[184:187]
s_xor_b32 s50, s46, 6319104
v_mfma_f32_16x16x32_bf16 v[188:191], v[64:67], a[44:47], v[188:191]
v_mfma_f32_16x16x32_bf16 v[188:191], v[68:71], a[60:63], v[188:191]
s_waitcnt lgkmcnt(0)
v_mfma_f32_16x16x32_bf16 v[160:163], v[40:43], a[64:67], v[160:163]
buffer_store_dwordx4 v[140:143], v21, s[20:23], s50 offen sc1
v_mfma_f32_16x16x32_bf16 v[160:163], v[44:47], a[80:83], v[160:163]
ds_read_b64_tr_b16 v[56:57], v8 offset:2048
v_mfma_f32_16x16x32_bf16 v[164:167], v[40:43], a[68:71], v[164:167]
ds_read_b64_tr_b16 v[58:59], v8 offset:6144
v_mfma_f32_16x16x32_bf16 v[164:167], v[44:47], a[84:87], v[164:167]
ds_read_b64_tr_b16 v[60:61], v8 offset:10240
v_mfma_f32_16x16x32_bf16 v[168:171], v[40:43], a[72:75], v[168:171]
v_mfma_f32_16x16x32_bf16 v[168:171], v[44:47], a[88:91], v[168:171]
ds_read_b64_tr_b16 v[62:63], v8 offset:14336
v_mfma_f32_16x16x32_bf16 v[172:175], v[40:43], a[76:79], v[172:175]
ds_read_b64_tr_b16 v[64:65], v9 offset:2048
v_mfma_f32_16x16x32_bf16 v[172:175], v[44:47], a[92:95], v[172:175]
ds_read_b64_tr_b16 v[66:67], v9 offset:6144
v_mfma_f32_16x16x32_bf16 v[176:179], v[48:51], a[64:67], v[176:179]
v_mfma_f32_16x16x32_bf16 v[176:179], v[52:55], a[80:83], v[176:179]
ds_read_b64_tr_b16 v[68:69], v9 offset:10240
v_mfma_f32_16x16x32_bf16 v[180:183], v[48:51], a[68:71], v[180:183]
ds_read_b64_tr_b16 v[70:71], v9 offset:14336
v_mfma_f32_16x16x32_bf16 v[180:183], v[52:55], a[84:87], v[180:183]
v_mfma_f32_16x16x32_bf16 v[184:187], v[48:51], a[72:75], v[184:187]
v_mov_b32 v20, 2
buffer_store_dword v20, v75, s[20:23], 0 offen offset:128 sc1
v_mfma_f32_16x16x32_bf16 v[184:187], v[52:55], a[88:91], v[184:187]
v_mfma_f32_16x16x32_bf16 v[188:191], v[48:51], a[76:79], v[188:191]
s_waitcnt vmcnt(12) lgkmcnt(0)
v_mfma_f32_16x16x32_bf16 v[188:191], v[52:55], a[92:95], v[188:191]
s_barrier
v_mfma_f32_16x16x32_bf16 v[160:163], v[56:59], a[96:99], v[160:163]
v_mfma_f32_16x16x32_bf16 v[160:163], v[60:63], a[112:115], v[160:163]
ds_read_b64_tr_b16 v[40:41], v6 offset:0
v_mfma_f32_16x16x32_bf16 v[164:167], v[56:59], a[100:103], v[164:167]
ds_read_b64_tr_b16 v[42:43], v6 offset:4096
v_mfma_f32_16x16x32_bf16 v[164:167], v[60:63], a[116:119], v[164:167]
ds_read_b64_tr_b16 v[44:45], v6 offset:8192
v_mfma_f32_16x16x32_bf16 v[168:171], v[56:59], a[104:107], v[168:171]
v_mfma_f32_16x16x32_bf16 v[168:171], v[60:63], a[120:123], v[168:171]
ds_read_b64_tr_b16 v[46:47], v6 offset:12288
v_mfma_f32_16x16x32_bf16 v[172:175], v[56:59], a[108:111], v[172:175]
ds_read_b64_tr_b16 v[48:49], v7 offset:0
v_mfma_f32_16x16x32_bf16 v[172:175], v[60:63], a[124:127], v[172:175]
ds_read_b64_tr_b16 v[50:51], v7 offset:4096
v_mfma_f32_16x16x32_bf16 v[176:179], v[64:67], a[96:99], v[176:179]
v_mfma_f32_16x16x32_bf16 v[176:179], v[68:71], a[112:115], v[176:179]
ds_read_b64_tr_b16 v[52:53], v7 offset:8192
v_mfma_f32_16x16x32_bf16 v[180:183], v[64:67], a[100:103], v[180:183]
ds_read_b64_tr_b16 v[54:55], v7 offset:12288
v_mfma_f32_16x16x32_bf16 v[180:183], v[68:71], a[116:119], v[180:183]
v_mfma_f32_16x16x32_bf16 v[184:187], v[64:67], a[104:107], v[184:187]
v_mfma_f32_16x16x32_bf16 v[184:187], v[68:71], a[120:123], v[184:187]
v_mfma_f32_16x16x32_bf16 v[188:191], v[64:67], a[108:111], v[188:191]
v_mfma_f32_16x16x32_bf16 v[188:191], v[68:71], a[124:127], v[188:191]
s_waitcnt lgkmcnt(0)
v_mfma_f32_16x16x32_bf16 v[160:163], v[40:43], a[128:131], v[160:163]
v_mfma_f32_16x16x32_bf16 v[160:163], v[44:47], a[144:147], v[160:163]
ds_read_b64_tr_b16 v[56:57], v6 offset:2048
v_mfma_f32_16x16x32_bf16 v[164:167], v[40:43], a[132:135], v[164:167]
ds_read_b64_tr_b16 v[58:59], v6 offset:6144
v_mfma_f32_16x16x32_bf16 v[164:167], v[44:47], a[148:151], v[164:167]
ds_read_b64_tr_b16 v[60:61], v6 offset:10240
v_mfma_f32_16x16x32_bf16 v[168:171], v[40:43], a[136:139], v[168:171]
v_mfma_f32_16x16x32_bf16 v[168:171], v[44:47], a[152:155], v[168:171]
ds_read_b64_tr_b16 v[62:63], v6 offset:14336
v_mfma_f32_16x16x32_bf16 v[172:175], v[40:43], a[140:143], v[172:175]
ds_read_b64_tr_b16 v[64:65], v7 offset:2048
v_mfma_f32_16x16x32_bf16 v[172:175], v[44:47], a[156:159], v[172:175]
ds_read_b64_tr_b16 v[66:67], v7 offset:6144
v_mfma_f32_16x16x32_bf16 v[176:179], v[48:51], a[128:131], v[176:179]
v_mfma_f32_16x16x32_bf16 v[176:179], v[52:55], a[144:147], v[176:179]
ds_read_b64_tr_b16 v[68:69], v7 offset:10240
v_mfma_f32_16x16x32_bf16 v[180:183], v[48:51], a[132:135], v[180:183]
ds_read_b64_tr_b16 v[70:71], v7 offset:14336
v_mfma_f32_16x16x32_bf16 v[180:183], v[52:55], a[148:151], v[180:183]
s_waitcnt vmcnt(5)
v_cmp_gt_u32 vcc, 5, v95
s_cmp_eq_u32 vcc_lo, 0
s_cbranch_scc0 L_spin5
L_back5:
v_mfma_f32_16x16x32_bf16 v[184:187], v[48:51], a[136:139], v[184:187]
v_mfma_f32_16x16x32_bf16 v[184:187], v[52:55], a[152:155], v[184:187]
v_mfma_f32_16x16x32_bf16 v[188:191], v[48:51], a[140:143], v[188:191]
s_waitcnt lgkmcnt(0)
v_mfma_f32_16x16x32_bf16 v[188:191], v[52:55], a[156:159], v[188:191]
s_barrier
v_mfma_f32_16x16x32_bf16 v[160:163], v[56:59], a[160:163], v[160:163]
buffer_load_dwordx4 a[0:3], v4, s[20:23], s10 offen sc1
v_mfma_f32_16x16x32_bf16 v[160:163], v[60:63], a[176:179], v[160:163]
ds_read_b64_tr_b16 v[40:41], v6 offset:16384
s_add_u32 s10, s10, 540672
v_mfma_f32_16x16x32_bf16 v[164:167], v[56:59], a[164:167], v[164:167]
ds_read_b64_tr_b16 v[42:43], v6 offset:20480
v_mfma_f32_16x16x32_bf16 v[164:167], v[60:63], a[180:183], v[164:167]
ds_read_b64_tr_b16 v[44:45], v6 offset:24576
v_mfma_f32_16x16x32_bf16 v[168:171], v[56:59], a[168:171], v[168:171]
buffer_load_dwordx4 a[4:7], v4, s[20:23], s10 offen sc1
v_mfma_f32_16x16x32_bf16 v[168:171], v[60:63], a[184:187], v[168:171]
ds_read_b64_tr_b16 v[46:47], v6 offset:28672
s_add_u32 s10, s10, 540672
v_mfma_f32_16x16x32_bf16 v[172:175], v[56:59], a[172:175], v[172:175]
ds_read_b64_tr_b16 v[48:49], v7 offset:16384
v_mfma_f32_16x16x32_bf16 v[172:175], v[60:63], a[188:191], v[172:175]
ds_read_b64_tr_b16 v[50:51], v7 offset:20480
v_mfma_f32_16x16x32_bf16 v[176:179], v[64:67], a[160:163], v[176:179]
buffer_load_dwordx4 a[8:11], v4, s[20:23], s10 offen sc1
v_mfma_f32_16x16x32_bf16 v[176:179], v[68:71], a[176:179], v[176:179]
ds_read_b64_tr_b16 v[52:53], v7 offset:24576
v_mfma_f32_16x16x32_bf16 v[180:183], v[64:67], a[164:167], v[180:183]
ds_read_b64_tr_b16 v[54:55], v7 offset:28672
v_mfma_f32_16x16x32_bf16 v[180:183], v[68:71], a[180:183], v[180:183]
v_mfma_f32_16x16x32_bf16 v[184:187], v[64:67], a[168:171], v[184:187]
v_mfma_f32_16x16x32_bf16 v[184:187], v[68:71], a[184:187], v[184:187]
v_mfma_f32_16x16x32_bf16 v[188:191], v[64:67], a[172:175], v[188:191]
v_mfma_f32_16x16x32_bf16 v[188:191], v[68:71], a[188:191], v[188:191]
s_waitcnt lgkmcnt(0)
v_mfma_f32_16x16x32_bf16 v[160:163], v[40:43], a[192:195], v[160:163]
v_mfma_f32_16x16x32_bf16 v[160:163], v[44:47], a[208:211], v[160:163]
ds_read_b64_tr_b16 v[56:57], v6 offset:18432
v_mfma_f32_16x16x32_bf16 v[164:167], v[40:43], a[196:199], v[164:167]
ds_read_b64_tr_b16 v[58:59], v6 offset:22528
v_mfma_f32_16x16x32_bf16 v[164:167], v[44:47], a[212:215], v[164:167]
ds_read_b64_tr_b16 v[60:61], v6 offset:26624
v_mfma_f32_16x16x32_bf16 v[168:171], v[40:43], a[200:203], v[168:171]
v_mfma_f32_16x16x32_bf16 v[168:171], v[44:47], a[216:219], v[168:171]
ds_read_b64_tr_b16 v[62:63], v6 offset:30720
v_mfma_f32_16x16x32_bf16 v[172:175], v[40:43], a[204:207], v[172:175]
ds_read_b64_tr_b16 v[64:65], v7 offset:18432
v_mfma_f32_16x16x32_bf16 v[172:175], v[44:47], a[220:223], v[172:175]
ds_read_b64_tr_b16 v[66:67], v7 offset:22528
v_mfma_f32_16x16x32_bf16 v[176:179], v[48:51], a[192:195], v[176:179]
v_mfma_f32_16x16x32_bf16 v[176:179], v[52:55], a[208:211], v[176:179]
ds_read_b64_tr_b16 v[68:69], v7 offset:26624
v_mfma_f32_16x16x32_bf16 v[180:183], v[48:51], a[196:199], v[180:183]
ds_read_b64_tr_b16 v[70:71], v7 offset:30720
v_mfma_f32_16x16x32_bf16 v[180:183], v[52:55], a[212:215], v[180:183]
v_mfma_f32_16x16x32_bf16 v[184:187], v[48:51], a[200:203], v[184:187]
v_mfma_f32_16x16x32_bf16 v[184:187], v[52:55], a[216:219], v[184:187]
v_mfma_f32_16x16x32_bf16 v[188:191], v[48:51], a[204:207], v[188:191]
s_waitcnt lgkmcnt(0)
v_mfma_f32_16x16x32_bf16 v[188:191], v[52:55], a[220:223], v[188:191]
s_barrier
v_mfma_f32_16x16x32_bf16 v[160:163], v[56:59], a[224:227], v[160:163]
v_mfma_f32_16x16x32_bf16 v[160:163], v[60:63], a[240:243], v[160:163]
ds_read_b64_tr_b16 v[40:41], v6 offset:32768
v_mfma_f32_16x16x32_bf16 v[164:167], v[56:59], a[228:231], v[164:167]
ds_read_b64_tr_b16 v[42:43], v6 offset:36864
v_mfma_f32_16x16x32_bf16 v[164:167], v[60:63], a[244:247], v[164:167]
ds_read_b64_tr_b16 v[44:45], v6 offset:40960
v_mfma_f32_16x16x32_bf16 v[168:171], v[56:59], a[232:235], v[168:171]
v_mfma_f32_16x16x32_bf16 v[168:171], v[60:63], a[248:251], v[168:171]
ds_read_b64_tr_b16 v[46:47], v6 offset:45056
v_mfma_f32_16x16x32_bf16 v[172:175], v[56:59], a[236:239], v[172:175]
ds_read_b64_tr_b16 v[48:49], v7 offset:32768
v_mfma_f32_16x16x32_bf16 v[172:175], v[60:63], a[252:255], v[172:175]
ds_read_b64_tr_b16 v[50:51], v7 offset:36864
v_mfma_f32_16x16x32_bf16 v[176:179], v[64:67], a[224:227], v[176:179]
v_mfma_f32_16x16x32_bf16 v[176:179], v[68:71], a[240:243], v[176:179]
ds_read_b64_tr_b16 v[52:53], v7 offset:40960
v_mfma_f32_16x16x32_bf16 v[180:183], v[64:67], a[228:231], v[180:183]
ds_read_b64_tr_b16 v[54:55], v7 offset:45056
v_mfma_f32_16x16x32_bf16 v[180:183], v[68:71], a[244:247], v[180:183]
v_mfma_f32_16x16x32_bf16 v[184:187], v[64:67], a[232:235], v[184:187]
v_mfma_f32_16x16x32_bf16 v[184:187], v[68:71], a[248:251], v[184:187]
v_mfma_f32_16x16x32_bf16 v[188:191], v[64:67], a[236:239], v[188:191]
v_mfma_f32_16x16x32_bf16 v[188:191], v[68:71], a[252:255], v[188:191]
s_waitcnt lgkmcnt(0)
v_mfma_f32_16x16x32_bf16 v[160:163], v[40:43], v[224:227], v[160:163]
v_mfma_f32_16x16x32_bf16 v[160:163], v[44:47], v[240:243], v[160:163]
v_mfma_f32_16x16x32_bf16 v[164:167], v[40:43], v[228:231], v[164:167]
v_mfma_f32_16x16x32_bf16 v[164:167], v[44:47], v[244:247], v[164:167]
v_mfma_f32_16x16x32_bf16 v[168:171], v[40:43], v[232:235], v[168:171]
v_mfma_f32_16x16x32_bf16 v[168:171], v[44:47], v[248:251], v[168:171]
v_mfma_f32_16x16x32_bf16 v[172:175], v[40:43], v[236:239], v[172:175]
v_mfma_f32_16x16x32_bf16 v[172:175], v[44:47], v[252:255], v[172:175]
v_mfma_f32_16x16x32_bf16 v[176:179], v[48:51], v[224:227], v[176:179]
v_mfma_f32_16x16x32_bf16 v[176:179], v[52:55], v[240:243], v[176:179]
v_mfma_f32_16x16x32_bf16 v[180:183], v[48:51], v[228:231], v[180:183]
v_mfma_f32_16x16x32_bf16 v[180:183], v[52:55], v[244:247], v[180:183]
v_mfma_f32_16x16x32_bf16 v[184:187], v[48:51], v[232:235], v[184:187]
v_mfma_f32_16x16x32_bf16 v[184:187], v[52:55], v[248:251], v[184:187]
v_mfma_f32_16x16x32_bf16 v[188:191], v[48:51], v[236:239], v[188:191]
v_mfma_f32_16x16x32_bf16 v[188:191], v[52:55], v[252:255], v[188:191]
s_nop 7
v_cvt_pk_bf16_f32 v160, v160, v161
s_xor_b32 s50, s46, 8388608
v_cvt_pk_bf16_f32 v161, v162, v163
v_cvt_pk_bf16_f32 v164, v164, v165
v_cvt_pk_bf16_f32 v162, v176, v177
v_cvt_pk_bf16_f32 v163, v178, v179
v_cvt_pk_bf16_f32 v165, v166, v167
buffer_store_dwordx4 v[160:163], v14, s[20:23], s50 offen sc1
ds_write_b128 v16, v[160:163] offset:16384
v_cvt_pk_bf16_f32 v166, v180, v181
v_cvt_pk_bf16_f32 v167, v182, v183
s_xor_b32 s50, s46, 8397824
v_cvt_pk_bf16_f32 v168, v168, v169
buffer_store_dwordx4 v[164:167], v21, s[20:23], s50 offen sc1
v_cvt_pk_bf16_f32 v169, v170, v171
s_xor_b32 s50, s46, 8407040
v_cvt_pk_bf16_f32 v170, v184, v185
v_cvt_pk_bf16_f32 v171, v186, v187
v_cvt_pk_bf16_f32 v172, v172, v173
buffer_store_dwordx4 v[168:171], v21, s[20:23], s50 offen sc1
v_cvt_pk_bf16_f32 v173, v174, v175
s_xor_b32 s50, s46, 8416256
v_cvt_pk_bf16_f32 v174, v188, v189
v_cvt_pk_bf16_f32 v175, v190, v191
buffer_store_dwordx4 v[172:175], v21, s[20:23], s50 offen sc1
s_waitcnt vmcnt(8)
v_mov_b32 v20, 3
buffer_store_dword v20, v75, s[20:23], 0 offen offset:128 sc1
s_cmp_ge_u32 s38, 2
s_cbranch_scc1 L_hi0
s_waitcnt vmcnt(1) lgkmcnt(0)
v_mov_b32 v20, 4
buffer_store_dword v20, v75, s[20:23], 0 offen offset:128 sc1
L_rc6:
s_add_u32 s57, s57, 1
s_cmp_ge_u32 s57, 0x80000
s_cbranch_scc1 L_rk6
s_buffer_load_dwordx8 s[92:99], s[20:23], s59 glc
s_waitcnt lgkmcnt(0)
s_min_u32 s92, s92, s93
s_min_u32 s92, s92, s94
s_min_u32 s92, s92, s95
s_min_u32 s92, s92, s96
s_min_u32 s92, s92, s97
s_min_u32 s92, s92, s98
s_min_u32 s92, s92, s99
s_cmp_lt_u32 s92, 2
s_cbranch_scc1 L_rc6
L_rk6:
ds_read_b128 v[192:195], v22 offset:0
buffer_load_dwordx4 v[196:199], v2, s[20:23], s28 offen offset:1024 sc1
buffer_load_dwordx4 v[200:203], v2, s[20:23], s28 offen offset:2048 sc1
buffer_load_dwordx4 v[204:207], v2, s[20:23], s28 offen offset:3072 sc1
buffer_load_dwordx4 v[208:211], v2, s[20:23], s29 offen offset:0 sc1
buffer_load_dwordx4 v[212:215], v2, s[20:23], s29 offen offset:1024 sc1
buffer_load_dwordx4 v[216:219], v2, s[20:23], s29 offen offset:2048 sc1
buffer_load_dwordx4 v[220:223], v2, s[20:23], s29 offen offset:3072 sc1
ds_read_b128 v[96:99], v22 offset:8192
buffer_load_dwordx4 v[100:103], v2, s[20:23], s30 offen offset:1024 sc1
buffer_load_dwordx4 v[104:107], v2, s[20:23], s30 offen offset:2048 sc1
buffer_load_dwordx4 v[108:111], v2, s[20:23], s30 offen offset:3072 sc1
buffer_load_dwordx4 v[112:115], v2, s[20:23], s31 offen offset:0 sc1
buffer_load_dwordx4 v[116:119], v2, s[20:23], s31 offen offset:1024 sc1
buffer_load_dwordx4 v[120:123], v2, s[20:23], s31 offen offset:2048 sc1
buffer_load_dwordx4 v[124:127], v2, s[20:23], s31 offen offset:3072 sc1
v_mfma_f32_16x16x32_bf16 v[160:163], a[0:3], v[32:35], 0
v_mfma_f32_16x16x32_bf16 v[164:167], a[0:3], v[36:39], 0
v_mfma_f32_16x16x32_bf16 v[168:171], a[4:7], v[32:35], 0
v_mfma_f32_16x16x32_bf16 v[172:175], a[4:7], v[36:39], 0
v_mfma_f32_16x16x32_bf16 v[176:179], a[8:11], v[32:35], 0
v_mfma_f32_16x16x32_bf16 v[180:183], a[8:11], v[36:39], 0
v_lshlrev_b32 v40, 16, v80
v_and_b32 v41, 0xffff0000, v80
v_lshlrev_b32 v42, 16, v81
v_and_b32 v43, 0xffff0000, v81
v_lshlrev_b32 v44, 16, v82
v_and_b32 v45, 0xffff0000, v82
v_lshlrev_b32 v46, 16, v83
v_and_b32 v47, 0xffff0000, v83
v_lshlrev_b32 v48, 16, v84
v_and_b32 v49, 0xffff0000, v84
v_lshlrev_b32 v50, 16, v85
v_and_b32 v51, 0xffff0000, v85
v_lshlrev_b32 v52, 16, v86
v_and_b32 v53, 0xffff0000, v86
v_lshlrev_b32 v54, 16, v87
v_and_b32 v55, 0xffff0000, v87
v_lshlrev_b32 v56, 16, v88
v_and_b32 v57, 0xffff0000, v88
v_lshlrev_b32 v58, 16, v89
v_and_b32 v59, 0xffff0000, v89
v_lshlrev_b32 v60, 16, v90
v_and_b32 v61, 0xffff0000, v90
v_lshlrev_b32 v62, 16, v91
v_and_b32 v63, 0xffff0000, v91
v_pk_mul_f32 v[40:41], v[40:41], v[92:93] op_sel_hi:[1,0]
v_pk_mul_f32 v[42:43], v[42:43], v[92:93] op_sel_hi:[1,0]
v_pk_mul_f32 v[44:45], v[44:45], v[92:93] op_sel_hi:[1,0]
v_pk_mul_f32 v[46:47], v[46:47], v[92:93] op_sel_hi:[1,0]
v_pk_mul_f32 v[48:49], v[48:49], v[92:93] op_sel_hi:[1,0]
v_pk_mul_f32 v[50:51], v[50:51], v[92:93] op_sel_hi:[1,0]
v_pk_mul_f32 v[52:53], v[52:53], v[92:93] op_sel_hi:[1,0]
v_pk_mul_f32 v[54:55], v[54:55], v[92:93] op_sel_hi:[1,0]
v_pk_mul_f32 v[56:57], v[56:57], v[92:93] op_sel_hi:[1,0]
v_pk_mul_f32 v[58:59], v[58:59], v[92:93] op_sel_hi:[1,0]
v_pk_mul_f32 v[60:61], v[60:61], v[92:93] op_sel_hi:[1,0]
v_pk_mul_f32 v[62:63], v[62:63], v[92:93] op_sel_hi:[1,0]
v_pk_mul_f32 v[40:41], v[40:41], v[160:161]
v_pk_mul_f32 v[42:43], v[42:43], v[162:163]
v_pk_mul_f32 v[44:45], v[44:45], v[164:165]
v_pk_mul_f32 v[46:47], v[46:47], v[166:167]
v_pk_mul_f32 v[48:49], v[48:49], v[168:169]
v_pk_mul_f32 v[50:51], v[50:51], v[170:171]
v_pk_mul_f32 v[52:53], v[52:53], v[172:173]
v_pk_mul_f32 v[54:55], v[54:55], v[174:175]
v_pk_mul_f32 v[56:57], v[56:57], v[176:177]
v_pk_mul_f32 v[58:59], v[58:59], v[178:179]
v_pk_mul_f32 v[60:61], v[60:61], v[180:181]
v_pk_mul_f32 v[62:63], v[62:63], v[182:183]
L_rc7:
s_add_u32 s57, s57, 1
s_cmp_ge_u32 s57, 0x80000
s_cbranch_scc1 L_rk7
s_buffer_load_dwordx8 s[92:99], s[20:23], s59 glc
s_waitcnt lgkmcnt(0)
s_min_u32 s92, s92, s93
s_min_u32 s92, s92, s94
s_min_u32 s92, s92, s95
s_min_u32 s92, s92, s96
s_min_u32 s92, s92, s97
s_min_u32 s92, s92, s98
s_min_u32 s92, s92, s99
s_cmp_lt_u32 s92, 4
s_cbranch_scc1 L_rc7
L_rk7:
ds_read_b128 v[128:131], v22 offset:16384
buffer_load_dwordx4 v[132:135], v2, s[20:23], s32 offen offset:1024 sc1
buffer_load_dwordx4 v[136:139], v2, s[20:23], s32 offen offset:2048 sc1
buffer_load_dwordx4 v[140:143], v2, s[20:23], s32 offen offset:3072 sc1
buffer_load_dwordx4 v[144:147], v2, s[20:23], s33 offen offset:0 sc1
buffer_load_dwordx4 v[148:151], v2, s[20:23], s33 offen offset:1024 sc1
buffer_load_dwordx4 v[152:155], v2, s[20:23], s33 offen offset:2048 sc1
buffer_load_dwordx4 v[156:159], v2, s[20:23], s33 offen offset:3072 sc1
s_waitcnt lgkmcnt(2)
v_mfma_f32_16x16x32_bf16 v[224:227], v[24:27], v[192:195], 0
v_mfma_f32_16x16x32_bf16 v[228:231], v[28:31], v[192:195], 0
s_waitcnt vmcnt(20)
v_mfma_f32_16x16x32_bf16 v[224:227], v[24:27], v[196:199], v[224:227]
v_mfma_f32_16x16x32_bf16 v[228:231], v[28:31], v[196:199], v[228:231]
s_waitcnt vmcnt(19)
v_mfma_f32_16x16x32_bf16 v[224:227], v[24:27], v[200:203], v[224:227]
v_mfma_f32_16x16x32_bf16 v[228:231], v[28:31], v[200:203], v[228:231]
s_waitcnt vmcnt(18)
v_mfma_f32_16x16x32_bf16 v[224:227], v[24:27], v[204:207], v[224:227]
v_mfma_f32_16x16x32_bf16 v[228:231], v[28:31], v[204:207], v[228:231]
s_waitcnt vmcnt(17)
v_mfma_f32_16x16x32_bf16 v[224:227], v[24:27], v[208:211], v[224:227]
v_mfma_f32_16x16x32_bf16 v[228:231], v[28:31], v[208:211], v[228:231]
s_waitcnt vmcnt(16)
v_mfma_f32_16x16x32_bf16 v[224:227], v[24:27], v[212:215], v[224:227]
v_mfma_f32_16x16x32_bf16 v[228:231], v[28:31], v[212:215], v[228:231]
s_waitcnt vmcnt(15)
v_mfma_f32_16x16x32_bf16 v[224:227], v[24:27], v[216:219], v[224:227]
v_mfma_f32_16x16x32_bf16 v[228:231], v[28:31], v[216:219], v[228:231]
s_waitcnt vmcnt(14)
v_mfma_f32_16x16x32_bf16 v[224:227], v[24:27], v[220:223], v[224:227]
v_mfma_f32_16x16x32_bf16 v[228:231], v[28:31], v[220:223], v[228:231]
s_nop 6
v_pk_fma_f32 v[224:225], v[224:225], v[92:93], v[40:41] op_sel:[0,1,0]
v_pk_fma_f32 v[226:227], v[226:227], v[92:93], v[42:43] op_sel:[0,1,0]
v_pk_fma_f32 v[228:229], v[228:229], v[92:93], v[44:45] op_sel:[0,1,0]
v_pk_fma_f32 v[230:231], v[230:231], v[92:93], v[46:47] op_sel:[0,1,0]
v_cvt_pk_bf16_f32 v224, v224, v225
v_cvt_pk_bf16_f32 v225, v226, v227
v_cvt_pk_bf16_f32 v226, v228, v229
v_cvt_pk_bf16_f32 v227, v230, v231
buffer_store_dwordx4 v[224:227], v3, s[4:7], s9 offen offset:0 nt
s_waitcnt lgkmcnt(1)
v_mfma_f32_16x16x32_bf16 v[232:235], v[24:27], v[96:99], 0
v_mfma_f32_16x16x32_bf16 v[236:239], v[28:31], v[96:99], 0
s_waitcnt vmcnt(14)
v_mfma_f32_16x16x32_bf16 v[232:235], v[24:27], v[100:103], v[232:235]
v_mfma_f32_16x16x32_bf16 v[236:239], v[28:31], v[100:103], v[236:239]
s_waitcnt vmcnt(13)
v_mfma_f32_16x16x32_bf16 v[232:235], v[24:27], v[104:107], v[232:235]
v_mfma_f32_16x16x32_bf16 v[236:239], v[28:31], v[104:107], v[236:239]
s_waitcnt vmcnt(12)
v_mfma_f32_16x16x32_bf16 v[232:235], v[24:27], v[108:111], v[232:235]
v_mfma_f32_16x16x32_bf16 v[236:239], v[28:31], v[108:111], v[236:239]
s_waitcnt vmcnt(11)
v_mfma_f32_16x16x32_bf16 v[232:235], v[24:27], v[112:115], v[232:235]
v_mfma_f32_16x16x32_bf16 v[236:239], v[28:31], v[112:115], v[236:239]
s_waitcnt vmcnt(10)
v_mfma_f32_16x16x32_bf16 v[232:235], v[24:27], v[116:119], v[232:235]
v_mfma_f32_16x16x32_bf16 v[236:239], v[28:31], v[116:119], v[236:239]
s_waitcnt vmcnt(9)
v_mfma_f32_16x16x32_bf16 v[232:235], v[24:27], v[120:123], v[232:235]
v_mfma_f32_16x16x32_bf16 v[236:239], v[28:31], v[120:123], v[236:239]
s_waitcnt vmcnt(8)
v_mfma_f32_16x16x32_bf16 v[232:235], v[24:27], v[124:127], v[232:235]
v_mfma_f32_16x16x32_bf16 v[236:239], v[28:31], v[124:127], v[236:239]
s_nop 6
v_pk_fma_f32 v[232:233], v[232:233], v[92:93], v[48:49] op_sel:[0,1,0]
v_pk_fma_f32 v[234:235], v[234:235], v[92:93], v[50:51] op_sel:[0,1,0]
v_pk_fma_f32 v[236:237], v[236:237], v[92:93], v[52:53] op_sel:[0,1,0]
v_pk_fma_f32 v[238:239], v[238:239], v[92:93], v[54:55] op_sel:[0,1,0]
v_cvt_pk_bf16_f32 v232, v232, v233
v_cvt_pk_bf16_f32 v233, v234, v235
v_cvt_pk_bf16_f32 v234, v236, v237
v_cvt_pk_bf16_f32 v235, v238, v239
buffer_store_dwordx4 v[232:235], v3, s[4:7], s9 offen offset:256 nt
s_waitcnt lgkmcnt(0)
v_mfma_f32_16x16x32_bf16 v[240:243], v[24:27], v[128:131], 0
v_mfma_f32_16x16x32_bf16 v[244:247], v[28:31], v[128:131], 0
s_waitcnt vmcnt(8)
v_mfma_f32_16x16x32_bf16 v[240:243], v[24:27], v[132:135], v[240:243]
v_mfma_f32_16x16x32_bf16 v[244:247], v[28:31], v[132:135], v[244:247]
s_waitcnt vmcnt(7)
v_mfma_f32_16x16x32_bf16 v[240:243], v[24:27], v[136:139], v[240:243]
v_mfma_f32_16x16x32_bf16 v[244:247], v[28:31], v[136:139], v[244:247]
s_waitcnt vmcnt(6)
v_mfma_f32_16x16x32_bf16 v[240:243], v[24:27], v[140:143], v[240:243]
v_mfma_f32_16x16x32_bf16 v[244:247], v[28:31], v[140:143], v[244:247]
s_waitcnt vmcnt(5)
v_mfma_f32_16x16x32_bf16 v[240:243], v[24:27], v[144:147], v[240:243]
v_mfma_f32_16x16x32_bf16 v[244:247], v[28:31], v[144:147], v[244:247]
s_waitcnt vmcnt(4)
v_mfma_f32_16x16x32_bf16 v[240:243], v[24:27], v[148:151], v[240:243]
v_mfma_f32_16x16x32_bf16 v[244:247], v[28:31], v[148:151], v[244:247]
s_waitcnt vmcnt(3)
v_mfma_f32_16x16x32_bf16 v[240:243], v[24:27], v[152:155], v[240:243]
v_mfma_f32_16x16x32_bf16 v[244:247], v[28:31], v[152:155], v[244:247]
s_waitcnt vmcnt(2)
v_mfma_f32_16x16x32_bf16 v[240:243], v[24:27], v[156:159], v[240:243]
v_mfma_f32_16x16x32_bf16 v[244:247], v[28:31], v[156:159], v[244:247]
s_nop 6
v_pk_fma_f32 v[240:241], v[240:241], v[92:93], v[56:57] op_sel:[0,1,0]
v_pk_fma_f32 v[242:243], v[242:243], v[92:93], v[58:59] op_sel:[0,1,0]
v_pk_fma_f32 v[244:245], v[244:245], v[92:93], v[60:61] op_sel:[0,1,0]
v_pk_fma_f32 v[246:247], v[246:247], v[92:93], v[62:63] op_sel:[0,1,0]
v_cvt_pk_bf16_f32 v240, v240, v241
v_cvt_pk_bf16_f32 v241, v242, v243
v_cvt_pk_bf16_f32 v242, v244, v245
v_cvt_pk_bf16_f32 v243, v246, v247
buffer_store_dwordx4 v[240:243], v3, s[4:7], s9 offen offset:512 nt
s_endpgm
L_hi0:
s_waitcnt vmcnt(1) lgkmcnt(0)
v_mov_b32 v20, 4
buffer_store_dword v20, v75, s[20:23], 0 offen offset:128 sc1
L_rc8:
s_add_u32 s57, s57, 1
s_cmp_ge_u32 s57, 0x80000
s_cbranch_scc1 L_rk8
s_buffer_load_dwordx8 s[92:99], s[20:23], s59 glc
s_waitcnt lgkmcnt(0)
s_min_u32 s92, s92, s93
s_min_u32 s92, s92, s94
s_min_u32 s92, s92, s95
s_min_u32 s92, s92, s96
s_min_u32 s92, s92, s97
s_min_u32 s92, s92, s98
s_min_u32 s92, s92, s99
s_cmp_lt_u32 s92, 3
s_cbranch_scc1 L_rc8
L_rk8:
ds_read_b128 v[192:195], v22 offset:0
buffer_load_dwordx4 v[196:199], v2, s[20:23], s28 offen offset:1024 sc1
buffer_load_dwordx4 v[200:203], v2, s[20:23], s28 offen offset:2048 sc1
buffer_load_dwordx4 v[204:207], v2, s[20:23], s28 offen offset:3072 sc1
buffer_load_dwordx4 v[208:211], v2, s[20:23], s29 offen offset:0 sc1
buffer_load_dwordx4 v[212:215], v2, s[20:23], s29 offen offset:1024 sc1
buffer_load_dwordx4 v[216:219], v2, s[20:23], s29 offen offset:2048 sc1
buffer_load_dwordx4 v[220:223], v2, s[20:23], s29 offen offset:3072 sc1
ds_read_b128 v[96:99], v22 offset:8192
buffer_load_dwordx4 v[100:103], v2, s[20:23], s30 offen offset:1024 sc1
buffer_load_dwordx4 v[104:107], v2, s[20:23], s30 offen offset:2048 sc1
buffer_load_dwordx4 v[108:111], v2, s[20:23], s30 offen offset:3072 sc1
buffer_load_dwordx4 v[112:115], v2, s[20:23], s31 offen offset:0 sc1
buffer_load_dwordx4 v[116:119], v2, s[20:23], s31 offen offset:1024 sc1
buffer_load_dwordx4 v[120:123], v2, s[20:23], s31 offen offset:2048 sc1
buffer_load_dwordx4 v[124:127], v2, s[20:23], s31 offen offset:3072 sc1
v_mfma_f32_16x16x32_bf16 v[160:163], a[0:3], v[32:35], 0
v_mfma_f32_16x16x32_bf16 v[164:167], a[0:3], v[36:39], 0
v_mfma_f32_16x16x32_bf16 v[168:171], a[4:7], v[32:35], 0
v_mfma_f32_16x16x32_bf16 v[172:175], a[4:7], v[36:39], 0
v_lshlrev_b32 v40, 16, v80
v_and_b32 v41, 0xffff0000, v80
v_lshlrev_b32 v42, 16, v81
v_and_b32 v43, 0xffff0000, v81
v_lshlrev_b32 v44, 16, v82
v_and_b32 v45, 0xffff0000, v82
v_lshlrev_b32 v46, 16, v83
v_and_b32 v47, 0xffff0000, v83
v_lshlrev_b32 v48, 16, v84
v_and_b32 v49, 0xffff0000, v84
v_lshlrev_b32 v50, 16, v85
v_and_b32 v51, 0xffff0000, v85
v_lshlrev_b32 v52, 16, v86
v_and_b32 v53, 0xffff0000, v86
v_lshlrev_b32 v54, 16, v87
v_and_b32 v55, 0xffff0000, v87
v_pk_mul_f32 v[40:41], v[40:41], v[92:93] op_sel_hi:[1,0]
v_pk_mul_f32 v[42:43], v[42:43], v[92:93] op_sel_hi:[1,0]
v_pk_mul_f32 v[44:45], v[44:45], v[92:93] op_sel_hi:[1,0]
v_pk_mul_f32 v[46:47], v[46:47], v[92:93] op_sel_hi:[1,0]
v_pk_mul_f32 v[48:49], v[48:49], v[92:93] op_sel_hi:[1,0]
v_pk_mul_f32 v[50:51], v[50:51], v[92:93] op_sel_hi:[1,0]
v_pk_mul_f32 v[52:53], v[52:53], v[92:93] op_sel_hi:[1,0]
v_pk_mul_f32 v[54:55], v[54:55], v[92:93] op_sel_hi:[1,0]
v_pk_mul_f32 v[40:41], v[40:41], v[160:161]
v_pk_mul_f32 v[42:43], v[42:43], v[162:163]
v_pk_mul_f32 v[44:45], v[44:45], v[164:165]
v_pk_mul_f32 v[46:47], v[46:47], v[166:167]
v_pk_mul_f32 v[48:49], v[48:49], v[168:169]
v_pk_mul_f32 v[50:51], v[50:51], v[170:171]
v_pk_mul_f32 v[52:53], v[52:53], v[172:173]
v_pk_mul_f32 v[54:55], v[54:55], v[174:175]
s_waitcnt lgkmcnt(1)
v_mfma_f32_16x16x32_bf16 v[224:227], v[24:27], v[192:195], 0
v_mfma_f32_16x16x32_bf16 v[228:231], v[28:31], v[192:195], 0
s_waitcnt vmcnt(13)
v_mfma_f32_16x16x32_bf16 v[224:227], v[24:27], v[196:199], v[224:227]
v_mfma_f32_16x16x32_bf16 v[228:231], v[28:31], v[196:199], v[228:231]
s_waitcnt vmcnt(12)
v_mfma_f32_16x16x32_bf16 v[224:227], v[24:27], v[200:203], v[224:227]
v_mfma_f32_16x16x32_bf16 v[228:231], v[28:31], v[200:203], v[228:231]
s_waitcnt vmcnt(11)
v_mfma_f32_16x16x32_bf16 v[224:227], v[24:27], v[204:207], v[224:227]
v_mfma_f32_16x16x32_bf16 v[228:231], v[28:31], v[204:207], v[228:231]
s_waitcnt vmcnt(10)
v_mfma_f32_16x16x32_bf16 v[224:227], v[24:27], v[208:211], v[224:227]
v_mfma_f32_16x16x32_bf16 v[228:231], v[28:31], v[208:211], v[228:231]
s_waitcnt vmcnt(9)
v_mfma_f32_16x16x32_bf16 v[224:227], v[24:27], v[212:215], v[224:227]
v_mfma_f32_16x16x32_bf16 v[228:231], v[28:31], v[212:215], v[228:231]
s_waitcnt vmcnt(8)
v_mfma_f32_16x16x32_bf16 v[224:227], v[24:27], v[216:219], v[224:227]
v_mfma_f32_16x16x32_bf16 v[228:231], v[28:31], v[216:219], v[228:231]
s_waitcnt vmcnt(7)
v_mfma_f32_16x16x32_bf16 v[224:227], v[24:27], v[220:223], v[224:227]
v_mfma_f32_16x16x32_bf16 v[228:231], v[28:31], v[220:223], v[228:231]
s_nop 6
v_pk_fma_f32 v[224:225], v[224:225], v[92:93], v[40:41] op_sel:[0,1,0]
v_pk_fma_f32 v[226:227], v[226:227], v[92:93], v[42:43] op_sel:[0,1,0]
v_pk_fma_f32 v[228:229], v[228:229], v[92:93], v[44:45] op_sel:[0,1,0]
v_pk_fma_f32 v[230:231], v[230:231], v[92:93], v[46:47] op_sel:[0,1,0]
v_cvt_pk_bf16_f32 v224, v224, v225
v_cvt_pk_bf16_f32 v225, v226, v227
v_cvt_pk_bf16_f32 v226, v228, v229
v_cvt_pk_bf16_f32 v227, v230, v231
buffer_store_dwordx4 v[224:227], v3, s[4:7], s9 offen offset:0 nt
s_waitcnt lgkmcnt(0)
v_mfma_f32_16x16x32_bf16 v[232:235], v[24:27], v[96:99], 0
v_mfma_f32_16x16x32_bf16 v[236:239], v[28:31], v[96:99], 0
s_waitcnt vmcnt(7)
v_mfma_f32_16x16x32_bf16 v[232:235], v[24:27], v[100:103], v[232:235]
v_mfma_f32_16x16x32_bf16 v[236:239], v[28:31], v[100:103], v[236:239]
s_waitcnt vmcnt(6)
v_mfma_f32_16x16x32_bf16 v[232:235], v[24:27], v[104:107], v[232:235]
v_mfma_f32_16x16x32_bf16 v[236:239], v[28:31], v[104:107], v[236:239]
s_waitcnt vmcnt(5)
v_mfma_f32_16x16x32_bf16 v[232:235], v[24:27], v[108:111], v[232:235]
v_mfma_f32_16x16x32_bf16 v[236:239], v[28:31], v[108:111], v[236:239]
s_waitcnt vmcnt(4)
v_mfma_f32_16x16x32_bf16 v[232:235], v[24:27], v[112:115], v[232:235]
v_mfma_f32_16x16x32_bf16 v[236:239], v[28:31], v[112:115], v[236:239]
s_waitcnt vmcnt(3)
v_mfma_f32_16x16x32_bf16 v[232:235], v[24:27], v[116:119], v[232:235]
v_mfma_f32_16x16x32_bf16 v[236:239], v[28:31], v[116:119], v[236:239]
s_waitcnt vmcnt(2)
v_mfma_f32_16x16x32_bf16 v[232:235], v[24:27], v[120:123], v[232:235]
v_mfma_f32_16x16x32_bf16 v[236:239], v[28:31], v[120:123], v[236:239]
s_waitcnt vmcnt(1)
v_mfma_f32_16x16x32_bf16 v[232:235], v[24:27], v[124:127], v[232:235]
v_mfma_f32_16x16x32_bf16 v[236:239], v[28:31], v[124:127], v[236:239]
s_nop 6
v_pk_fma_f32 v[232:233], v[232:233], v[92:93], v[48:49] op_sel:[0,1,0]
v_pk_fma_f32 v[234:235], v[234:235], v[92:93], v[50:51] op_sel:[0,1,0]
v_pk_fma_f32 v[236:237], v[236:237], v[92:93], v[52:53] op_sel:[0,1,0]
v_pk_fma_f32 v[238:239], v[238:239], v[92:93], v[54:55] op_sel:[0,1,0]
v_cvt_pk_bf16_f32 v232, v232, v233
v_cvt_pk_bf16_f32 v233, v234, v235
v_cvt_pk_bf16_f32 v234, v236, v237
v_cvt_pk_bf16_f32 v235, v238, v239
buffer_store_dwordx4 v[232:235], v3, s[4:7], s9 offen offset:256 nt
L_fin0:
s_endpgm
L_spin1:
s_add_u32 s57, s57, 1
s_cmp_ge_u32 s57, 0x80000
s_cbranch_scc1 L_back1
s_sleep 4
buffer_load_dword v78, v72, s[24:27], 0 offen sc1
s_waitcnt vmcnt(0)
v_readfirstlane_b32 s58, v78
s_cmp_ge_u32 s58, s101
s_cbranch_scc0 L_spin1
s_branch L_back1
L_spin2:
s_add_u32 s57, s57, 1
s_cmp_ge_u32 s57, 0x80000
s_cbranch_scc1 L_back2
s_sleep 4
buffer_load_dword v78, v79, s[20:23], 0 offen sc1
s_waitcnt vmcnt(0)
v_readfirstlane_b32 s58, v78
s_cmp_ge_u32 s58, 2
s_cbranch_scc0 L_spin2
s_branch L_back2
L_spin3:
s_add_u32 s57, s57, 1
s_cmp_ge_u32 s57, 0x80000
s_cbranch_scc1 L_back3
s_sleep 4
buffer_load_dword v78, v79, s[20:23], 0 offen sc1
s_waitcnt vmcnt(0)
v_readfirstlane_b32 s58, v78
s_cmp_ge_u32 s58, 3
s_cbranch_scc0 L_spin3
s_branch L_back3
L_spin4:
s_add_u32 s57, s57, 1
s_cmp_ge_u32 s57, 0x80000
s_cbranch_scc1 L_back4
s_sleep 4
buffer_load_dword v78, v79, s[20:23], 0 offen sc1
s_waitcnt vmcnt(0)
v_readfirstlane_b32 s58, v78
s_cmp_ge_u32 s58, 4
s_cbranch_scc0 L_spin4
s_branch L_back4
L_spin5:
s_add_u32 s57, s57, 1
s_cmp_ge_u32 s57, 0x80000
s_cbranch_scc1 L_back5
s_sleep 4
buffer_load_dword v95, v10, s[20:23], 0 offen sc1
s_waitcnt vmcnt(0)
v_cmp_gt_u32 vcc, 5, v95
s_cmp_eq_u32 vcc_lo, 0
s_cbranch_scc0 L_spin5
s_branch L_back5
L_typeb:
v_add_u32 v8, 114688, v6
v_add_u32 v9, 114688, v7
s_waitcnt vmcnt(19)
s_barrier
ds_read_b128 a[0:3], v74 offset:0
ds_read_b128 a[4:7], v74 offset:2048
ds_read_b128 a[8:11], v74 offset:4096
ds_read_b128 a[12:15], v74 offset:6144
ds_read_b128 a[16:19], v75 offset:0
ds_read_b128 a[20:23], v75 offset:2048
ds_read_b128 a[24:27], v75 offset:4096
ds_read_b128 a[28:31], v75 offset:6144
ds_read_b64_tr_b16 v[40:41], v2 offset:0
ds_read_b64_tr_b16 v[42:43], v2 offset:512
ds_read_b64_tr_b16 v[44:45], v2 offset:8192
ds_read_b64_tr_b16 v[46:47], v2 offset:8704
ds_read_b64_tr_b16 v[48:49], v2 offset:2048
ds_read_b64_tr_b16 v[50:51], v2 offset:2560
ds_read_b64_tr_b16 v[52:53], v2 offset:10240
ds_read_b64_tr_b16 v[54:55], v2 offset:10752
s_waitcnt lgkmcnt(0)
v_mfma_f32_16x16x32_bf16 v[96:99], v[40:43], a[0:3], 0
v_mfma_f32_16x16x32_bf16 v[96:99], v[44:47], a[16:19], v[96:99]
ds_read_b64_tr_b16 v[56:57], v3 offset:0
s_add_u32 m0, s37, 49152
v_mfma_f32_16x16x32_bf16 v[100:103], v[40:43], a[4:7], 0
ds_read_b64_tr_b16 v[58:59], v3 offset:512
v_mfma_f32_16x16x32_bf16 v[100:103], v[44:47], a[20:23], v[100:103]
ds_read_b64_tr_b16 v[60:61], v3 offset:8192
v_mfma_f32_16x16x32_bf16 v[104:107], v[40:43], a[8:11], 0
buffer_load_dwordx4 v10, s[4:7], s31 offen offset:0 lds
v_mfma_f32_16x16x32_bf16 v[104:107], v[44:47], a[24:27], v[104:107]
ds_read_b64_tr_b16 v[62:63], v3 offset:8704
v_mfma_f32_16x16x32_bf16 v[108:111], v[40:43], a[12:15], 0
ds_read_b64_tr_b16 v[64:65], v3 offset:2048
v_mfma_f32_16x16x32_bf16 v[108:111], v[44:47], a[28:31], v[108:111]
ds_read_b64_tr_b16 v[66:67], v3 offset:2560
v_mfma_f32_16x16x32_bf16 v[112:115], v[48:51], a[0:3], 0
buffer_load_dwordx4 v11, s[4:7], s31 offen offset:1024 lds
v_mfma_f32_16x16x32_bf16 v[112:115], v[52:55], a[16:19], v[112:115]
ds_read_b64_tr_b16 v[68:69], v3 offset:10240
v_mov_b32 v20, 1
v_mfma_f32_16x16x32_bf16 v[116:119], v[48:51], a[4:7], 0
ds_read_b64_tr_b16 v[70:71], v3 offset:10752
v_mfma_f32_16x16x32_bf16 v[116:119], v[52:55], a[20:23], v[116:119]
buffer_store_dword v20, v220, s[24:27], 0 offen sc1
v_mfma_f32_16x16x32_bf16 v[120:123], v[48:51], a[8:11], 0
buffer_load_dwordx4 v10, s[8:11], s31 offen offset:2048 lds
v_mfma_f32_16x16x32_bf16 v[120:123], v[52:55], a[24:27], v[120:123]
v_mfma_f32_16x16x32_bf16 v[124:127], v[48:51], a[12:15], 0
s_waitcnt vmcnt(12) lgkmcnt(0)
v_mfma_f32_16x16x32_bf16 v[124:127], v[52:55], a[28:31], v[124:127]
s_barrier
v_mfma_f32_16x16x32_bf16 v[128:131], v[56:59], a[0:3], 0
buffer_load_dwordx4 v11, s[8:11], s31 offen offset:3072 lds
v_mfma_f32_16x16x32_bf16 v[128:131], v[60:63], a[16:19], v[128:131]
ds_read_b128 a[32:35], v74 offset:16384
ds_read_b128 a[36:39], v74 offset:18432
s_mov_b32 s48, 384
v_mfma_f32_16x16x32_bf16 v[132:135], v[56:59], a[4:7], 0
ds_read_b128 a[40:43], v74 offset:20480
ds_read_b128 a[44:47], v74 offset:22528
s_add_u32 m0, s37, 131072
v_mfma_f32_16x16x32_bf16 v[132:135], v[60:63], a[20:23], v[132:135]
ds_read_b128 a[48:51], v75 offset:16384
ds_read_b128 a[52:55], v75 offset:18432
v_mfma_f32_16x16x32_bf16 v[136:139], v[56:59], a[8:11], 0
buffer_load_dwordx4 v72, s[12:15], s48 offen offset:0 lds
v_mfma_f32_16x16x32_bf16 v[136:139], v[60:63], a[24:27], v[136:139]
ds_read_b128 a[56:59], v75 offset:20480
ds_read_b128 a[60:63], v75 offset:22528
v_mfma_f32_16x16x32_bf16 v[140:143], v[56:59], a[12:15], 0
ds_read_b64_tr_b16 v[40:41], v2 offset:16384
ds_read_b64_tr_b16 v[42:43], v2 offset:16896
v_mfma_f32_16x16x32_bf16 v[140:143], v[60:63], a[28:31], v[140:143]
ds_read_b64_tr_b16 v[44:45], v2 offset:24576
ds_read_b64_tr_b16 v[46:47], v2 offset:25088
v_mfma_f32_16x16x32_bf16 v[144:147], v[64:67], a[0:3], 0
buffer_load_dwordx4 v73, s[12:15], s48 offen offset:1024 lds
v_mfma_f32_16x16x32_bf16 v[144:147], v[68:71], a[16:19], v[144:147]
ds_read_b64_tr_b16 v[48:49], v2 offset:18432
ds_read_b64_tr_b16 v[50:51], v2 offset:18944
v_mfma_f32_16x16x32_bf16 v[148:151], v[64:67], a[4:7], 0
ds_read_b64_tr_b16 v[52:53], v2 offset:26624
ds_read_b64_tr_b16 v[54:55], v2 offset:27136
v_mfma_f32_16x16x32_bf16 v[148:151], v[68:71], a[20:23], v[148:151]
v_mfma_f32_16x16x32_bf16 v[152:155], v[64:67], a[8:11], 0
buffer_load_dwordx4 v92, s[12:15], s48 offen offset:2048 lds
v_mfma_f32_16x16x32_bf16 v[152:155], v[68:71], a[24:27], v[152:155]
v_mfma_f32_16x16x32_bf16 v[156:159], v[64:67], a[12:15], 0
v_mfma_f32_16x16x32_bf16 v[156:159], v[68:71], a[28:31], v[156:159]
s_waitcnt lgkmcnt(0)
v_mfma_f32_16x16x32_bf16 v[96:99], v[40:43], a[32:35], v[96:99]
buffer_load_dwordx4 v93, s[12:15], s48 offen offset:3072 lds
v_mfma_f32_16x16x32_bf16 v[96:99], v[44:47], a[48:51], v[96:99]
ds_read_b64_tr_b16 v[56:57], v3 offset:16384
s_add_u32 m0, s37, 65536
v_mfma_f32_16x16x32_bf16 v[100:103], v[40:43], a[36:39], v[100:103]
ds_read_b64_tr_b16 v[58:59], v3 offset:16896
v_mfma_f32_16x16x32_bf16 v[100:103], v[44:47], a[52:55], v[100:103]
ds_read_b64_tr_b16 v[60:61], v3 offset:24576
v_mfma_f32_16x16x32_bf16 v[104:107], v[40:43], a[40:43], v[104:107]
buffer_load_dwordx4 v10, s[4:7], s32 offen offset:0 lds
v_mfma_f32_16x16x32_bf16 v[104:107], v[44:47], a[56:59], v[104:107]
ds_read_b64_tr_b16 v[62:63], v3 offset:25088
v_mfma_f32_16x16x32_bf16 v[108:111], v[40:43], a[44:47], v[108:111]
ds_read_b64_tr_b16 v[64:65], v3 offset:18432
v_mfma_f32_16x16x32_bf16 v[108:111], v[44:47], a[60:63], v[108:111]
ds_read_b64_tr_b16 v[66:67], v3 offset:18944
v_mfma_f32_16x16x32_bf16 v[112:115], v[48:51], a[32:35], v[112:115]
buffer_load_dwordx4 v11, s[4:7], s32 offen offset:1024 lds
v_mfma_f32_16x16x32_bf16 v[112:115], v[52:55], a[48:51], v[112:115]
ds_read_b64_tr_b16 v[68:69], v3 offset:26624
v_mfma_f32_16x16x32_bf16 v[116:119], v[48:51], a[36:39], v[116:119]
ds_read_b64_tr_b16 v[70:71], v3 offset:27136
v_mfma_f32_16x16x32_bf16 v[116:119], v[52:55], a[52:55], v[116:119]
v_mfma_f32_16x16x32_bf16 v[120:123], v[48:51], a[40:43], v[120:123]
buffer_load_dwordx4 v10, s[8:11], s32 offen offset:2048 lds
v_mfma_f32_16x16x32_bf16 v[120:123], v[52:55], a[56:59], v[120:123]
v_mfma_f32_16x16x32_bf16 v[124:127], v[48:51], a[44:47], v[124:127]
s_waitcnt vmcnt(12) lgkmcnt(0)
v_mfma_f32_16x16x32_bf16 v[124:127], v[52:55], a[60:63], v[124:127]
s_barrier
v_mfma_f32_16x16x32_bf16 v[128:131], v[56:59], a[32:35], v[128:131]
buffer_load_dwordx4 v11, s[8:11], s32 offen offset:3072 lds
v_mfma_f32_16x16x32_bf16 v[128:131], v[60:63], a[48:51], v[128:131]
ds_read_b128 a[64:67], v74 offset:32768
ds_read_b128 a[68:71], v74 offset:34816
s_mov_b32 s48, 512
v_mfma_f32_16x16x32_bf16 v[132:135], v[56:59], a[36:39], v[132:135]
ds_read_b128 a[72:75], v74 offset:36864
ds_read_b128 a[76:79], v74 offset:38912
s_add_u32 m0, s37, 147456
v_mfma_f32_16x16x32_bf16 v[132:135], v[60:63], a[52:55], v[132:135]
ds_read_b128 a[80:83], v75 offset:32768
ds_read_b128 a[84:87], v75 offset:34816
v_mfma_f32_16x16x32_bf16 v[136:139], v[56:59], a[40:43], v[136:139]
buffer_load_dwordx4 v72, s[12:15], s48 offen offset:0 lds
v_mfma_f32_16x16x32_bf16 v[136:139], v[60:63], a[56:59], v[136:139]
ds_read_b128 a[88:91], v75 offset:36864
ds_read_b128 a[92:95], v75 offset:38912
v_mfma_f32_16x16x32_bf16 v[140:143], v[56:59], a[44:47], v[140:143]
ds_read_b64_tr_b16 v[40:41], v2 offset:32768
ds_read_b64_tr_b16 v[42:43], v2 offset:33280
v_mfma_f32_16x16x32_bf16 v[140:143], v[60:63], a[60:63], v[140:143]
ds_read_b64_tr_b16 v[44:45], v2 offset:40960
ds_read_b64_tr_b16 v[46:47], v2 offset:41472
v_mfma_f32_16x16x32_bf16 v[144:147], v[64:67], a[32:35], v[144:147]
buffer_load_dwordx4 v73, s[12:15], s48 offen offset:1024 lds
v_mfma_f32_16x16x32_bf16 v[144:147], v[68:71], a[48:51], v[144:147]
ds_read_b64_tr_b16 v[48:49], v2 offset:34816
ds_read_b64_tr_b16 v[50:51], v2 offset:35328
v_mfma_f32_16x16x32_bf16 v[148:151], v[64:67], a[36:39], v[148:151]
ds_read_b64_tr_b16 v[52:53], v2 offset:43008
ds_read_b64_tr_b16 v[54:55], v2 offset:43520
v_mfma_f32_16x16x32_bf16 v[148:151], v[68:71], a[52:55], v[148:151]
s_lshl2_add_u32 s58, s39, s38
s_mul_i32 s58, s58, 82944
v_mfma_f32_16x16x32_bf16 v[152:155], v[64:67], a[40:43], v[152:155]
buffer_load_dwordx4 v92, s[12:15], s48 offen offset:2048 lds
v_mfma_f32_16x16x32_bf16 v[152:155], v[68:71], a[56:59], v[152:155]
v_mul_u32_u24 v218, 128, v1
v_lshrrev_b32 v218, 8, v218
v_mfma_f32_16x16x32_bf16 v[156:159], v[64:67], a[44:47], v[156:159]
v_mul_u32_u24 v218, 8960, v218
v_lshl_add_u32 v218, v1, 7, v218
v_mfma_f32_16x16x32_bf16 v[156:159], v[68:71], a[60:63], v[156:159]
v_add_u32 v219, 46, v1
s_waitcnt lgkmcnt(0)
v_mfma_f32_16x16x32_bf16 v[96:99], v[40:43], a[64:67], v[96:99]
buffer_load_dwordx4 v93, s[12:15], s48 offen offset:3072 lds
v_mfma_f32_16x16x32_bf16 v[96:99], v[44:47], a[80:83], v[96:99]
ds_read_b64_tr_b16 v[56:57], v3 offset:32768
v_and_b32 v219, 64, v219
v_mfma_f32_16x16x32_bf16 v[100:103], v[40:43], a[68:71], v[100:103]
ds_read_b64_tr_b16 v[58:59], v3 offset:33280
v_lshl_add_u32 v218, v219, 22, v218
v_mfma_f32_16x16x32_bf16 v[100:103], v[44:47], a[84:87], v[100:103]
ds_read_b64_tr_b16 v[60:61], v3 offset:40960
v_add_u32 v218, s58, v218
v_mfma_f32_16x16x32_bf16 v[104:107], v[40:43], a[72:75], v[104:107]
buffer_load_dword v95, v218, s[4:7], 0 offen offset:128
v_mfma_f32_16x16x32_bf16 v[104:107], v[44:47], a[88:91], v[104:107]
ds_read_b64_tr_b16 v[62:63], v3 offset:41472
v_mfma_f32_16x16x32_bf16 v[108:111], v[40:43], a[76:79], v[108:111]
ds_read_b64_tr_b16 v[64:65], v3 offset:34816
v_mfma_f32_16x16x32_bf16 v[108:111], v[44:47], a[92:95], v[108:111]
ds_read_b64_tr_b16 v[66:67], v3 offset:35328
v_mfma_f32_16x16x32_bf16 v[112:115], v[48:51], a[64:67], v[112:115]
buffer_load_dword v95, v218, s[8:11], 0 offen offset:2176
v_mfma_f32_16x16x32_bf16 v[112:115], v[52:55], a[80:83], v[112:115]
ds_read_b64_tr_b16 v[68:69], v3 offset:43008
s_add_u32 m0, s37, 0
v_mfma_f32_16x16x32_bf16 v[116:119], v[48:51], a[68:71], v[116:119]
ds_read_b64_tr_b16 v[70:71], v3 offset:43520
v_mfma_f32_16x16x32_bf16 v[116:119], v[52:55], a[84:87], v[116:119]
v_mfma_f32_16x16x32_bf16 v[120:123], v[48:51], a[72:75], v[120:123]
buffer_load_dwordx4 v10, s[4:7], s33 offen offset:0 lds
v_mfma_f32_16x16x32_bf16 v[120:123], v[52:55], a[88:91], v[120:123]
v_mfma_f32_16x16x32_bf16 v[124:127], v[48:51], a[76:79], v[124:127]
s_waitcnt vmcnt(11) lgkmcnt(0)
v_mfma_f32_16x16x32_bf16 v[124:127], v[52:55], a[92:95], v[124:127]
s_barrier
v_mfma_f32_16x16x32_bf16 v[128:131], v[56:59], a[64:67], v[128:131]
buffer_load_dwordx4 v11, s[4:7], s33 offen offset:1024 lds
v_mfma_f32_16x16x32_bf16 v[128:131], v[60:63], a[80:83], v[128:131]
ds_read_b128 a[96:99], v74 offset:49152
ds_read_b128 a[100:103], v74 offset:51200
v_mfma_f32_16x16x32_bf16 v[132:135], v[56:59], a[68:71], v[132:135]
ds_read_b128 a[104:107], v74 offset:53248
ds_read_b128 a[108:111], v74 offset:55296
v_mfma_f32_16x16x32_bf16 v[132:135], v[60:63], a[84:87], v[132:135]
ds_read_b128 a[112:115], v75 offset:49152
ds_read_b128 a[116:119], v75 offset:51200
v_mfma_f32_16x16x32_bf16 v[136:139], v[56:59], a[72:75], v[136:139]
buffer_load_dwordx4 v10, s[8:11], s33 offen offset:2048 lds
v_mfma_f32_16x16x32_bf16 v[136:139], v[60:63], a[88:91], v[136:139]
ds_read_b128 a[120:123], v75 offset:53248
ds_read_b128 a[124:127], v75 offset:55296
v_mfma_f32_16x16x32_bf16 v[140:143], v[56:59], a[76:79], v[140:143]
ds_read_b64_tr_b16 v[40:41], v2 offset:49152
ds_read_b64_tr_b16 v[42:43], v2 offset:49664
v_mfma_f32_16x16x32_bf16 v[140:143], v[60:63], a[92:95], v[140:143]
ds_read_b64_tr_b16 v[44:45], v2 offset:57344
ds_read_b64_tr_b16 v[46:47], v2 offset:57856
v_mfma_f32_16x16x32_bf16 v[144:147], v[64:67], a[64:67], v[144:147]
buffer_load_dwordx4 v11, s[8:11], s33 offen offset:3072 lds
v_mfma_f32_16x16x32_bf16 v[144:147], v[68:71], a[80:83], v[144:147]
ds_read_b64_tr_b16 v[48:49], v2 offset:51200
ds_read_b64_tr_b16 v[50:51], v2 offset:51712
s_mov_b32 s48, 640
v_mfma_f32_16x16x32_bf16 v[148:151], v[64:67], a[68:71], v[148:151]
ds_read_b64_tr_b16 v[52:53], v2 offset:59392
ds_read_b64_tr_b16 v[54:55], v2 offset:59904
s_add_u32 m0, s37, 81920
v_mfma_f32_16x16x32_bf16 v[148:151], v[68:71], a[84:87], v[148:151]
v_mfma_f32_16x16x32_bf16 v[152:155], v[64:67], a[72:75], v[152:155]
buffer_load_dwordx4 v72, s[12:15], s48 offen offset:0 lds
v_mfma_f32_16x16x32_bf16 v[152:155], v[68:71], a[88:91], v[152:155]
v_mfma_f32_16x16x32_bf16 v[156:159], v[64:67], a[76:79], v[156:159]
v_mfma_f32_16x16x32_bf16 v[156:159], v[68:71], a[92:95], v[156:159]
s_waitcnt lgkmcnt(0)
v_mfma_f32_16x16x32_bf16 v[96:99], v[40:43], a[96:99], v[96:99]
buffer_load_dwordx4 v73, s[12:15], s48 offen offset:1024 lds
v_mfma_f32_16x16x32_bf16 v[96:99], v[44:47], a[112:115], v[96:99]
ds_read_b64_tr_b16 v[56:57], v3 offset:49152
v_mfma_f32_16x16x32_bf16 v[100:103], v[40:43], a[100:103], v[100:103]
ds_read_b64_tr_b16 v[58:59], v3 offset:49664
v_mfma_f32_16x16x32_bf16 v[100:103], v[44:47], a[116:119], v[100:103]
ds_read_b64_tr_b16 v[60:61], v3 offset:57344
v_mfma_f32_16x16x32_bf16 v[104:107], v[40:43], a[104:107], v[104:107]
buffer_load_dwordx4 v92, s[12:15], s48 offen offset:2048 lds
v_mfma_f32_16x16x32_bf16 v[104:107], v[44:47], a[120:123], v[104:107]
ds_read_b64_tr_b16 v[62:63], v3 offset:57856
v_mfma_f32_16x16x32_bf16 v[108:111], v[40:43], a[108:111], v[108:111]
ds_read_b64_tr_b16 v[64:65], v3 offset:51200
v_mfma_f32_16x16x32_bf16 v[108:111], v[44:47], a[124:127], v[108:111]
ds_read_b64_tr_b16 v[66:67], v3 offset:51712
v_mfma_f32_16x16x32_bf16 v[112:115], v[48:51], a[96:99], v[112:115]
buffer_load_dwordx4 v93, s[12:15], s48 offen offset:3072 lds
v_mfma_f32_16x16x32_bf16 v[112:115], v[52:55], a[112:115], v[112:115]
ds_read_b64_tr_b16 v[68:69], v3 offset:59392
s_add_u32 m0, s37, 16384
v_mfma_f32_16x16x32_bf16 v[116:119], v[48:51], a[100:103], v[116:119]
ds_read_b64_tr_b16 v[70:71], v3 offset:59904
v_mfma_f32_16x16x32_bf16 v[116:119], v[52:55], a[116:119], v[116:119]
v_mfma_f32_16x16x32_bf16 v[120:123], v[48:51], a[104:107], v[120:123]
buffer_load_dwordx4 v10, s[4:7], s34 offen offset:0 lds
v_mfma_f32_16x16x32_bf16 v[120:123], v[52:55], a[120:123], v[120:123]
v_mfma_f32_16x16x32_bf16 v[124:127], v[48:51], a[108:111], v[124:127]
s_waitcnt vmcnt(11) lgkmcnt(0)
v_mfma_f32_16x16x32_bf16 v[124:127], v[52:55], a[124:127], v[124:127]
s_barrier
v_mfma_f32_16x16x32_bf16 v[128:131], v[56:59], a[96:99], v[128:131]
buffer_load_dwordx4 v11, s[4:7], s34 offen offset:1024 lds
v_mfma_f32_16x16x32_bf16 v[128:131], v[60:63], a[112:115], v[128:131]
ds_read_b128 a[128:131], v76 offset:0
ds_read_b128 a[132:135], v76 offset:2048
v_mfma_f32_16x16x32_bf16 v[132:135], v[56:59], a[100:103], v[132:135]
ds_read_b128 a[136:139], v76 offset:4096
ds_read_b128 a[140:143], v76 offset:6144
v_mfma_f32_16x16x32_bf16 v[132:135], v[60:63], a[116:119], v[132:135]
ds_read_b128 a[144:147], v77 offset:0
ds_read_b128 a[148:151], v77 offset:2048
v_mfma_f32_16x16x32_bf16 v[136:139], v[56:59], a[104:107], v[136:139]
buffer_load_dwordx4 v10, s[8:11], s34 offen offset:2048 lds
v_mfma_f32_16x16x32_bf16 v[136:139], v[60:63], a[120:123], v[136:139]
ds_read_b128 a[152:155], v77 offset:4096
ds_read_b128 a[156:159], v77 offset:6144
v_mfma_f32_16x16x32_bf16 v[140:143], v[56:59], a[108:111], v[140:143]
ds_read_b64_tr_b16 v[40:41], v4 offset:0
ds_read_b64_tr_b16 v[42:43], v4 offset:512
v_mfma_f32_16x16x32_bf16 v[140:143], v[60:63], a[124:127], v[140:143]
ds_read_b64_tr_b16 v[44:45], v4 offset:8192
ds_read_b64_tr_b16 v[46:47], v4 offset:8704
v_mfma_f32_16x16x32_bf16 v[144:147], v[64:67], a[96:99], v[144:147]
buffer_load_dwordx4 v11, s[8:11], s34 offen offset:3072 lds
v_mfma_f32_16x16x32_bf16 v[144:147], v[68:71], a[112:115], v[144:147]
ds_read_b64_tr_b16 v[48:49], v4 offset:2048
ds_read_b64_tr_b16 v[50:51], v4 offset:2560
s_mov_b32 s48, 768
v_mfma_f32_16x16x32_bf16 v[148:151], v[64:67], a[100:103], v[148:151]
ds_read_b64_tr_b16 v[52:53], v4 offset:10240
ds_read_b64_tr_b16 v[54:55], v4 offset:10752
s_add_u32 m0, s37, 98304
v_mfma_f32_16x16x32_bf16 v[148:151], v[68:71], a[116:119], v[148:151]
v_mfma_f32_16x16x32_bf16 v[152:155], v[64:67], a[104:107], v[152:155]
buffer_load_dwordx4 v72, s[12:15], s48 offen offset:0 lds
v_mfma_f32_16x16x32_bf16 v[152:155], v[68:71], a[120:123], v[152:155]
v_mfma_f32_16x16x32_bf16 v[156:159], v[64:67], a[108:111], v[156:159]
v_mfma_f32_16x16x32_bf16 v[156:159], v[68:71], a[124:127], v[156:159]
s_waitcnt lgkmcnt(0)
v_mfma_f32_16x16x32_bf16 v[96:99], v[40:43], a[128:131], v[96:99]
buffer_load_dwordx4 v73, s[12:15], s48 offen offset:1024 lds
v_mfma_f32_16x16x32_bf16 v[96:99], v[44:47], a[144:147], v[96:99]
ds_read_b64_tr_b16 v[56:57], v5 offset:0
v_mfma_f32_16x16x32_bf16 v[100:103], v[40:43], a[132:135], v[100:103]
ds_read_b64_tr_b16 v[58:59], v5 offset:512
v_mfma_f32_16x16x32_bf16 v[100:103], v[44:47], a[148:151], v[100:103]
ds_read_b64_tr_b16 v[60:61], v5 offset:8192
v_mfma_f32_16x16x32_bf16 v[104:107], v[40:43], a[136:139], v[104:107]
buffer_load_dwordx4 v92, s[12:15], s48 offen offset:2048 lds
v_mfma_f32_16x16x32_bf16 v[104:107], v[44:47], a[152:155], v[104:107]
ds_read_b64_tr_b16 v[62:63], v5 offset:8704
v_mfma_f32_16x16x32_bf16 v[108:111], v[40:43], a[140:143], v[108:111]
ds_read_b64_tr_b16 v[64:65], v5 offset:2048
v_mfma_f32_16x16x32_bf16 v[108:111], v[44:47], a[156:159], v[108:111]
ds_read_b64_tr_b16 v[66:67], v5 offset:2560
v_mfma_f32_16x16x32_bf16 v[112:115], v[48:51], a[128:131], v[112:115]
buffer_load_dwordx4 v93, s[12:15], s48 offen offset:3072 lds
v_mfma_f32_16x16x32_bf16 v[112:115], v[52:55], a[144:147], v[112:115]
ds_read_b64_tr_b16 v[68:69], v5 offset:10240
s_add_u32 m0, s37, 32768
v_mfma_f32_16x16x32_bf16 v[116:119], v[48:51], a[132:135], v[116:119]
ds_read_b64_tr_b16 v[70:71], v5 offset:10752
v_mfma_f32_16x16x32_bf16 v[116:119], v[52:55], a[148:151], v[116:119]
v_mfma_f32_16x16x32_bf16 v[120:123], v[48:51], a[136:139], v[120:123]
buffer_load_dwordx4 v10, s[4:7], s35 offen offset:0 lds
v_mfma_f32_16x16x32_bf16 v[120:123], v[52:55], a[152:155], v[120:123]
v_mfma_f32_16x16x32_bf16 v[124:127], v[48:51], a[140:143], v[124:127]
s_waitcnt vmcnt(9) lgkmcnt(0)
v_mfma_f32_16x16x32_bf16 v[124:127], v[52:55], a[156:159], v[124:127]
s_barrier
v_mfma_f32_16x16x32_bf16 v[128:131], v[56:59], a[128:131], v[128:131]
buffer_load_dwordx4 v11, s[4:7], s35 offen offset:1024 lds
v_mfma_f32_16x16x32_bf16 v[128:131], v[60:63], a[144:147], v[128:131]
ds_read_b128 a[160:163], v74 offset:0
ds_read_b128 a[164:167], v74 offset:2048
v_mfma_f32_16x16x32_bf16 v[132:135], v[56:59], a[132:135], v[132:135]
ds_read_b128 a[168:171], v74 offset:4096
ds_read_b128 a[172:175], v74 offset:6144
v_mfma_f32_16x16x32_bf16 v[132:135], v[60:63], a[148:151], v[132:135]
ds_read_b128 a[176:179], v75 offset:0
ds_read_b128 a[180:183], v75 offset:2048
v_mfma_f32_16x16x32_bf16 v[136:139], v[56:59], a[136:139], v[136:139]
buffer_load_dwordx4 v10, s[8:11], s35 offen offset:2048 lds
v_mfma_f32_16x16x32_bf16 v[136:139], v[60:63], a[152:155], v[136:139]
ds_read_b128 a[184:187], v75 offset:4096
ds_read_b128 a[188:191], v75 offset:6144
v_mfma_f32_16x16x32_bf16 v[140:143], v[56:59], a[140:143], v[140:143]
ds_read_b64_tr_b16 v[40:41], v2 offset:0
ds_read_b64_tr_b16 v[42:43], v2 offset:512
v_mfma_f32_16x16x32_bf16 v[140:143], v[60:63], a[156:159], v[140:143]
ds_read_b64_tr_b16 v[44:45], v2 offset:8192
ds_read_b64_tr_b16 v[46:47], v2 offset:8704
v_mfma_f32_16x16x32_bf16 v[144:147], v[64:67], a[128:131], v[144:147]
buffer_load_dwordx4 v11, s[8:11], s35 offen offset:3072 lds
v_mfma_f32_16x16x32_bf16 v[144:147], v[68:71], a[144:147], v[144:147]
ds_read_b64_tr_b16 v[48:49], v2 offset:2048
ds_read_b64_tr_b16 v[50:51], v2 offset:2560
s_mov_b32 s48, 896
v_mfma_f32_16x16x32_bf16 v[148:151], v[64:67], a[132:135], v[148:151]
ds_read_b64_tr_b16 v[52:53], v2 offset:10240
ds_read_b64_tr_b16 v[54:55], v2 offset:10752
s_add_u32 m0, s37, 114688
v_mfma_f32_16x16x32_bf16 v[148:151], v[68:71], a[148:151], v[148:151]
v_mfma_f32_16x16x32_bf16 v[152:155], v[64:67], a[136:139], v[152:155]
buffer_load_dwordx4 v72, s[12:15], s48 offen offset:0 lds
v_mfma_f32_16x16x32_bf16 v[152:155], v[68:71], a[152:155], v[152:155]
v_mfma_f32_16x16x32_bf16 v[156:159], v[64:67], a[140:143], v[156:159]
v_mfma_f32_16x16x32_bf16 v[156:159], v[68:71], a[156:159], v[156:159]
s_waitcnt lgkmcnt(0)
v_mfma_f32_16x16x32_bf16 v[96:99], v[40:43], a[160:163], v[96:99]
buffer_load_dwordx4 v73, s[12:15], s48 offen offset:1024 lds
v_mfma_f32_16x16x32_bf16 v[96:99], v[44:47], a[176:179], v[96:99]
ds_read_b64_tr_b16 v[56:57], v3 offset:0
v_mfma_f32_16x16x32_bf16 v[100:103], v[40:43], a[164:167], v[100:103]
ds_read_b64_tr_b16 v[58:59], v3 offset:512
v_mfma_f32_16x16x32_bf16 v[100:103], v[44:47], a[180:183], v[100:103]
ds_read_b64_tr_b16 v[60:61], v3 offset:8192
v_mfma_f32_16x16x32_bf16 v[104:107], v[40:43], a[168:171], v[104:107]
buffer_load_dwordx4 v92, s[12:15], s48 offen offset:2048 lds
v_mfma_f32_16x16x32_bf16 v[104:107], v[44:47], a[184:187], v[104:107]
ds_read_b64_tr_b16 v[62:63], v3 offset:8704
v_mfma_f32_16x16x32_bf16 v[108:111], v[40:43], a[172:175], v[108:111]
ds_read_b64_tr_b16 v[64:65], v3 offset:2048
v_mfma_f32_16x16x32_bf16 v[108:111], v[44:47], a[188:191], v[108:111]
ds_read_b64_tr_b16 v[66:67], v3 offset:2560
v_mfma_f32_16x16x32_bf16 v[112:115], v[48:51], a[160:163], v[112:115]
buffer_load_dwordx4 v93, s[12:15], s48 offen offset:3072 lds
v_mfma_f32_16x16x32_bf16 v[112:115], v[52:55], a[176:179], v[112:115]
ds_read_b64_tr_b16 v[68:69], v3 offset:10240
s_add_u32 m0, s37, 49152
v_mfma_f32_16x16x32_bf16 v[116:119], v[48:51], a[164:167], v[116:119]
ds_read_b64_tr_b16 v[70:71], v3 offset:10752
v_mfma_f32_16x16x32_bf16 v[116:119], v[52:55], a[180:183], v[116:119]
v_mfma_f32_16x16x32_bf16 v[120:123], v[48:51], a[168:171], v[120:123]
buffer_load_dwordx4 v10, s[4:7], s36 offen offset:0 lds
v_mfma_f32_16x16x32_bf16 v[120:123], v[52:55], a[184:187], v[120:123]
v_mfma_f32_16x16x32_bf16 v[124:127], v[48:51], a[172:175], v[124:127]
s_waitcnt vmcnt(9) lgkmcnt(0)
v_mfma_f32_16x16x32_bf16 v[124:127], v[52:55], a[188:191], v[124:127]
s_barrier
v_mfma_f32_16x16x32_bf16 v[128:131], v[56:59], a[160:163], v[128:131]
buffer_load_dwordx4 v11, s[4:7], s36 offen offset:1024 lds
v_mfma_f32_16x16x32_bf16 v[128:131], v[60:63], a[176:179], v[128:131]
ds_read_b128 a[192:195], v74 offset:16384
ds_read_b128 a[196:199], v74 offset:18432
v_mfma_f32_16x16x32_bf16 v[132:135], v[56:59], a[164:167], v[132:135]
ds_read_b128 a[200:203], v74 offset:20480
ds_read_b128 a[204:207], v74 offset:22528
v_mfma_f32_16x16x32_bf16 v[132:135], v[60:63], a[180:183], v[132:135]
ds_read_b128 a[208:211], v75 offset:16384
ds_read_b128 a[212:215], v75 offset:18432
v_mfma_f32_16x16x32_bf16 v[136:139], v[56:59], a[168:171], v[136:139]
buffer_load_dwordx4 v10, s[8:11], s36 offen offset:2048 lds
v_mfma_f32_16x16x32_bf16 v[136:139], v[60:63], a[184:187], v[136:139]
ds_read_b128 a[216:219], v75 offset:20480
ds_read_b128 a[220:223], v75 offset:22528
v_mfma_f32_16x16x32_bf16 v[140:143], v[56:59], a[172:175], v[140:143]
ds_read_b64_tr_b16 v[40:41], v2 offset:16384
ds_read_b64_tr_b16 v[42:43], v2 offset:16896
v_mfma_f32_16x16x32_bf16 v[140:143], v[60:63], a[188:191], v[140:143]
ds_read_b64_tr_b16 v[44:45], v2 offset:24576
ds_read_b64_tr_b16 v[46:47], v2 offset:25088
v_mfma_f32_16x16x32_bf16 v[144:147], v[64:67], a[160:163], v[144:147]
buffer_load_dwordx4 v11, s[8:11], s36 offen offset:3072 lds
v_mfma_f32_16x16x32_bf16 v[144:147], v[68:71], a[176:179], v[144:147]
ds_read_b64_tr_b16 v[48:49], v2 offset:18432
ds_read_b64_tr_b16 v[50:51], v2 offset:18944
s_mov_b32 s48, 1024
v_mfma_f32_16x16x32_bf16 v[148:151], v[64:67], a[164:167], v[148:151]
ds_read_b64_tr_b16 v[52:53], v2 offset:26624
ds_read_b64_tr_b16 v[54:55], v2 offset:27136
s_add_u32 m0, s37, 131072
v_mfma_f32_16x16x32_bf16 v[148:151], v[68:71], a[180:183], v[148:151]
v_mfma_f32_16x16x32_bf16 v[152:155], v[64:67], a[168:171], v[152:155]
buffer_load_dwordx4 v72, s[12:15], s48 offen offset:0 lds
v_mfma_f32_16x16x32_bf16 v[152:155], v[68:71], a[184:187], v[152:155]
v_mfma_f32_16x16x32_bf16 v[156:159], v[64:67], a[172:175], v[156:159]
v_mfma_f32_16x16x32_bf16 v[156:159], v[68:71], a[188:191], v[156:159]
s_waitcnt lgkmcnt(0)
v_mfma_f32_16x16x32_bf16 v[96:99], v[40:43], a[192:195], v[96:99]
buffer_load_dwordx4 v73, s[12:15], s48 offen offset:1024 lds
v_mfma_f32_16x16x32_bf16 v[96:99], v[44:47], a[208:211], v[96:99]
ds_read_b64_tr_b16 v[56:57], v3 offset:16384
v_mov_b32 v160, 0
v_mfma_f32_16x16x32_bf16 v[100:103], v[40:43], a[196:199], v[100:103]
ds_read_b64_tr_b16 v[58:59], v3 offset:16896
v_mov_b32 v161, 0
v_mfma_f32_16x16x32_bf16 v[100:103], v[44:47], a[212:215], v[100:103]
ds_read_b64_tr_b16 v[60:61], v3 offset:24576
v_mov_b32 v162, 0
v_mfma_f32_16x16x32_bf16 v[104:107], v[40:43], a[200:203], v[104:107]
buffer_load_dwordx4 v92, s[12:15], s48 offen offset:2048 lds
v_mfma_f32_16x16x32_bf16 v[104:107], v[44:47], a[216:219], v[104:107]
ds_read_b64_tr_b16 v[62:63], v3 offset:25088
v_mov_b32 v163, 0
v_mfma_f32_16x16x32_bf16 v[108:111], v[40:43], a[204:207], v[108:111]
ds_read_b64_tr_b16 v[64:65], v3 offset:18432
s_mov_b32 s50, 67112960
v_mfma_f32_16x16x32_bf16 v[108:111], v[44:47], a[220:223], v[108:111]
ds_read_b64_tr_b16 v[66:67], v3 offset:18944
v_mfma_f32_16x16x32_bf16 v[112:115], v[48:51], a[192:195], v[112:115]
buffer_load_dwordx4 v93, s[12:15], s48 offen offset:3072 lds
v_mfma_f32_16x16x32_bf16 v[112:115], v[52:55], a[208:211], v[112:115]
ds_read_b64_tr_b16 v[68:69], v3 offset:26624
v_add_u32 v10, 128, v10
v_mfma_f32_16x16x32_bf16 v[116:119], v[48:51], a[196:199], v[116:119]
ds_read_b64_tr_b16 v[70:71], v3 offset:27136
v_add_u32 v11, 128, v11
s_add_u32 m0, s37, 65536
v_mfma_f32_16x16x32_bf16 v[116:119], v[52:55], a[212:215], v[116:119]
buffer_store_dwordx4 v[160:163], v91, s[20:23], s50 offen sc1
v_mfma_f32_16x16x32_bf16 v[120:123], v[48:51], a[200:203], v[120:123]
buffer_load_dwordx4 v10, s[4:7], s28 offen offset:0 lds
v_mfma_f32_16x16x32_bf16 v[120:123], v[52:55], a[216:219], v[120:123]
buffer_store_dwordx4 v[160:163], v217, s[20:23], 0 offen offset:128 sc1
v_mfma_f32_16x16x32_bf16 v[124:127], v[48:51], a[204:207], v[124:127]
s_waitcnt vmcnt(11) lgkmcnt(0)
v_mfma_f32_16x16x32_bf16 v[124:127], v[52:55], a[220:223], v[124:127]
s_barrier
v_mfma_f32_16x16x32_bf16 v[128:131], v[56:59], a[192:195], v[128:131]
buffer_load_dwordx4 v11, s[4:7], s28 offen offset:1024 lds
v_mfma_f32_16x16x32_bf16 v[128:131], v[60:63], a[208:211], v[128:131]
ds_read_b128 a[224:227], v74 offset:32768
ds_read_b128 a[228:231], v74 offset:34816
v_mfma_f32_16x16x32_bf16 v[132:135], v[56:59], a[196:199], v[132:135]
ds_read_b128 a[232:235], v74 offset:36864
ds_read_b128 a[236:239], v74 offset:38912
v_mfma_f32_16x16x32_bf16 v[132:135], v[60:63], a[212:215], v[132:135]
ds_read_b128 a[240:243], v75 offset:32768
ds_read_b128 a[244:247], v75 offset:34816
v_mfma_f32_16x16x32_bf16 v[136:139], v[56:59], a[200:203], v[136:139]
buffer_load_dwordx4 v10, s[8:11], s28 offen offset:2048 lds
v_mfma_f32_16x16x32_bf16 v[136:139], v[60:63], a[216:219], v[136:139]
ds_read_b128 a[248:251], v75 offset:36864
ds_read_b128 a[252:255], v75 offset:38912
v_mfma_f32_16x16x32_bf16 v[140:143], v[56:59], a[204:207], v[140:143]
ds_read_b64_tr_b16 v[40:41], v2 offset:32768
ds_read_b64_tr_b16 v[42:43], v2 offset:33280
v_mfma_f32_16x16x32_bf16 v[140:143], v[60:63], a[220:223], v[140:143]
ds_read_b64_tr_b16 v[44:45], v2 offset:40960
ds_read_b64_tr_b16 v[46:47], v2 offset:41472
v_mfma_f32_16x16x32_bf16 v[144:147], v[64:67], a[192:195], v[144:147]
buffer_load_dwordx4 v11, s[8:11], s28 offen offset:3072 lds
v_mfma_f32_16x16x32_bf16 v[144:147], v[68:71], a[208:211], v[144:147]
ds_read_b64_tr_b16 v[48:49], v2 offset:34816
ds_read_b64_tr_b16 v[50:51], v2 offset:35328
s_add_u32 m0, s37, 0
v_mfma_f32_16x16x32_bf16 v[148:151], v[64:67], a[196:199], v[148:151]
ds_read_b64_tr_b16 v[52:53], v2 offset:43008
ds_read_b64_tr_b16 v[54:55], v2 offset:43520
v_mfma_f32_16x16x32_bf16 v[148:151], v[68:71], a[212:215], v[148:151]
v_mfma_f32_16x16x32_bf16 v[152:155], v[64:67], a[200:203], v[152:155]
buffer_load_dwordx4 v10, s[4:7], s29 offen offset:0 lds
v_mfma_f32_16x16x32_bf16 v[152:155], v[68:71], a[216:219], v[152:155]
v_mfma_f32_16x16x32_bf16 v[156:159], v[64:67], a[204:207], v[156:159]
v_mfma_f32_16x16x32_bf16 v[156:159], v[68:71], a[220:223], v[156:159]
s_waitcnt lgkmcnt(0)
v_mfma_f32_16x16x32_bf16 v[96:99], v[40:43], a[224:227], v[96:99]
buffer_load_dwordx4 v11, s[4:7], s29 offen offset:1024 lds
v_mfma_f32_16x16x32_bf16 v[96:99], v[44:47], a[240:243], v[96:99]
ds_read_b64_tr_b16 v[56:57], v3 offset:32768
v_mfma_f32_16x16x32_bf16 v[100:103], v[40:43], a[228:231], v[100:103]
ds_read_b64_tr_b16 v[58:59], v3 offset:33280
v_mfma_f32_16x16x32_bf16 v[100:103], v[44:47], a[244:247], v[100:103]
ds_read_b64_tr_b16 v[60:61], v3 offset:40960
v_mfma_f32_16x16x32_bf16 v[104:107], v[40:43], a[232:235], v[104:107]
buffer_load_dwordx4 v10, s[8:11], s29 offen offset:2048 lds
v_mfma_f32_16x16x32_bf16 v[104:107], v[44:47], a[248:251], v[104:107]
ds_read_b64_tr_b16 v[62:63], v3 offset:41472
v_mfma_f32_16x16x32_bf16 v[108:111], v[40:43], a[236:239], v[108:111]
ds_read_b64_tr_b16 v[64:65], v3 offset:34816
v_mfma_f32_16x16x32_bf16 v[108:111], v[44:47], a[252:255], v[108:111]
ds_read_b64_tr_b16 v[66:67], v3 offset:35328
v_mfma_f32_16x16x32_bf16 v[112:115], v[48:51], a[224:227], v[112:115]
buffer_load_dwordx4 v11, s[8:11], s29 offen offset:3072 lds
v_mfma_f32_16x16x32_bf16 v[112:115], v[52:55], a[240:243], v[112:115]
ds_read_b64_tr_b16 v[68:69], v3 offset:43008
s_add_u32 m0, s37, 16384
v_mfma_f32_16x16x32_bf16 v[116:119], v[48:51], a[228:231], v[116:119]
ds_read_b64_tr_b16 v[70:71], v3 offset:43520
v_mfma_f32_16x16x32_bf16 v[116:119], v[52:55], a[244:247], v[116:119]
buffer_load_dword v78, v221, s[24:27], 0 offen sc1
v_mfma_f32_16x16x32_bf16 v[120:123], v[48:51], a[232:235], v[120:123]
buffer_load_dwordx4 v10, s[4:7], s30 offen offset:0 lds
v_mfma_f32_16x16x32_bf16 v[120:123], v[52:55], a[248:251], v[120:123]
v_mfma_f32_16x16x32_bf16 v[124:127], v[48:51], a[236:239], v[124:127]
s_waitcnt vmcnt(12) lgkmcnt(0)
v_mfma_f32_16x16x32_bf16 v[124:127], v[52:55], a[252:255], v[124:127]
s_barrier
v_mfma_f32_16x16x32_bf16 v[128:131], v[56:59], a[224:227], v[128:131]
buffer_load_dwordx4 v11, s[4:7], s30 offen offset:1024 lds
v_mfma_f32_16x16x32_bf16 v[128:131], v[60:63], a[240:243], v[128:131]
ds_read_b128 v[224:227], v74 offset:49152
ds_read_b128 v[228:231], v74 offset:51200
v_mfma_f32_16x16x32_bf16 v[132:135], v[56:59], a[228:231], v[132:135]
ds_read_b128 v[232:235], v74 offset:53248
ds_read_b128 v[236:239], v74 offset:55296
v_mfma_f32_16x16x32_bf16 v[132:135], v[60:63], a[244:247], v[132:135]
ds_read_b128 v[240:243], v75 offset:49152
ds_read_b128 v[244:247], v75 offset:51200
v_mfma_f32_16x16x32_bf16 v[136:139], v[56:59], a[232:235], v[136:139]
buffer_load_dwordx4 v10, s[8:11], s30 offen offset:2048 lds
v_mfma_f32_16x16x32_bf16 v[136:139], v[60:63], a[248:251], v[136:139]
ds_read_b128 v[248:251], v75 offset:53248
ds_read_b128 v[252:255], v75 offset:55296
v_mfma_f32_16x16x32_bf16 v[140:143], v[56:59], a[236:239], v[140:143]
ds_read_b64_tr_b16 v[40:41], v2 offset:49152
ds_read_b64_tr_b16 v[42:43], v2 offset:49664
v_mfma_f32_16x16x32_bf16 v[140:143], v[60:63], a[252:255], v[140:143]
ds_read_b64_tr_b16 v[44:45], v2 offset:57344
ds_read_b64_tr_b16 v[46:47], v2 offset:57856
v_mfma_f32_16x16x32_bf16 v[144:147], v[64:67], a[224:227], v[144:147]
buffer_load_dwordx4 v11, s[8:11], s30 offen offset:3072 lds
v_mfma_f32_16x16x32_bf16 v[144:147], v[68:71], a[240:243], v[144:147]
ds_read_b64_tr_b16 v[48:49], v2 offset:51200
ds_read_b64_tr_b16 v[50:51], v2 offset:51712
v_mfma_f32_16x16x32_bf16 v[148:151], v[64:67], a[228:231], v[148:151]
ds_read_b64_tr_b16 v[52:53], v2 offset:59392
ds_read_b64_tr_b16 v[54:55], v2 offset:59904
v_mfma_f32_16x16x32_bf16 v[148:151], v[68:71], a[244:247], v[148:151]
v_lshlrev_b32 v73, 4, v0
s_lshr_b32 s41, s37, 2
s_add_u32 m0, s41, 81920
v_mfma_f32_16x16x32_bf16 v[152:155], v[64:67], a[232:235], v[152:155]
buffer_load_dwordx4 v73, s[92:95], 0 offen lds
v_mfma_f32_16x16x32_bf16 v[152:155], v[68:71], a[248:251], v[152:155]
s_add_u32 m0, s37, 32768
v_mfma_f32_16x16x32_bf16 v[156:159], v[64:67], a[236:239], v[156:159]
v_mfma_f32_16x16x32_bf16 v[156:159], v[68:71], a[252:255], v[156:159]
s_waitcnt lgkmcnt(0)
v_mfma_f32_16x16x32_bf16 v[96:99], v[40:43], v[224:227], v[96:99]
ds_read_b64_tr_b16 v[56:57], v3 offset:49152
v_mfma_f32_16x16x32_bf16 v[96:99], v[44:47], v[240:243], v[96:99]
ds_read_b64_tr_b16 v[58:59], v3 offset:49664
v_mfma_f32_16x16x32_bf16 v[100:103], v[40:43], v[228:231], v[100:103]
ds_read_b64_tr_b16 v[60:61], v3 offset:57344
v_mfma_f32_16x16x32_bf16 v[100:103], v[44:47], v[244:247], v[100:103]
ds_read_b64_tr_b16 v[62:63], v3 offset:57856
v_mfma_f32_16x16x32_bf16 v[104:107], v[40:43], v[232:235], v[104:107]
ds_read_b64_tr_b16 v[64:65], v3 offset:51200
v_mfma_f32_16x16x32_bf16 v[104:107], v[44:47], v[248:251], v[104:107]
ds_read_b64_tr_b16 v[66:67], v3 offset:51712
v_mfma_f32_16x16x32_bf16 v[108:111], v[40:43], v[236:239], v[108:111]
ds_read_b64_tr_b16 v[68:69], v3 offset:59392
v_mfma_f32_16x16x32_bf16 v[108:111], v[44:47], v[252:255], v[108:111]
ds_read_b64_tr_b16 v[70:71], v3 offset:59904
v_mfma_f32_16x16x32_bf16 v[112:115], v[48:51], v[224:227], v[112:115]
buffer_load_dwordx4 v10, s[4:7], s31 offen offset:0 lds
v_mfma_f32_16x16x32_bf16 v[112:115], v[52:55], v[240:243], v[112:115]
v_mov_b32 v72, v221
v_mfma_f32_16x16x32_bf16 v[116:119], v[48:51], v[228:231], v[116:119]
buffer_load_dwordx4 v11, s[4:7], s31 offen offset:1024 lds
v_mfma_f32_16x16x32_bf16 v[116:119], v[52:55], v[244:247], v[116:119]
v_mfma_f32_16x16x32_bf16 v[120:123], v[48:51], v[232:235], v[120:123]
buffer_load_dwordx4 v10, s[8:11], s31 offen offset:2048 lds
v_mfma_f32_16x16x32_bf16 v[120:123], v[52:55], v[248:251], v[120:123]
v_mfma_f32_16x16x32_bf16 v[124:127], v[48:51], v[236:239], v[124:127]
s_waitcnt vmcnt(13) lgkmcnt(0)
v_mfma_f32_16x16x32_bf16 v[124:127], v[52:55], v[252:255], v[124:127]
s_barrier
v_mfma_f32_16x16x32_bf16 v[128:131], v[56:59], v[224:227], v[128:131]
ds_read_b64_tr_b16 v[40:41], v4 offset:0
v_and_b32 v76, 48, v1
v_mfma_f32_16x16x32_bf16 v[128:131], v[60:63], v[240:243], v[128:131]
ds_read_b64_tr_b16 v[42:43], v4 offset:512
v_add_u32 v76, 81920, v76
v_mfma_f32_16x16x32_bf16 v[132:135], v[56:59], v[228:231], v[132:135]
ds_read_b64_tr_b16 v[44:45], v4 offset:8192
v_mfma_f32_16x16x32_bf16 v[132:135], v[60:63], v[244:247], v[132:135]
ds_read_b64_tr_b16 v[46:47], v4 offset:8704
v_mfma_f32_16x16x32_bf16 v[136:139], v[56:59], v[232:235], v[136:139]
ds_read_b64_tr_b16 v[48:49], v4 offset:2048
v_mfma_f32_16x16x32_bf16 v[136:139], v[60:63], v[248:251], v[136:139]
ds_read_b64_tr_b16 v[50:51], v4 offset:2560
v_mfma_f32_16x16x32_bf16 v[140:143], v[56:59], v[236:239], v[140:143]
ds_read_b64_tr_b16 v[52:53], v4 offset:10240
v_mfma_f32_16x16x32_bf16 v[140:143], v[60:63], v[252:255], v[140:143]
ds_read_b64_tr_b16 v[54:55], v4 offset:10752
v_mfma_f32_16x16x32_bf16 v[144:147], v[64:67], v[224:227], v[144:147]
buffer_load_dwordx4 v11, s[8:11], s31 offen offset:3072 lds
v_mfma_f32_16x16x32_bf16 v[144:147], v[68:71], v[240:243], v[144:147]
s_add_u32 m0, s43, 131072
v_mfma_f32_16x16x32_bf16 v[148:151], v[64:67], v[228:231], v[148:151]
buffer_load_dwordx4 v83, s[52:55], 0 offen offset:0 lds
v_mfma_f32_16x16x32_bf16 v[148:151], v[68:71], v[244:247], v[148:151]
s_add_u32 m0, s43, 131072
v_mfma_f32_16x16x32_bf16 v[152:155], v[64:67], v[232:235], v[152:155]
buffer_load_dwordx4 v84, s[52:55], 0 offen offset:1024 lds
v_mfma_f32_16x16x32_bf16 v[152:155], v[68:71], v[248:251], v[152:155]
s_add_u32 m0, s37, 49152
v_mfma_f32_16x16x32_bf16 v[156:159], v[64:67], v[236:239], v[156:159]
v_mfma_f32_16x16x32_bf16 v[156:159], v[68:71], v[252:255], v[156:159]
s_waitcnt lgkmcnt(0)
v_mfma_f32_16x16x32_bf16 v[160:163], v[40:43], a[0:3], 0
ds_read_b64_tr_b16 v[56:57], v5 offset:0
v_mfma_f32_16x16x32_bf16 v[160:163], v[44:47], a[16:19], v[160:163]
ds_read_b64_tr_b16 v[58:59], v5 offset:512
s_add_u32 s50, s44, 0
v_mfma_f32_16x16x32_bf16 v[164:167], v[40:43], a[4:7], 0
ds_read_b64_tr_b16 v[60:61], v5 offset:8192
v_mul_f32 v24, v96, v96
v_mfma_f32_16x16x32_bf16 v[164:167], v[44:47], a[20:23], v[164:167]
ds_read_b64_tr_b16 v[62:63], v5 offset:8704
v_mul_f32 v25, v97, v97
v_mfma_f32_16x16x32_bf16 v[168:171], v[40:43], a[8:11], 0
ds_read_b64_tr_b16 v[64:65], v5 offset:2048
v_fma_f32 v24, v24, s47, v18
v_fma_f32 v25, v25, s47, v18
v_mfma_f32_16x16x32_bf16 v[168:171], v[44:47], a[24:27], v[168:171]
ds_read_b64_tr_b16 v[66:67], v5 offset:2560
v_mul_f32 v24, v24, v96
v_mfma_f32_16x16x32_bf16 v[172:175], v[40:43], a[12:15], 0
ds_read_b64_tr_b16 v[68:69], v5 offset:10240
v_mul_f32 v25, v25, v97
v_mfma_f32_16x16x32_bf16 v[172:175], v[44:47], a[28:31], v[172:175]
ds_read_b64_tr_b16 v[70:71], v5 offset:10752
v_exp_f32 v24, v24
v_mfma_f32_16x16x32_bf16 v[176:179], v[48:51], a[0:3], 0
buffer_load_dwordx4 v10, s[4:7], s32 offen offset:0 lds
v_mfma_f32_16x16x32_bf16 v[176:179], v[52:55], a[16:19], v[176:179]
v_exp_f32 v25, v25
v_mfma_f32_16x16x32_bf16 v[180:183], v[48:51], a[4:7], 0
buffer_load_dwordx4 v11, s[4:7], s32 offen offset:1024 lds
v_mfma_f32_16x16x32_bf16 v[180:183], v[52:55], a[20:23], v[180:183]
v_mul_f32 v112, v112, v96
v_mul_f32 v113, v113, v97
v_add_f32 v24, 1.0, v24
v_mfma_f32_16x16x32_bf16 v[184:187], v[48:51], a[8:11], 0
buffer_load_dwordx4 v10, s[8:11], s32 offen offset:2048 lds
v_mfma_f32_16x16x32_bf16 v[184:187], v[52:55], a[24:27], v[184:187]
v_add_f32 v25, 1.0, v25
v_rcp_f32 v24, v24
v_mfma_f32_16x16x32_bf16 v[188:191], v[48:51], a[12:15], 0
v_mul_f32 v112, v112, v24
s_waitcnt vmcnt(15) lgkmcnt(0)
v_mfma_f32_16x16x32_bf16 v[188:191], v[52:55], a[28:31], v[188:191]
s_barrier
v_mfma_f32_16x16x32_bf16 v[192:195], v[56:59], a[0:3], 0
ds_read_b64_tr_b16 v[40:41], v2 offset:0
v_rcp_f32 v25, v25
v_mfma_f32_16x16x32_bf16 v[192:195], v[60:63], a[16:19], v[192:195]
ds_read_b64_tr_b16 v[42:43], v2 offset:512
v_mul_f32 v113, v113, v25
v_mfma_f32_16x16x32_bf16 v[196:199], v[56:59], a[4:7], 0
ds_read_b64_tr_b16 v[44:45], v2 offset:8192
v_mul_f32 v26, v98, v98
v_mfma_f32_16x16x32_bf16 v[196:199], v[60:63], a[20:23], v[196:199]
ds_read_b64_tr_b16 v[46:47], v2 offset:8704
v_mul_f32 v27, v99, v99
v_fma_f32 v26, v26, s47, v18
v_mfma_f32_16x16x32_bf16 v[200:203], v[56:59], a[8:11], 0
ds_read_b64_tr_b16 v[48:49], v2 offset:2048
v_fma_f32 v27, v27, s47, v18
v_mfma_f32_16x16x32_bf16 v[200:203], v[60:63], a[24:27], v[200:203]
ds_read_b64_tr_b16 v[50:51], v2 offset:2560
v_mul_f32 v26, v26, v98
v_mfma_f32_16x16x32_bf16 v[204:207], v[56:59], a[12:15], 0
ds_read_b64_tr_b16 v[52:53], v2 offset:10240
v_mul_f32 v27, v27, v99
v_mul_f32 v114, v114, v98
v_mfma_f32_16x16x32_bf16 v[204:207], v[60:63], a[28:31], v[204:207]
ds_read_b64_tr_b16 v[54:55], v2 offset:10752
v_mul_f32 v115, v115, v99
v_mfma_f32_16x16x32_bf16 v[208:211], v[64:67], a[0:3], 0
buffer_load_dwordx4 v11, s[8:11], s32 offen offset:3072 lds
v_mfma_f32_16x16x32_bf16 v[208:211], v[68:71], a[16:19], v[208:211]
s_add_u32 m0, s43, 131072
v_exp_f32 v26, v26
v_mfma_f32_16x16x32_bf16 v[212:215], v[64:67], a[4:7], 0
buffer_load_dwordx4 v85, s[52:55], 0 offen offset:2048 lds
v_mfma_f32_16x16x32_bf16 v[212:215], v[68:71], a[20:23], v[212:215]
s_mov_b64 s[92:93], s[90:91]
s_movk_i32 s94, 4608
v_mfma_f32_16x16x32_bf16 v[216:219], v[64:67], a[8:11], 0
v_exp_f32 v27, v27
v_add_f32 v26, 1.0, v26
v_mfma_f32_16x16x32_bf16 v[216:219], v[68:71], a[24:27], v[216:219]
s_add_u32 m0, s43, 134144
v_add_f32 v27, 1.0, v27
v_mfma_f32_16x16x32_bf16 v[220:223], v[64:67], a[12:15], 0
buffer_load_dwordx4 v86, s[92:95], 0 offen lds
v_mfma_f32_16x16x32_bf16 v[220:223], v[68:71], a[28:31], v[220:223]
s_add_u32 m0, s37, 65536
s_waitcnt lgkmcnt(0)
v_mfma_f32_16x16x32_bf16 v[160:163], v[40:43], a[32:35], v[160:163]
ds_read_b64_tr_b16 v[56:57], v3 offset:0
v_rcp_f32 v26, v26
v_mfma_f32_16x16x32_bf16 v[160:163], v[44:47], a[48:51], v[160:163]
ds_read_b64_tr_b16 v[58:59], v3 offset:512
v_mul_f32 v114, v114, v26
v_mfma_f32_16x16x32_bf16 v[164:167], v[40:43], a[36:39], v[164:167]
ds_read_b64_tr_b16 v[60:61], v3 offset:8192
v_rcp_f32 v27, v27
v_mfma_f32_16x16x32_bf16 v[164:167], v[44:47], a[52:55], v[164:167]
ds_read_b64_tr_b16 v[62:63], v3 offset:8704
v_mul_f32 v115, v115, v27
v_mfma_f32_16x16x32_bf16 v[168:171], v[40:43], a[40:43], v[168:171]
ds_read_b64_tr_b16 v[64:65], v3 offset:2048
v_cvt_pk_bf16_f32 v96, v112, v113
v_mfma_f32_16x16x32_bf16 v[168:171], v[44:47], a[56:59], v[168:171]
ds_read_b64_tr_b16 v[66:67], v3 offset:2560
v_cvt_pk_bf16_f32 v97, v114, v115
v_mul_f32 v28, v128, v128
v_mfma_f32_16x16x32_bf16 v[172:175], v[40:43], a[44:47], v[172:175]
ds_read_b64_tr_b16 v[68:69], v3 offset:10240
v_mul_f32 v29, v129, v129
v_mfma_f32_16x16x32_bf16 v[172:175], v[44:47], a[60:63], v[172:175]
ds_read_b64_tr_b16 v[70:71], v3 offset:10752
v_fma_f32 v28, v28, s47, v18
v_mfma_f32_16x16x32_bf16 v[176:179], v[48:51], a[32:35], v[176:179]
buffer_load_dwordx4 v10, s[4:7], s33 offen offset:0 lds
v_mfma_f32_16x16x32_bf16 v[176:179], v[52:55], a[48:51], v[176:179]
v_fma_f32 v29, v29, s47, v18
v_mul_f32 v28, v28, v128
v_mul_f32 v29, v29, v129
v_mfma_f32_16x16x32_bf16 v[180:183], v[48:51], a[36:39], v[180:183]
buffer_load_dwordx4 v11, s[4:7], s33 offen offset:1024 lds
v_mfma_f32_16x16x32_bf16 v[180:183], v[52:55], a[52:55], v[180:183]
v_exp_f32 v28, v28
v_mul_f32 v144, v144, v128
v_mfma_f32_16x16x32_bf16 v[184:187], v[48:51], a[40:43], v[184:187]
buffer_load_dwordx4 v10, s[8:11], s33 offen offset:2048 lds
v_mfma_f32_16x16x32_bf16 v[184:187], v[52:55], a[56:59], v[184:187]
v_exp_f32 v29, v29
v_mfma_f32_16x16x32_bf16 v[188:191], v[48:51], a[44:47], v[188:191]
v_mul_f32 v145, v145, v129
v_add_f32 v28, 1.0, v28
s_waitcnt vmcnt(15) lgkmcnt(0)
v_mfma_f32_16x16x32_bf16 v[188:191], v[52:55], a[60:63], v[188:191]
s_barrier
v_mfma_f32_16x16x32_bf16 v[192:195], v[56:59], a[32:35], v[192:195]
ds_read_b64_tr_b16 v[40:41], v2 offset:16384
v_add_f32 v29, 1.0, v29
v_mfma_f32_16x16x32_bf16 v[192:195], v[60:63], a[48:51], v[192:195]
ds_read_b64_tr_b16 v[42:43], v2 offset:16896
v_rcp_f32 v28, v28
v_mfma_f32_16x16x32_bf16 v[196:199], v[56:59], a[36:39], v[196:199]
ds_read_b64_tr_b16 v[44:45], v2 offset:24576
v_mul_f32 v144, v144, v28
v_mfma_f32_16x16x32_bf16 v[196:199], v[60:63], a[52:55], v[196:199]
ds_read_b64_tr_b16 v[46:47], v2 offset:25088
v_mul_f32 v30, v130, v130
v_mfma_f32_16x16x32_bf16 v[200:203], v[56:59], a[40:43], v[200:203]
ds_read_b64_tr_b16 v[48:49], v2 offset:18432
v_rcp_f32 v29, v29
v_mfma_f32_16x16x32_bf16 v[200:203], v[60:63], a[56:59], v[200:203]
ds_read_b64_tr_b16 v[50:51], v2 offset:18944
v_mul_f32 v145, v145, v29
v_mfma_f32_16x16x32_bf16 v[204:207], v[56:59], a[44:47], v[204:207]
ds_read_b64_tr_b16 v[52:53], v2 offset:26624
v_mul_f32 v31, v131, v131
v_mfma_f32_16x16x32_bf16 v[204:207], v[60:63], a[60:63], v[204:207]
ds_read_b64_tr_b16 v[54:55], v2 offset:27136
v_fma_f32 v30, v30, s47, v18
v_mfma_f32_16x16x32_bf16 v[208:211], v[64:67], a[32:35], v[208:211]
buffer_load_dwordx4 v11, s[8:11], s33 offen offset:3072 lds
v_mfma_f32_16x16x32_bf16 v[208:211], v[68:71], a[48:51], v[208:211]
s_add_u32 m0, s43, 147520
v_fma_f32 v31, v31, s47, v18
v_mul_f32 v30, v30, v130
v_mfma_f32_16x16x32_bf16 v[212:215], v[64:67], a[36:39], v[212:215]
buffer_load_dwordx4 v80, s[96:99], 0 offen offset:0 lds
v_mfma_f32_16x16x32_bf16 v[212:215], v[68:71], a[52:55], v[212:215]
s_add_u32 m0, s43, 147520
v_mul_f32 v31, v31, v131
v_mul_f32 v146, v146, v130
v_mfma_f32_16x16x32_bf16 v[216:219], v[64:67], a[40:43], v[216:219]
buffer_load_dwordx4 v81, s[96:99], 0 offen offset:1024 lds
v_mfma_f32_16x16x32_bf16 v[216:219], v[68:71], a[56:59], v[216:219]
s_add_u32 m0, s37, 0
v_mul_f32 v147, v147, v131
v_mfma_f32_16x16x32_bf16 v[220:223], v[64:67], a[44:47], v[220:223]
v_exp_f32 v30, v30
v_cvt_pk_bf16_f32 v98, v144, v145
v_mfma_f32_16x16x32_bf16 v[220:223], v[68:71], a[60:63], v[220:223]
v_add_f32 v30, 1.0, v30
s_waitcnt lgkmcnt(0)
v_mfma_f32_16x16x32_bf16 v[160:163], v[40:43], a[64:67], v[160:163]
ds_read_b64_tr_b16 v[56:57], v3 offset:16384
v_mul_f32 v32, v100, v100
v_mfma_f32_16x16x32_bf16 v[160:163], v[44:47], a[80:83], v[160:163]
ds_read_b64_tr_b16 v[58:59], v3 offset:16896
v_exp_f32 v31, v31
v_mfma_f32_16x16x32_bf16 v[164:167], v[40:43], a[68:71], v[164:167]
ds_read_b64_tr_b16 v[60:61], v3 offset:24576
v_add_f32 v31, 1.0, v31
v_mfma_f32_16x16x32_bf16 v[164:167], v[44:47], a[84:87], v[164:167]
ds_read_b64_tr_b16 v[62:63], v3 offset:25088
v_mul_f32 v33, v101, v101
v_mfma_f32_16x16x32_bf16 v[168:171], v[40:43], a[72:75], v[168:171]
ds_read_b64_tr_b16 v[64:65], v3 offset:18432
v_rcp_f32 v30, v30
v_mfma_f32_16x16x32_bf16 v[168:171], v[44:47], a[88:91], v[168:171]
ds_read_b64_tr_b16 v[66:67], v3 offset:18944
v_mul_f32 v146, v146, v30
v_mfma_f32_16x16x32_bf16 v[172:175], v[40:43], a[76:79], v[172:175]
ds_read_b64_tr_b16 v[68:69], v3 offset:26624
v_fma_f32 v32, v32, s47, v18
v_mfma_f32_16x16x32_bf16 v[172:175], v[44:47], a[92:95], v[172:175]
ds_read_b64_tr_b16 v[70:71], v3 offset:27136
v_rcp_f32 v31, v31
v_mfma_f32_16x16x32_bf16 v[176:179], v[48:51], a[64:67], v[176:179]
buffer_load_dwordx4 v10, s[4:7], s34 offen offset:0 lds
v_mfma_f32_16x16x32_bf16 v[176:179], v[52:55], a[80:83], v[176:179]
v_mul_f32 v147, v147, v31
v_cvt_pk_bf16_f32 v99, v146, v147
v_mfma_f32_16x16x32_bf16 v[180:183], v[48:51], a[68:71], v[180:183]
buffer_load_dwordx4 v11, s[4:7], s34 offen offset:1024 lds
v_mfma_f32_16x16x32_bf16 v[180:183], v[52:55], a[84:87], v[180:183]
v_readfirstlane_b32 s58, v78
s_cmp_ge_u32 s58, s101
s_cbranch_scc0 L_spin9
L_back9:
v_mfma_f32_16x16x32_bf16 v[184:187], v[48:51], a[72:75], v[184:187]
buffer_load_dwordx4 v10, s[8:11], s34 offen offset:2048 lds
v_mfma_f32_16x16x32_bf16 v[184:187], v[52:55], a[88:91], v[184:187]
v_fma_f32 v33, v33, s47, v18
v_mul_f32 v32, v32, v100
v_mul_f32 v33, v33, v101
v_mul_f32 v116, v116, v100
v_mfma_f32_16x16x32_bf16 v[188:191], v[48:51], a[76:79], v[188:191]
v_mul_f32 v117, v117, v101
s_waitcnt vmcnt(17) lgkmcnt(0)
v_mfma_f32_16x16x32_bf16 v[188:191], v[52:55], a[92:95], v[188:191]
s_barrier
v_mfma_f32_16x16x32_bf16 v[192:195], v[56:59], a[64:67], v[192:195]
ds_read_b64_tr_b16 v[40:41], v2 offset:32768
v_exp_f32 v32, v32
v_mfma_f32_16x16x32_bf16 v[192:195], v[60:63], a[80:83], v[192:195]
ds_read_b64_tr_b16 v[42:43], v2 offset:33280
v_add_f32 v32, 1.0, v32
v_mfma_f32_16x16x32_bf16 v[196:199], v[56:59], a[68:71], v[196:199]
ds_read_b64_tr_b16 v[44:45], v2 offset:40960
v_mul_f32 v34, v102, v102
v_mfma_f32_16x16x32_bf16 v[196:199], v[60:63], a[84:87], v[196:199]
ds_read_b64_tr_b16 v[46:47], v2 offset:41472
v_exp_f32 v33, v33
v_mfma_f32_16x16x32_bf16 v[200:203], v[56:59], a[72:75], v[200:203]
ds_read_b64_tr_b16 v[48:49], v2 offset:34816
v_add_f32 v33, 1.0, v33
v_mfma_f32_16x16x32_bf16 v[200:203], v[60:63], a[88:91], v[200:203]
ds_read_b64_tr_b16 v[50:51], v2 offset:35328
v_mul_f32 v35, v103, v103
v_mfma_f32_16x16x32_bf16 v[204:207], v[56:59], a[76:79], v[204:207]
ds_read_b64_tr_b16 v[52:53], v2 offset:43008
v_fma_f32 v34, v34, s47, v18
v_mfma_f32_16x16x32_bf16 v[204:207], v[60:63], a[92:95], v[204:207]
ds_read_b64_tr_b16 v[54:55], v2 offset:43520
v_rcp_f32 v32, v32
v_mfma_f32_16x16x32_bf16 v[208:211], v[64:67], a[64:67], v[208:211]
buffer_load_dwordx4 v11, s[8:11], s34 offen offset:3072 lds
v_mfma_f32_16x16x32_bf16 v[208:211], v[68:71], a[80:83], v[208:211]
s_add_u32 m0, s43, 147520
v_mul_f32 v116, v116, v32
v_mfma_f32_16x16x32_bf16 v[212:215], v[64:67], a[68:71], v[212:215]
buffer_load_dwordx4 v82, s[96:99], 0 offen offset:2048 lds
v_mfma_f32_16x16x32_bf16 v[212:215], v[68:71], a[84:87], v[212:215]
s_add_u32 m0, s37, 16384
v_rcp_f32 v33, v33
v_mfma_f32_16x16x32_bf16 v[216:219], v[64:67], a[72:75], v[216:219]
buffer_load_dwordx4 v10, s[4:7], s35 offen offset:0 lds
v_mfma_f32_16x16x32_bf16 v[216:219], v[68:71], a[88:91], v[216:219]
v_mul_f32 v117, v117, v33
v_fma_f32 v35, v35, s47, v18
v_mul_f32 v34, v34, v102
v_mfma_f32_16x16x32_bf16 v[220:223], v[64:67], a[76:79], v[220:223]
v_mul_f32 v35, v35, v103
v_mul_f32 v118, v118, v102
v_mfma_f32_16x16x32_bf16 v[220:223], v[68:71], a[92:95], v[220:223]
v_mul_f32 v119, v119, v103
s_waitcnt lgkmcnt(0)
v_mfma_f32_16x16x32_bf16 v[160:163], v[40:43], a[96:99], v[160:163]
ds_read_b64_tr_b16 v[56:57], v3 offset:32768
v_exp_f32 v34, v34
v_mfma_f32_16x16x32_bf16 v[160:163], v[44:47], a[112:115], v[160:163]
ds_read_b64_tr_b16 v[58:59], v3 offset:33280
v_add_f32 v34, 1.0, v34
v_mfma_f32_16x16x32_bf16 v[164:167], v[40:43], a[100:103], v[164:167]
ds_read_b64_tr_b16 v[60:61], v3 offset:40960
v_cvt_pk_bf16_f32 v100, v116, v117
v_mfma_f32_16x16x32_bf16 v[164:167], v[44:47], a[116:119], v[164:167]
ds_read_b64_tr_b16 v[62:63], v3 offset:41472
v_exp_f32 v35, v35
v_mfma_f32_16x16x32_bf16 v[168:171], v[40:43], a[104:107], v[168:171]
ds_read_b64_tr_b16 v[64:65], v3 offset:34816
v_add_f32 v35, 1.0, v35
v_mfma_f32_16x16x32_bf16 v[168:171], v[44:47], a[120:123], v[168:171]
ds_read_b64_tr_b16 v[66:67], v3 offset:35328
v_mul_f32 v36, v132, v132
v_mfma_f32_16x16x32_bf16 v[172:175], v[40:43], a[108:111], v[172:175]
ds_read_b64_tr_b16 v[68:69], v3 offset:43008
v_rcp_f32 v34, v34
v_mfma_f32_16x16x32_bf16 v[172:175], v[44:47], a[124:127], v[172:175]
ds_read_b64_tr_b16 v[70:71], v3 offset:43520
v_mul_f32 v118, v118, v34
v_mfma_f32_16x16x32_bf16 v[176:179], v[48:51], a[96:99], v[176:179]
buffer_load_dwordx4 v11, s[4:7], s35 offen offset:1024 lds
v_mfma_f32_16x16x32_bf16 v[176:179], v[52:55], a[112:115], v[176:179]
ds_write_b128 v14, v[96:99] offset:16384
v_mul_f32 v37, v133, v133
v_mfma_f32_16x16x32_bf16 v[180:183], v[48:51], a[100:103], v[180:183]
buffer_load_dwordx4 v10, s[8:11], s35 offen offset:2048 lds
v_mfma_f32_16x16x32_bf16 v[180:183], v[52:55], a[116:119], v[180:183]
v_rcp_f32 v35, v35
v_mfma_f32_16x16x32_bf16 v[184:187], v[48:51], a[104:107], v[184:187]
buffer_load_dwordx4 v11, s[8:11], s35 offen offset:3072 lds
v_mfma_f32_16x16x32_bf16 v[184:187], v[52:55], a[120:123], v[184:187]
s_add_u32 m0, s37, 32768
v_mul_f32 v119, v119, v35
v_cvt_pk_bf16_f32 v101, v118, v119
v_mfma_f32_16x16x32_bf16 v[188:191], v[48:51], a[108:111], v[188:191]
v_fma_f32 v36, v36, s47, v18
s_waitcnt vmcnt(17) lgkmcnt(0)
v_mfma_f32_16x16x32_bf16 v[188:191], v[52:55], a[124:127], v[188:191]
s_barrier
v_mfma_f32_16x16x32_bf16 v[192:195], v[56:59], a[96:99], v[192:195]
ds_read_b64_tr_b16 v[40:41], v2 offset:49152
v_fma_f32 v37, v37, s47, v18
v_mul_f32 v36, v36, v132
v_mfma_f32_16x16x32_bf16 v[192:195], v[60:63], a[112:115], v[192:195]
ds_read_b64_tr_b16 v[42:43], v2 offset:49664
v_mul_f32 v37, v37, v133
v_mfma_f32_16x16x32_bf16 v[196:199], v[56:59], a[100:103], v[196:199]
ds_read_b64_tr_b16 v[44:45], v2 offset:57344
v_mul_f32 v148, v148, v132
v_mfma_f32_16x16x32_bf16 v[196:199], v[60:63], a[116:119], v[196:199]
ds_read_b64_tr_b16 v[46:47], v2 offset:57856
v_exp_f32 v36, v36
v_mfma_f32_16x16x32_bf16 v[200:203], v[56:59], a[104:107], v[200:203]
ds_read_b64_tr_b16 v[48:49], v2 offset:51200
v_mul_f32 v149, v149, v133
v_mfma_f32_16x16x32_bf16 v[200:203], v[60:63], a[120:123], v[200:203]
ds_read_b64_tr_b16 v[50:51], v2 offset:51712
v_add_f32 v36, 1.0, v36
v_mfma_f32_16x16x32_bf16 v[204:207], v[56:59], a[108:111], v[204:207]
ds_read_b64_tr_b16 v[52:53], v2 offset:59392
v_exp_f32 v37, v37
v_mfma_f32_16x16x32_bf16 v[204:207], v[60:63], a[124:127], v[204:207]
ds_read_b64_tr_b16 v[54:55], v2 offset:59904
v_add_f32 v37, 1.0, v37
v_mfma_f32_16x16x32_bf16 v[208:211], v[64:67], a[96:99], v[208:211]
buffer_load_dwordx4 v10, s[4:7], s36 offen offset:0 lds
v_mfma_f32_16x16x32_bf16 v[208:211], v[68:71], a[112:115], v[208:211]
v_rcp_f32 v36, v36
v_mul_f32 v38, v134, v134
v_mfma_f32_16x16x32_bf16 v[212:215], v[64:67], a[100:103], v[212:215]
buffer_store_dwordx4 v[96:99], v16, s[20:23], s50 offen offset:0 sc1
v_mfma_f32_16x16x32_bf16 v[212:215], v[68:71], a[116:119], v[212:215]
v_rcp_f32 v37, v37
v_mfma_f32_16x16x32_bf16 v[216:219], v[64:67], a[104:107], v[216:219]
buffer_load_dwordx4 v11, s[4:7], s36 offen offset:1024 lds
v_mfma_f32_16x16x32_bf16 v[216:219], v[68:71], a[120:123], v[216:219]
v_mul_f32 v148, v148, v36
v_mul_f32 v149, v149, v37
v_mul_f32 v39, v135, v135
v_mfma_f32_16x16x32_bf16 v[220:223], v[64:67], a[108:111], v[220:223]
v_fma_f32 v38, v38, s47, v18
v_fma_f32 v39, v39, s47, v18
v_mfma_f32_16x16x32_bf16 v[220:223], v[68:71], a[124:127], v[220:223]
v_mul_f32 v38, v38, v134
s_waitcnt lgkmcnt(0)
v_mfma_f32_16x16x32_bf16 v[160:163], v[40:43], a[128:131], v[160:163]
ds_read_b64_tr_b16 v[56:57], v3 offset:49152
v_mul_f32 v39, v39, v135
v_mul_f32 v150, v150, v134
v_mfma_f32_16x16x32_bf16 v[160:163], v[44:47], a[144:147], v[160:163]
ds_read_b64_tr_b16 v[58:59], v3 offset:49664
v_mul_f32 v151, v151, v135
v_mfma_f32_16x16x32_bf16 v[164:167], v[40:43], a[132:135], v[164:167]
ds_read_b64_tr_b16 v[60:61], v3 offset:57344
v_cvt_pk_bf16_f32 v102, v148, v149
v_mfma_f32_16x16x32_bf16 v[164:167], v[44:47], a[148:151], v[164:167]
ds_read_b64_tr_b16 v[62:63], v3 offset:57856
v_exp_f32 v38, v38
v_mfma_f32_16x16x32_bf16 v[168:171], v[40:43], a[136:139], v[168:171]
ds_read_b64_tr_b16 v[64:65], v3 offset:51200
v_add_f32 v38, 1.0, v38
v_mfma_f32_16x16x32_bf16 v[168:171], v[44:47], a[152:155], v[168:171]
ds_read_b64_tr_b16 v[66:67], v3 offset:51712
v_mul_f32 v24, v104, v104
v_mfma_f32_16x16x32_bf16 v[172:175], v[40:43], a[140:143], v[172:175]
ds_read_b64_tr_b16 v[68:69], v3 offset:59392
v_exp_f32 v39, v39
v_mfma_f32_16x16x32_bf16 v[172:175], v[44:47], a[156:159], v[172:175]
ds_read_b64_tr_b16 v[70:71], v3 offset:59904
v_add_f32 v39, 1.0, v39
v_mfma_f32_16x16x32_bf16 v[176:179], v[48:51], a[128:131], v[176:179]
buffer_load_dwordx4 v10, s[8:11], s36 offen offset:2048 lds
v_mfma_f32_16x16x32_bf16 v[176:179], v[52:55], a[144:147], v[176:179]
v_rcp_f32 v38, v38
v_mul_f32 v25, v105, v105
v_mfma_f32_16x16x32_bf16 v[180:183], v[48:51], a[132:135], v[180:183]
v_rcp_f32 v39, v39
v_mfma_f32_16x16x32_bf16 v[180:183], v[52:55], a[148:151], v[180:183]
v_mul_f32 v150, v150, v38
v_mul_f32 v151, v151, v39
v_mfma_f32_16x16x32_bf16 v[184:187], v[48:51], a[136:139], v[184:187]
buffer_load_dwordx4 v11, s[8:11], s36 offen offset:3072 lds
v_mfma_f32_16x16x32_bf16 v[184:187], v[52:55], a[152:155], v[184:187]
v_add_u32 v10, 128, v10
v_add_u32 v11, 128, v11
v_mfma_f32_16x16x32_bf16 v[188:191], v[48:51], a[140:143], v[188:191]
s_add_u32 m0, s37, 49152
s_waitcnt vmcnt(16) lgkmcnt(0)
v_mfma_f32_16x16x32_bf16 v[188:191], v[52:55], a[156:159], v[188:191]
s_barrier
v_mfma_f32_16x16x32_bf16 v[192:195], v[56:59], a[128:131], v[192:195]
ds_read_b64_tr_b16 v[40:41], v4 offset:0
v_cvt_pk_bf16_f32 v103, v150, v151
v_fma_f32 v24, v24, s47, v18
v_fma_f32 v25, v25, s47, v18
v_mfma_f32_16x16x32_bf16 v[192:195], v[60:63], a[144:147], v[192:195]
ds_read_b64_tr_b16 v[42:43], v4 offset:512
v_mul_f32 v24, v24, v104
v_mfma_f32_16x16x32_bf16 v[196:199], v[56:59], a[132:135], v[196:199]
ds_read_b64_tr_b16 v[44:45], v4 offset:8192
v_mul_f32 v25, v25, v105
v_mfma_f32_16x16x32_bf16 v[196:199], v[60:63], a[148:151], v[196:199]
ds_read_b64_tr_b16 v[46:47], v4 offset:8704
v_exp_f32 v24, v24
v_mfma_f32_16x16x32_bf16 v[200:203], v[56:59], a[136:139], v[200:203]
ds_read_b64_tr_b16 v[48:49], v4 offset:2048
v_mul_f32 v120, v120, v104
v_mfma_f32_16x16x32_bf16 v[200:203], v[60:63], a[152:155], v[200:203]
ds_read_b64_tr_b16 v[50:51], v4 offset:2560
v_mul_f32 v121, v121, v105
v_mfma_f32_16x16x32_bf16 v[204:207], v[56:59], a[140:143], v[204:207]
ds_read_b64_tr_b16 v[52:53], v4 offset:10240
v_exp_f32 v25, v25
v_mfma_f32_16x16x32_bf16 v[204:207], v[60:63], a[156:159], v[204:207]
ds_read_b64_tr_b16 v[54:55], v4 offset:10752
v_add_f32 v24, 1.0, v24
v_mfma_f32_16x16x32_bf16 v[208:211], v[64:67], a[128:131], v[208:211]
buffer_load_dwordx4 v10, s[4:7], s28 offen offset:0 lds
v_mfma_f32_16x16x32_bf16 v[208:211], v[68:71], a[144:147], v[208:211]
ds_write_b128 v14, v[100:103] offset:17408
v_add_f32 v25, 1.0, v25
v_mfma_f32_16x16x32_bf16 v[212:215], v[64:67], a[132:135], v[212:215]
buffer_store_dwordx4 v[100:103], v16, s[20:23], s50 offen offset:1024 sc1
v_mfma_f32_16x16x32_bf16 v[212:215], v[68:71], a[148:151], v[212:215]
v_rcp_f32 v24, v24
v_mfma_f32_16x16x32_bf16 v[216:219], v[64:67], a[136:139], v[216:219]
buffer_load_dwordx4 v11, s[4:7], s28 offen offset:1024 lds
v_mfma_f32_16x16x32_bf16 v[216:219], v[68:71], a[152:155], v[216:219]
v_rcp_f32 v25, v25
v_mul_f32 v120, v120, v24
v_mfma_f32_16x16x32_bf16 v[220:223], v[64:67], a[140:143], v[220:223]
v_mul_f32 v121, v121, v25
v_mul_f32 v26, v106, v106
v_mfma_f32_16x16x32_bf16 v[220:223], v[68:71], a[156:159], v[220:223]
v_mul_f32 v27, v107, v107
s_waitcnt lgkmcnt(0)
v_mfma_f32_16x16x32_bf16 v[160:163], v[40:43], a[160:163], v[160:163]
ds_read_b64_tr_b16 v[56:57], v5 offset:0
v_fma_f32 v26, v26, s47, v18
v_fma_f32 v27, v27, s47, v18
v_mfma_f32_16x16x32_bf16 v[160:163], v[44:47], a[176:179], v[160:163]
ds_read_b64_tr_b16 v[58:59], v5 offset:512
v_mul_f32 v26, v26, v106
v_mfma_f32_16x16x32_bf16 v[164:167], v[40:43], a[164:167], v[164:167]
ds_read_b64_tr_b16 v[60:61], v5 offset:8192
v_mul_f32 v27, v27, v107
v_mfma_f32_16x16x32_bf16 v[164:167], v[44:47], a[180:183], v[164:167]
ds_read_b64_tr_b16 v[62:63], v5 offset:8704
v_exp_f32 v26, v26
v_mfma_f32_16x16x32_bf16 v[168:171], v[40:43], a[168:171], v[168:171]
ds_read_b64_tr_b16 v[64:65], v5 offset:2048
v_mul_f32 v122, v122, v106
v_mfma_f32_16x16x32_bf16 v[168:171], v[44:47], a[184:187], v[168:171]
ds_read_b64_tr_b16 v[66:67], v5 offset:2560
v_mul_f32 v123, v123, v107
v_mfma_f32_16x16x32_bf16 v[172:175], v[40:43], a[172:175], v[172:175]
ds_read_b64_tr_b16 v[68:69], v5 offset:10240
v_exp_f32 v27, v27
v_mfma_f32_16x16x32_bf16 v[172:175], v[44:47], a[188:191], v[172:175]
ds_read_b64_tr_b16 v[70:71], v5 offset:10752
v_add_f32 v26, 1.0, v26
v_mfma_f32_16x16x32_bf16 v[176:179], v[48:51], a[160:163], v[176:179]
buffer_load_dwordx4 v10, s[8:11], s28 offen offset:2048 lds
v_mfma_f32_16x16x32_bf16 v[176:179], v[52:55], a[176:179], v[176:179]
v_add_f32 v27, 1.0, v27
v_cvt_pk_bf16_f32 v104, v120, v121
v_mfma_f32_16x16x32_bf16 v[180:183], v[48:51], a[164:167], v[180:183]
v_rcp_f32 v26, v26
v_mul_f32 v28, v136, v136
v_mfma_f32_16x16x32_bf16 v[180:183], v[52:55], a[180:183], v[180:183]
v_rcp_f32 v27, v27
v_mfma_f32_16x16x32_bf16 v[184:187], v[48:51], a[168:171], v[184:187]
buffer_load_dwordx4 v11, s[8:11], s28 offen offset:3072 lds
v_mfma_f32_16x16x32_bf16 v[184:187], v[52:55], a[184:187], v[184:187]
s_add_u32 m0, s37, 65536
v_mul_f32 v122, v122, v26
v_mul_f32 v123, v123, v27
v_mfma_f32_16x16x32_bf16 v[188:191], v[48:51], a[172:175], v[188:191]
v_cvt_pk_bf16_f32 v105, v122, v123
s_waitcnt vmcnt(15) lgkmcnt(0)
v_mfma_f32_16x16x32_bf16 v[188:191], v[52:55], a[188:191], v[188:191]
s_barrier
v_mfma_f32_16x16x32_bf16 v[192:195], v[56:59], a[160:163], v[192:195]
ds_read_b64_tr_b16 v[40:41], v2 offset:0
v_mul_f32 v29, v137, v137
v_fma_f32 v28, v28, s47, v18
v_mfma_f32_16x16x32_bf16 v[192:195], v[60:63], a[176:179], v[192:195]
ds_read_b64_tr_b16 v[42:43], v2 offset:512
v_fma_f32 v29, v29, s47, v18
v_mfma_f32_16x16x32_bf16 v[196:199], v[56:59], a[164:167], v[196:199]
ds_read_b64_tr_b16 v[44:45], v2 offset:8192
v_mul_f32 v28, v28, v136
v_mfma_f32_16x16x32_bf16 v[196:199], v[60:63], a[180:183], v[196:199]
ds_read_b64_tr_b16 v[46:47], v2 offset:8704
v_mul_f32 v29, v29, v137
v_mfma_f32_16x16x32_bf16 v[200:203], v[56:59], a[168:171], v[200:203]
ds_read_b64_tr_b16 v[48:49], v2 offset:2048
v_exp_f32 v28, v28
v_mfma_f32_16x16x32_bf16 v[200:203], v[60:63], a[184:187], v[200:203]
ds_read_b64_tr_b16 v[50:51], v2 offset:2560
v_mul_f32 v152, v152, v136
v_mfma_f32_16x16x32_bf16 v[204:207], v[56:59], a[172:175], v[204:207]
ds_read_b64_tr_b16 v[52:53], v2 offset:10240
v_mul_f32 v153, v153, v137
v_mfma_f32_16x16x32_bf16 v[204:207], v[60:63], a[188:191], v[204:207]
ds_read_b64_tr_b16 v[54:55], v2 offset:10752
v_exp_f32 v29, v29
v_mfma_f32_16x16x32_bf16 v[208:211], v[64:67], a[160:163], v[208:211]
buffer_load_dwordx4 v10, s[4:7], s29 offen offset:0 lds
v_mfma_f32_16x16x32_bf16 v[208:211], v[68:71], a[176:179], v[208:211]
v_add_f32 v28, 1.0, v28
v_add_f32 v29, 1.0, v29
v_mfma_f32_16x16x32_bf16 v[212:215], v[64:67], a[164:167], v[212:215]
v_rcp_f32 v28, v28
v_mul_f32 v30, v138, v138
v_mfma_f32_16x16x32_bf16 v[212:215], v[68:71], a[180:183], v[212:215]
v_rcp_f32 v29, v29
v_mfma_f32_16x16x32_bf16 v[216:219], v[64:67], a[168:171], v[216:219]
buffer_load_dwordx4 v11, s[4:7], s29 offen offset:1024 lds
v_mfma_f32_16x16x32_bf16 v[216:219], v[68:71], a[184:187], v[216:219]
v_mul_f32 v152, v152, v28
v_mul_f32 v153, v153, v29
v_mfma_f32_16x16x32_bf16 v[220:223], v[64:67], a[172:175], v[220:223]
v_mul_f32 v31, v139, v139
v_fma_f32 v30, v30, s47, v18
v_fma_f32 v31, v31, s47, v18
v_mfma_f32_16x16x32_bf16 v[220:223], v[68:71], a[188:191], v[220:223]
v_mul_f32 v30, v30, v138
s_waitcnt lgkmcnt(0)
v_mfma_f32_16x16x32_bf16 v[160:163], v[40:43], a[192:195], v[160:163]
ds_read_b64_tr_b16 v[56:57], v3 offset:0
v_mul_f32 v31, v31, v139
v_mfma_f32_16x16x32_bf16 v[160:163], v[44:47], a[208:211], v[160:163]
ds_read_b64_tr_b16 v[58:59], v3 offset:512
v_exp_f32 v30, v30
v_mfma_f32_16x16x32_bf16 v[164:167], v[40:43], a[196:199], v[164:167]
ds_read_b64_tr_b16 v[60:61], v3 offset:8192
v_mul_f32 v154, v154, v138
v_mfma_f32_16x16x32_bf16 v[164:167], v[44:47], a[212:215], v[164:167]
ds_read_b64_tr_b16 v[62:63], v3 offset:8704
v_mul_f32 v155, v155, v139
v_mfma_f32_16x16x32_bf16 v[168:171], v[40:43], a[200:203], v[168:171]
ds_read_b64_tr_b16 v[64:65], v3 offset:2048
v_exp_f32 v31, v31
v_mfma_f32_16x16x32_bf16 v[168:171], v[44:47], a[216:219], v[168:171]
ds_read_b64_tr_b16 v[66:67], v3 offset:2560
v_add_f32 v30, 1.0, v30
v_mfma_f32_16x16x32_bf16 v[172:175], v[40:43], a[204:207], v[172:175]
ds_read_b64_tr_b16 v[68:69], v3 offset:10240
v_add_f32 v31, 1.0, v31
v_mfma_f32_16x16x32_bf16 v[172:175], v[44:47], a[220:223], v[172:175]
ds_read_b64_tr_b16 v[70:71], v3 offset:10752
v_cvt_pk_bf16_f32 v106, v152, v153
v_mfma_f32_16x16x32_bf16 v[176:179], v[48:51], a[192:195], v[176:179]
buffer_load_dwordx4 v10, s[8:11], s29 offen offset:2048 lds
v_mfma_f32_16x16x32_bf16 v[176:179], v[52:55], a[208:211], v[176:179]
v_rcp_f32 v30, v30
v_mul_f32 v32, v108, v108
v_mfma_f32_16x16x32_bf16 v[180:183], v[48:51], a[196:199], v[180:183]
v_rcp_f32 v31, v31
v_mfma_f32_16x16x32_bf16 v[180:183], v[52:55], a[212:215], v[180:183]
v_mul_f32 v154, v154, v30
v_mul_f32 v155, v155, v31
v_cvt_pk_bf16_f32 v107, v154, v155
v_mfma_f32_16x16x32_bf16 v[184:187], v[48:51], a[200:203], v[184:187]
buffer_load_dwordx4 v11, s[8:11], s29 offen offset:3072 lds
v_mfma_f32_16x16x32_bf16 v[184:187], v[52:55], a[216:219], v[184:187]
s_add_u32 m0, s37, 0
v_mul_f32 v33, v109, v109
v_mfma_f32_16x16x32_bf16 v[188:191], v[48:51], a[204:207], v[188:191]
v_fma_f32 v32, v32, s47, v18
s_waitcnt vmcnt(14) lgkmcnt(0)
v_mfma_f32_16x16x32_bf16 v[188:191], v[52:55], a[220:223], v[188:191]
s_barrier
v_mfma_f32_16x16x32_bf16 v[192:195], v[56:59], a[192:195], v[192:195]
ds_read_b64_tr_b16 v[40:41], v2 offset:16384
s_lshl2_add_u32 s58, s39, s38
v_mfma_f32_16x16x32_bf16 v[192:195], v[60:63], a[208:211], v[192:195]
ds_read_b64_tr_b16 v[42:43], v2 offset:16896
s_mul_i32 s58, s58, 82944
v_mfma_f32_16x16x32_bf16 v[196:199], v[56:59], a[196:199], v[196:199]
ds_read_b64_tr_b16 v[44:45], v2 offset:24576
v_mul_u32_u24 v74, 256, v1
v_mfma_f32_16x16x32_bf16 v[196:199], v[60:63], a[212:215], v[196:199]
ds_read_b64_tr_b16 v[46:47], v2 offset:25088
v_lshrrev_b32 v74, 8, v74
v_mfma_f32_16x16x32_bf16 v[200:203], v[56:59], a[200:203], v[200:203]
ds_read_b64_tr_b16 v[48:49], v2 offset:18432
v_mul_u32_u24 v74, 9088, v74
v_mfma_f32_16x16x32_bf16 v[200:203], v[60:63], a[216:219], v[200:203]
ds_read_b64_tr_b16 v[50:51], v2 offset:18944
v_lshl_add_u32 v74, v1, 7, v74
v_mfma_f32_16x16x32_bf16 v[204:207], v[56:59], a[204:207], v[204:207]
ds_read_b64_tr_b16 v[52:53], v2 offset:26624
v_add_u32 v75, 55, v1
v_mfma_f32_16x16x32_bf16 v[204:207], v[60:63], a[220:223], v[204:207]
ds_read_b64_tr_b16 v[54:55], v2 offset:27136
v_and_b32 v75, 64, v75
v_mfma_f32_16x16x32_bf16 v[208:211], v[64:67], a[192:195], v[208:211]
buffer_load_dwordx4 v10, s[4:7], s30 offen offset:0 lds
v_mfma_f32_16x16x32_bf16 v[208:211], v[68:71], a[208:211], v[208:211]
v_lshl_add_u32 v74, v75, 22, v74
v_add_u32 v74, s58, v74
v_mfma_f32_16x16x32_bf16 v[212:215], v[64:67], a[196:199], v[212:215]
buffer_store_dwordx4 v[104:107], v16, s[20:23], s50 offen offset:2048 sc1
v_mfma_f32_16x16x32_bf16 v[212:215], v[68:71], a[212:215], v[212:215]
ds_write_b128 v14, v[104:107] offset:18432
v_fma_f32 v33, v33, s47, v18
v_mul_f32 v32, v32, v108
v_mul_f32 v33, v33, v109
v_exp_f32 v32, v32
v_mfma_f32_16x16x32_bf16 v[216:219], v[64:67], a[200:203], v[216:219]
buffer_load_dwordx4 v11, s[4:7], s30 offen offset:1024 lds
v_mfma_f32_16x16x32_bf16 v[216:219], v[68:71], a[216:219], v[216:219]
v_exp_f32 v33, v33
v_mfma_f32_16x16x32_bf16 v[220:223], v[64:67], a[204:207], v[220:223]
v_mul_f32 v124, v124, v108
v_mul_f32 v125, v125, v109
v_mfma_f32_16x16x32_bf16 v[220:223], v[68:71], a[220:223], v[220:223]
v_add_f32 v32, 1.0, v32
v_add_f32 v33, 1.0, v33
s_waitcnt lgkmcnt(0)
v_mfma_f32_16x16x32_bf16 v[160:163], v[40:43], a[224:227], v[160:163]
ds_read_b64_tr_b16 v[56:57], v3 offset:16384
v_mul_f32 v34, v110, v110
v_mfma_f32_16x16x32_bf16 v[160:163], v[44:47], a[240:243], v[160:163]
ds_read_b64_tr_b16 v[58:59], v3 offset:16896
v_mul_f32 v35, v111, v111
v_mfma_f32_16x16x32_bf16 v[164:167], v[40:43], a[228:231], v[164:167]
ds_read_b64_tr_b16 v[60:61], v3 offset:24576
v_rcp_f32 v32, v32
v_mfma_f32_16x16x32_bf16 v[164:167], v[44:47], a[244:247], v[164:167]
ds_read_b64_tr_b16 v[62:63], v3 offset:25088
v_mul_f32 v124, v124, v32
v_mfma_f32_16x16x32_bf16 v[168:171], v[40:43], a[232:235], v[168:171]
ds_read_b64_tr_b16 v[64:65], v3 offset:18432
v_fma_f32 v34, v34, s47, v18
v_mfma_f32_16x16x32_bf16 v[168:171], v[44:47], a[248:251], v[168:171]
ds_read_b64_tr_b16 v[66:67], v3 offset:18944
v_fma_f32 v35, v35, s47, v18
v_mfma_f32_16x16x32_bf16 v[172:175], v[40:43], a[236:239], v[172:175]
ds_read_b64_tr_b16 v[68:69], v3 offset:26624
v_rcp_f32 v33, v33
v_mfma_f32_16x16x32_bf16 v[172:175], v[44:47], a[252:255], v[172:175]
ds_read_b64_tr_b16 v[70:71], v3 offset:27136
v_mul_f32 v125, v125, v33
v_mfma_f32_16x16x32_bf16 v[176:179], v[48:51], a[224:227], v[176:179]
buffer_load_dwordx4 v10, s[8:11], s30 offen offset:2048 lds
v_mfma_f32_16x16x32_bf16 v[176:179], v[52:55], a[240:243], v[176:179]
v_mul_f32 v34, v34, v110
v_mul_f32 v35, v35, v111
v_mul_f32 v126, v126, v110
v_mfma_f32_16x16x32_bf16 v[180:183], v[48:51], a[228:231], v[180:183]
v_exp_f32 v34, v34
v_mfma_f32_16x16x32_bf16 v[180:183], v[52:55], a[244:247], v[180:183]
v_exp_f32 v35, v35
v_mfma_f32_16x16x32_bf16 v[184:187], v[48:51], a[232:235], v[184:187]
buffer_load_dwordx4 v11, s[8:11], s30 offen offset:3072 lds
v_mfma_f32_16x16x32_bf16 v[184:187], v[52:55], a[248:251], v[184:187]
buffer_load_dword v77, v74, s[4:7], 0 offen offset:384
v_mfma_f32_16x16x32_bf16 v[188:191], v[48:51], a[236:239], v[188:191]
v_mul_f32 v127, v127, v111
v_add_f32 v34, 1.0, v34
s_waitcnt vmcnt(15) lgkmcnt(0)
v_mfma_f32_16x16x32_bf16 v[188:191], v[52:55], a[252:255], v[188:191]
s_barrier
v_mfma_f32_16x16x32_bf16 v[192:195], v[56:59], a[224:227], v[192:195]
ds_read_b64_tr_b16 v[40:41], v2 offset:32768
ds_read_b128 v[96:99], v89 offset:3072
v_add_f32 v35, 1.0, v35
v_mfma_f32_16x16x32_bf16 v[192:195], v[60:63], a[240:243], v[192:195]
ds_read_b64_tr_b16 v[42:43], v2 offset:33280
ds_read_b128 v[100:103], v89 offset:3088
v_cvt_pk_bf16_f32 v108, v124, v125
v_mfma_f32_16x16x32_bf16 v[196:199], v[56:59], a[228:231], v[196:199]
ds_read_b64_tr_b16 v[44:45], v2 offset:40960
ds_read_b128 v[104:107], v89 offset:3104
v_mfma_f32_16x16x32_bf16 v[196:199], v[60:63], a[244:247], v[196:199]
ds_read_b64_tr_b16 v[46:47], v2 offset:41472
ds_read2_b32 v[112:113], v87 offset0:0 offset1:1
v_mul_f32 v36, v140, v140
v_mfma_f32_16x16x32_bf16 v[200:203], v[56:59], a[232:235], v[200:203]
ds_read_b64_tr_b16 v[48:49], v2 offset:34816
ds_read2_b32 v[114:115], v87 offset0:36 offset1:37
v_mul_f32 v37, v141, v141
v_mfma_f32_16x16x32_bf16 v[200:203], v[60:63], a[248:251], v[200:203]
ds_read_b64_tr_b16 v[50:51], v2 offset:35328
ds_read2_b32 v[116:117], v87 offset0:72 offset1:73
v_mfma_f32_16x16x32_bf16 v[204:207], v[56:59], a[236:239], v[204:207]
ds_read_b64_tr_b16 v[52:53], v2 offset:43008
ds_read2_b32 v[118:119], v87 offset0:108 offset1:109
v_fma_f32 v36, v36, s47, v18
v_mfma_f32_16x16x32_bf16 v[204:207], v[60:63], a[252:255], v[204:207]
ds_read_b64_tr_b16 v[54:55], v2 offset:43520
ds_read2_b32 v[120:121], v87 offset0:144 offset1:145
v_fma_f32 v37, v37, s47, v18
v_mfma_f32_16x16x32_bf16 v[208:211], v[64:67], a[224:227], v[208:211]
buffer_load_dword v77, v74, s[8:11], 0 offen offset:2432
v_mfma_f32_16x16x32_bf16 v[208:211], v[68:71], a[240:243], v[208:211]
s_add_u32 m0, s37, 16384
v_rcp_f32 v34, v34
v_mfma_f32_16x16x32_bf16 v[212:215], v[64:67], a[228:231], v[212:215]
buffer_load_dwordx4 v10, s[4:7], s31 offen offset:0 lds
v_mfma_f32_16x16x32_bf16 v[212:215], v[68:71], a[244:247], v[212:215]
ds_read2_b32 v[122:123], v87 offset0:180 offset1:181
ds_read2_b32 v[128:129], v87 offset0:216 offset1:217
v_rcp_f32 v35, v35
v_mfma_f32_16x16x32_bf16 v[216:219], v[64:67], a[232:235], v[216:219]
buffer_load_dwordx4 v11, s[4:7], s31 offen offset:1024 lds
v_mfma_f32_16x16x32_bf16 v[216:219], v[68:71], a[248:251], v[216:219]
v_mul_f32 v126, v126, v34
v_mul_f32 v127, v127, v35
v_cvt_pk_bf16_f32 v109, v126, v127
v_mfma_f32_16x16x32_bf16 v[220:223], v[64:67], a[236:239], v[220:223]
v_mul_f32 v36, v36, v140
v_mul_f32 v37, v37, v141
v_mul_f32 v156, v156, v140
v_mfma_f32_16x16x32_bf16 v[220:223], v[68:71], a[252:255], v[220:223]
v_exp_f32 v36, v36
s_waitcnt lgkmcnt(0)
v_mfma_f32_16x16x32_bf16 v[160:163], v[40:43], v[224:227], v[160:163]
ds_read_b64_tr_b16 v[56:57], v3 offset:32768
s_mov_b32 s52, s88
v_mfma_f32_16x16x32_bf16 v[160:163], v[44:47], v[240:243], v[160:163]
ds_read_b64_tr_b16 v[58:59], v3 offset:33280
s_mov_b32 s53, s89
v_mfma_f32_16x16x32_bf16 v[164:167], v[40:43], v[228:231], v[164:167]
ds_read_b64_tr_b16 v[60:61], v3 offset:40960
ds_read2_b32 v[146:147], v88 offset0:0 offset1:1
v_exp_f32 v37, v37
v_mfma_f32_16x16x32_bf16 v[164:167], v[44:47], v[244:247], v[164:167]
ds_read_b64_tr_b16 v[62:63], v3 offset:41472
ds_read2_b32 v[148:149], v88 offset0:36 offset1:37
v_mfma_f32_16x16x32_bf16 v[168:171], v[40:43], v[232:235], v[168:171]
ds_read_b64_tr_b16 v[64:65], v3 offset:34816
ds_read2_b32 v[150:151], v88 offset0:72 offset1:73
v_mul_f32 v157, v157, v141
v_mfma_f32_16x16x32_bf16 v[168:171], v[44:47], v[248:251], v[168:171]
ds_read_b64_tr_b16 v[66:67], v3 offset:35328
ds_read2_b32 v[152:153], v88 offset0:108 offset1:109
v_add_f32 v36, 1.0, v36
v_mfma_f32_16x16x32_bf16 v[172:175], v[40:43], v[236:239], v[172:175]
ds_read_b64_tr_b16 v[68:69], v3 offset:43008
ds_read2_b32 v[130:131], v87 offset0:2 offset1:38
v_mfma_f32_16x16x32_bf16 v[172:175], v[44:47], v[252:255], v[172:175]
ds_read_b64_tr_b16 v[70:71], v3 offset:43520
ds_read2_b32 v[132:133], v87 offset0:74 offset1:110
v_add_f32 v37, 1.0, v37
v_mfma_f32_16x16x32_bf16 v[176:179], v[48:51], v[224:227], v[176:179]
buffer_load_dwordx4 v10, s[8:11], s31 offen offset:2048 lds
v_mfma_f32_16x16x32_bf16 v[176:179], v[52:55], v[240:243], v[176:179]
ds_read2_b32 v[134:135], v87 offset0:146 offset1:182
ds_read2_b32 v[136:137], v87 offset0:218 offset1:254
v_rcp_f32 v36, v36
v_mfma_f32_16x16x32_bf16 v[180:183], v[48:51], v[228:231], v[180:183]
buffer_load_dwordx4 v11, s[8:11], s31 offen offset:3072 lds
v_mfma_f32_16x16x32_bf16 v[180:183], v[52:55], v[244:247], v[180:183]
s_add_u32 m0, s37, 32768
v_rcp_f32 v37, v37
v_mfma_f32_16x16x32_bf16 v[184:187], v[48:51], v[232:235], v[184:187]
ds_read2_b32 v[138:139], v88 offset0:2 offset1:38
ds_read2_b32 v[144:145], v88 offset0:74 offset1:110
v_mul_f32 v156, v156, v36
v_mfma_f32_16x16x32_bf16 v[184:187], v[52:55], v[248:251], v[184:187]
v_mul_f32 v157, v157, v37
v_mul_f32 v38, v142, v142
v_mfma_f32_16x16x32_bf16 v[188:191], v[48:51], v[236:239], v[188:191]
v_mul_f32 v39, v143, v143
v_fma_f32 v38, v38, s47, v18
s_waitcnt vmcnt(15) lgkmcnt(0)
v_mfma_f32_16x16x32_bf16 v[188:191], v[52:55], v[252:255], v[188:191]
s_barrier
v_mfma_f32_16x16x32_bf16 v[192:195], v[56:59], v[224:227], v[192:195]
ds_read_b64_tr_b16 v[40:41], v2 offset:49152
v_fma_f32 v39, v39, s47, v18
v_mul_f32 v38, v38, v142
v_mfma_f32_16x16x32_bf16 v[192:195], v[60:63], v[240:243], v[192:195]
ds_read_b64_tr_b16 v[42:43], v2 offset:49664
v_mul_f32 v39, v39, v143
v_mul_f32 v158, v158, v142
v_mfma_f32_16x16x32_bf16 v[196:199], v[56:59], v[228:231], v[196:199]
ds_read_b64_tr_b16 v[44:45], v2 offset:57344
v_exp_f32 v38, v38
v_mfma_f32_16x16x32_bf16 v[196:199], v[60:63], v[244:247], v[196:199]
ds_read_b64_tr_b16 v[46:47], v2 offset:57856
v_mul_f32 v159, v159, v143
v_mfma_f32_16x16x32_bf16 v[200:203], v[56:59], v[232:235], v[200:203]
ds_read_b64_tr_b16 v[48:49], v2 offset:51200
v_exp_f32 v39, v39
v_mfma_f32_16x16x32_bf16 v[200:203], v[60:63], v[248:251], v[200:203]
ds_read_b64_tr_b16 v[50:51], v2 offset:51712
v_add_f32 v38, 1.0, v38
v_add_f32 v39, 1.0, v39
v_mfma_f32_16x16x32_bf16 v[204:207], v[56:59], v[236:239], v[204:207]
ds_read_b64_tr_b16 v[52:53], v2 offset:59392
v_cvt_pk_bf16_f32 v110, v156, v157
v_mfma_f32_16x16x32_bf16 v[204:207], v[60:63], v[252:255], v[204:207]
ds_read_b64_tr_b16 v[54:55], v2 offset:59904
v_rcp_f32 v38, v38
v_mfma_f32_16x16x32_bf16 v[208:211], v[64:67], v[224:227], v[208:211]
buffer_load_dwordx4 v10, s[4:7], s32 offen offset:0 lds
v_mfma_f32_16x16x32_bf16 v[208:211], v[68:71], v[240:243], v[208:211]
v_rcp_f32 v39, v39
v_mul_f32 v158, v158, v38
v_mfma_f32_16x16x32_bf16 v[212:215], v[64:67], v[228:231], v[212:215]
v_mul_f32 v159, v159, v39
v_cvt_pk_bf16_f32 v111, v158, v159
v_mfma_f32_16x16x32_bf16 v[212:215], v[68:71], v[244:247], v[212:215]
ds_write_b128 v14, v[108:111] offset:19456
v_mfma_f32_16x16x32_bf16 v[216:219], v[64:67], v[232:235], v[216:219]
buffer_load_dwordx4 v11, s[4:7], s32 offen offset:1024 lds
buffer_store_dwordx4 v[108:111], v16, s[20:23], s50 offen offset:3072 sc1
v_mfma_f32_16x16x32_bf16 v[216:219], v[68:71], v[248:251], v[216:219]
v_mfma_f32_16x16x32_bf16 v[220:223], v[64:67], v[236:239], v[220:223]
v_mfma_f32_16x16x32_bf16 v[220:223], v[68:71], v[252:255], v[220:223]
s_waitcnt lgkmcnt(0)
s_mov_b32 s41, 0x05040100
s_mov_b32 s42, 0x07060302
v_perm_b32 v24, v112, v114, s41
v_perm_b32 v25, v114, v116, s41
v_perm_b32 v26, v116, v118, s41
v_perm_b32 v27, v118, v120, s41
v_perm_b32 v28, v120, v122, s41
v_perm_b32 v29, v122, v128, s41
v_dot2_f32_bf16 v108, v26, v96, 0
v_dot2_f32_bf16 v109, v27, v96, 0
v_dot2_f32_bf16 v110, v28, v96, 0
v_dot2_f32_bf16 v111, v29, v96, 0
v_lshlrev_b32 v32, 16, v146
v_lshlrev_b32 v33, 16, v148
v_lshlrev_b32 v34, 16, v150
v_lshlrev_b32 v35, 16, v152
v_dot2_f32_bf16 v108, v24, v97, v108
v_dot2_f32_bf16 v109, v25, v97, v109
v_dot2_f32_bf16 v110, v26, v97, v110
v_dot2_f32_bf16 v111, v27, v97, v111
s_mov_b32 s50, 67113088
s_nop 1
v_pk_mul_f32 v[108:109], v[108:109], v[32:33]
v_pk_mul_f32 v[110:111], v[110:111], v[34:35]
v_cvt_pk_bf16_f32 v108, v108, v109
v_cvt_pk_bf16_f32 v109, v110, v111
buffer_store_dwordx2 v[108:109], v90, s[20:23], s50 offen sc1
v_perm_b32 v24, v112, v114, s42
v_perm_b32 v25, v114, v116, s42
v_perm_b32 v26, v116, v118, s42
v_perm_b32 v27, v118, v120, s42
v_perm_b32 v28, v120, v122, s42
v_perm_b32 v29, v122, v128, s42
v_dot2_f32_bf16 v124, v26, v98, 0
v_dot2_f32_bf16 v125, v27, v98, 0
v_dot2_f32_bf16 v126, v28, v98, 0
v_dot2_f32_bf16 v127, v29, v98, 0
v_and_b32 v32, 0xffff0000, v146
v_and_b32 v33, 0xffff0000, v148
v_and_b32 v34, 0xffff0000, v150
v_and_b32 v35, 0xffff0000, v152
v_dot2_f32_bf16 v124, v24, v99, v124
v_dot2_f32_bf16 v125, v25, v99, v125
v_dot2_f32_bf16 v126, v26, v99, v126
v_dot2_f32_bf16 v127, v27, v99, v127
s_mov_b32 s50, 67117312
s_nop 1
v_pk_mul_f32 v[124:125], v[124:125], v[32:33]
v_pk_mul_f32 v[126:127], v[126:127], v[34:35]
v_cvt_pk_bf16_f32 v124, v124, v125
v_cvt_pk_bf16_f32 v125, v126, v127
buffer_store_dwordx2 v[124:125], v90, s[20:23], s50 offen sc1
v_perm_b32 v24, v113, v115, s41
v_perm_b32 v25, v115, v117, s41
v_perm_b32 v26, v117, v119, s41
v_perm_b32 v27, v119, v121, s41
v_perm_b32 v28, v121, v123, s41
v_perm_b32 v29, v123, v129, s41
v_dot2_f32_bf16 v140, v26, v100, 0
v_dot2_f32_bf16 v141, v27, v100, 0
v_dot2_f32_bf16 v142, v28, v100, 0
v_dot2_f32_bf16 v143, v29, v100, 0
v_lshlrev_b32 v32, 16, v147
v_lshlrev_b32 v33, 16, v149
v_lshlrev_b32 v34, 16, v151
v_lshlrev_b32 v35, 16, v153
v_dot2_f32_bf16 v140, v24, v101, v140
v_dot2_f32_bf16 v141, v25, v101, v141
v_dot2_f32_bf16 v142, v26, v101, v142
v_dot2_f32_bf16 v143, v27, v101, v143
s_mov_b32 s50, 67121536
s_nop 1
v_pk_mul_f32 v[140:141], v[140:141], v[32:33]
v_pk_mul_f32 v[142:143], v[142:143], v[34:35]
v_cvt_pk_bf16_f32 v140, v140, v141
v_cvt_pk_bf16_f32 v141, v142, v143
buffer_store_dwordx2 v[140:141], v90, s[20:23], s50 offen sc1
v_perm_b32 v24, v113, v115, s42
v_perm_b32 v25, v115, v117, s42
v_perm_b32 v26, v117, v119, s42
v_perm_b32 v27, v119, v121, s42
v_perm_b32 v28, v121, v123, s42
v_perm_b32 v29, v123, v129, s42
v_dot2_f32_bf16 v156, v26, v102, 0
v_dot2_f32_bf16 v157, v27, v102, 0
v_dot2_f32_bf16 v158, v28, v102, 0
v_dot2_f32_bf16 v159, v29, v102, 0
v_and_b32 v32, 0xffff0000, v147
v_and_b32 v33, 0xffff0000, v149
v_and_b32 v34, 0xffff0000, v151
v_and_b32 v35, 0xffff0000, v153
v_dot2_f32_bf16 v156, v24, v103, v156
v_dot2_f32_bf16 v157, v25, v103, v157
v_dot2_f32_bf16 v158, v26, v103, v158
v_dot2_f32_bf16 v159, v27, v103, v159
s_mov_b32 s50, 67125760
s_nop 1
v_pk_mul_f32 v[156:157], v[156:157], v[32:33]
v_pk_mul_f32 v[158:159], v[158:159], v[34:35]
v_cvt_pk_bf16_f32 v156, v156, v157
v_cvt_pk_bf16_f32 v157, v158, v159
buffer_store_dwordx2 v[156:157], v90, s[20:23], s50 offen sc1
v_perm_b32 v24, v130, v131, s41
v_perm_b32 v25, v131, v132, s41
v_perm_b32 v26, v132, v133, s41
v_perm_b32 v27, v133, v134, s41
v_perm_b32 v28, v134, v135, s41
v_perm_b32 v29, v135, v136, s41
v_dot2_f32_bf16 v108, v26, v104, 0
v_dot2_f32_bf16 v109, v27, v104, 0
v_dot2_f32_bf16 v110, v28, v104, 0
v_dot2_f32_bf16 v111, v29, v104, 0
v_lshlrev_b32 v32, 16, v138
v_lshlrev_b32 v33, 16, v139
v_lshlrev_b32 v34, 16, v144
v_lshlrev_b32 v35, 16, v145
v_dot2_f32_bf16 v108, v24, v105, v108
v_dot2_f32_bf16 v109, v25, v105, v109
v_dot2_f32_bf16 v110, v26, v105, v110
v_dot2_f32_bf16 v111, v27, v105, v111
s_mov_b32 s50, 67129984
s_nop 1
v_pk_mul_f32 v[108:109], v[108:109], v[32:33]
v_pk_mul_f32 v[110:111], v[110:111], v[34:35]
v_cvt_pk_bf16_f32 v108, v108, v109
v_cvt_pk_bf16_f32 v109, v110, v111
buffer_store_dwordx2 v[108:109], v90, s[20:23], s50 offen sc1
v_perm_b32 v24, v130, v131, s42
v_perm_b32 v25, v131, v132, s42
v_perm_b32 v26, v132, v133, s42
v_perm_b32 v27, v133, v134, s42
v_perm_b32 v28, v134, v135, s42
v_perm_b32 v29, v135, v136, s42
v_dot2_f32_bf16 v124, v26, v106, 0
v_dot2_f32_bf16 v125, v27, v106, 0
v_dot2_f32_bf16 v126, v28, v106, 0
v_dot2_f32_bf16 v127, v29, v106, 0
v_and_b32 v32, 0xffff0000, v138
v_and_b32 v33, 0xffff0000, v139
v_and_b32 v34, 0xffff0000, v144
v_and_b32 v35, 0xffff0000, v145
v_dot2_f32_bf16 v124, v24, v107, v124
v_dot2_f32_bf16 v125, v25, v107, v125
v_dot2_f32_bf16 v126, v26, v107, v126
v_dot2_f32_bf16 v127, v27, v107, v127
s_mov_b32 s50, 67134208
s_nop 1
v_pk_mul_f32 v[124:125], v[124:125], v[32:33]
v_pk_mul_f32 v[126:127], v[126:127], v[34:35]
v_cvt_pk_bf16_f32 v124, v124, v125
v_cvt_pk_bf16_f32 v125, v126, v127
buffer_store_dwordx2 v[124:125], v90, s[20:23], s50 offen sc1
v_mfma_f32_16x16x32_bf16 v[96:99], v[40:43], a[0:3], 0
ds_read_b64_tr_b16 v[56:57], v3 offset:49152
v_mfma_f32_16x16x32_bf16 v[96:99], v[44:47], a[16:19], v[96:99]
ds_read_b64_tr_b16 v[58:59], v3 offset:49664
s_add_u32 s50, s44, 4194304
v_mfma_f32_16x16x32_bf16 v[100:103], v[40:43], a[4:7], 0
ds_read_b64_tr_b16 v[60:61], v3 offset:57344
v_mul_f32 v24, v160, v160
v_mfma_f32_16x16x32_bf16 v[100:103], v[44:47], a[20:23], v[100:103]
ds_read_b64_tr_b16 v[62:63], v3 offset:57856
v_mul_f32 v25, v161, v161
v_mfma_f32_16x16x32_bf16 v[104:107], v[40:43], a[8:11], 0
ds_read_b64_tr_b16 v[64:65], v3 offset:51200
v_fma_f32 v24, v24, s47, v18
v_mfma_f32_16x16x32_bf16 v[104:107], v[44:47], a[24:27], v[104:107]
ds_read_b64_tr_b16 v[66:67], v3 offset:51712
v_fma_f32 v25, v25, s47, v18
v_mul_f32 v24, v24, v160
v_mfma_f32_16x16x32_bf16 v[108:111], v[40:43], a[12:15], 0
ds_read_b64_tr_b16 v[68:69], v3 offset:59392
v_mul_f32 v25, v25, v161
v_mfma_f32_16x16x32_bf16 v[108:111], v[44:47], a[28:31], v[108:111]
ds_read_b64_tr_b16 v[70:71], v3 offset:59904
v_mul_f32 v176, v176, v160
v_mfma_f32_16x16x32_bf16 v[112:115], v[48:51], a[0:3], 0
buffer_load_dwordx4 v10, s[8:11], s32 offen offset:2048 lds
v_mfma_f32_16x16x32_bf16 v[112:115], v[52:55], a[16:19], v[112:115]
ds_read_b128 v[80:83], v76 offset:0
v_exp_f32 v24, v24
v_mfma_f32_16x16x32_bf16 v[116:119], v[48:51], a[4:7], 0
v_exp_f32 v25, v25
v_mfma_f32_16x16x32_bf16 v[116:119], v[52:55], a[20:23], v[116:119]
v_mul_f32 v177, v177, v161
v_add_f32 v24, 1.0, v24
v_mfma_f32_16x16x32_bf16 v[120:123], v[48:51], a[8:11], 0
buffer_load_dwordx4 v11, s[8:11], s32 offen offset:3072 lds
v_mfma_f32_16x16x32_bf16 v[120:123], v[52:55], a[24:27], v[120:123]
s_add_u32 m0, s37, 49152
v_add_f32 v25, 1.0, v25
v_mfma_f32_16x16x32_bf16 v[124:127], v[48:51], a[12:15], 0
v_rcp_f32 v24, v24
s_waitcnt vmcnt(22) lgkmcnt(0)
v_mfma_f32_16x16x32_bf16 v[124:127], v[52:55], a[28:31], v[124:127]
s_barrier
v_mfma_f32_16x16x32_bf16 v[128:131], v[56:59], a[0:3], 0
ds_read_b64_tr_b16 v[40:41], v4 offset:0
v_mul_f32 v176, v176, v24
v_mfma_f32_16x16x32_bf16 v[128:131], v[60:63], a[16:19], v[128:131]
ds_read_b64_tr_b16 v[42:43], v4 offset:512
v_mul_f32 v26, v162, v162
v_mfma_f32_16x16x32_bf16 v[132:135], v[56:59], a[4:7], 0
ds_read_b64_tr_b16 v[44:45], v4 offset:8192
v_rcp_f32 v25, v25
v_mfma_f32_16x16x32_bf16 v[132:135], v[60:63], a[20:23], v[132:135]
ds_read_b64_tr_b16 v[46:47], v4 offset:8704
v_mul_f32 v177, v177, v25
v_mfma_f32_16x16x32_bf16 v[136:139], v[56:59], a[8:11], 0
ds_read_b64_tr_b16 v[48:49], v4 offset:2048
v_mul_f32 v27, v163, v163
v_mfma_f32_16x16x32_bf16 v[136:139], v[60:63], a[24:27], v[136:139]
ds_read_b64_tr_b16 v[50:51], v4 offset:2560
v_fma_f32 v26, v26, s47, v18
v_mfma_f32_16x16x32_bf16 v[140:143], v[56:59], a[12:15], 0
ds_read_b64_tr_b16 v[52:53], v4 offset:10240
v_fma_f32 v27, v27, s47, v18
v_mfma_f32_16x16x32_bf16 v[140:143], v[60:63], a[28:31], v[140:143]
ds_read_b64_tr_b16 v[54:55], v4 offset:10752
v_mul_f32 v26, v26, v162
v_mul_f32 v27, v27, v163
v_mfma_f32_16x16x32_bf16 v[144:147], v[64:67], a[0:3], 0
buffer_load_dwordx4 v10, s[4:7], s33 offen offset:0 lds
v_mfma_f32_16x16x32_bf16 v[144:147], v[68:71], a[16:19], v[144:147]
ds_read_b128 v[84:87], v76 offset:64
v_mul_f32 v178, v178, v162
v_mfma_f32_16x16x32_bf16 v[148:151], v[64:67], a[4:7], 0
v_exp_f32 v26, v26
v_mfma_f32_16x16x32_bf16 v[148:151], v[68:71], a[20:23], v[148:151]
v_exp_f32 v27, v27
v_mul_f32 v179, v179, v163
v_mfma_f32_16x16x32_bf16 v[152:155], v[64:67], a[8:11], 0
buffer_load_dwordx4 v11, s[4:7], s33 offen offset:1024 lds
v_mfma_f32_16x16x32_bf16 v[152:155], v[68:71], a[24:27], v[152:155]
v_add_f32 v26, 1.0, v26
v_add_f32 v27, 1.0, v27
v_mfma_f32_16x16x32_bf16 v[156:159], v[64:67], a[12:15], 0
v_rcp_f32 v26, v26
v_mfma_f32_16x16x32_bf16 v[156:159], v[68:71], a[28:31], v[156:159]
v_rcp_f32 v27, v27
v_mfma_f32_16x16x32_bf16 v[92:95], v[80:83], a[0:3], 0
v_mul_f32 v178, v178, v26
v_mul_f32 v179, v179, v27
s_waitcnt lgkmcnt(0)
v_mfma_f32_16x16x32_bf16 v[96:99], v[40:43], a[32:35], v[96:99]
ds_read_b64_tr_b16 v[56:57], v5 offset:0
v_cvt_pk_bf16_f32 v160, v176, v177
v_mfma_f32_16x16x32_bf16 v[96:99], v[44:47], a[48:51], v[96:99]
ds_read_b64_tr_b16 v[58:59], v5 offset:512
v_cvt_pk_bf16_f32 v161, v178, v179
v_mfma_f32_16x16x32_bf16 v[100:103], v[40:43], a[36:39], v[100:103]
ds_read_b64_tr_b16 v[60:61], v5 offset:8192
v_mul_f32 v28, v192, v192
v_mfma_f32_16x16x32_bf16 v[100:103], v[44:47], a[52:55], v[100:103]
ds_read_b64_tr_b16 v[62:63], v5 offset:8704
v_mul_f32 v29, v193, v193
v_fma_f32 v28, v28, s47, v18
v_mfma_f32_16x16x32_bf16 v[104:107], v[40:43], a[40:43], v[104:107]
ds_read_b64_tr_b16 v[64:65], v5 offset:2048
v_fma_f32 v29, v29, s47, v18
v_mfma_f32_16x16x32_bf16 v[104:107], v[44:47], a[56:59], v[104:107]
ds_read_b64_tr_b16 v[66:67], v5 offset:2560
v_mul_f32 v28, v28, v192
v_mfma_f32_16x16x32_bf16 v[108:111], v[40:43], a[44:47], v[108:111]
ds_read_b64_tr_b16 v[68:69], v5 offset:10240
v_mul_f32 v29, v29, v193
v_mfma_f32_16x16x32_bf16 v[108:111], v[44:47], a[60:63], v[108:111]
ds_read_b64_tr_b16 v[70:71], v5 offset:10752
v_mul_f32 v208, v208, v192
v_mfma_f32_16x16x32_bf16 v[112:115], v[48:51], a[32:35], v[112:115]
buffer_load_dwordx4 v10, s[8:11], s33 offen offset:2048 lds
v_mfma_f32_16x16x32_bf16 v[112:115], v[52:55], a[48:51], v[112:115]
ds_read_b128 v[80:83], v76 offset:128
v_exp_f32 v28, v28
v_mfma_f32_16x16x32_bf16 v[116:119], v[48:51], a[36:39], v[116:119]
v_exp_f32 v29, v29
v_mfma_f32_16x16x32_bf16 v[116:119], v[52:55], a[52:55], v[116:119]
v_mul_f32 v209, v209, v193
v_add_f32 v28, 1.0, v28
v_mfma_f32_16x16x32_bf16 v[120:123], v[48:51], a[40:43], v[120:123]
buffer_load_dwordx4 v11, s[8:11], s33 offen offset:3072 lds
v_mfma_f32_16x16x32_bf16 v[120:123], v[52:55], a[56:59], v[120:123]
s_add_u32 m0, s37, 65536
v_add_f32 v29, 1.0, v29
v_mul_f32 v30, v194, v194
v_mfma_f32_16x16x32_bf16 v[124:127], v[48:51], a[44:47], v[124:127]
v_rcp_f32 v28, v28
v_mfma_f32_16x16x32_bf16 v[124:127], v[52:55], a[60:63], v[124:127]
v_mul_f32 v208, v208, v28
s_waitcnt vmcnt(21) lgkmcnt(0)
v_mfma_f32_16x16x32_bf16 v[92:95], v[84:87], a[16:19], v[92:95]
s_barrier
v_mfma_f32_16x16x32_bf16 v[128:131], v[56:59], a[32:35], v[128:131]
ds_read_b64_tr_b16 v[40:41], v2 offset:0
v_rcp_f32 v29, v29
v_mfma_f32_16x16x32_bf16 v[128:131], v[60:63], a[48:51], v[128:131]
ds_read_b64_tr_b16 v[42:43], v2 offset:512
v_mul_f32 v209, v209, v29
v_mfma_f32_16x16x32_bf16 v[132:135], v[56:59], a[36:39], v[132:135]
ds_read_b64_tr_b16 v[44:45], v2 offset:8192
v_mul_f32 v31, v195, v195
v_mfma_f32_16x16x32_bf16 v[132:135], v[60:63], a[52:55], v[132:135]
ds_read_b64_tr_b16 v[46:47], v2 offset:8704
v_fma_f32 v30, v30, s47, v18
v_mfma_f32_16x16x32_bf16 v[136:139], v[56:59], a[40:43], v[136:139]
ds_read_b64_tr_b16 v[48:49], v2 offset:2048
v_fma_f32 v31, v31, s47, v18
v_mul_f32 v30, v30, v194
v_mfma_f32_16x16x32_bf16 v[136:139], v[60:63], a[56:59], v[136:139]
ds_read_b64_tr_b16 v[50:51], v2 offset:2560
v_mul_f32 v31, v31, v195
v_mfma_f32_16x16x32_bf16 v[140:143], v[56:59], a[44:47], v[140:143]
ds_read_b64_tr_b16 v[52:53], v2 offset:10240
v_mul_f32 v210, v210, v194
v_mfma_f32_16x16x32_bf16 v[140:143], v[60:63], a[60:63], v[140:143]
ds_read_b64_tr_b16 v[54:55], v2 offset:10752
v_mul_f32 v211, v211, v195
v_mfma_f32_16x16x32_bf16 v[144:147], v[64:67], a[32:35], v[144:147]
buffer_load_dwordx4 v10, s[4:7], s34 offen offset:0 lds
v_mfma_f32_16x16x32_bf16 v[144:147], v[68:71], a[48:51], v[144:147]
ds_read_b128 v[84:87], v76 offset:192
v_exp_f32 v30, v30
v_mfma_f32_16x16x32_bf16 v[148:151], v[64:67], a[36:39], v[148:151]
v_exp_f32 v31, v31
v_mfma_f32_16x16x32_bf16 v[148:151], v[68:71], a[52:55], v[148:151]
v_add_f32 v30, 1.0, v30
v_add_f32 v31, 1.0, v31
v_mfma_f32_16x16x32_bf16 v[152:155], v[64:67], a[40:43], v[152:155]
buffer_load_dwordx4 v11, s[4:7], s34 offen offset:1024 lds
v_mfma_f32_16x16x32_bf16 v[152:155], v[68:71], a[56:59], v[152:155]
v_rcp_f32 v30, v30
v_cvt_pk_bf16_f32 v162, v208, v209
v_mfma_f32_16x16x32_bf16 v[156:159], v[64:67], a[44:47], v[156:159]
v_rcp_f32 v31, v31
v_mfma_f32_16x16x32_bf16 v[156:159], v[68:71], a[60:63], v[156:159]
v_mul_f32 v210, v210, v30
v_mul_f32 v211, v211, v31
v_mfma_f32_16x16x32_bf16 v[92:95], v[80:83], a[32:35], v[92:95]
v_cvt_pk_bf16_f32 v163, v210, v211
s_waitcnt lgkmcnt(0)
v_mfma_f32_16x16x32_bf16 v[96:99], v[40:43], a[64:67], v[96:99]
ds_read_b64_tr_b16 v[56:57], v3 offset:0
v_mul_f32 v32, v164, v164
v_mfma_f32_16x16x32_bf16 v[96:99], v[44:47], a[80:83], v[96:99]
ds_read_b64_tr_b16 v[58:59], v3 offset:512
v_mul_f32 v33, v165, v165
v_fma_f32 v32, v32, s47, v18
v_mfma_f32_16x16x32_bf16 v[100:103], v[40:43], a[68:71], v[100:103]
ds_read_b64_tr_b16 v[60:61], v3 offset:8192
v_fma_f32 v33, v33, s47, v18
v_mfma_f32_16x16x32_bf16 v[100:103], v[44:47], a[84:87], v[100:103]
ds_read_b64_tr_b16 v[62:63], v3 offset:8704
v_mul_f32 v32, v32, v164
v_mfma_f32_16x16x32_bf16 v[104:107], v[40:43], a[72:75], v[104:107]
ds_read_b64_tr_b16 v[64:65], v3 offset:2048
v_mul_f32 v33, v33, v165
v_mfma_f32_16x16x32_bf16 v[104:107], v[44:47], a[88:91], v[104:107]
ds_read_b64_tr_b16 v[66:67], v3 offset:2560
v_exp_f32 v32, v32
v_mfma_f32_16x16x32_bf16 v[108:111], v[40:43], a[76:79], v[108:111]
ds_read_b64_tr_b16 v[68:69], v3 offset:10240
v_mul_f32 v180, v180, v164
v_mfma_f32_16x16x32_bf16 v[108:111], v[44:47], a[92:95], v[108:111]
ds_read_b64_tr_b16 v[70:71], v3 offset:10752
v_mul_f32 v181, v181, v165
v_mfma_f32_16x16x32_bf16 v[112:115], v[48:51], a[64:67], v[112:115]
buffer_load_dwordx4 v10, s[8:11], s34 offen offset:2048 lds
v_mfma_f32_16x16x32_bf16 v[112:115], v[52:55], a[80:83], v[112:115]
ds_read_b128 v[80:83], v76 offset:256
v_add_f32 v32, 1.0, v32
v_mfma_f32_16x16x32_bf16 v[116:119], v[48:51], a[68:71], v[116:119]
buffer_store_dwordx4 v[160:163], v16, s[20:23], s50 offen offset:0 sc1
v_mfma_f32_16x16x32_bf16 v[116:119], v[52:55], a[84:87], v[116:119]
ds_write_b128 v14, v[160:163] offset:32768
v_mul_f32 v34, v166, v166
v_mfma_f32_16x16x32_bf16 v[120:123], v[48:51], a[72:75], v[120:123]
buffer_load_dwordx4 v11, s[8:11], s34 offen offset:3072 lds
v_mfma_f32_16x16x32_bf16 v[120:123], v[52:55], a[88:91], v[120:123]
s_add_u32 m0, s37, 0
v_mul_f32 v35, v167, v167
v_mfma_f32_16x16x32_bf16 v[124:127], v[48:51], a[76:79], v[124:127]
v_exp_f32 v33, v33
v_fma_f32 v34, v34, s47, v18
v_mfma_f32_16x16x32_bf16 v[124:127], v[52:55], a[92:95], v[124:127]
v_add_f32 v33, 1.0, v33
s_waitcnt vmcnt(20) lgkmcnt(0)
v_mfma_f32_16x16x32_bf16 v[92:95], v[84:87], a[48:51], v[92:95]
s_barrier
v_mfma_f32_16x16x32_bf16 v[128:131], v[56:59], a[64:67], v[128:131]
ds_read_b64_tr_b16 v[40:41], v2 offset:16384
v_and_b32 v74, 32, v1
v_mfma_f32_16x16x32_bf16 v[128:131], v[60:63], a[80:83], v[128:131]
ds_read_b64_tr_b16 v[42:43], v2 offset:16896
v_lshl_add_u32 v74, v74, 16, v1
v_mfma_f32_16x16x32_bf16 v[132:135], v[56:59], a[68:71], v[132:135]
ds_read_b64_tr_b16 v[44:45], v2 offset:24576
v_lshlrev_b32 v74, 7, v74
v_mfma_f32_16x16x32_bf16 v[132:135], v[60:63], a[84:87], v[132:135]
ds_read_b64_tr_b16 v[46:47], v2 offset:25088
s_lshl_b32 s48, s3, 12
v_mfma_f32_16x16x32_bf16 v[136:139], v[56:59], a[72:75], v[136:139]
ds_read_b64_tr_b16 v[48:49], v2 offset:18432
v_rcp_f32 v32, v32
v_mfma_f32_16x16x32_bf16 v[136:139], v[60:63], a[88:91], v[136:139]
ds_read_b64_tr_b16 v[50:51], v2 offset:18944
v_mul_f32 v180, v180, v32
v_mfma_f32_16x16x32_bf16 v[140:143], v[56:59], a[76:79], v[140:143]
ds_read_b64_tr_b16 v[52:53], v2 offset:26624
v_fma_f32 v35, v35, s47, v18
v_mfma_f32_16x16x32_bf16 v[140:143], v[60:63], a[92:95], v[140:143]
ds_read_b64_tr_b16 v[54:55], v2 offset:27136
v_rcp_f32 v33, v33
v_mfma_f32_16x16x32_bf16 v[144:147], v[64:67], a[64:67], v[144:147]
buffer_load_dwordx4 v10, s[4:7], s35 offen offset:0 lds
v_mfma_f32_16x16x32_bf16 v[144:147], v[68:71], a[80:83], v[144:147]
ds_read_b128 v[84:87], v76 offset:320
v_mul_f32 v181, v181, v33
v_mfma_f32_16x16x32_bf16 v[148:151], v[64:67], a[68:71], v[148:151]
v_mul_f32 v34, v34, v166
v_mul_f32 v35, v35, v167
v_mfma_f32_16x16x32_bf16 v[148:151], v[68:71], a[84:87], v[148:151]
v_exp_f32 v34, v34
v_mul_f32 v182, v182, v166
v_mfma_f32_16x16x32_bf16 v[152:155], v[64:67], a[72:75], v[152:155]
buffer_load_dwordx4 v11, s[4:7], s35 offen offset:1024 lds
v_mfma_f32_16x16x32_bf16 v[152:155], v[68:71], a[88:91], v[152:155]
v_exp_f32 v35, v35
v_mfma_f32_16x16x32_bf16 v[156:159], v[64:67], a[76:79], v[156:159]
v_mul_f32 v183, v183, v167
v_add_f32 v34, 1.0, v34
v_mfma_f32_16x16x32_bf16 v[156:159], v[68:71], a[92:95], v[156:159]
v_add_f32 v35, 1.0, v35
v_cvt_pk_bf16_f32 v164, v180, v181
v_mfma_f32_16x16x32_bf16 v[92:95], v[80:83], a[64:67], v[92:95]
v_rcp_f32 v34, v34
s_waitcnt lgkmcnt(0)
v_mfma_f32_16x16x32_bf16 v[96:99], v[40:43], a[96:99], v[96:99]
ds_read_b64_tr_b16 v[56:57], v3 offset:16384
v_mul_f32 v182, v182, v34
v_mfma_f32_16x16x32_bf16 v[96:99], v[44:47], a[112:115], v[96:99]
ds_read_b64_tr_b16 v[58:59], v3 offset:16896
v_mul_f32 v36, v196, v196
v_mfma_f32_16x16x32_bf16 v[100:103], v[40:43], a[100:103], v[100:103]
ds_read_b64_tr_b16 v[60:61], v3 offset:24576
v_mul_f32 v37, v197, v197
v_mfma_f32_16x16x32_bf16 v[100:103], v[44:47], a[116:119], v[100:103]
ds_read_b64_tr_b16 v[62:63], v3 offset:25088
v_fma_f32 v36, v36, s47, v18
v_mfma_f32_16x16x32_bf16 v[104:107], v[40:43], a[104:107], v[104:107]
ds_read_b64_tr_b16 v[64:65], v3 offset:18432
v_rcp_f32 v35, v35
v_mfma_f32_16x16x32_bf16 v[104:107], v[44:47], a[120:123], v[104:107]
ds_read_b64_tr_b16 v[66:67], v3 offset:18944
v_mul_f32 v183, v183, v35
v_mfma_f32_16x16x32_bf16 v[108:111], v[40:43], a[108:111], v[108:111]
ds_read_b64_tr_b16 v[68:69], v3 offset:26624
v_cvt_pk_bf16_f32 v165, v182, v183
v_mfma_f32_16x16x32_bf16 v[108:111], v[44:47], a[124:127], v[108:111]
ds_read_b64_tr_b16 v[70:71], v3 offset:27136
v_fma_f32 v37, v37, s47, v18
v_mfma_f32_16x16x32_bf16 v[112:115], v[48:51], a[96:99], v[112:115]
buffer_load_dwordx4 v10, s[8:11], s35 offen offset:2048 lds
v_mfma_f32_16x16x32_bf16 v[112:115], v[52:55], a[112:115], v[112:115]
ds_read_b128 v[80:83], v76 offset:384
v_mul_f32 v36, v36, v196
v_mul_f32 v37, v37, v197
v_mfma_f32_16x16x32_bf16 v[116:119], v[48:51], a[100:103], v[116:119]
v_exp_f32 v36, v36
v_mfma_f32_16x16x32_bf16 v[116:119], v[52:55], a[116:119], v[116:119]
v_exp_f32 v37, v37
v_mfma_f32_16x16x32_bf16 v[120:123], v[48:51], a[104:107], v[120:123]
buffer_load_dwordx4 v11, s[8:11], s35 offen offset:3072 lds
v_mfma_f32_16x16x32_bf16 v[120:123], v[52:55], a[120:123], v[120:123]
buffer_load_dword v77, v74, s[52:55], s48 offen offset:0
v_mfma_f32_16x16x32_bf16 v[124:127], v[48:51], a[108:111], v[124:127]
v_and_b32 v75, 56, v1
v_lshl_add_u32 v75, v75, 12, v1
v_mfma_f32_16x16x32_bf16 v[124:127], v[52:55], a[124:127], v[124:127]
v_lshlrev_b32 v75, 7, v75
s_waitcnt vmcnt(14) lgkmcnt(0)
v_mfma_f32_16x16x32_bf16 v[92:95], v[84:87], a[80:83], v[92:95]
s_barrier
v_mfma_f32_16x16x32_bf16 v[128:131], v[56:59], a[96:99], v[128:131]
ds_read_b64_tr_b16 v[40:41], v2 offset:32768
s_lshl_b32 s48, s100, 2
v_mfma_f32_16x16x32_bf16 v[128:131], v[60:63], a[112:115], v[128:131]
ds_read_b64_tr_b16 v[42:43], v2 offset:33280
s_add_u32 s48, s48, s38
v_mfma_f32_16x16x32_bf16 v[132:135], v[56:59], a[100:103], v[132:135]
ds_read_b64_tr_b16 v[44:45], v2 offset:40960
s_lshl_b32 s48, s48, 10
v_mfma_f32_16x16x32_bf16 v[132:135], v[60:63], a[116:119], v[132:135]
ds_read_b64_tr_b16 v[46:47], v2 offset:41472
v_mul_f32 v212, v212, v196
v_mul_f32 v213, v213, v197
v_add_f32 v36, 1.0, v36
v_mfma_f32_16x16x32_bf16 v[136:139], v[56:59], a[104:107], v[136:139]
ds_read_b64_tr_b16 v[48:49], v2 offset:34816
v_add_f32 v37, 1.0, v37
v_mfma_f32_16x16x32_bf16 v[136:139], v[60:63], a[120:123], v[136:139]
ds_read_b64_tr_b16 v[50:51], v2 offset:35328
v_rcp_f32 v36, v36
v_mfma_f32_16x16x32_bf16 v[140:143], v[56:59], a[108:111], v[140:143]
ds_read_b64_tr_b16 v[52:53], v2 offset:43008
v_mov_b32 v20, 1
v_mfma_f32_16x16x32_bf16 v[140:143], v[60:63], a[124:127], v[140:143]
ds_read_b64_tr_b16 v[54:55], v2 offset:43520
v_mul_f32 v212, v212, v36
v_mfma_f32_16x16x32_bf16 v[144:147], v[64:67], a[96:99], v[144:147]
buffer_load_dword v77, v75, s[52:55], s48 offen
v_mfma_f32_16x16x32_bf16 v[144:147], v[68:71], a[112:115], v[144:147]
ds_read_b128 v[84:87], v76 offset:448
s_add_u32 m0, s37, 16384
v_mfma_f32_16x16x32_bf16 v[148:151], v[64:67], a[100:103], v[148:151]
buffer_load_dwordx4 v10, s[4:7], s36 offen offset:0 lds
v_mfma_f32_16x16x32_bf16 v[148:151], v[68:71], a[116:119], v[148:151]
v_rcp_f32 v37, v37
v_mul_f32 v38, v198, v198
v_mfma_f32_16x16x32_bf16 v[152:155], v[64:67], a[104:107], v[152:155]
buffer_load_dwordx4 v11, s[4:7], s36 offen offset:1024 lds
v_mfma_f32_16x16x32_bf16 v[152:155], v[68:71], a[120:123], v[152:155]
v_mul_f32 v213, v213, v37
v_mul_f32 v39, v199, v199
v_mfma_f32_16x16x32_bf16 v[156:159], v[64:67], a[108:111], v[156:159]
v_fma_f32 v38, v38, s47, v18
v_fma_f32 v39, v39, s47, v18
v_mul_f32 v38, v38, v198
v_mfma_f32_16x16x32_bf16 v[156:159], v[68:71], a[124:127], v[156:159]
v_mul_f32 v39, v39, v199
v_mul_f32 v214, v214, v198
v_mfma_f32_16x16x32_bf16 v[92:95], v[80:83], a[96:99], v[92:95]
v_mul_f32 v215, v215, v199
s_waitcnt lgkmcnt(0)
v_mfma_f32_16x16x32_bf16 v[96:99], v[40:43], a[128:131], v[96:99]
ds_read_b64_tr_b16 v[56:57], v3 offset:32768
v_cvt_pk_bf16_f32 v166, v212, v213
v_mfma_f32_16x16x32_bf16 v[96:99], v[44:47], a[144:147], v[96:99]
ds_read_b64_tr_b16 v[58:59], v3 offset:33280
v_mul_f32 v24, v168, v168
v_mfma_f32_16x16x32_bf16 v[100:103], v[40:43], a[132:135], v[100:103]
ds_read_b64_tr_b16 v[60:61], v3 offset:40960
v_exp_f32 v38, v38
v_mfma_f32_16x16x32_bf16 v[100:103], v[44:47], a[148:151], v[100:103]
ds_read_b64_tr_b16 v[62:63], v3 offset:41472
v_add_f32 v38, 1.0, v38
v_mfma_f32_16x16x32_bf16 v[104:107], v[40:43], a[136:139], v[104:107]
ds_read_b64_tr_b16 v[64:65], v3 offset:34816
v_mul_f32 v25, v169, v169
v_mfma_f32_16x16x32_bf16 v[104:107], v[44:47], a[152:155], v[104:107]
ds_read_b64_tr_b16 v[66:67], v3 offset:35328
v_fma_f32 v24, v24, s47, v18
v_mfma_f32_16x16x32_bf16 v[108:111], v[40:43], a[140:143], v[108:111]
ds_read_b64_tr_b16 v[68:69], v3 offset:43008
v_fma_f32 v25, v25, s47, v18
v_mfma_f32_16x16x32_bf16 v[108:111], v[44:47], a[156:159], v[108:111]
ds_read_b64_tr_b16 v[70:71], v3 offset:43520
v_exp_f32 v39, v39
v_mfma_f32_16x16x32_bf16 v[112:115], v[48:51], a[128:131], v[112:115]
buffer_load_dwordx4 v10, s[8:11], s36 offen offset:2048 lds
v_mfma_f32_16x16x32_bf16 v[112:115], v[52:55], a[144:147], v[112:115]
ds_read_b128 v[80:83], v76 offset:512
v_add_f32 v39, 1.0, v39
v_mfma_f32_16x16x32_bf16 v[116:119], v[48:51], a[132:135], v[116:119]
buffer_load_dwordx4 v11, s[8:11], s36 offen offset:3072 lds
v_mfma_f32_16x16x32_bf16 v[116:119], v[52:55], a[148:151], v[116:119]
v_add_u32 v10, 128, v10
v_add_u32 v11, 128, v11
v_mfma_f32_16x16x32_bf16 v[120:123], v[48:51], a[136:139], v[120:123]
buffer_store_dword v20, v19, s[20:23], 0 offen sc1
v_mfma_f32_16x16x32_bf16 v[120:123], v[52:55], a[152:155], v[120:123]
s_add_u32 m0, s37, 32768
v_rcp_f32 v38, v38
v_mfma_f32_16x16x32_bf16 v[124:127], v[48:51], a[140:143], v[124:127]
v_rcp_f32 v39, v39
v_mfma_f32_16x16x32_bf16 v[124:127], v[52:55], a[156:159], v[124:127]
v_mul_f32 v214, v214, v38
s_waitcnt vmcnt(16) lgkmcnt(0)
v_mfma_f32_16x16x32_bf16 v[92:95], v[84:87], a[112:115], v[92:95]
s_barrier
v_mfma_f32_16x16x32_bf16 v[128:131], v[56:59], a[128:131], v[128:131]
ds_read_b64_tr_b16 v[40:41], v2 offset:49152
v_mul_f32 v215, v215, v39
v_cvt_pk_bf16_f32 v167, v214, v215
v_mfma_f32_16x16x32_bf16 v[128:131], v[60:63], a[144:147], v[128:131]
ds_read_b64_tr_b16 v[42:43], v2 offset:49664
v_mul_f32 v24, v24, v168
v_mfma_f32_16x16x32_bf16 v[132:135], v[56:59], a[132:135], v[132:135]
ds_read_b64_tr_b16 v[44:45], v2 offset:57344
v_mul_f32 v25, v25, v169
v_mfma_f32_16x16x32_bf16 v[132:135], v[60:63], a[148:151], v[132:135]
ds_read_b64_tr_b16 v[46:47], v2 offset:57856
v_mul_f32 v184, v184, v168
v_mfma_f32_16x16x32_bf16 v[136:139], v[56:59], a[136:139], v[136:139]
ds_read_b64_tr_b16 v[48:49], v2 offset:51200
v_exp_f32 v24, v24
v_mfma_f32_16x16x32_bf16 v[136:139], v[60:63], a[152:155], v[136:139]
ds_read_b64_tr_b16 v[50:51], v2 offset:51712
v_mul_f32 v185, v185, v169
v_mfma_f32_16x16x32_bf16 v[140:143], v[56:59], a[140:143], v[140:143]
ds_read_b64_tr_b16 v[52:53], v2 offset:59392
v_add_f32 v24, 1.0, v24
v_mfma_f32_16x16x32_bf16 v[140:143], v[60:63], a[156:159], v[140:143]
ds_read_b64_tr_b16 v[54:55], v2 offset:59904
v_mul_f32 v26, v170, v170
v_mfma_f32_16x16x32_bf16 v[144:147], v[64:67], a[128:131], v[144:147]
buffer_load_dwordx4 v10, s[4:7], s28 offen offset:0 lds
v_mfma_f32_16x16x32_bf16 v[144:147], v[68:71], a[144:147], v[144:147]
ds_read_b128 v[84:87], v76 offset:576
v_exp_f32 v25, v25
v_mfma_f32_16x16x32_bf16 v[148:151], v[64:67], a[132:135], v[148:151]
buffer_store_dwordx4 v[164:167], v16, s[20:23], s50 offen offset:1024 sc1
v_mfma_f32_16x16x32_bf16 v[148:151], v[68:71], a[148:151], v[148:151]
ds_write_b128 v14, v[164:167] offset:33792
v_mfma_f32_16x16x32_bf16 v[152:155], v[64:67], a[136:139], v[152:155]
buffer_load_dwordx4 v11, s[4:7], s28 offen offset:1024 lds
v_mfma_f32_16x16x32_bf16 v[152:155], v[68:71], a[152:155], v[152:155]
v_add_f32 v25, 1.0, v25
v_mul_f32 v27, v171, v171
v_mfma_f32_16x16x32_bf16 v[156:159], v[64:67], a[140:143], v[156:159]
v_rcp_f32 v24, v24
v_fma_f32 v26, v26, s47, v18
v_mfma_f32_16x16x32_bf16 v[156:159], v[68:71], a[156:159], v[156:159]
v_rcp_f32 v25, v25
v_mfma_f32_16x16x32_bf16 v[92:95], v[80:83], a[128:131], v[92:95]
v_mul_f32 v184, v184, v24
s_waitcnt lgkmcnt(0)
v_mfma_f32_16x16x32_bf16 v[96:99], v[40:43], a[160:163], v[96:99]
ds_read_b64_tr_b16 v[56:57], v3 offset:49152
v_mul_f32 v185, v185, v25
v_mfma_f32_16x16x32_bf16 v[96:99], v[44:47], a[176:179], v[96:99]
ds_read_b64_tr_b16 v[58:59], v3 offset:49664
v_fma_f32 v27, v27, s47, v18
v_mfma_f32_16x16x32_bf16 v[100:103], v[40:43], a[164:167], v[100:103]
ds_read_b64_tr_b16 v[60:61], v3 offset:57344
v_mul_f32 v26, v26, v170
v_mul_f32 v27, v27, v171
v_mfma_f32_16x16x32_bf16 v[100:103], v[44:47], a[180:183], v[100:103]
ds_read_b64_tr_b16 v[62:63], v3 offset:57856
v_mul_f32 v186, v186, v170
v_mfma_f32_16x16x32_bf16 v[104:107], v[40:43], a[168:171], v[104:107]
ds_read_b64_tr_b16 v[64:65], v3 offset:51200
v_mul_f32 v187, v187, v171
v_mfma_f32_16x16x32_bf16 v[104:107], v[44:47], a[184:187], v[104:107]
ds_read_b64_tr_b16 v[66:67], v3 offset:51712
v_cvt_pk_bf16_f32 v168, v184, v185
v_mfma_f32_16x16x32_bf16 v[108:111], v[40:43], a[172:175], v[108:111]
ds_read_b64_tr_b16 v[68:69], v3 offset:59392
v_mul_f32 v28, v200, v200
v_mfma_f32_16x16x32_bf16 v[108:111], v[44:47], a[188:191], v[108:111]
ds_read_b64_tr_b16 v[70:71], v3 offset:59904
v_exp_f32 v26, v26
v_mfma_f32_16x16x32_bf16 v[112:115], v[48:51], a[160:163], v[112:115]
buffer_load_dwordx4 v10, s[8:11], s28 offen offset:2048 lds
v_mfma_f32_16x16x32_bf16 v[112:115], v[52:55], a[176:179], v[112:115]
ds_read_b128 v[80:83], v76 offset:640
v_add_f32 v26, 1.0, v26
v_mfma_f32_16x16x32_bf16 v[116:119], v[48:51], a[164:167], v[116:119]
v_exp_f32 v27, v27
v_mfma_f32_16x16x32_bf16 v[116:119], v[52:55], a[180:183], v[116:119]
v_add_f32 v27, 1.0, v27
v_mul_f32 v29, v201, v201
v_mfma_f32_16x16x32_bf16 v[120:123], v[48:51], a[168:171], v[120:123]
buffer_load_dwordx4 v11, s[8:11], s28 offen offset:3072 lds
v_mfma_f32_16x16x32_bf16 v[120:123], v[52:55], a[184:187], v[120:123]
s_add_u32 m0, s37, 49152
v_rcp_f32 v26, v26
v_mfma_f32_16x16x32_bf16 v[124:127], v[48:51], a[172:175], v[124:127]
v_rcp_f32 v27, v27
v_mfma_f32_16x16x32_bf16 v[124:127], v[52:55], a[188:191], v[124:127]
v_mul_f32 v186, v186, v26
s_waitcnt vmcnt(16) lgkmcnt(0)
v_mfma_f32_16x16x32_bf16 v[92:95], v[84:87], a[144:147], v[92:95]
s_barrier
v_mfma_f32_16x16x32_bf16 v[128:131], v[56:59], a[160:163], v[128:131]
ds_read_b64_tr_b16 v[40:41], v4 offset:0
v_mul_f32 v187, v187, v27
v_cvt_pk_bf16_f32 v169, v186, v187
v_mfma_f32_16x16x32_bf16 v[128:131], v[60:63], a[176:179], v[128:131]
ds_read_b64_tr_b16 v[42:43], v4 offset:512
v_fma_f32 v28, v28, s47, v18
v_mfma_f32_16x16x32_bf16 v[132:135], v[56:59], a[164:167], v[132:135]
ds_read_b64_tr_b16 v[44:45], v4 offset:8192
v_fma_f32 v29, v29, s47, v18
v_mfma_f32_16x16x32_bf16 v[132:135], v[60:63], a[180:183], v[132:135]
ds_read_b64_tr_b16 v[46:47], v4 offset:8704
v_mul_f32 v28, v28, v200
v_mfma_f32_16x16x32_bf16 v[136:139], v[56:59], a[168:171], v[136:139]
ds_read_b64_tr_b16 v[48:49], v4 offset:2048
v_mul_f32 v29, v29, v201
v_mfma_f32_16x16x32_bf16 v[136:139], v[60:63], a[184:187], v[136:139]
ds_read_b64_tr_b16 v[50:51], v4 offset:2560
v_exp_f32 v28, v28
v_mfma_f32_16x16x32_bf16 v[140:143], v[56:59], a[172:175], v[140:143]
ds_read_b64_tr_b16 v[52:53], v4 offset:10240
v_mul_f32 v216, v216, v200
v_mfma_f32_16x16x32_bf16 v[140:143], v[60:63], a[188:191], v[140:143]
ds_read_b64_tr_b16 v[54:55], v4 offset:10752
v_mul_f32 v217, v217, v201
v_mfma_f32_16x16x32_bf16 v[144:147], v[64:67], a[160:163], v[144:147]
buffer_load_dwordx4 v10, s[4:7], s29 offen offset:0 lds
v_mfma_f32_16x16x32_bf16 v[144:147], v[68:71], a[176:179], v[144:147]
ds_read_b128 v[84:87], v76 offset:704
v_add_f32 v28, 1.0, v28
v_mfma_f32_16x16x32_bf16 v[148:151], v[64:67], a[164:167], v[148:151]
v_exp_f32 v29, v29
v_mul_f32 v30, v202, v202
v_mfma_f32_16x16x32_bf16 v[148:151], v[68:71], a[180:183], v[148:151]
v_add_f32 v29, 1.0, v29
v_mul_f32 v31, v203, v203
v_mfma_f32_16x16x32_bf16 v[152:155], v[64:67], a[168:171], v[152:155]
buffer_load_dwordx4 v11, s[4:7], s29 offen offset:1024 lds
v_mfma_f32_16x16x32_bf16 v[152:155], v[68:71], a[184:187], v[152:155]
v_rcp_f32 v28, v28
v_mfma_f32_16x16x32_bf16 v[156:159], v[64:67], a[172:175], v[156:159]
v_rcp_f32 v29, v29
v_mfma_f32_16x16x32_bf16 v[156:159], v[68:71], a[188:191], v[156:159]
v_mul_f32 v216, v216, v28
v_mul_f32 v217, v217, v29
v_fma_f32 v30, v30, s47, v18
v_mfma_f32_16x16x32_bf16 v[92:95], v[80:83], a[160:163], v[92:95]
v_fma_f32 v31, v31, s47, v18
s_waitcnt lgkmcnt(0)
v_mfma_f32_16x16x32_bf16 v[96:99], v[40:43], a[192:195], v[96:99]
ds_read_b64_tr_b16 v[56:57], v5 offset:0
v_mul_f32 v30, v30, v202
v_mfma_f32_16x16x32_bf16 v[96:99], v[44:47], a[208:211], v[96:99]
ds_read_b64_tr_b16 v[58:59], v5 offset:512
v_mul_f32 v31, v31, v203
v_mfma_f32_16x16x32_bf16 v[100:103], v[40:43], a[196:199], v[100:103]
ds_read_b64_tr_b16 v[60:61], v5 offset:8192
v_mul_f32 v218, v218, v202
v_mfma_f32_16x16x32_bf16 v[100:103], v[44:47], a[212:215], v[100:103]
ds_read_b64_tr_b16 v[62:63], v5 offset:8704
v_mul_f32 v219, v219, v203
v_mfma_f32_16x16x32_bf16 v[104:107], v[40:43], a[200:203], v[104:107]
ds_read_b64_tr_b16 v[64:65], v5 offset:2048
v_exp_f32 v30, v30
v_mfma_f32_16x16x32_bf16 v[104:107], v[44:47], a[216:219], v[104:107]
ds_read_b64_tr_b16 v[66:67], v5 offset:2560
v_add_f32 v30, 1.0, v30
v_mfma_f32_16x16x32_bf16 v[108:111], v[40:43], a[204:207], v[108:111]
ds_read_b64_tr_b16 v[68:69], v5 offset:10240
v_cvt_pk_bf16_f32 v170, v216, v217
v_mfma_f32_16x16x32_bf16 v[108:111], v[44:47], a[220:223], v[108:111]
ds_read_b64_tr_b16 v[70:71], v5 offset:10752
v_mul_f32 v32, v172, v172
v_mfma_f32_16x16x32_bf16 v[112:115], v[48:51], a[192:195], v[112:115]
buffer_load_dwordx4 v10, s[8:11], s29 offen offset:2048 lds
v_mfma_f32_16x16x32_bf16 v[112:115], v[52:55], a[208:211], v[112:115]
ds_read_b128 v[80:83], v76 offset:768
v_exp_f32 v31, v31
v_mfma_f32_16x16x32_bf16 v[116:119], v[48:51], a[196:199], v[116:119]
v_add_f32 v31, 1.0, v31
v_mul_f32 v33, v173, v173
v_mfma_f32_16x16x32_bf16 v[116:119], v[52:55], a[212:215], v[116:119]
v_rcp_f32 v30, v30
v_mfma_f32_16x16x32_bf16 v[120:123], v[48:51], a[200:203], v[120:123]
buffer_load_dwordx4 v11, s[8:11], s29 offen offset:3072 lds
v_mfma_f32_16x16x32_bf16 v[120:123], v[52:55], a[216:219], v[120:123]
s_add_u32 m0, s37, 65536
v_mul_f32 v218, v218, v30
v_mfma_f32_16x16x32_bf16 v[124:127], v[48:51], a[204:207], v[124:127]
v_rcp_f32 v31, v31
v_fma_f32 v32, v32, s47, v18
v_mfma_f32_16x16x32_bf16 v[124:127], v[52:55], a[220:223], v[124:127]
v_mul_f32 v219, v219, v31
s_waitcnt vmcnt(16) lgkmcnt(0)
v_mfma_f32_16x16x32_bf16 v[92:95], v[84:87], a[176:179], v[92:95]
s_barrier
v_mfma_f32_16x16x32_bf16 v[128:131], v[56:59], a[192:195], v[128:131]
ds_read_b64_tr_b16 v[40:41], v2 offset:0
s_lshl2_add_u32 s58, s39, s38
v_mfma_f32_16x16x32_bf16 v[128:131], v[60:63], a[208:211], v[128:131]
ds_read_b64_tr_b16 v[42:43], v2 offset:512
s_mul_i32 s58, s58, 10368
v_mfma_f32_16x16x32_bf16 v[132:135], v[56:59], a[196:199], v[132:135]
ds_read_b64_tr_b16 v[44:45], v2 offset:8192
v_mul_u32_u24 v74, 64, v1
v_mfma_f32_16x16x32_bf16 v[132:135], v[60:63], a[212:215], v[132:135]
ds_read_b64_tr_b16 v[46:47], v2 offset:8704
v_lshrrev_b32 v74, 8, v74
v_mfma_f32_16x16x32_bf16 v[136:139], v[56:59], a[200:203], v[136:139]
ds_read_b64_tr_b16 v[48:49], v2 offset:2048
v_mul_u32_u24 v74, 640, v74
v_mfma_f32_16x16x32_bf16 v[136:139], v[60:63], a[216:219], v[136:139]
ds_read_b64_tr_b16 v[50:51], v2 offset:2560
v_lshl_add_u32 v74, v1, 7, v74
v_mfma_f32_16x16x32_bf16 v[140:143], v[56:59], a[204:207], v[140:143]
ds_read_b64_tr_b16 v[52:53], v2 offset:10240
v_add_u32 v75, 28, v1
v_mfma_f32_16x16x32_bf16 v[140:143], v[60:63], a[220:223], v[140:143]
ds_read_b64_tr_b16 v[54:55], v2 offset:10752
v_and_b32 v75, 64, v75
v_mfma_f32_16x16x32_bf16 v[144:147], v[64:67], a[192:195], v[144:147]
buffer_load_dwordx4 v10, s[4:7], s30 offen offset:0 lds
v_mfma_f32_16x16x32_bf16 v[144:147], v[68:71], a[208:211], v[144:147]
ds_read_b128 v[84:87], v76 offset:832
v_lshl_add_u32 v74, v75, 22, v74
v_mfma_f32_16x16x32_bf16 v[148:151], v[64:67], a[196:199], v[148:151]
v_cvt_pk_bf16_f32 v171, v218, v219
v_fma_f32 v33, v33, s47, v18
v_mul_f32 v32, v32, v172
v_mul_f32 v33, v33, v173
v_mfma_f32_16x16x32_bf16 v[148:151], v[68:71], a[212:215], v[148:151]
v_add_u32 v74, s58, v74
v_mul_f32 v188, v188, v172
v_mfma_f32_16x16x32_bf16 v[152:155], v[64:67], a[200:203], v[152:155]
buffer_load_dwordx4 v11, s[4:7], s30 offen offset:1024 lds
v_mfma_f32_16x16x32_bf16 v[152:155], v[68:71], a[216:219], v[152:155]
ds_write_b128 v14, v[168:171] offset:34816
v_mul_f32 v189, v189, v173
v_mfma_f32_16x16x32_bf16 v[156:159], v[64:67], a[204:207], v[156:159]
v_exp_f32 v32, v32
v_mfma_f32_16x16x32_bf16 v[156:159], v[68:71], a[220:223], v[156:159]
v_exp_f32 v33, v33
v_mfma_f32_16x16x32_bf16 v[92:95], v[80:83], a[192:195], v[92:95]
v_add_f32 v32, 1.0, v32
s_waitcnt lgkmcnt(0)
v_mfma_f32_16x16x32_bf16 v[96:99], v[40:43], a[224:227], v[96:99]
ds_read_b64_tr_b16 v[56:57], v3 offset:0
v_add_f32 v33, 1.0, v33
v_mfma_f32_16x16x32_bf16 v[96:99], v[44:47], a[240:243], v[96:99]
ds_read_b64_tr_b16 v[58:59], v3 offset:512
v_rcp_f32 v32, v32
v_mfma_f32_16x16x32_bf16 v[100:103], v[40:43], a[228:231], v[100:103]
ds_read_b64_tr_b16 v[60:61], v3 offset:8192
v_mul_f32 v188, v188, v32
v_mfma_f32_16x16x32_bf16 v[100:103], v[44:47], a[244:247], v[100:103]
ds_read_b64_tr_b16 v[62:63], v3 offset:8704
v_mul_f32 v34, v174, v174
v_mfma_f32_16x16x32_bf16 v[104:107], v[40:43], a[232:235], v[104:107]
ds_read_b64_tr_b16 v[64:65], v3 offset:2048
v_mul_f32 v35, v175, v175
v_mfma_f32_16x16x32_bf16 v[104:107], v[44:47], a[248:251], v[104:107]
ds_read_b64_tr_b16 v[66:67], v3 offset:2560
v_fma_f32 v34, v34, s47, v18
v_mfma_f32_16x16x32_bf16 v[108:111], v[40:43], a[236:239], v[108:111]
ds_read_b64_tr_b16 v[68:69], v3 offset:10240
v_rcp_f32 v33, v33
v_mfma_f32_16x16x32_bf16 v[108:111], v[44:47], a[252:255], v[108:111]
ds_read_b64_tr_b16 v[70:71], v3 offset:10752
v_mul_f32 v189, v189, v33
v_mfma_f32_16x16x32_bf16 v[112:115], v[48:51], a[224:227], v[112:115]
buffer_load_dwordx4 v10, s[8:11], s30 offen offset:2048 lds
v_mfma_f32_16x16x32_bf16 v[112:115], v[52:55], a[240:243], v[112:115]
ds_read_b128 v[80:83], v76 offset:896
v_fma_f32 v35, v35, s47, v18
v_mfma_f32_16x16x32_bf16 v[116:119], v[48:51], a[228:231], v[116:119]
buffer_store_dwordx4 v[168:171], v16, s[20:23], s50 offen offset:2048 sc1
v_mfma_f32_16x16x32_bf16 v[116:119], v[52:55], a[244:247], v[116:119]
v_mul_f32 v34, v34, v174
v_mul_f32 v35, v35, v175
v_mfma_f32_16x16x32_bf16 v[120:123], v[48:51], a[232:235], v[120:123]
buffer_load_dwordx4 v11, s[8:11], s30 offen offset:3072 lds
v_mfma_f32_16x16x32_bf16 v[120:123], v[52:55], a[248:251], v[120:123]
buffer_load_dword v77, v74, s[16:19], 0 offen offset:2688
v_mfma_f32_16x16x32_bf16 v[124:127], v[48:51], a[236:239], v[124:127]
s_add_u32 m0, s37, 0
v_exp_f32 v34, v34
v_mfma_f32_16x16x32_bf16 v[124:127], v[52:55], a[252:255], v[124:127]
v_mul_f32 v190, v190, v174
s_waitcnt vmcnt(16) lgkmcnt(0)
v_mfma_f32_16x16x32_bf16 v[92:95], v[84:87], a[208:211], v[92:95]
s_barrier
v_mfma_f32_16x16x32_bf16 v[128:131], v[56:59], a[224:227], v[128:131]
ds_read_b64_tr_b16 v[40:41], v2 offset:16384
v_mul_f32 v191, v191, v175
v_mfma_f32_16x16x32_bf16 v[128:131], v[60:63], a[240:243], v[128:131]
ds_read_b64_tr_b16 v[42:43], v2 offset:16896
v_exp_f32 v35, v35
v_mfma_f32_16x16x32_bf16 v[132:135], v[56:59], a[228:231], v[132:135]
ds_read_b64_tr_b16 v[44:45], v2 offset:24576
v_add_f32 v34, 1.0, v34
v_mfma_f32_16x16x32_bf16 v[132:135], v[60:63], a[244:247], v[132:135]
ds_read_b64_tr_b16 v[46:47], v2 offset:25088
v_add_f32 v35, 1.0, v35
v_mfma_f32_16x16x32_bf16 v[136:139], v[56:59], a[232:235], v[136:139]
ds_read_b64_tr_b16 v[48:49], v2 offset:18432
v_cvt_pk_bf16_f32 v172, v188, v189
v_mfma_f32_16x16x32_bf16 v[136:139], v[60:63], a[248:251], v[136:139]
ds_read_b64_tr_b16 v[50:51], v2 offset:18944
v_mul_f32 v36, v204, v204
v_mfma_f32_16x16x32_bf16 v[140:143], v[56:59], a[236:239], v[140:143]
ds_read_b64_tr_b16 v[52:53], v2 offset:26624
v_mul_f32 v37, v205, v205
v_mfma_f32_16x16x32_bf16 v[140:143], v[60:63], a[252:255], v[140:143]
ds_read_b64_tr_b16 v[54:55], v2 offset:27136
v_rcp_f32 v34, v34
v_mfma_f32_16x16x32_bf16 v[144:147], v[64:67], a[224:227], v[144:147]
buffer_load_dwordx4 v10, s[4:7], s31 offen offset:0 lds
v_mfma_f32_16x16x32_bf16 v[144:147], v[68:71], a[240:243], v[144:147]
ds_read_b128 v[84:87], v76 offset:960
v_mul_f32 v190, v190, v34
v_mfma_f32_16x16x32_bf16 v[148:151], v[64:67], a[228:231], v[148:151]
v_rcp_f32 v35, v35
v_mfma_f32_16x16x32_bf16 v[148:151], v[68:71], a[244:247], v[148:151]
v_mul_f32 v191, v191, v35
v_cvt_pk_bf16_f32 v173, v190, v191
v_mfma_f32_16x16x32_bf16 v[152:155], v[64:67], a[232:235], v[152:155]
buffer_load_dwordx4 v11, s[4:7], s31 offen offset:1024 lds
v_mfma_f32_16x16x32_bf16 v[152:155], v[68:71], a[248:251], v[152:155]
v_fma_f32 v36, v36, s47, v18
v_fma_f32 v37, v37, s47, v18
v_mul_f32 v36, v36, v204
v_mfma_f32_16x16x32_bf16 v[156:159], v[64:67], a[236:239], v[156:159]
v_mul_f32 v37, v37, v205
v_mul_f32 v220, v220, v204
v_mfma_f32_16x16x32_bf16 v[156:159], v[68:71], a[252:255], v[156:159]
v_exp_f32 v36, v36
v_mfma_f32_16x16x32_bf16 v[92:95], v[80:83], a[224:227], v[92:95]
v_mul_f32 v221, v221, v205
s_waitcnt lgkmcnt(0)
v_mfma_f32_16x16x32_bf16 v[96:99], v[40:43], v[224:227], v[96:99]
ds_read_b64_tr_b16 v[56:57], v3 offset:16384
v_add_f32 v36, 1.0, v36
v_mfma_f32_16x16x32_bf16 v[96:99], v[44:47], v[240:243], v[96:99]
ds_read_b64_tr_b16 v[58:59], v3 offset:16896
v_mul_f32 v38, v206, v206
v_mfma_f32_16x16x32_bf16 v[100:103], v[40:43], v[228:231], v[100:103]
ds_read_b64_tr_b16 v[60:61], v3 offset:24576
v_exp_f32 v37, v37
v_mfma_f32_16x16x32_bf16 v[100:103], v[44:47], v[244:247], v[100:103]
ds_read_b64_tr_b16 v[62:63], v3 offset:25088
v_add_f32 v37, 1.0, v37
v_mfma_f32_16x16x32_bf16 v[104:107], v[40:43], v[232:235], v[104:107]
ds_read_b64_tr_b16 v[64:65], v3 offset:18432
v_mul_f32 v39, v207, v207
v_mfma_f32_16x16x32_bf16 v[104:107], v[44:47], v[248:251], v[104:107]
ds_read_b64_tr_b16 v[66:67], v3 offset:18944
v_fma_f32 v38, v38, s47, v18
v_mfma_f32_16x16x32_bf16 v[108:111], v[40:43], v[236:239], v[108:111]
ds_read_b64_tr_b16 v[68:69], v3 offset:26624
v_fma_f32 v39, v39, s47, v18
v_mfma_f32_16x16x32_bf16 v[108:111], v[44:47], v[252:255], v[108:111]
ds_read_b64_tr_b16 v[70:71], v3 offset:27136
v_mul_f32 v38, v38, v206
v_mfma_f32_16x16x32_bf16 v[112:115], v[48:51], v[224:227], v[112:115]
buffer_load_dwordx4 v10, s[8:11], s31 offen offset:2048 lds
v_mfma_f32_16x16x32_bf16 v[112:115], v[52:55], v[240:243], v[112:115]
ds_read_b128 v[80:83], v76 offset:1024
v_rcp_f32 v36, v36
v_mfma_f32_16x16x32_bf16 v[116:119], v[48:51], v[228:231], v[116:119]
v_rcp_f32 v37, v37
v_mfma_f32_16x16x32_bf16 v[116:119], v[52:55], v[244:247], v[116:119]
v_mul_f32 v220, v220, v36
v_mul_f32 v221, v221, v37
v_mfma_f32_16x16x32_bf16 v[120:123], v[48:51], v[232:235], v[120:123]
buffer_load_dwordx4 v11, s[8:11], s31 offen offset:3072 lds
v_mfma_f32_16x16x32_bf16 v[120:123], v[52:55], v[248:251], v[120:123]
s_add_u32 m0, s37, 16384
v_mul_f32 v39, v39, v207
v_mfma_f32_16x16x32_bf16 v[124:127], v[48:51], v[236:239], v[124:127]
v_exp_f32 v38, v38
v_mfma_f32_16x16x32_bf16 v[124:127], v[52:55], v[252:255], v[124:127]
v_exp_f32 v39, v39
s_waitcnt vmcnt(14) lgkmcnt(0)
v_mfma_f32_16x16x32_bf16 v[92:95], v[84:87], a[240:243], v[92:95]
s_barrier
v_mfma_f32_16x16x32_bf16 v[128:131], v[56:59], v[224:227], v[128:131]
ds_read_b64_tr_b16 v[40:41], v2 offset:32768
v_mul_f32 v222, v222, v206
v_mfma_f32_16x16x32_bf16 v[128:131], v[60:63], v[240:243], v[128:131]
ds_read_b64_tr_b16 v[42:43], v2 offset:33280
v_mul_f32 v223, v223, v207
v_mfma_f32_16x16x32_bf16 v[132:135], v[56:59], v[228:231], v[132:135]
ds_read_b64_tr_b16 v[44:45], v2 offset:40960
v_add_f32 v38, 1.0, v38
v_mfma_f32_16x16x32_bf16 v[132:135], v[60:63], v[244:247], v[132:135]
ds_read_b64_tr_b16 v[46:47], v2 offset:41472
v_add_f32 v39, 1.0, v39
v_mfma_f32_16x16x32_bf16 v[136:139], v[56:59], v[232:235], v[136:139]
ds_read_b64_tr_b16 v[48:49], v2 offset:34816
v_cvt_pk_bf16_f32 v174, v220, v221
v_mfma_f32_16x16x32_bf16 v[136:139], v[60:63], v[248:251], v[136:139]
ds_read_b64_tr_b16 v[50:51], v2 offset:35328
v_mfma_f32_16x16x32_bf16 v[140:143], v[56:59], v[236:239], v[140:143]
ds_read_b64_tr_b16 v[52:53], v2 offset:43008
v_rcp_f32 v38, v38
v_mfma_f32_16x16x32_bf16 v[140:143], v[60:63], v[252:255], v[140:143]
ds_read_b64_tr_b16 v[54:55], v2 offset:43520
v_mul_f32 v222, v222, v38
v_mfma_f32_16x16x32_bf16 v[144:147], v[64:67], v[224:227], v[144:147]
buffer_load_dwordx4 v10, s[4:7], s32 offen offset:0 lds
v_mfma_f32_16x16x32_bf16 v[144:147], v[68:71], v[240:243], v[144:147]
ds_read_b128 v[84:87], v76 offset:1088
v_mfma_f32_16x16x32_bf16 v[148:151], v[64:67], v[228:231], v[148:151]
v_rcp_f32 v39, v39
v_mfma_f32_16x16x32_bf16 v[148:151], v[68:71], v[244:247], v[148:151]
v_mul_f32 v223, v223, v39
v_cvt_pk_bf16_f32 v175, v222, v223
v_mfma_f32_16x16x32_bf16 v[152:155], v[64:67], v[232:235], v[152:155]
buffer_load_dwordx4 v11, s[4:7], s32 offen offset:1024 lds
v_mfma_f32_16x16x32_bf16 v[152:155], v[68:71], v[248:251], v[152:155]
ds_write_b128 v14, v[172:175] offset:35840
buffer_store_dwordx4 v[172:175], v16, s[20:23], s50 offen offset:3072 sc1
v_mfma_f32_16x16x32_bf16 v[156:159], v[64:67], v[236:239], v[156:159]
v_mfma_f32_16x16x32_bf16 v[156:159], v[68:71], v[252:255], v[156:159]
v_mfma_f32_16x16x32_bf16 v[92:95], v[80:83], v[224:227], v[92:95]
s_waitcnt lgkmcnt(0)
v_mfma_f32_16x16x32_bf16 v[160:163], v[40:43], a[0:3], 0
ds_read_b64_tr_b16 v[56:57], v3 offset:32768
v_mfma_f32_16x16x32_bf16 v[160:163], v[44:47], a[16:19], v[160:163]
ds_read_b64_tr_b16 v[58:59], v3 offset:33280
s_add_u32 s50, s44, 8388608
v_mfma_f32_16x16x32_bf16 v[164:167], v[40:43], a[4:7], 0
ds_read_b64_tr_b16 v[60:61], v3 offset:40960
v_mul_f32 v24, v96, v96
v_mfma_f32_16x16x32_bf16 v[164:167], v[44:47], a[20:23], v[164:167]
ds_read_b64_tr_b16 v[62:63], v3 offset:41472
v_mul_f32 v25, v97, v97
v_mfma_f32_16x16x32_bf16 v[168:171], v[40:43], a[8:11], 0
ds_read_b64_tr_b16 v[64:65], v3 offset:34816
v_fma_f32 v24, v24, s47, v18
v_fma_f32 v25, v25, s47, v18
v_mfma_f32_16x16x32_bf16 v[168:171], v[44:47], a[24:27], v[168:171]
ds_read_b64_tr_b16 v[66:67], v3 offset:35328
v_mul_f32 v24, v24, v96
v_mfma_f32_16x16x32_bf16 v[172:175], v[40:43], a[12:15], 0
ds_read_b64_tr_b16 v[68:69], v3 offset:43008
v_mul_f32 v25, v25, v97
v_mfma_f32_16x16x32_bf16 v[172:175], v[44:47], a[28:31], v[172:175]
ds_read_b64_tr_b16 v[70:71], v3 offset:43520
v_exp_f32 v24, v24
v_mfma_f32_16x16x32_bf16 v[176:179], v[48:51], a[0:3], 0
buffer_load_dwordx4 v10, s[8:11], s32 offen offset:2048 lds
v_mfma_f32_16x16x32_bf16 v[176:179], v[52:55], a[16:19], v[176:179]
s_bfe_u32 s41, s2, 0x30003
s_lshl_b32 s41, s41, 13
v_mfma_f32_16x16x32_bf16 v[180:183], v[48:51], a[4:7], 0
v_exp_f32 v25, v25
v_mfma_f32_16x16x32_bf16 v[180:183], v[52:55], a[20:23], v[180:183]
s_add_u32 s41, s41, 76546048
v_lshrrev_b32 v76, 5, v0
v_mfma_f32_16x16x32_bf16 v[184:187], v[48:51], a[8:11], 0
buffer_load_dwordx4 v11, s[8:11], s32 offen offset:3072 lds
v_mfma_f32_16x16x32_bf16 v[184:187], v[52:55], a[24:27], v[184:187]
s_add_u32 m0, s37, 32768
v_lshlrev_b32 v76, 28, v76
v_mfma_f32_16x16x32_bf16 v[188:191], v[48:51], a[12:15], 0
v_lshl_add_u32 v73, v0, 8, s41
v_add_u32 v76, v76, v73
v_mfma_f32_16x16x32_bf16 v[188:191], v[52:55], a[28:31], v[188:191]
v_mul_f32 v112, v112, v96
v_mul_f32 v113, v113, v97
v_add_f32 v24, 1.0, v24
s_waitcnt vmcnt(15) lgkmcnt(0)
v_mfma_f32_16x16x32_bf16 v[92:95], v[84:87], v[240:243], v[92:95]
s_barrier
v_mfma_f32_16x16x32_bf16 v[192:195], v[56:59], a[0:3], 0
ds_read_b64_tr_b16 v[40:41], v2 offset:49152
v_add_f32 v25, 1.0, v25
v_mul_f32 v26, v98, v98
v_mfma_f32_16x16x32_bf16 v[192:195], v[60:63], a[16:19], v[192:195]
ds_read_b64_tr_b16 v[42:43], v2 offset:49664
v_mul_f32 v27, v99, v99
v_mfma_f32_16x16x32_bf16 v[196:199], v[56:59], a[4:7], 0
ds_read_b64_tr_b16 v[44:45], v2 offset:57344
v_fma_f32 v26, v26, s47, v18
v_mfma_f32_16x16x32_bf16 v[196:199], v[60:63], a[20:23], v[196:199]
ds_read_b64_tr_b16 v[46:47], v2 offset:57856
v_fma_f32 v27, v27, s47, v18
v_mfma_f32_16x16x32_bf16 v[200:203], v[56:59], a[8:11], 0
ds_read_b64_tr_b16 v[48:49], v2 offset:51200
s_and_b32 s43, s40, 3
s_and_b32 s42, s38, 2
v_mfma_f32_16x16x32_bf16 v[200:203], v[60:63], a[24:27], v[200:203]
ds_read_b64_tr_b16 v[50:51], v2 offset:51712
s_lshl1_add_u32 s43, s42, s43
v_mfma_f32_16x16x32_bf16 v[204:207], v[56:59], a[12:15], 0
ds_read_b64_tr_b16 v[52:53], v2 offset:59392
s_lshl3_add_u32 s43, s39, s43
s_lshl_b32 s43, s43, 7
v_mfma_f32_16x16x32_bf16 v[204:207], v[60:63], a[28:31], v[204:207]
ds_read_b64_tr_b16 v[54:55], v2 offset:59904
s_add_u32 s43, s43, 75497472
v_mfma_f32_16x16x32_bf16 v[208:211], v[64:67], a[0:3], 0
buffer_load_dwordx4 v10, s[4:7], s33 offen offset:0 lds
v_mfma_f32_16x16x32_bf16 v[208:211], v[68:71], a[16:19], v[208:211]
v_and_b32 v94, 0x70, v0
v_lshlrev_b32 v94, 24, v94
v_lshl_add_u32 v94, v1, 3, v94
v_mfma_f32_16x16x32_bf16 v[212:215], v[64:67], a[4:7], 0
buffer_load_dword v78, v76, s[20:23], 0 offen sc1
v_mfma_f32_16x16x32_bf16 v[212:215], v[68:71], a[20:23], v[212:215]
v_cvt_pk_bf16_f32 v92, v92, v92
v_and_b32 v92, 0xffff0000, v92
v_mfma_f32_16x16x32_bf16 v[216:219], v[64:67], a[8:11], 0
buffer_load_dwordx4 v11, s[4:7], s33 offen offset:1024 lds
v_mfma_f32_16x16x32_bf16 v[216:219], v[68:71], a[24:27], v[216:219]
v_mul_f32 v92, 0xbfb8aa3b, v92
v_exp_f32 v92, v92
v_mfma_f32_16x16x32_bf16 v[220:223], v[64:67], a[12:15], 0
v_add_f32 v92, 1.0, v92
v_rcp_f32 v92, v92
v_mfma_f32_16x16x32_bf16 v[220:223], v[68:71], a[28:31], v[220:223]
v_cvt_pk_bf16_f32 v92, v92, v92
s_waitcnt lgkmcnt(0)
v_mfma_f32_16x16x32_bf16 v[160:163], v[40:43], a[32:35], v[160:163]
ds_read_b64_tr_b16 v[56:57], v3 offset:49152
v_and_b32 v92, 0xffff0000, v92
v_mfma_f32_16x16x32_bf16 v[160:163], v[44:47], a[48:51], v[160:163]
ds_read_b64_tr_b16 v[58:59], v3 offset:49664
v_sub_f32 v93, 1.0, v92
v_cvt_pk_bf16_f32 v93, v93, v93
v_mfma_f32_16x16x32_bf16 v[164:167], v[40:43], a[36:39], v[164:167]
ds_read_b64_tr_b16 v[60:61], v3 offset:57344
v_and_b32 v93, 0xffff0000, v93
v_mfma_f32_16x16x32_bf16 v[164:167], v[44:47], a[52:55], v[164:167]
ds_read_b64_tr_b16 v[62:63], v3 offset:57856
v_rcp_f32 v24, v24
v_mfma_f32_16x16x32_bf16 v[168:171], v[40:43], a[40:43], v[168:171]
ds_read_b64_tr_b16 v[64:65], v3 offset:51200
v_mul_f32 v112, v112, v24
v_mfma_f32_16x16x32_bf16 v[168:171], v[44:47], a[56:59], v[168:171]
ds_read_b64_tr_b16 v[66:67], v3 offset:51712
v_mul_f32 v26, v26, v98
v_mfma_f32_16x16x32_bf16 v[172:175], v[40:43], a[44:47], v[172:175]
ds_read_b64_tr_b16 v[68:69], v3 offset:59392
v_rcp_f32 v25, v25
v_mfma_f32_16x16x32_bf16 v[172:175], v[44:47], a[60:63], v[172:175]
ds_read_b64_tr_b16 v[70:71], v3 offset:59904
v_mul_f32 v113, v113, v25
v_mfma_f32_16x16x32_bf16 v[176:179], v[48:51], a[32:35], v[176:179]
buffer_load_dwordx4 v10, s[8:11], s33 offen offset:2048 lds
v_mfma_f32_16x16x32_bf16 v[176:179], v[52:55], a[48:51], v[176:179]
ds_read_b128 a[0:3], v15 offset:16384
v_mul_f32 v27, v27, v99
v_mul_f32 v114, v114, v98
v_mfma_f32_16x16x32_bf16 v[180:183], v[48:51], a[36:39], v[180:183]
buffer_store_dwordx2 v[92:93], v94, s[20:23], s43 offen sc1
v_mfma_f32_16x16x32_bf16 v[180:183], v[52:55], a[52:55], v[180:183]
ds_read_b128 a[4:7], v15 offset:17408
v_exp_f32 v26, v26
v_mfma_f32_16x16x32_bf16 v[184:187], v[48:51], a[40:43], v[184:187]
buffer_load_dwordx4 v11, s[8:11], s33 offen offset:3072 lds
v_mfma_f32_16x16x32_bf16 v[184:187], v[52:55], a[56:59], v[184:187]
s_add_u32 m0, s37, 49152
v_exp_f32 v27, v27
v_mfma_f32_16x16x32_bf16 v[188:191], v[48:51], a[44:47], v[188:191]
v_mul_f32 v115, v115, v99
s_waitcnt vmcnt(16) lgkmcnt(0)
v_mfma_f32_16x16x32_bf16 v[188:191], v[52:55], a[60:63], v[188:191]
s_barrier
v_mfma_f32_16x16x32_bf16 v[192:195], v[56:59], a[32:35], v[192:195]
ds_read_b64_tr_b16 v[40:41], v4 offset:0
v_add_f32 v26, 1.0, v26
v_add_f32 v27, 1.0, v27
v_mfma_f32_16x16x32_bf16 v[192:195], v[60:63], a[48:51], v[192:195]
ds_read_b64_tr_b16 v[42:43], v4 offset:512
v_cvt_pk_bf16_f32 v96, v112, v113
v_mfma_f32_16x16x32_bf16 v[196:199], v[56:59], a[36:39], v[196:199]
ds_read_b64_tr_b16 v[44:45], v4 offset:8192
v_rcp_f32 v26, v26
v_mfma_f32_16x16x32_bf16 v[196:199], v[60:63], a[52:55], v[196:199]
ds_read_b64_tr_b16 v[46:47], v4 offset:8704
v_mul_f32 v114, v114, v26
v_mfma_f32_16x16x32_bf16 v[200:203], v[56:59], a[40:43], v[200:203]
ds_read_b64_tr_b16 v[48:49], v4 offset:2048
v_rcp_f32 v27, v27
v_mfma_f32_16x16x32_bf16 v[200:203], v[60:63], a[56:59], v[200:203]
ds_read_b64_tr_b16 v[50:51], v4 offset:2560
v_mul_f32 v115, v115, v27
v_mfma_f32_16x16x32_bf16 v[204:207], v[56:59], a[44:47], v[204:207]
ds_read_b64_tr_b16 v[52:53], v4 offset:10240
v_cvt_pk_bf16_f32 v97, v114, v115
v_mfma_f32_16x16x32_bf16 v[204:207], v[60:63], a[60:63], v[204:207]
ds_read_b64_tr_b16 v[54:55], v4 offset:10752
v_mul_f32 v28, v128, v128
v_mul_f32 v29, v129, v129
v_mfma_f32_16x16x32_bf16 v[208:211], v[64:67], a[32:35], v[208:211]
buffer_load_dwordx4 v10, s[4:7], s34 offen offset:0 lds
v_mfma_f32_16x16x32_bf16 v[208:211], v[68:71], a[48:51], v[208:211]
ds_read_b128 a[8:11], v15 offset:18432
v_fma_f32 v28, v28, s47, v18
v_fma_f32 v29, v29, s47, v18
v_mfma_f32_16x16x32_bf16 v[212:215], v[64:67], a[36:39], v[212:215]
ds_read_b128 a[12:15], v15 offset:19456
v_mul_f32 v28, v28, v128
v_mfma_f32_16x16x32_bf16 v[212:215], v[68:71], a[52:55], v[212:215]
ds_read_b128 a[16:19], v15 offset:24576
v_mul_f32 v29, v29, v129
v_mul_f32 v144, v144, v128
v_mfma_f32_16x16x32_bf16 v[216:219], v[64:67], a[40:43], v[216:219]
buffer_load_dwordx4 v11, s[4:7], s34 offen offset:1024 lds
v_mfma_f32_16x16x32_bf16 v[216:219], v[68:71], a[56:59], v[216:219]
v_exp_f32 v28, v28
v_mfma_f32_16x16x32_bf16 v[220:223], v[64:67], a[44:47], v[220:223]
v_exp_f32 v29, v29
v_mul_f32 v145, v145, v129
v_mfma_f32_16x16x32_bf16 v[220:223], v[68:71], a[60:63], v[220:223]
v_add_f32 v28, 1.0, v28
s_waitcnt lgkmcnt(0)
v_mfma_f32_16x16x32_bf16 v[160:163], v[40:43], a[64:67], v[160:163]
ds_read_b64_tr_b16 v[56:57], v5 offset:0
v_add_f32 v29, 1.0, v29
v_mul_f32 v30, v130, v130
v_mfma_f32_16x16x32_bf16 v[160:163], v[44:47], a[80:83], v[160:163]
ds_read_b64_tr_b16 v[58:59], v5 offset:512
v_mul_f32 v31, v131, v131
v_mfma_f32_16x16x32_bf16 v[164:167], v[40:43], a[68:71], v[164:167]
ds_read_b64_tr_b16 v[60:61], v5 offset:8192
v_fma_f32 v30, v30, s47, v18
v_mfma_f32_16x16x32_bf16 v[164:167], v[44:47], a[84:87], v[164:167]
ds_read_b64_tr_b16 v[62:63], v5 offset:8704
v_rcp_f32 v28, v28
v_mfma_f32_16x16x32_bf16 v[168:171], v[40:43], a[72:75], v[168:171]
ds_read_b64_tr_b16 v[64:65], v5 offset:2048
v_mul_f32 v144, v144, v28
v_mfma_f32_16x16x32_bf16 v[168:171], v[44:47], a[88:91], v[168:171]
ds_read_b64_tr_b16 v[66:67], v5 offset:2560
v_rcp_f32 v29, v29
v_mfma_f32_16x16x32_bf16 v[172:175], v[40:43], a[76:79], v[172:175]
ds_read_b64_tr_b16 v[68:69], v5 offset:10240
v_mul_f32 v145, v145, v29
v_mfma_f32_16x16x32_bf16 v[172:175], v[44:47], a[92:95], v[172:175]
ds_read_b64_tr_b16 v[70:71], v5 offset:10752
v_fma_f32 v31, v31, s47, v18
v_mfma_f32_16x16x32_bf16 v[176:179], v[48:51], a[64:67], v[176:179]
buffer_load_dwordx4 v10, s[8:11], s34 offen offset:2048 lds
v_mfma_f32_16x16x32_bf16 v[176:179], v[52:55], a[80:83], v[176:179]
ds_read_b128 a[20:23], v15 offset:25600
v_mul_f32 v30, v30, v130
v_mul_f32 v31, v31, v131
v_mfma_f32_16x16x32_bf16 v[180:183], v[48:51], a[68:71], v[180:183]
ds_read_b128 a[24:27], v15 offset:26624
v_exp_f32 v30, v30
v_mfma_f32_16x16x32_bf16 v[180:183], v[52:55], a[84:87], v[180:183]
ds_read_b128 a[28:31], v15 offset:27648
v_mul_f32 v146, v146, v130
v_mfma_f32_16x16x32_bf16 v[184:187], v[48:51], a[72:75], v[184:187]
buffer_load_dwordx4 v11, s[8:11], s34 offen offset:3072 lds
v_mfma_f32_16x16x32_bf16 v[184:187], v[52:55], a[88:91], v[184:187]
s_add_u32 m0, s37, 65536
v_exp_f32 v31, v31
v_mfma_f32_16x16x32_bf16 v[188:191], v[48:51], a[76:79], v[188:191]
v_mul_f32 v147, v147, v131
s_waitcnt vmcnt(12) lgkmcnt(0)
v_mfma_f32_16x16x32_bf16 v[188:191], v[52:55], a[92:95], v[188:191]
s_barrier
v_mfma_f32_16x16x32_bf16 v[192:195], v[56:59], a[64:67], v[192:195]
ds_read_b64_tr_b16 v[40:41], v2 offset:0
v_add_f32 v30, 1.0, v30
v_add_f32 v31, 1.0, v31
v_mfma_f32_16x16x32_bf16 v[192:195], v[60:63], a[80:83], v[192:195]
ds_read_b64_tr_b16 v[42:43], v2 offset:512
v_cvt_pk_bf16_f32 v98, v144, v145
v_mfma_f32_16x16x32_bf16 v[196:199], v[56:59], a[68:71], v[196:199]
ds_read_b64_tr_b16 v[44:45], v2 offset:8192
v_rcp_f32 v30, v30
v_mfma_f32_16x16x32_bf16 v[196:199], v[60:63], a[84:87], v[196:199]
ds_read_b64_tr_b16 v[46:47], v2 offset:8704
v_mul_f32 v146, v146, v30
v_mfma_f32_16x16x32_bf16 v[200:203], v[56:59], a[72:75], v[200:203]
ds_read_b64_tr_b16 v[48:49], v2 offset:2048
v_rcp_f32 v31, v31
v_mfma_f32_16x16x32_bf16 v[200:203], v[60:63], a[88:91], v[200:203]
ds_read_b64_tr_b16 v[50:51], v2 offset:2560
v_mul_f32 v147, v147, v31
v_mfma_f32_16x16x32_bf16 v[204:207], v[56:59], a[76:79], v[204:207]
ds_read_b64_tr_b16 v[52:53], v2 offset:10240
v_mov_b32 v20, 2
v_mfma_f32_16x16x32_bf16 v[204:207], v[60:63], a[92:95], v[204:207]
ds_read_b64_tr_b16 v[54:55], v2 offset:10752
v_cvt_pk_bf16_f32 v99, v146, v147
v_mul_f32 v32, v100, v100
v_mfma_f32_16x16x32_bf16 v[208:211], v[64:67], a[64:67], v[208:211]
buffer_load_dwordx4 v10, s[4:7], s35 offen offset:0 lds
v_mfma_f32_16x16x32_bf16 v[208:211], v[68:71], a[80:83], v[208:211]
ds_write_b128 v14, v[96:99] offset:49152
v_mul_f32 v33, v101, v101
v_mfma_f32_16x16x32_bf16 v[212:215], v[64:67], a[68:71], v[212:215]
buffer_store_dword v20, v19, s[20:23], 0 offen sc1
v_mfma_f32_16x16x32_bf16 v[212:215], v[68:71], a[84:87], v[212:215]
v_fma_f32 v32, v32, s47, v18
v_fma_f32 v33, v33, s47, v18
v_mul_f32 v32, v32, v100
v_mfma_f32_16x16x32_bf16 v[216:219], v[64:67], a[72:75], v[216:219]
buffer_load_dwordx4 v11, s[4:7], s35 offen offset:1024 lds
v_mfma_f32_16x16x32_bf16 v[216:219], v[68:71], a[88:91], v[216:219]
v_mul_f32 v33, v33, v101
v_mul_f32 v116, v116, v100
v_mfma_f32_16x16x32_bf16 v[220:223], v[64:67], a[76:79], v[220:223]
v_exp_f32 v32, v32
v_mul_f32 v117, v117, v101
v_mfma_f32_16x16x32_bf16 v[220:223], v[68:71], a[92:95], v[220:223]
v_add_f32 v32, 1.0, v32
s_waitcnt lgkmcnt(0)
v_mfma_f32_16x16x32_bf16 v[160:163], v[40:43], a[96:99], v[160:163]
ds_read_b64_tr_b16 v[56:57], v3 offset:0
v_exp_f32 v33, v33
v_mfma_f32_16x16x32_bf16 v[160:163], v[44:47], a[112:115], v[160:163]
ds_read_b64_tr_b16 v[58:59], v3 offset:512
v_add_f32 v33, 1.0, v33
v_mfma_f32_16x16x32_bf16 v[164:167], v[40:43], a[100:103], v[164:167]
ds_read_b64_tr_b16 v[60:61], v3 offset:8192
v_rcp_f32 v32, v32
v_mfma_f32_16x16x32_bf16 v[164:167], v[44:47], a[116:119], v[164:167]
ds_read_b64_tr_b16 v[62:63], v3 offset:8704
v_mul_f32 v116, v116, v32
v_mfma_f32_16x16x32_bf16 v[168:171], v[40:43], a[104:107], v[168:171]
ds_read_b64_tr_b16 v[64:65], v3 offset:2048
v_mul_f32 v34, v102, v102
v_mfma_f32_16x16x32_bf16 v[168:171], v[44:47], a[120:123], v[168:171]
ds_read_b64_tr_b16 v[66:67], v3 offset:2560
v_rcp_f32 v33, v33
v_mfma_f32_16x16x32_bf16 v[172:175], v[40:43], a[108:111], v[172:175]
ds_read_b64_tr_b16 v[68:69], v3 offset:10240
v_mul_f32 v117, v117, v33
v_mfma_f32_16x16x32_bf16 v[172:175], v[44:47], a[124:127], v[172:175]
ds_read_b64_tr_b16 v[70:71], v3 offset:10752
v_mul_f32 v35, v103, v103
v_fma_f32 v34, v34, s47, v18
v_mfma_f32_16x16x32_bf16 v[176:179], v[48:51], a[96:99], v[176:179]
buffer_load_dwordx4 v10, s[8:11], s35 offen offset:2048 lds
v_mfma_f32_16x16x32_bf16 v[176:179], v[52:55], a[112:115], v[176:179]
ds_read_b128 a[32:35], v15 offset:32768
v_fma_f32 v35, v35, s47, v18
v_mul_f32 v34, v34, v102
v_mfma_f32_16x16x32_bf16 v[180:183], v[48:51], a[100:103], v[180:183]
buffer_store_dwordx4 v[96:99], v16, s[20:23], s50 offen offset:0 sc1
v_mfma_f32_16x16x32_bf16 v[180:183], v[52:55], a[116:119], v[180:183]
ds_read_b128 a[36:39], v15 offset:33792
v_mul_f32 v35, v35, v103
v_mul_f32 v118, v118, v102
v_mfma_f32_16x16x32_bf16 v[184:187], v[48:51], a[104:107], v[184:187]
buffer_load_dwordx4 v11, s[8:11], s35 offen offset:3072 lds
v_mfma_f32_16x16x32_bf16 v[184:187], v[52:55], a[120:123], v[184:187]
s_add_u32 m0, s37, 0
v_mul_f32 v119, v119, v103
v_mfma_f32_16x16x32_bf16 v[188:191], v[48:51], a[108:111], v[188:191]
v_exp_f32 v34, v34
s_waitcnt vmcnt(16) lgkmcnt(0)
v_mfma_f32_16x16x32_bf16 v[188:191], v[52:55], a[124:127], v[188:191]
s_barrier
v_mfma_f32_16x16x32_bf16 v[192:195], v[56:59], a[96:99], v[192:195]
ds_read_b64_tr_b16 v[40:41], v2 offset:16384
v_exp_f32 v35, v35
v_mfma_f32_16x16x32_bf16 v[192:195], v[60:63], a[112:115], v[192:195]
ds_read_b64_tr_b16 v[42:43], v2 offset:16896
v_add_f32 v34, 1.0, v34
v_mfma_f32_16x16x32_bf16 v[196:199], v[56:59], a[100:103], v[196:199]
ds_read_b64_tr_b16 v[44:45], v2 offset:24576
v_add_f32 v35, 1.0, v35
v_cvt_pk_bf16_f32 v100, v116, v117
v_mfma_f32_16x16x32_bf16 v[196:199], v[60:63], a[116:119], v[196:199]
ds_read_b64_tr_b16 v[46:47], v2 offset:25088
v_mul_f32 v36, v132, v132
v_mfma_f32_16x16x32_bf16 v[200:203], v[56:59], a[104:107], v[200:203]
ds_read_b64_tr_b16 v[48:49], v2 offset:18432
v_rcp_f32 v34, v34
v_mfma_f32_16x16x32_bf16 v[200:203], v[60:63], a[120:123], v[200:203]
ds_read_b64_tr_b16 v[50:51], v2 offset:18944
v_mul_f32 v118, v118, v34
v_mfma_f32_16x16x32_bf16 v[204:207], v[56:59], a[108:111], v[204:207]
ds_read_b64_tr_b16 v[52:53], v2 offset:26624
v_mul_f32 v37, v133, v133
v_mfma_f32_16x16x32_bf16 v[204:207], v[60:63], a[124:127], v[204:207]
ds_read_b64_tr_b16 v[54:55], v2 offset:27136
v_rcp_f32 v35, v35
v_mfma_f32_16x16x32_bf16 v[208:211], v[64:67], a[96:99], v[208:211]
buffer_load_dwordx4 v10, s[4:7], s36 offen offset:0 lds
v_mfma_f32_16x16x32_bf16 v[208:211], v[68:71], a[112:115], v[208:211]
ds_read_b128 a[40:43], v15 offset:34816
v_mul_f32 v119, v119, v35
v_cvt_pk_bf16_f32 v101, v118, v119
v_mfma_f32_16x16x32_bf16 v[212:215], v[64:67], a[100:103], v[212:215]
ds_read_b128 a[44:47], v15 offset:35840
v_fma_f32 v36, v36, s47, v18
v_mfma_f32_16x16x32_bf16 v[212:215], v[68:71], a[116:119], v[212:215]
ds_read_b128 a[48:51], v15 offset:40960
v_fma_f32 v37, v37, s47, v18
v_mul_f32 v36, v36, v132
v_mfma_f32_16x16x32_bf16 v[216:219], v[64:67], a[104:107], v[216:219]
buffer_load_dwordx4 v11, s[4:7], s36 offen offset:1024 lds
v_mfma_f32_16x16x32_bf16 v[216:219], v[68:71], a[120:123], v[216:219]
v_mul_f32 v37, v37, v133
v_mul_f32 v148, v148, v132
v_mfma_f32_16x16x32_bf16 v[220:223], v[64:67], a[108:111], v[220:223]
v_exp_f32 v36, v36
v_mul_f32 v149, v149, v133
v_mfma_f32_16x16x32_bf16 v[220:223], v[68:71], a[124:127], v[220:223]
v_add_f32 v36, 1.0, v36
s_waitcnt lgkmcnt(0)
v_mfma_f32_16x16x32_bf16 v[160:163], v[40:43], a[128:131], v[160:163]
ds_read_b64_tr_b16 v[56:57], v3 offset:16384
v_exp_f32 v37, v37
v_mfma_f32_16x16x32_bf16 v[160:163], v[44:47], a[144:147], v[160:163]
ds_read_b64_tr_b16 v[58:59], v3 offset:16896
v_add_f32 v37, 1.0, v37
v_mfma_f32_16x16x32_bf16 v[164:167], v[40:43], a[132:135], v[164:167]
ds_read_b64_tr_b16 v[60:61], v3 offset:24576
v_rcp_f32 v36, v36
v_mfma_f32_16x16x32_bf16 v[164:167], v[44:47], a[148:151], v[164:167]
ds_read_b64_tr_b16 v[62:63], v3 offset:25088
v_mul_f32 v148, v148, v36
v_mfma_f32_16x16x32_bf16 v[168:171], v[40:43], a[136:139], v[168:171]
ds_read_b64_tr_b16 v[64:65], v3 offset:18432
v_rcp_f32 v37, v37
v_mfma_f32_16x16x32_bf16 v[168:171], v[44:47], a[152:155], v[168:171]
ds_read_b64_tr_b16 v[66:67], v3 offset:18944
v_mul_f32 v149, v149, v37
v_mfma_f32_16x16x32_bf16 v[172:175], v[40:43], a[140:143], v[172:175]
ds_read_b64_tr_b16 v[68:69], v3 offset:26624
v_mul_f32 v38, v134, v134
v_mfma_f32_16x16x32_bf16 v[172:175], v[44:47], a[156:159], v[172:175]
ds_read_b64_tr_b16 v[70:71], v3 offset:27136
v_mul_f32 v39, v135, v135
v_fma_f32 v38, v38, s47, v18
v_mfma_f32_16x16x32_bf16 v[176:179], v[48:51], a[128:131], v[176:179]
buffer_load_dwordx4 v10, s[8:11], s36 offen offset:2048 lds
v_mfma_f32_16x16x32_bf16 v[176:179], v[52:55], a[144:147], v[176:179]
ds_read_b128 a[52:55], v15 offset:41984
v_fma_f32 v39, v39, s47, v18
v_mul_f32 v38, v38, v134
v_mfma_f32_16x16x32_bf16 v[180:183], v[48:51], a[132:135], v[180:183]
ds_read_b128 a[56:59], v15 offset:43008
v_mul_f32 v39, v39, v135
v_mfma_f32_16x16x32_bf16 v[180:183], v[52:55], a[148:151], v[180:183]
s_waitcnt vmcnt(17)
v_cmp_gt_u32 vcc, s101, v78
s_cmp_eq_u32 vcc_lo, 0
s_cbranch_scc0 L_spin10
L_back10:
v_mfma_f32_16x16x32_bf16 v[184:187], v[48:51], a[136:139], v[184:187]
buffer_load_dwordx4 v11, s[8:11], s36 offen offset:3072 lds
v_mfma_f32_16x16x32_bf16 v[184:187], v[52:55], a[152:155], v[184:187]
v_exp_f32 v38, v38
v_exp_f32 v39, v39
v_mfma_f32_16x16x32_bf16 v[188:191], v[48:51], a[140:143], v[188:191]
v_mul_f32 v150, v150, v134
s_waitcnt vmcnt(14) lgkmcnt(0)
v_mfma_f32_16x16x32_bf16 v[188:191], v[52:55], a[156:159], v[188:191]
s_barrier
v_mfma_f32_16x16x32_bf16 v[192:195], v[56:59], a[128:131], v[192:195]
ds_read_b64_tr_b16 v[40:41], v2 offset:32768
s_mul_i32 s41, s38, 21504
v_mfma_f32_16x16x32_bf16 v[192:195], v[60:63], a[144:147], v[192:195]
ds_read_b64_tr_b16 v[42:43], v2 offset:33280
s_add_u32 s41, s41, 16384
v_mfma_f32_16x16x32_bf16 v[196:199], v[56:59], a[132:135], v[196:199]
ds_read_b64_tr_b16 v[44:45], v2 offset:40960
v_lshlrev_b32 v74, 4, v1
v_mfma_f32_16x16x32_bf16 v[196:199], v[60:63], a[148:151], v[196:199]
ds_read_b64_tr_b16 v[46:47], v2 offset:41472
v_bfe_u32 v84, v1, 2, 2
v_mfma_f32_16x16x32_bf16 v[200:203], v[56:59], a[136:139], v[200:203]
ds_read_b64_tr_b16 v[48:49], v2 offset:34816
v_mul_u32_u24 v84, 4160, v84
v_mfma_f32_16x16x32_bf16 v[200:203], v[60:63], a[152:155], v[200:203]
ds_read_b64_tr_b16 v[50:51], v2 offset:35328
v_and_b32 v85, 48, v74
v_mfma_f32_16x16x32_bf16 v[204:207], v[56:59], a[140:143], v[204:207]
ds_read_b64_tr_b16 v[52:53], v2 offset:43008
v_add_u32 v84, v84, v85
v_mfma_f32_16x16x32_bf16 v[204:207], v[60:63], a[156:159], v[204:207]
ds_read_b64_tr_b16 v[54:55], v2 offset:43520
v_add_u32 v85, 16640, v74
v_mfma_f32_16x16x32_bf16 v[208:211], v[64:67], a[128:131], v[208:211]
ds_read_b128 a[60:63], v15 offset:44032
v_mul_f32 v151, v151, v135
v_add_f32 v38, 1.0, v38
v_add_f32 v39, 1.0, v39
v_rcp_f32 v38, v38
v_mfma_f32_16x16x32_bf16 v[208:211], v[68:71], a[144:147], v[208:211]
v_cmp_gt_u32 vcc, 32, v1
v_mov_b32 v80, 0
v_mfma_f32_16x16x32_bf16 v[212:215], v[64:67], a[132:135], v[212:215]
v_rcp_f32 v39, v39
v_mul_f32 v150, v150, v38
v_mfma_f32_16x16x32_bf16 v[212:215], v[68:71], a[148:151], v[212:215]
v_mov_b32 v81, 0
v_cndmask_b32 v84, v84, v85, vcc
v_mfma_f32_16x16x32_bf16 v[216:219], v[64:67], a[136:139], v[216:219]
v_mul_f32 v151, v151, v39
v_cvt_pk_bf16_f32 v102, v148, v149
v_cvt_pk_bf16_f32 v103, v150, v151
v_mfma_f32_16x16x32_bf16 v[216:219], v[68:71], a[152:155], v[216:219]
v_mov_b32 v82, 0
v_mov_b32 v83, 0
v_mfma_f32_16x16x32_bf16 v[220:223], v[64:67], a[140:143], v[220:223]
v_add_u32 v72, s41, v84
v_add_u32 v73, 102400, v84
v_mfma_f32_16x16x32_bf16 v[220:223], v[68:71], a[156:159], v[220:223]
s_bfe_u32 s42, s2, 0x10006
s_waitcnt lgkmcnt(0)
v_mfma_f32_16x16x32_bf16 v[160:163], v[40:43], a[160:163], v[160:163]
ds_read_b64_tr_b16 v[56:57], v3 offset:32768
s_mul_i32 s42, s42, 2146435072
v_mfma_f32_16x16x32_bf16 v[160:163], v[44:47], a[176:179], v[160:163]
ds_read_b64_tr_b16 v[58:59], v3 offset:33280
v_add_u32 v75, s42, v74
v_mfma_f32_16x16x32_bf16 v[164:167], v[40:43], a[164:167], v[164:167]
ds_read_b64_tr_b16 v[60:61], v3 offset:40960
s_mul_i32 s42, s3, 4224
v_mfma_f32_16x16x32_bf16 v[164:167], v[44:47], a[180:183], v[164:167]
ds_read_b64_tr_b16 v[62:63], v3 offset:41472
s_mul_i32 s43, s100, 4224
v_mfma_f32_16x16x32_bf16 v[168:171], v[40:43], a[168:171], v[168:171]
ds_read_b64_tr_b16 v[64:65], v3 offset:34816
v_mul_f32 v24, v104, v104
v_mul_f32 v25, v105, v105
v_fma_f32 v24, v24, s47, v18
v_fma_f32 v25, v25, s47, v18
v_mul_f32 v24, v24, v104
v_mfma_f32_16x16x32_bf16 v[168:171], v[44:47], a[184:187], v[168:171]
ds_read_b64_tr_b16 v[66:67], v3 offset:35328
v_mul_f32 v25, v25, v105
v_mfma_f32_16x16x32_bf16 v[172:175], v[40:43], a[172:175], v[172:175]
ds_read_b64_tr_b16 v[68:69], v3 offset:43008
v_exp_f32 v24, v24
v_mfma_f32_16x16x32_bf16 v[172:175], v[44:47], a[188:191], v[172:175]
ds_read_b64_tr_b16 v[70:71], v3 offset:43520
v_mul_f32 v120, v120, v104
v_mfma_f32_16x16x32_bf16 v[176:179], v[48:51], a[160:163], v[176:179]
buffer_store_dwordx4 v[100:103], v16, s[20:23], s50 offen offset:1024 sc1
v_mfma_f32_16x16x32_bf16 v[176:179], v[52:55], a[176:179], v[176:179]
ds_write_b128 v14, v[100:103] offset:50176
v_mul_f32 v121, v121, v105
v_mfma_f32_16x16x32_bf16 v[180:183], v[48:51], a[164:167], v[180:183]
v_exp_f32 v25, v25
v_mfma_f32_16x16x32_bf16 v[180:183], v[52:55], a[180:183], v[180:183]
v_add_f32 v24, 1.0, v24
v_add_f32 v25, 1.0, v25
v_mul_f32 v26, v106, v106
v_mfma_f32_16x16x32_bf16 v[184:187], v[48:51], a[168:171], v[184:187]
v_rcp_f32 v24, v24
v_mfma_f32_16x16x32_bf16 v[184:187], v[52:55], a[184:187], v[184:187]
v_rcp_f32 v25, v25
v_mul_f32 v120, v120, v24
v_mfma_f32_16x16x32_bf16 v[188:191], v[48:51], a[172:175], v[188:191]
v_mul_f32 v121, v121, v25
s_waitcnt vmcnt(11) lgkmcnt(0)
v_mfma_f32_16x16x32_bf16 v[188:191], v[52:55], a[188:191], v[188:191]
s_barrier
v_mfma_f32_16x16x32_bf16 v[192:195], v[56:59], a[160:163], v[192:195]
ds_read_b64_tr_b16 v[40:41], v2 offset:49152
v_mul_f32 v27, v107, v107
v_fma_f32 v26, v26, s47, v18
v_mfma_f32_16x16x32_bf16 v[192:195], v[60:63], a[176:179], v[192:195]
ds_read_b64_tr_b16 v[42:43], v2 offset:49664
v_fma_f32 v27, v27, s47, v18
v_mfma_f32_16x16x32_bf16 v[196:199], v[56:59], a[164:167], v[196:199]
ds_read_b64_tr_b16 v[44:45], v2 offset:57344
v_mul_f32 v26, v26, v106
v_mul_f32 v27, v27, v107
v_mfma_f32_16x16x32_bf16 v[196:199], v[60:63], a[180:183], v[196:199]
ds_read_b64_tr_b16 v[46:47], v2 offset:57856
v_mul_f32 v122, v122, v106
v_mfma_f32_16x16x32_bf16 v[200:203], v[56:59], a[168:171], v[200:203]
ds_read_b64_tr_b16 v[48:49], v2 offset:51200
v_exp_f32 v26, v26
v_mfma_f32_16x16x32_bf16 v[200:203], v[60:63], a[184:187], v[200:203]
ds_read_b64_tr_b16 v[50:51], v2 offset:51712
v_mul_f32 v123, v123, v107
v_mfma_f32_16x16x32_bf16 v[204:207], v[56:59], a[172:175], v[204:207]
ds_read_b64_tr_b16 v[52:53], v2 offset:59392
v_exp_f32 v27, v27
v_mfma_f32_16x16x32_bf16 v[204:207], v[60:63], a[188:191], v[204:207]
ds_read_b64_tr_b16 v[54:55], v2 offset:59904
v_add_f32 v26, 1.0, v26
v_mfma_f32_16x16x32_bf16 v[208:211], v[64:67], a[160:163], v[208:211]
v_add_f32 v27, 1.0, v27
v_cvt_pk_bf16_f32 v104, v120, v121
v_mfma_f32_16x16x32_bf16 v[208:211], v[68:71], a[176:179], v[208:211]
ds_write_b128 v73, v[80:83]
v_mfma_f32_16x16x32_bf16 v[212:215], v[64:67], a[164:167], v[212:215]
v_rcp_f32 v26, v26
v_mul_f32 v28, v136, v136
v_mfma_f32_16x16x32_bf16 v[212:215], v[68:71], a[180:183], v[212:215]
s_lshl_b32 s49, s38, 10
s_add_u32 s48, s43, s49
v_mfma_f32_16x16x32_bf16 v[216:219], v[64:67], a[168:171], v[216:219]
v_rcp_f32 v27, v27
v_mul_f32 v122, v122, v26
v_mfma_f32_16x16x32_bf16 v[216:219], v[68:71], a[184:187], v[216:219]
s_add_u32 s48, s48, 67113088
s_add_u32 m0, s49, 102464
v_mfma_f32_16x16x32_bf16 v[220:223], v[64:67], a[172:175], v[220:223]
v_mul_f32 v123, v123, v27
v_cvt_pk_bf16_f32 v105, v122, v123
v_mul_f32 v29, v137, v137
v_mfma_f32_16x16x32_bf16 v[220:223], v[68:71], a[188:191], v[220:223]
v_fma_f32 v28, v28, s47, v18
s_waitcnt lgkmcnt(0)
v_mfma_f32_16x16x32_bf16 v[160:163], v[40:43], a[192:195], v[160:163]
ds_read_b64_tr_b16 v[56:57], v3 offset:49152
v_fma_f32 v29, v29, s47, v18
v_mul_f32 v28, v28, v136
v_mfma_f32_16x16x32_bf16 v[160:163], v[44:47], a[208:211], v[160:163]
ds_read_b64_tr_b16 v[58:59], v3 offset:49664
v_mul_f32 v29, v29, v137
v_mfma_f32_16x16x32_bf16 v[164:167], v[40:43], a[196:199], v[164:167]
ds_read_b64_tr_b16 v[60:61], v3 offset:57344
v_exp_f32 v28, v28
v_mfma_f32_16x16x32_bf16 v[164:167], v[44:47], a[212:215], v[164:167]
ds_read_b64_tr_b16 v[62:63], v3 offset:57856
v_mul_f32 v152, v152, v136
v_mfma_f32_16x16x32_bf16 v[168:171], v[40:43], a[200:203], v[168:171]
ds_read_b64_tr_b16 v[64:65], v3 offset:51200
v_exp_f32 v29, v29
v_mfma_f32_16x16x32_bf16 v[168:171], v[44:47], a[216:219], v[168:171]
ds_read_b64_tr_b16 v[66:67], v3 offset:51712
v_mul_f32 v153, v153, v137
v_mfma_f32_16x16x32_bf16 v[172:175], v[40:43], a[204:207], v[172:175]
ds_read_b64_tr_b16 v[68:69], v3 offset:59392
v_add_f32 v28, 1.0, v28
v_mfma_f32_16x16x32_bf16 v[172:175], v[44:47], a[220:223], v[172:175]
ds_read_b64_tr_b16 v[70:71], v3 offset:59904
v_add_f32 v29, 1.0, v29
v_mul_f32 v30, v138, v138
v_mfma_f32_16x16x32_bf16 v[176:179], v[48:51], a[192:195], v[176:179]
buffer_load_dwordx4 v75, s[20:23], s48 offen sc1 lds
v_mfma_f32_16x16x32_bf16 v[176:179], v[52:55], a[208:211], v[176:179]
s_sub_u32 s48, s48, 4
s_add_u32 m0, s49, 110784
v_mfma_f32_16x16x32_bf16 v[180:183], v[48:51], a[196:199], v[180:183]
buffer_load_dwordx4 v75, s[20:23], s48 offen sc1 lds
v_mfma_f32_16x16x32_bf16 v[180:183], v[52:55], a[212:215], v[180:183]
s_lshl_b32 s48, s100, 12
s_add_u32 s48, s48, s49
v_mfma_f32_16x16x32_bf16 v[184:187], v[48:51], a[200:203], v[184:187]
v_rcp_f32 v28, v28
v_rcp_f32 v29, v29
v_mfma_f32_16x16x32_bf16 v[184:187], v[52:55], a[216:219], v[184:187]
s_add_u32 m0, s49, 119552
v_mul_f32 v152, v152, v28
v_mfma_f32_16x16x32_bf16 v[188:191], v[48:51], a[204:207], v[188:191]
v_mul_f32 v153, v153, v29
v_mul_f32 v31, v139, v139
s_waitcnt vmcnt(7) lgkmcnt(0)
v_mfma_f32_16x16x32_bf16 v[188:191], v[52:55], a[220:223], v[188:191]
s_barrier
v_mfma_f32_16x16x32_bf16 v[192:195], v[56:59], a[192:195], v[192:195]
ds_read_b64_tr_b16 v[40:41], v4 offset:0
v_fma_f32 v30, v30, s47, v18
v_fma_f32 v31, v31, s47, v18
v_mfma_f32_16x16x32_bf16 v[192:195], v[60:63], a[208:211], v[192:195]
ds_read_b64_tr_b16 v[42:43], v4 offset:512
v_mul_f32 v30, v30, v138
v_mfma_f32_16x16x32_bf16 v[196:199], v[56:59], a[196:199], v[196:199]
ds_read_b64_tr_b16 v[44:45], v4 offset:8192
v_mul_f32 v31, v31, v139
v_mfma_f32_16x16x32_bf16 v[196:199], v[60:63], a[212:215], v[196:199]
ds_read_b64_tr_b16 v[46:47], v4 offset:8704
v_exp_f32 v30, v30
v_mfma_f32_16x16x32_bf16 v[200:203], v[56:59], a[200:203], v[200:203]
ds_read_b64_tr_b16 v[48:49], v4 offset:2048
v_mul_f32 v154, v154, v138
v_mfma_f32_16x16x32_bf16 v[200:203], v[60:63], a[216:219], v[200:203]
ds_read_b64_tr_b16 v[50:51], v4 offset:2560
v_exp_f32 v31, v31
v_mfma_f32_16x16x32_bf16 v[204:207], v[56:59], a[204:207], v[204:207]
ds_read_b64_tr_b16 v[52:53], v4 offset:10240
v_mul_f32 v155, v155, v139
v_mfma_f32_16x16x32_bf16 v[204:207], v[60:63], a[220:223], v[204:207]
ds_read_b64_tr_b16 v[54:55], v4 offset:10752
v_add_f32 v30, 1.0, v30
v_add_f32 v31, 1.0, v31
v_mfma_f32_16x16x32_bf16 v[208:211], v[64:67], a[192:195], v[208:211]
buffer_load_dwordx4 v75, s[52:55], s48 offen lds
v_mfma_f32_16x16x32_bf16 v[208:211], v[68:71], a[208:211], v[208:211]
v_rcp_f32 v30, v30
v_mfma_f32_16x16x32_bf16 v[212:215], v[64:67], a[196:199], v[212:215]
v_rcp_f32 v31, v31
v_mul_f32 v154, v154, v30
v_mfma_f32_16x16x32_bf16 v[212:215], v[68:71], a[212:215], v[212:215]
v_mul_f32 v155, v155, v31
v_cvt_pk_bf16_f32 v106, v152, v153
v_mfma_f32_16x16x32_bf16 v[216:219], v[64:67], a[200:203], v[216:219]
v_cvt_pk_bf16_f32 v107, v154, v155
v_mul_f32 v32, v108, v108
v_mul_f32 v33, v109, v109
v_mfma_f32_16x16x32_bf16 v[216:219], v[68:71], a[216:219], v[216:219]
v_fma_f32 v32, v32, s47, v18
v_fma_f32 v33, v33, s47, v18
v_mfma_f32_16x16x32_bf16 v[220:223], v[64:67], a[204:207], v[220:223]
v_mul_f32 v32, v32, v108
v_mul_f32 v33, v33, v109
v_mfma_f32_16x16x32_bf16 v[220:223], v[68:71], a[220:223], v[220:223]
v_exp_f32 v32, v32
s_waitcnt lgkmcnt(0)
v_mfma_f32_16x16x32_bf16 v[160:163], v[40:43], a[224:227], v[160:163]
ds_read_b64_tr_b16 v[56:57], v5 offset:0
v_mul_f32 v124, v124, v108
v_mfma_f32_16x16x32_bf16 v[160:163], v[44:47], a[240:243], v[160:163]
ds_read_b64_tr_b16 v[58:59], v5 offset:512
v_exp_f32 v33, v33
v_mfma_f32_16x16x32_bf16 v[164:167], v[40:43], a[228:231], v[164:167]
ds_read_b64_tr_b16 v[60:61], v5 offset:8192
v_mul_f32 v125, v125, v109
v_mfma_f32_16x16x32_bf16 v[164:167], v[44:47], a[244:247], v[164:167]
ds_read_b64_tr_b16 v[62:63], v5 offset:8704
v_add_f32 v32, 1.0, v32
v_mfma_f32_16x16x32_bf16 v[168:171], v[40:43], a[232:235], v[168:171]
ds_read_b64_tr_b16 v[64:65], v5 offset:2048
v_add_f32 v33, 1.0, v33
v_mul_f32 v34, v110, v110
v_mfma_f32_16x16x32_bf16 v[168:171], v[44:47], a[248:251], v[168:171]
ds_read_b64_tr_b16 v[66:67], v5 offset:2560
v_mul_f32 v35, v111, v111
v_mfma_f32_16x16x32_bf16 v[172:175], v[40:43], a[236:239], v[172:175]
ds_read_b64_tr_b16 v[68:69], v5 offset:10240
v_rcp_f32 v32, v32
v_mfma_f32_16x16x32_bf16 v[172:175], v[44:47], a[252:255], v[172:175]
ds_read_b64_tr_b16 v[70:71], v5 offset:10752
v_mul_f32 v124, v124, v32
v_mfma_f32_16x16x32_bf16 v[176:179], v[48:51], a[224:227], v[176:179]
buffer_store_dwordx4 v[104:107], v16, s[20:23], s50 offen offset:2048 sc1
v_mfma_f32_16x16x32_bf16 v[176:179], v[52:55], a[240:243], v[176:179]
s_add_u32 s48, s42, 67113088
s_add_u32 m0, s41, 64
v_mfma_f32_16x16x32_bf16 v[180:183], v[48:51], a[228:231], v[180:183]
ds_write_b128 v14, v[104:107] offset:51200
v_fma_f32 v34, v34, s47, v18
v_mfma_f32_16x16x32_bf16 v[180:183], v[52:55], a[244:247], v[180:183]
v_rcp_f32 v33, v33
v_fma_f32 v35, v35, s47, v18
v_mfma_f32_16x16x32_bf16 v[184:187], v[48:51], a[232:235], v[184:187]
v_mul_f32 v125, v125, v33
v_mul_f32 v34, v34, v110
v_mfma_f32_16x16x32_bf16 v[184:187], v[52:55], a[248:251], v[184:187]
v_mul_f32 v35, v35, v111
v_exp_f32 v34, v34
v_mfma_f32_16x16x32_bf16 v[188:191], v[48:51], a[236:239], v[188:191]
v_mul_f32 v126, v126, v110
s_waitcnt vmcnt(5) lgkmcnt(0)
v_mfma_f32_16x16x32_bf16 v[188:191], v[52:55], a[252:255], v[188:191]
s_barrier
v_mfma_f32_16x16x32_bf16 v[192:195], v[56:59], a[224:227], v[192:195]
buffer_load_dwordx4 v74, s[20:23], s48 offen offset:0 sc1 lds
v_mfma_f32_16x16x32_bf16 v[192:195], v[60:63], a[240:243], v[192:195]
ds_read_b64_tr_b16 v[40:41], v2 offset:0
v_exp_f32 v35, v35
v_mfma_f32_16x16x32_bf16 v[196:199], v[56:59], a[228:231], v[196:199]
ds_read_b64_tr_b16 v[42:43], v2 offset:512
v_mul_f32 v127, v127, v111
v_add_f32 v34, 1.0, v34
v_mfma_f32_16x16x32_bf16 v[196:199], v[60:63], a[244:247], v[196:199]
ds_read_b64_tr_b16 v[44:45], v2 offset:8192
v_add_f32 v35, 1.0, v35
v_mfma_f32_16x16x32_bf16 v[200:203], v[56:59], a[232:235], v[200:203]
buffer_load_dwordx4 v74, s[20:23], s48 offen offset:1024 sc1 lds
v_mfma_f32_16x16x32_bf16 v[200:203], v[60:63], a[248:251], v[200:203]
ds_read_b64_tr_b16 v[46:47], v2 offset:8704
v_rcp_f32 v34, v34
v_mfma_f32_16x16x32_bf16 v[204:207], v[56:59], a[236:239], v[204:207]
ds_read_b64_tr_b16 v[48:49], v2 offset:2048
v_mul_f32 v126, v126, v34
v_mfma_f32_16x16x32_bf16 v[204:207], v[60:63], a[252:255], v[204:207]
ds_read_b64_tr_b16 v[50:51], v2 offset:2560
v_rcp_f32 v35, v35
v_mfma_f32_16x16x32_bf16 v[208:211], v[64:67], a[224:227], v[208:211]
buffer_load_dwordx4 v74, s[20:23], s48 offen offset:2048 sc1 lds
v_mfma_f32_16x16x32_bf16 v[208:211], v[68:71], a[240:243], v[208:211]
ds_read_b64_tr_b16 v[52:53], v2 offset:10240
v_mul_f32 v127, v127, v35
v_mfma_f32_16x16x32_bf16 v[212:215], v[64:67], a[228:231], v[212:215]
ds_read_b64_tr_b16 v[54:55], v2 offset:10752
v_cvt_pk_bf16_f32 v108, v124, v125
v_cvt_pk_bf16_f32 v109, v126, v127
v_mfma_f32_16x16x32_bf16 v[212:215], v[68:71], a[244:247], v[212:215]
ds_write_b128 v72, v[80:83]
v_mfma_f32_16x16x32_bf16 v[216:219], v[64:67], a[232:235], v[216:219]
buffer_load_dwordx4 v74, s[20:23], s48 offen offset:3072 sc1 lds
v_mfma_f32_16x16x32_bf16 v[216:219], v[68:71], a[248:251], v[216:219]
s_add_u32 s48, s42, 67113084
s_add_u32 m0, s41, 8384
v_mfma_f32_16x16x32_bf16 v[220:223], v[64:67], a[236:239], v[220:223]
v_mul_f32 v36, v140, v140
v_mul_f32 v37, v141, v141
v_fma_f32 v36, v36, s47, v18
v_mfma_f32_16x16x32_bf16 v[220:223], v[68:71], a[252:255], v[220:223]
v_fma_f32 v37, v37, s47, v18
v_mul_f32 v36, v36, v140
s_waitcnt lgkmcnt(0)
v_mfma_f32_16x16x32_bf16 v[160:163], v[40:43], v[224:227], v[160:163]
buffer_load_dwordx4 v74, s[20:23], s48 offen offset:0 sc1 lds
v_mfma_f32_16x16x32_bf16 v[160:163], v[44:47], v[240:243], v[160:163]
ds_read_b64_tr_b16 v[56:57], v3 offset:0
v_mul_f32 v37, v37, v141
v_mul_f32 v156, v156, v140
v_mfma_f32_16x16x32_bf16 v[164:167], v[40:43], v[228:231], v[164:167]
ds_read_b64_tr_b16 v[58:59], v3 offset:512
v_mul_f32 v157, v157, v141
v_mfma_f32_16x16x32_bf16 v[164:167], v[44:47], v[244:247], v[164:167]
ds_read_b64_tr_b16 v[60:61], v3 offset:8192
v_mul_f32 v38, v142, v142
v_mfma_f32_16x16x32_bf16 v[168:171], v[40:43], v[232:235], v[168:171]
buffer_load_dwordx4 v74, s[20:23], s48 offen offset:1024 sc1 lds
v_mfma_f32_16x16x32_bf16 v[168:171], v[44:47], v[248:251], v[168:171]
ds_read_b64_tr_b16 v[62:63], v3 offset:8704
v_exp_f32 v36, v36
v_mfma_f32_16x16x32_bf16 v[172:175], v[40:43], v[236:239], v[172:175]
ds_read_b64_tr_b16 v[64:65], v3 offset:2048
v_add_f32 v36, 1.0, v36
v_mfma_f32_16x16x32_bf16 v[172:175], v[44:47], v[252:255], v[172:175]
ds_read_b64_tr_b16 v[66:67], v3 offset:2560
v_exp_f32 v37, v37
v_mfma_f32_16x16x32_bf16 v[176:179], v[48:51], v[224:227], v[176:179]
buffer_load_dwordx4 v74, s[20:23], s48 offen offset:2048 sc1 lds
v_mfma_f32_16x16x32_bf16 v[176:179], v[52:55], v[240:243], v[176:179]
ds_read_b64_tr_b16 v[68:69], v3 offset:10240
v_add_f32 v37, 1.0, v37
v_mul_f32 v39, v143, v143
v_mfma_f32_16x16x32_bf16 v[180:183], v[48:51], v[228:231], v[180:183]
ds_read_b64_tr_b16 v[70:71], v3 offset:10752
v_fma_f32 v38, v38, s47, v18
v_mfma_f32_16x16x32_bf16 v[180:183], v[52:55], v[244:247], v[180:183]
v_rcp_f32 v36, v36
v_mfma_f32_16x16x32_bf16 v[184:187], v[48:51], v[232:235], v[184:187]
buffer_load_dwordx4 v74, s[20:23], s48 offen offset:3072 sc1 lds
v_mfma_f32_16x16x32_bf16 v[184:187], v[52:55], v[248:251], v[184:187]
s_lshl_b32 s48, s3, 12
s_add_u32 m0, s41, 17152
v_mfma_f32_16x16x32_bf16 v[188:191], v[48:51], v[236:239], v[188:191]
v_rcp_f32 v37, v37
v_mul_f32 v156, v156, v36
v_fma_f32 v39, v39, s47, v18
v_mfma_f32_16x16x32_bf16 v[188:191], v[52:55], v[252:255], v[188:191]
v_mul_f32 v157, v157, v37
s_waitcnt lgkmcnt(0)
v_mfma_f32_16x16x32_bf16 v[192:195], v[56:59], v[224:227], v[192:195]
buffer_load_dwordx4 v74, s[52:55], s48 offen offset:0 lds
v_mfma_f32_16x16x32_bf16 v[192:195], v[60:63], v[240:243], v[192:195]
v_mul_f32 v38, v38, v142
v_mul_f32 v39, v39, v143
v_mul_f32 v158, v158, v142
v_mfma_f32_16x16x32_bf16 v[196:199], v[56:59], v[228:231], v[196:199]
v_exp_f32 v38, v38
v_mfma_f32_16x16x32_bf16 v[196:199], v[60:63], v[244:247], v[196:199]
v_exp_f32 v39, v39
v_mfma_f32_16x16x32_bf16 v[200:203], v[56:59], v[232:235], v[200:203]
buffer_load_dwordx4 v74, s[52:55], s48 offen offset:1024 lds
v_mfma_f32_16x16x32_bf16 v[200:203], v[60:63], v[248:251], v[200:203]
v_mul_f32 v159, v159, v143
v_add_f32 v38, 1.0, v38
v_add_f32 v39, 1.0, v39
v_mfma_f32_16x16x32_bf16 v[204:207], v[56:59], v[236:239], v[204:207]
v_rcp_f32 v38, v38
v_mfma_f32_16x16x32_bf16 v[204:207], v[60:63], v[252:255], v[204:207]
v_rcp_f32 v39, v39
v_mul_f32 v158, v158, v38
v_mfma_f32_16x16x32_bf16 v[208:211], v[64:67], v[224:227], v[208:211]
buffer_load_dwordx4 v74, s[52:55], s48 offen offset:2048 lds
v_mfma_f32_16x16x32_bf16 v[208:211], v[68:71], v[240:243], v[208:211]
v_mul_f32 v159, v159, v39
v_cvt_pk_bf16_f32 v110, v156, v157
v_mfma_f32_16x16x32_bf16 v[212:215], v[64:67], v[228:231], v[212:215]
v_cvt_pk_bf16_f32 v111, v158, v159
v_mfma_f32_16x16x32_bf16 v[212:215], v[68:71], v[244:247], v[212:215]
ds_write_b128 v14, v[108:111] offset:52224
v_mfma_f32_16x16x32_bf16 v[216:219], v[64:67], v[232:235], v[216:219]
buffer_load_dwordx4 v74, s[52:55], s48 offen offset:3072 lds
buffer_store_dwordx4 v[108:111], v16, s[20:23], s50 offen offset:3072 sc1
v_mfma_f32_16x16x32_bf16 v[216:219], v[68:71], v[248:251], v[216:219]
v_mfma_f32_16x16x32_bf16 v[220:223], v[64:67], v[236:239], v[220:223]
v_mfma_f32_16x16x32_bf16 v[220:223], v[68:71], v[252:255], v[220:223]
v_lshrrev_b32 v84, 4, v1
v_bfe_u32 v85, v1, 2, 2
v_and_b32 v86, 3, v1
v_and_b32 v87, 15, v1
v_mul_u32_u24 v85, 4160, v85
v_lshl_add_u32 v85, v86, 3, v85
v_lshlrev_b32 v86, 4, v84
v_sub_u32 v85, v85, v86
v_lshl_add_u32 v86, v87, 5, v86
v_lshlrev_b32 v87, 5, v87
v_lshl_add_u32 v11, v84, 3, v87
s_add_u32 s48, s41, 64
v_add_u32 v2, s48, v85
v_add_u32 v10, s48, v11
s_add_u32 s48, s41, 16672
v_add_u32 v3, s48, v86
s_lshl_b32 s49, s38, 7
s_sub_u32 s48, 102464, s49
v_add_u32 v4, s48, v85
s_add_u32 s48, s49, 119072
v_add_u32 v5, s48, v86
s_lshl_b32 s49, s38, 10
v_add_u32 v84, s49, v11
v_add_u32 v76, 102464, v84
s_add_u32 s48, s49, 102456
v_add_u32 v80, s48, v74
s_add_u32 s48, s41, 56
v_add_u32 v81, s48, v74
v_sub_u32 v85, v75, v74
v_add_u32 v77, v85, v84
s_lshr_b32 s48, s38, 1
s_mul_i32 s48, s48, 5
s_lshl3_add_u32 s48, s38, s48
s_lshl_b32 s48, s48, 10
s_add_u32 s48, s48, 64512
v_add_u32 v72, s48, v74
s_lshl_b32 s48, s38, 11
s_add_u32 s48, s48, 64512
v_add_u32 v73, s48, v74
s_add_u32 s42, s42, 71303168
s_add_u32 s43, s43, 71303168
s_lshl_b32 s48, s56, 16
s_and_b32 s56, s56, 0xffff0000
s_bitcmp0_b32 s3, 0
s_cmov_b32 s56, s48
s_lshl_b32 s48, s59, 16
s_and_b32 s59, s59, 0xffff0000
s_bitcmp0_b32 s100, 0
s_cmov_b32 s59, s48
s_add_u32 s50, s44, 12582912
v_mov_b32 v82, s47
v_mov_b32 v83, v18
v_pk_mul_f32 v[24:25], v[160:161], v[160:161]
v_pk_mul_f32 v[26:27], v[162:163], v[162:163]
v_pk_mul_f32 v[28:29], v[192:193], v[192:193]
v_pk_mul_f32 v[30:31], v[194:195], v[194:195]
v_pk_fma_f32 v[24:25], v[24:25], v[82:83], v[82:83] op_sel:[0,0,1] op_sel_hi:[1,0,1]
v_pk_fma_f32 v[26:27], v[26:27], v[82:83], v[82:83] op_sel:[0,0,1] op_sel_hi:[1,0,1]
v_pk_fma_f32 v[28:29], v[28:29], v[82:83], v[82:83] op_sel:[0,0,1] op_sel_hi:[1,0,1]
v_pk_fma_f32 v[30:31], v[30:31], v[82:83], v[82:83] op_sel:[0,0,1] op_sel_hi:[1,0,1]
v_pk_mul_f32 v[24:25], v[24:25], v[160:161]
v_pk_mul_f32 v[26:27], v[26:27], v[162:163]
v_pk_mul_f32 v[28:29], v[28:29], v[192:193]
v_pk_mul_f32 v[30:31], v[30:31], v[194:195]
v_exp_f32 v24, v24
v_exp_f32 v25, v25
v_exp_f32 v26, v26
v_exp_f32 v27, v27
v_exp_f32 v28, v28
v_exp_f32 v29, v29
v_exp_f32 v30, v30
v_exp_f32 v31, v31
v_pk_mul_f32 v[176:177], v[176:177], v[160:161]
v_pk_mul_f32 v[178:179], v[178:179], v[162:163]
v_pk_mul_f32 v[208:209], v[208:209], v[192:193]
v_pk_mul_f32 v[210:211], v[210:211], v[194:195]
v_pk_add_f32 v[24:25], v[24:25], 1.0 op_sel_hi:[1,0]
v_pk_add_f32 v[26:27], v[26:27], 1.0 op_sel_hi:[1,0]
v_pk_add_f32 v[28:29], v[28:29], 1.0 op_sel_hi:[1,0]
v_pk_add_f32 v[30:31], v[30:31], 1.0 op_sel_hi:[1,0]
v_rcp_f32 v24, v24
v_rcp_f32 v25, v25
v_rcp_f32 v26, v26
v_rcp_f32 v27, v27
v_rcp_f32 v28, v28
v_rcp_f32 v29, v29
v_rcp_f32 v30, v30
v_rcp_f32 v31, v31
v_pk_mul_f32 v[176:177], v[176:177], v[24:25]
v_pk_mul_f32 v[178:179], v[178:179], v[26:27]
v_pk_mul_f32 v[208:209], v[208:209], v[28:29]
v_pk_mul_f32 v[210:211], v[210:211], v[30:31]
v_cvt_pk_bf16_f32 v160, v176, v177
v_cvt_pk_bf16_f32 v161, v178, v179
v_cvt_pk_bf16_f32 v162, v208, v209
v_cvt_pk_bf16_f32 v163, v210, v211
ds_write_b128 v22, v[160:163] offset:0
buffer_store_dwordx4 v[160:163], v16, s[20:23], s50 offen offset:0 sc1
v_pk_mul_f32 v[32:33], v[164:165], v[164:165]
v_pk_mul_f32 v[34:35], v[166:167], v[166:167]
v_pk_mul_f32 v[36:37], v[196:197], v[196:197]
v_pk_mul_f32 v[38:39], v[198:199], v[198:199]
v_pk_fma_f32 v[32:33], v[32:33], v[82:83], v[82:83] op_sel:[0,0,1] op_sel_hi:[1,0,1]
v_pk_fma_f32 v[34:35], v[34:35], v[82:83], v[82:83] op_sel:[0,0,1] op_sel_hi:[1,0,1]
v_pk_fma_f32 v[36:37], v[36:37], v[82:83], v[82:83] op_sel:[0,0,1] op_sel_hi:[1,0,1]
v_pk_fma_f32 v[38:39], v[38:39], v[82:83], v[82:83] op_sel:[0,0,1] op_sel_hi:[1,0,1]
v_pk_mul_f32 v[32:33], v[32:33], v[164:165]
v_pk_mul_f32 v[34:35], v[34:35], v[166:167]
v_pk_mul_f32 v[36:37], v[36:37], v[196:197]
v_pk_mul_f32 v[38:39], v[38:39], v[198:199]
v_exp_f32 v32, v32
v_exp_f32 v33, v33
v_exp_f32 v34, v34
v_exp_f32 v35, v35
v_exp_f32 v36, v36
v_exp_f32 v37, v37
v_exp_f32 v38, v38
v_exp_f32 v39, v39
v_pk_mul_f32 v[180:181], v[180:181], v[164:165]
v_pk_mul_f32 v[182:183], v[182:183], v[166:167]
v_pk_mul_f32 v[212:213], v[212:213], v[196:197]
v_pk_mul_f32 v[214:215], v[214:215], v[198:199]
v_pk_add_f32 v[32:33], v[32:33], 1.0 op_sel_hi:[1,0]
v_pk_add_f32 v[34:35], v[34:35], 1.0 op_sel_hi:[1,0]
v_pk_add_f32 v[36:37], v[36:37], 1.0 op_sel_hi:[1,0]
v_pk_add_f32 v[38:39], v[38:39], 1.0 op_sel_hi:[1,0]
v_rcp_f32 v32, v32
v_rcp_f32 v33, v33
v_rcp_f32 v34, v34
v_rcp_f32 v35, v35
v_rcp_f32 v36, v36
v_rcp_f32 v37, v37
v_rcp_f32 v38, v38
v_rcp_f32 v39, v39
v_pk_mul_f32 v[180:181], v[180:181], v[32:33]
v_pk_mul_f32 v[182:183], v[182:183], v[34:35]
v_pk_mul_f32 v[212:213], v[212:213], v[36:37]
v_pk_mul_f32 v[214:215], v[214:215], v[38:39]
v_cvt_pk_bf16_f32 v164, v180, v181
v_cvt_pk_bf16_f32 v165, v182, v183
v_cvt_pk_bf16_f32 v166, v212, v213
v_cvt_pk_bf16_f32 v167, v214, v215
ds_write_b128 v22, v[164:167] offset:1024
buffer_store_dwordx4 v[164:167], v16, s[20:23], s50 offen offset:1024 sc1
v_pk_mul_f32 v[24:25], v[168:169], v[168:169]
v_pk_mul_f32 v[26:27], v[170:171], v[170:171]
v_pk_mul_f32 v[28:29], v[200:201], v[200:201]
v_pk_mul_f32 v[30:31], v[202:203], v[202:203]
v_pk_fma_f32 v[24:25], v[24:25], v[82:83], v[82:83] op_sel:[0,0,1] op_sel_hi:[1,0,1]
v_pk_fma_f32 v[26:27], v[26:27], v[82:83], v[82:83] op_sel:[0,0,1] op_sel_hi:[1,0,1]
v_pk_fma_f32 v[28:29], v[28:29], v[82:83], v[82:83] op_sel:[0,0,1] op_sel_hi:[1,0,1]
v_pk_fma_f32 v[30:31], v[30:31], v[82:83], v[82:83] op_sel:[0,0,1] op_sel_hi:[1,0,1]
v_pk_mul_f32 v[24:25], v[24:25], v[168:169]
v_pk_mul_f32 v[26:27], v[26:27], v[170:171]
v_pk_mul_f32 v[28:29], v[28:29], v[200:201]
v_pk_mul_f32 v[30:31], v[30:31], v[202:203]
v_exp_f32 v24, v24
v_exp_f32 v25, v25
v_exp_f32 v26, v26
v_exp_f32 v27, v27
v_exp_f32 v28, v28
v_exp_f32 v29, v29
v_exp_f32 v30, v30
v_exp_f32 v31, v31
v_pk_mul_f32 v[184:185], v[184:185], v[168:169]
v_pk_mul_f32 v[186:187], v[186:187], v[170:171]
v_pk_mul_f32 v[216:217], v[216:217], v[200:201]
v_pk_mul_f32 v[218:219], v[218:219], v[202:203]
v_pk_add_f32 v[24:25], v[24:25], 1.0 op_sel_hi:[1,0]
v_pk_add_f32 v[26:27], v[26:27], 1.0 op_sel_hi:[1,0]
v_pk_add_f32 v[28:29], v[28:29], 1.0 op_sel_hi:[1,0]
v_pk_add_f32 v[30:31], v[30:31], 1.0 op_sel_hi:[1,0]
v_rcp_f32 v24, v24
v_rcp_f32 v25, v25
v_rcp_f32 v26, v26
v_rcp_f32 v27, v27
v_rcp_f32 v28, v28
v_rcp_f32 v29, v29
v_rcp_f32 v30, v30
v_rcp_f32 v31, v31
v_pk_mul_f32 v[184:185], v[184:185], v[24:25]
v_pk_mul_f32 v[186:187], v[186:187], v[26:27]
v_pk_mul_f32 v[216:217], v[216:217], v[28:29]
v_pk_mul_f32 v[218:219], v[218:219], v[30:31]
v_cvt_pk_bf16_f32 v168, v184, v185
v_cvt_pk_bf16_f32 v169, v186, v187
v_cvt_pk_bf16_f32 v170, v216, v217
v_cvt_pk_bf16_f32 v171, v218, v219
ds_write_b128 v22, v[168:171] offset:2048
buffer_store_dwordx4 v[168:171], v16, s[20:23], s50 offen offset:2048 sc1
v_pk_mul_f32 v[32:33], v[172:173], v[172:173]
v_pk_mul_f32 v[34:35], v[174:175], v[174:175]
v_pk_mul_f32 v[36:37], v[204:205], v[204:205]
v_pk_mul_f32 v[38:39], v[206:207], v[206:207]
v_pk_fma_f32 v[32:33], v[32:33], v[82:83], v[82:83] op_sel:[0,0,1] op_sel_hi:[1,0,1]
v_pk_fma_f32 v[34:35], v[34:35], v[82:83], v[82:83] op_sel:[0,0,1] op_sel_hi:[1,0,1]
v_pk_fma_f32 v[36:37], v[36:37], v[82:83], v[82:83] op_sel:[0,0,1] op_sel_hi:[1,0,1]
v_pk_fma_f32 v[38:39], v[38:39], v[82:83], v[82:83] op_sel:[0,0,1] op_sel_hi:[1,0,1]
v_pk_mul_f32 v[32:33], v[32:33], v[172:173]
v_pk_mul_f32 v[34:35], v[34:35], v[174:175]
v_pk_mul_f32 v[36:37], v[36:37], v[204:205]
v_pk_mul_f32 v[38:39], v[38:39], v[206:207]
v_exp_f32 v32, v32
v_exp_f32 v33, v33
v_exp_f32 v34, v34
v_exp_f32 v35, v35
v_exp_f32 v36, v36
v_exp_f32 v37, v37
v_exp_f32 v38, v38
v_exp_f32 v39, v39
v_pk_mul_f32 v[188:189], v[188:189], v[172:173]
v_pk_mul_f32 v[190:191], v[190:191], v[174:175]
v_pk_mul_f32 v[220:221], v[220:221], v[204:205]
v_pk_mul_f32 v[222:223], v[222:223], v[206:207]
v_pk_add_f32 v[32:33], v[32:33], 1.0 op_sel_hi:[1,0]
v_pk_add_f32 v[34:35], v[34:35], 1.0 op_sel_hi:[1,0]
v_pk_add_f32 v[36:37], v[36:37], 1.0 op_sel_hi:[1,0]
v_pk_add_f32 v[38:39], v[38:39], 1.0 op_sel_hi:[1,0]
v_rcp_f32 v32, v32
v_rcp_f32 v33, v33
v_rcp_f32 v34, v34
v_rcp_f32 v35, v35
v_rcp_f32 v36, v36
v_rcp_f32 v37, v37
v_rcp_f32 v38, v38
v_rcp_f32 v39, v39
v_pk_mul_f32 v[188:189], v[188:189], v[32:33]
v_pk_mul_f32 v[190:191], v[190:191], v[34:35]
v_pk_mul_f32 v[220:221], v[220:221], v[36:37]
v_pk_mul_f32 v[222:223], v[222:223], v[38:39]
v_cvt_pk_bf16_f32 v172, v188, v189
v_cvt_pk_bf16_f32 v173, v190, v191
v_cvt_pk_bf16_f32 v174, v220, v221
v_cvt_pk_bf16_f32 v175, v222, v223
ds_write_b128 v22, v[172:175] offset:3072
buffer_store_dwordx4 v[172:175], v16, s[20:23], s50 offen offset:3072 sc1
s_waitcnt vmcnt(4)
ds_read_b64 v[98:99], v81 offset:0
ds_read_b128 v[100:103], v81 offset:8
ds_read_b64 v[114:115], v81 offset:1024
ds_read_b128 v[116:119], v81 offset:1032
ds_read_b64 v[130:131], v81 offset:2048
ds_read_b128 v[132:135], v81 offset:2056
ds_read_b64 v[146:147], v81 offset:3072
ds_read_b128 v[148:151], v81 offset:3080
s_waitcnt lgkmcnt(8)
s_barrier
v_mov_b32 v20, 3
buffer_store_dword v20, v19, s[20:23], 0 offen sc1
s_waitcnt lgkmcnt(6)
v_alignbit_b32 v104, v100, v99, 16
v_alignbit_b32 v105, v101, v100, 16
v_alignbit_b32 v106, v102, v101, 16
v_alignbit_b32 v107, v103, v102, 16
ds_write_b128 v81, v[104:107] offset:4168
v_alignbit_b32 v108, v99, v98, 16
v_alignbit_b32 v109, v100, v99, 16
v_alignbit_b32 v110, v101, v100, 16
v_alignbit_b32 v111, v102, v101, 16
ds_write_b128 v81, v[108:111] offset:12488
s_waitcnt lgkmcnt(6)
v_alignbit_b32 v120, v116, v115, 16
v_alignbit_b32 v121, v117, v116, 16
v_alignbit_b32 v122, v118, v117, 16
v_alignbit_b32 v123, v119, v118, 16
ds_write_b128 v81, v[120:123] offset:5192
v_alignbit_b32 v124, v115, v114, 16
v_alignbit_b32 v125, v116, v115, 16
v_alignbit_b32 v126, v117, v116, 16
v_alignbit_b32 v127, v118, v117, 16
ds_write_b128 v81, v[124:127] offset:13512
s_waitcnt lgkmcnt(6)
v_alignbit_b32 v136, v132, v131, 16
v_alignbit_b32 v137, v133, v132, 16
v_alignbit_b32 v138, v134, v133, 16
v_alignbit_b32 v139, v135, v134, 16
ds_write_b128 v81, v[136:139] offset:6216
v_alignbit_b32 v140, v131, v130, 16
v_alignbit_b32 v141, v132, v131, 16
v_alignbit_b32 v142, v133, v132, 16
v_alignbit_b32 v143, v134, v133, 16
ds_write_b128 v81, v[140:143] offset:14536
s_waitcnt lgkmcnt(6)
v_alignbit_b32 v152, v148, v147, 16
v_alignbit_b32 v153, v149, v148, 16
v_alignbit_b32 v154, v150, v149, 16
v_alignbit_b32 v155, v151, v150, 16
ds_write_b128 v81, v[152:155] offset:7240
v_alignbit_b32 v156, v147, v146, 16
v_alignbit_b32 v157, v148, v147, 16
v_alignbit_b32 v158, v149, v148, 16
v_alignbit_b32 v159, v150, v149, 16
ds_write_b128 v81, v[156:159] offset:15560
ds_read_b64_tr_b16 v[192:193], v2 offset:480
ds_read_b64_tr_b16 v[194:195], v2 offset:472
ds_read_b128 v[40:43], v3 offset:0
ds_read_b64_tr_b16 v[196:197], v2 offset:992
ds_read_b64_tr_b16 v[198:199], v2 offset:984
ds_read_b128 v[44:47], v3 offset:512
ds_read_b64_tr_b16 v[200:201], v2 offset:1504
ds_read_b64_tr_b16 v[202:203], v2 offset:1496
ds_read_b128 v[48:51], v3 offset:1024
ds_read_b64_tr_b16 v[204:205], v2 offset:2016
ds_read_b64_tr_b16 v[206:207], v2 offset:2008
ds_read_b128 v[52:55], v3 offset:1536
ds_read_b64_tr_b16 v[208:209], v2 offset:2528
ds_read_b64_tr_b16 v[210:211], v2 offset:2520
ds_read_b128 v[56:59], v3 offset:2048
ds_read_b64_tr_b16 v[212:213], v2 offset:3040
ds_read_b64_tr_b16 v[214:215], v2 offset:3032
ds_read_b128 v[60:63], v3 offset:2560
ds_read_b64_tr_b16 v[216:217], v2 offset:3552
ds_read_b64_tr_b16 v[218:219], v2 offset:3544
ds_read_b128 v[64:67], v3 offset:3072
ds_read_b64_tr_b16 v[220:221], v2 offset:4064
ds_read_b64_tr_b16 v[222:223], v2 offset:4056
ds_read_b128 v[68:71], v3 offset:3584
s_waitcnt lgkmcnt(0)
v_mfma_f32_16x16x32_bf16 v[160:163], v[192:195], v[40:43], 0
ds_read_b64_tr_b16 v[96:97], v2 offset:416
v_mfma_f32_16x16x32_bf16 v[164:167], v[196:199], v[40:43], 0
ds_read_b64_tr_b16 v[98:99], v2 offset:408
v_mfma_f32_16x16x32_bf16 v[164:167], v[192:195], v[44:47], v[164:167]
ds_read_b128 v[128:131], v3 offset:64
v_mfma_f32_16x16x32_bf16 v[168:171], v[200:203], v[40:43], 0
ds_read_b64_tr_b16 v[100:101], v2 offset:928
v_mfma_f32_16x16x32_bf16 v[168:171], v[196:199], v[44:47], v[168:171]
buffer_load_dword v78, v79, s[20:23], 0 offen sc1
v_mfma_f32_16x16x32_bf16 v[168:171], v[192:195], v[48:51], v[168:171]
ds_read_b64_tr_b16 v[102:103], v2 offset:920
s_add_u32 m0, s37, 0
v_mfma_f32_16x16x32_bf16 v[172:175], v[204:207], v[40:43], 0
ds_read_b128 v[132:135], v3 offset:576
s_mov_b32 s48, 371328
v_mfma_f32_16x16x32_bf16 v[172:175], v[200:203], v[44:47], v[172:175]
ds_read_b64_tr_b16 v[104:105], v2 offset:1440
v_mfma_f32_16x16x32_bf16 v[172:175], v[196:199], v[48:51], v[172:175]
ds_read_b64_tr_b16 v[106:107], v2 offset:1432
v_mfma_f32_16x16x32_bf16 v[172:175], v[192:195], v[52:55], v[172:175]
ds_read_b128 v[136:139], v3 offset:1088
v_mfma_f32_16x16x32_bf16 v[176:179], v[208:211], v[40:43], 0
buffer_load_dwordx4 v12, s[16:19], s48 offen offset:0 lds
v_mfma_f32_16x16x32_bf16 v[176:179], v[204:207], v[44:47], v[176:179]
ds_read_b64_tr_b16 v[108:109], v2 offset:1952
v_mfma_f32_16x16x32_bf16 v[176:179], v[200:203], v[48:51], v[176:179]
ds_read_b64_tr_b16 v[110:111], v2 offset:1944
v_mfma_f32_16x16x32_bf16 v[176:179], v[196:199], v[52:55], v[176:179]
ds_read_b128 v[140:143], v3 offset:1600
v_mfma_f32_16x16x32_bf16 v[176:179], v[192:195], v[56:59], v[176:179]
ds_read_b64_tr_b16 v[112:113], v2 offset:2464
v_mfma_f32_16x16x32_bf16 v[180:183], v[212:215], v[40:43], 0
ds_read_b64_tr_b16 v[114:115], v2 offset:2456
v_mfma_f32_16x16x32_bf16 v[180:183], v[208:211], v[44:47], v[180:183]
buffer_load_dwordx4 v13, s[16:19], s48 offen offset:1024 lds
v_mfma_f32_16x16x32_bf16 v[180:183], v[204:207], v[48:51], v[180:183]
ds_read_b128 v[144:147], v3 offset:2112
s_mov_b32 s49, 369408
v_mfma_f32_16x16x32_bf16 v[180:183], v[200:203], v[52:55], v[180:183]
ds_read_b64_tr_b16 v[116:117], v2 offset:2976
v_mfma_f32_16x16x32_bf16 v[180:183], v[196:199], v[56:59], v[180:183]
ds_read_b64_tr_b16 v[118:119], v2 offset:2968
v_mfma_f32_16x16x32_bf16 v[180:183], v[192:195], v[60:63], v[180:183]
ds_read_b128 v[148:151], v3 offset:2624
v_mfma_f32_16x16x32_bf16 v[184:187], v[216:219], v[40:43], 0
ds_read_b64_tr_b16 v[120:121], v2 offset:3488
v_mfma_f32_16x16x32_bf16 v[184:187], v[212:215], v[44:47], v[184:187]
buffer_load_dwordx4 v12, s[16:19], s49 offen offset:2048 lds
v_mfma_f32_16x16x32_bf16 v[184:187], v[208:211], v[48:51], v[184:187]
ds_read_b64_tr_b16 v[122:123], v2 offset:3480
v_mfma_f32_16x16x32_bf16 v[184:187], v[204:207], v[52:55], v[184:187]
ds_read_b128 v[152:155], v3 offset:3136
v_mfma_f32_16x16x32_bf16 v[184:187], v[200:203], v[56:59], v[184:187]
ds_read_b64_tr_b16 v[124:125], v2 offset:4000
v_mfma_f32_16x16x32_bf16 v[184:187], v[196:199], v[60:63], v[184:187]
ds_read_b64_tr_b16 v[126:127], v2 offset:3992
v_mfma_f32_16x16x32_bf16 v[184:187], v[192:195], v[64:67], v[184:187]
ds_read_b128 v[156:159], v3 offset:3648
v_mfma_f32_16x16x32_bf16 v[188:191], v[220:223], v[40:43], 0
buffer_load_dwordx4 v13, s[16:19], s49 offen offset:3072 lds
v_mfma_f32_16x16x32_bf16 v[188:191], v[216:219], v[44:47], v[188:191]
ds_read_b128 a[64:67], v15 offset:49152
v_mfma_f32_16x16x32_bf16 v[188:191], v[212:215], v[48:51], v[188:191]
ds_read_b128 a[68:71], v15 offset:50176
v_mfma_f32_16x16x32_bf16 v[188:191], v[208:211], v[52:55], v[188:191]
ds_read_b128 a[72:75], v15 offset:51200
v_mfma_f32_16x16x32_bf16 v[188:191], v[204:207], v[56:59], v[188:191]
ds_read_b128 a[76:79], v15 offset:52224
v_mfma_f32_16x16x32_bf16 v[188:191], v[200:203], v[60:63], v[188:191]
v_mfma_f32_16x16x32_bf16 v[188:191], v[196:199], v[64:67], v[188:191]
v_mfma_f32_16x16x32_bf16 v[188:191], v[192:195], v[68:71], v[188:191]
s_waitcnt lgkmcnt(0)
v_mfma_f32_16x16x32_bf16 v[160:163], v[96:99], v[128:131], v[160:163]
ds_read_b64_tr_b16 v[192:193], v2 offset:352
v_mfma_f32_16x16x32_bf16 v[164:167], v[100:103], v[128:131], v[164:167]
ds_read_b64_tr_b16 v[194:195], v2 offset:344
v_mfma_f32_16x16x32_bf16 v[164:167], v[96:99], v[132:135], v[164:167]
ds_read_b128 v[40:43], v3 offset:128
v_mfma_f32_16x16x32_bf16 v[168:171], v[104:107], v[128:131], v[168:171]
ds_read_b64_tr_b16 v[196:197], v2 offset:864
v_mfma_f32_16x16x32_bf16 v[168:171], v[100:103], v[132:135], v[168:171]
s_waitcnt vmcnt(4)
v_readfirstlane_b32 s58, v78
s_cmp_ge_u32 s58, 2
s_cbranch_scc0 L_spin11
L_back11:
v_mfma_f32_16x16x32_bf16 v[168:171], v[96:99], v[136:139], v[168:171]
ds_read_b64_tr_b16 v[198:199], v2 offset:856
v_mfma_f32_16x16x32_bf16 v[172:175], v[108:111], v[128:131], v[172:175]
ds_read_b128 v[44:47], v3 offset:640
s_add_u32 s51, s45, 0
v_mfma_f32_16x16x32_bf16 v[172:175], v[104:107], v[132:135], v[172:175]
ds_read_b64_tr_b16 v[200:201], v2 offset:1376
v_mfma_f32_16x16x32_bf16 v[172:175], v[100:103], v[136:139], v[172:175]
ds_read_b64_tr_b16 v[202:203], v2 offset:1368
v_mfma_f32_16x16x32_bf16 v[172:175], v[96:99], v[140:143], v[172:175]
ds_read_b128 v[48:51], v3 offset:1152
v_mfma_f32_16x16x32_bf16 v[176:179], v[112:115], v[128:131], v[176:179]
buffer_load_dwordx4 a[128:131], v17, s[20:23], s51 offen offset:0
v_mfma_f32_16x16x32_bf16 v[176:179], v[108:111], v[132:135], v[176:179]
ds_read_b64_tr_b16 v[204:205], v2 offset:1888
v_mfma_f32_16x16x32_bf16 v[176:179], v[104:107], v[136:139], v[176:179]
ds_read_b64_tr_b16 v[206:207], v2 offset:1880
v_mfma_f32_16x16x32_bf16 v[176:179], v[100:103], v[140:143], v[176:179]
ds_read_b128 v[52:55], v3 offset:1664
v_mfma_f32_16x16x32_bf16 v[176:179], v[96:99], v[144:147], v[176:179]
ds_read_b64_tr_b16 v[208:209], v2 offset:2400
v_mfma_f32_16x16x32_bf16 v[180:183], v[116:119], v[128:131], v[180:183]
ds_read_b64_tr_b16 v[210:211], v2 offset:2392
v_mfma_f32_16x16x32_bf16 v[180:183], v[112:115], v[132:135], v[180:183]
buffer_load_dwordx4 a[132:135], v17, s[20:23], s51 offen offset:1024
v_mfma_f32_16x16x32_bf16 v[180:183], v[108:111], v[136:139], v[180:183]
ds_read_b128 v[56:59], v3 offset:2176
v_mfma_f32_16x16x32_bf16 v[180:183], v[104:107], v[140:143], v[180:183]
ds_read_b64_tr_b16 v[212:213], v2 offset:2912
v_mfma_f32_16x16x32_bf16 v[180:183], v[100:103], v[144:147], v[180:183]
ds_read_b64_tr_b16 v[214:215], v2 offset:2904
v_mfma_f32_16x16x32_bf16 v[180:183], v[96:99], v[148:151], v[180:183]
ds_read_b128 v[60:63], v3 offset:2688
v_mfma_f32_16x16x32_bf16 v[184:187], v[120:123], v[128:131], v[184:187]
ds_read_b64_tr_b16 v[216:217], v2 offset:3424
v_mfma_f32_16x16x32_bf16 v[184:187], v[116:119], v[132:135], v[184:187]
buffer_load_dwordx4 a[136:139], v17, s[20:23], s51 offen offset:2048
v_mfma_f32_16x16x32_bf16 v[184:187], v[112:115], v[136:139], v[184:187]
ds_read_b64_tr_b16 v[218:219], v2 offset:3416
v_mfma_f32_16x16x32_bf16 v[184:187], v[108:111], v[140:143], v[184:187]
ds_read_b128 v[64:67], v3 offset:3200
v_mfma_f32_16x16x32_bf16 v[184:187], v[104:107], v[144:147], v[184:187]
ds_read_b64_tr_b16 v[220:221], v2 offset:3936
v_mfma_f32_16x16x32_bf16 v[184:187], v[100:103], v[148:151], v[184:187]
ds_read_b64_tr_b16 v[222:223], v2 offset:3928
v_mfma_f32_16x16x32_bf16 v[184:187], v[96:99], v[152:155], v[184:187]
ds_read_b128 v[68:71], v3 offset:3712
v_mfma_f32_16x16x32_bf16 v[188:191], v[124:127], v[128:131], v[188:191]
buffer_load_dwordx4 a[140:143], v17, s[20:23], s51 offen offset:3072
v_mfma_f32_16x16x32_bf16 v[188:191], v[120:123], v[132:135], v[188:191]
ds_read_b128 a[80:83], v15 offset:57344
s_add_u32 s51, s45, 8192
v_mfma_f32_16x16x32_bf16 v[188:191], v[116:119], v[136:139], v[188:191]
ds_read_b128 a[84:87], v15 offset:58368
v_mfma_f32_16x16x32_bf16 v[188:191], v[112:115], v[140:143], v[188:191]
ds_read_b128 a[88:91], v15 offset:59392
v_mfma_f32_16x16x32_bf16 v[188:191], v[108:111], v[144:147], v[188:191]
buffer_load_dwordx4 a[144:147], v17, s[20:23], s51 offen offset:0
v_mfma_f32_16x16x32_bf16 v[188:191], v[104:107], v[148:151], v[188:191]
v_mfma_f32_16x16x32_bf16 v[188:191], v[100:103], v[152:155], v[188:191]
s_waitcnt lgkmcnt(0)
v_mfma_f32_16x16x32_bf16 v[188:191], v[96:99], v[156:159], v[188:191]
s_barrier
v_mfma_f32_16x16x32_bf16 v[160:163], v[192:195], v[40:43], v[160:163]
ds_read_b64_tr_b16 v[96:97], v2 offset:288
v_mov_b32 v20, 4
v_mfma_f32_16x16x32_bf16 v[164:167], v[196:199], v[40:43], v[164:167]
ds_read_b64_tr_b16 v[98:99], v2 offset:280
v_mfma_f32_16x16x32_bf16 v[164:167], v[192:195], v[44:47], v[164:167]
ds_read_b128 v[128:131], v3 offset:192
v_mfma_f32_16x16x32_bf16 v[168:171], v[200:203], v[40:43], v[168:171]
ds_read_b64_tr_b16 v[100:101], v2 offset:800
v_mfma_f32_16x16x32_bf16 v[168:171], v[196:199], v[44:47], v[168:171]
buffer_store_dword v20, v19, s[20:23], 0 offen sc1
v_mfma_f32_16x16x32_bf16 v[168:171], v[192:195], v[48:51], v[168:171]
ds_read_b64_tr_b16 v[102:103], v2 offset:792
v_mfma_f32_16x16x32_bf16 v[172:175], v[204:207], v[40:43], v[172:175]
ds_read_b128 v[132:135], v3 offset:704
v_mfma_f32_16x16x32_bf16 v[172:175], v[200:203], v[44:47], v[172:175]
ds_read_b64_tr_b16 v[104:105], v2 offset:1312
v_mfma_f32_16x16x32_bf16 v[172:175], v[196:199], v[48:51], v[172:175]
ds_read_b64_tr_b16 v[106:107], v2 offset:1304
v_mfma_f32_16x16x32_bf16 v[172:175], v[192:195], v[52:55], v[172:175]
ds_read_b128 v[136:139], v3 offset:1216
v_mfma_f32_16x16x32_bf16 v[176:179], v[208:211], v[40:43], v[176:179]
buffer_load_dwordx4 a[148:151], v17, s[20:23], s51 offen offset:1024
v_mfma_f32_16x16x32_bf16 v[176:179], v[204:207], v[44:47], v[176:179]
ds_read_b64_tr_b16 v[108:109], v2 offset:1824
v_mfma_f32_16x16x32_bf16 v[176:179], v[200:203], v[48:51], v[176:179]
ds_read_b64_tr_b16 v[110:111], v2 offset:1816
v_mfma_f32_16x16x32_bf16 v[176:179], v[196:199], v[52:55], v[176:179]
ds_read_b128 v[140:143], v3 offset:1728
v_mfma_f32_16x16x32_bf16 v[176:179], v[192:195], v[56:59], v[176:179]
ds_read_b64_tr_b16 v[112:113], v2 offset:2336
v_mfma_f32_16x16x32_bf16 v[180:183], v[212:215], v[40:43], v[180:183]
ds_read_b64_tr_b16 v[114:115], v2 offset:2328
v_mfma_f32_16x16x32_bf16 v[180:183], v[208:211], v[44:47], v[180:183]
buffer_load_dwordx4 a[152:155], v17, s[20:23], s51 offen offset:2048
v_mfma_f32_16x16x32_bf16 v[180:183], v[204:207], v[48:51], v[180:183]
ds_read_b128 v[144:147], v3 offset:2240
v_mfma_f32_16x16x32_bf16 v[180:183], v[200:203], v[52:55], v[180:183]
ds_read_b64_tr_b16 v[116:117], v2 offset:2848
v_mfma_f32_16x16x32_bf16 v[180:183], v[196:199], v[56:59], v[180:183]
ds_read_b64_tr_b16 v[118:119], v2 offset:2840
v_mfma_f32_16x16x32_bf16 v[180:183], v[192:195], v[60:63], v[180:183]
ds_read_b128 v[148:151], v3 offset:2752
v_mfma_f32_16x16x32_bf16 v[184:187], v[216:219], v[40:43], v[184:187]
ds_read_b64_tr_b16 v[120:121], v2 offset:3360
v_mfma_f32_16x16x32_bf16 v[184:187], v[212:215], v[44:47], v[184:187]
buffer_load_dwordx4 a[156:159], v17, s[20:23], s51 offen offset:3072
v_mfma_f32_16x16x32_bf16 v[184:187], v[208:211], v[48:51], v[184:187]
ds_read_b64_tr_b16 v[122:123], v2 offset:3352
s_add_u32 s51, s45, 4194304
v_mfma_f32_16x16x32_bf16 v[184:187], v[204:207], v[52:55], v[184:187]
ds_read_b128 v[152:155], v3 offset:3264
v_mfma_f32_16x16x32_bf16 v[184:187], v[200:203], v[56:59], v[184:187]
ds_read_b64_tr_b16 v[124:125], v2 offset:3872
v_mfma_f32_16x16x32_bf16 v[184:187], v[196:199], v[60:63], v[184:187]
ds_read_b64_tr_b16 v[126:127], v2 offset:3864
v_mfma_f32_16x16x32_bf16 v[184:187], v[192:195], v[64:67], v[184:187]
ds_read_b128 v[156:159], v3 offset:3776
v_mfma_f32_16x16x32_bf16 v[188:191], v[220:223], v[40:43], v[188:191]
buffer_load_dwordx4 a[160:163], v17, s[20:23], s51 offen offset:0
v_mfma_f32_16x16x32_bf16 v[188:191], v[216:219], v[44:47], v[188:191]
ds_read_b128 a[92:95], v15 offset:60416
v_mfma_f32_16x16x32_bf16 v[188:191], v[212:215], v[48:51], v[188:191]
ds_read_b128 a[96:99], v23 offset:0
v_mfma_f32_16x16x32_bf16 v[188:191], v[208:211], v[52:55], v[188:191]
ds_read_b128 a[100:103], v23 offset:1024
v_mfma_f32_16x16x32_bf16 v[188:191], v[204:207], v[56:59], v[188:191]
buffer_load_dwordx4 a[164:167], v17, s[20:23], s51 offen offset:1024
v_mfma_f32_16x16x32_bf16 v[188:191], v[200:203], v[60:63], v[188:191]
v_mfma_f32_16x16x32_bf16 v[188:191], v[196:199], v[64:67], v[188:191]
v_mfma_f32_16x16x32_bf16 v[188:191], v[192:195], v[68:71], v[188:191]
s_waitcnt lgkmcnt(0)
v_mfma_f32_16x16x32_bf16 v[160:163], v[96:99], v[128:131], v[160:163]
ds_read_b64_tr_b16 v[192:193], v2 offset:224
v_mfma_f32_16x16x32_bf16 v[164:167], v[100:103], v[128:131], v[164:167]
ds_read_b64_tr_b16 v[194:195], v2 offset:216
v_mfma_f32_16x16x32_bf16 v[164:167], v[96:99], v[132:135], v[164:167]
ds_read_b128 v[40:43], v3 offset:256
v_mfma_f32_16x16x32_bf16 v[168:171], v[104:107], v[128:131], v[168:171]
ds_read_b64_tr_b16 v[196:197], v2 offset:736
v_mfma_f32_16x16x32_bf16 v[168:171], v[100:103], v[132:135], v[168:171]
buffer_load_dwordx4 a[168:171], v17, s[20:23], s51 offen offset:2048
v_mfma_f32_16x16x32_bf16 v[168:171], v[96:99], v[136:139], v[168:171]
ds_read_b64_tr_b16 v[198:199], v2 offset:728
v_mfma_f32_16x16x32_bf16 v[172:175], v[108:111], v[128:131], v[172:175]
ds_read_b128 v[44:47], v3 offset:768
v_mfma_f32_16x16x32_bf16 v[172:175], v[104:107], v[132:135], v[172:175]
ds_read_b64_tr_b16 v[200:201], v2 offset:1248
v_mfma_f32_16x16x32_bf16 v[172:175], v[100:103], v[136:139], v[172:175]
ds_read_b64_tr_b16 v[202:203], v2 offset:1240
v_mfma_f32_16x16x32_bf16 v[172:175], v[96:99], v[140:143], v[172:175]
ds_read_b128 v[48:51], v3 offset:1280
v_mfma_f32_16x16x32_bf16 v[176:179], v[112:115], v[128:131], v[176:179]
buffer_load_dwordx4 a[172:175], v17, s[20:23], s51 offen offset:3072
v_mfma_f32_16x16x32_bf16 v[176:179], v[108:111], v[132:135], v[176:179]
ds_read_b64_tr_b16 v[204:205], v2 offset:1760
s_add_u32 s51, s45, 4202496
v_mfma_f32_16x16x32_bf16 v[176:179], v[104:107], v[136:139], v[176:179]
ds_read_b64_tr_b16 v[206:207], v2 offset:1752
v_mfma_f32_16x16x32_bf16 v[176:179], v[100:103], v[140:143], v[176:179]
ds_read_b128 v[52:55], v3 offset:1792
v_mfma_f32_16x16x32_bf16 v[176:179], v[96:99], v[144:147], v[176:179]
ds_read_b64_tr_b16 v[208:209], v2 offset:2272
v_mfma_f32_16x16x32_bf16 v[180:183], v[116:119], v[128:131], v[180:183]
ds_read_b64_tr_b16 v[210:211], v2 offset:2264
v_mfma_f32_16x16x32_bf16 v[180:183], v[112:115], v[132:135], v[180:183]
buffer_load_dwordx4 a[176:179], v17, s[20:23], s51 offen offset:0
v_mfma_f32_16x16x32_bf16 v[180:183], v[108:111], v[136:139], v[180:183]
ds_read_b128 v[56:59], v3 offset:2304
v_mfma_f32_16x16x32_bf16 v[180:183], v[104:107], v[140:143], v[180:183]
ds_read_b64_tr_b16 v[212:213], v2 offset:2784
v_mfma_f32_16x16x32_bf16 v[180:183], v[100:103], v[144:147], v[180:183]
ds_read_b64_tr_b16 v[214:215], v2 offset:2776
v_mfma_f32_16x16x32_bf16 v[180:183], v[96:99], v[148:151], v[180:183]
ds_read_b128 v[60:63], v3 offset:2816
v_mfma_f32_16x16x32_bf16 v[184:187], v[120:123], v[128:131], v[184:187]
ds_read_b64_tr_b16 v[216:217], v2 offset:3296
v_mfma_f32_16x16x32_bf16 v[184:187], v[116:119], v[132:135], v[184:187]
buffer_load_dwordx4 a[180:183], v17, s[20:23], s51 offen offset:1024
v_mfma_f32_16x16x32_bf16 v[184:187], v[112:115], v[136:139], v[184:187]
ds_read_b64_tr_b16 v[218:219], v2 offset:3288
v_mfma_f32_16x16x32_bf16 v[184:187], v[108:111], v[140:143], v[184:187]
ds_read_b128 v[64:67], v3 offset:3328
v_mfma_f32_16x16x32_bf16 v[184:187], v[104:107], v[144:147], v[184:187]
ds_read_b64_tr_b16 v[220:221], v2 offset:3808
v_mfma_f32_16x16x32_bf16 v[184:187], v[100:103], v[148:151], v[184:187]
ds_read_b64_tr_b16 v[222:223], v2 offset:3800
v_mfma_f32_16x16x32_bf16 v[184:187], v[96:99], v[152:155], v[184:187]
ds_read_b128 v[68:71], v3 offset:3840
v_mfma_f32_16x16x32_bf16 v[188:191], v[124:127], v[128:131], v[188:191]
buffer_load_dwordx4 a[184:187], v17, s[20:23], s51 offen offset:2048
v_mfma_f32_16x16x32_bf16 v[188:191], v[120:123], v[132:135], v[188:191]
ds_read_b128 a[104:107], v23 offset:2048
v_mfma_f32_16x16x32_bf16 v[188:191], v[116:119], v[136:139], v[188:191]
ds_read_b128 a[108:111], v23 offset:3072
v_mfma_f32_16x16x32_bf16 v[188:191], v[112:115], v[140:143], v[188:191]
ds_read_b128 a[112:115], v23 offset:8192
v_mfma_f32_16x16x32_bf16 v[188:191], v[108:111], v[144:147], v[188:191]
buffer_load_dwordx4 a[188:191], v17, s[20:23], s51 offen offset:3072
v_mfma_f32_16x16x32_bf16 v[188:191], v[104:107], v[148:151], v[188:191]
s_add_u32 s51, s45, 8388608
v_mfma_f32_16x16x32_bf16 v[188:191], v[100:103], v[152:155], v[188:191]
v_mfma_f32_16x16x32_bf16 v[188:191], v[96:99], v[156:159], v[188:191]
s_waitcnt lgkmcnt(0)
v_mfma_f32_16x16x32_bf16 v[160:163], v[192:195], v[40:43], v[160:163]
ds_read_b64_tr_b16 v[96:97], v2 offset:160
v_mfma_f32_16x16x32_bf16 v[164:167], v[196:199], v[40:43], v[164:167]
ds_read_b64_tr_b16 v[98:99], v2 offset:152
v_mfma_f32_16x16x32_bf16 v[164:167], v[192:195], v[44:47], v[164:167]
ds_read_b128 v[128:131], v3 offset:320
v_mfma_f32_16x16x32_bf16 v[168:171], v[200:203], v[40:43], v[168:171]
ds_read_b64_tr_b16 v[100:101], v2 offset:672
v_mfma_f32_16x16x32_bf16 v[168:171], v[196:199], v[44:47], v[168:171]
buffer_load_dwordx4 a[192:195], v17, s[20:23], s51 offen offset:0
v_mfma_f32_16x16x32_bf16 v[168:171], v[192:195], v[48:51], v[168:171]
ds_read_b64_tr_b16 v[102:103], v2 offset:664
v_mfma_f32_16x16x32_bf16 v[172:175], v[204:207], v[40:43], v[172:175]
ds_read_b128 v[132:135], v3 offset:832
v_mfma_f32_16x16x32_bf16 v[172:175], v[200:203], v[44:47], v[172:175]
ds_read_b64_tr_b16 v[104:105], v2 offset:1184
v_mfma_f32_16x16x32_bf16 v[172:175], v[196:199], v[48:51], v[172:175]
ds_read_b64_tr_b16 v[106:107], v2 offset:1176
v_mfma_f32_16x16x32_bf16 v[172:175], v[192:195], v[52:55], v[172:175]
ds_read_b128 v[136:139], v3 offset:1344
v_mfma_f32_16x16x32_bf16 v[176:179], v[208:211], v[40:43], v[176:179]
buffer_load_dwordx4 a[196:199], v17, s[20:23], s51 offen offset:1024
v_mfma_f32_16x16x32_bf16 v[176:179], v[204:207], v[44:47], v[176:179]
ds_read_b64_tr_b16 v[108:109], v2 offset:1696
v_mfma_f32_16x16x32_bf16 v[176:179], v[200:203], v[48:51], v[176:179]
ds_read_b64_tr_b16 v[110:111], v2 offset:1688
v_mfma_f32_16x16x32_bf16 v[176:179], v[196:199], v[52:55], v[176:179]
ds_read_b128 v[140:143], v3 offset:1856
v_mfma_f32_16x16x32_bf16 v[176:179], v[192:195], v[56:59], v[176:179]
ds_read_b64_tr_b16 v[112:113], v2 offset:2208
v_mfma_f32_16x16x32_bf16 v[180:183], v[212:215], v[40:43], v[180:183]
ds_read_b64_tr_b16 v[114:115], v2 offset:2200
v_mfma_f32_16x16x32_bf16 v[180:183], v[208:211], v[44:47], v[180:183]
buffer_load_dwordx4 a[200:203], v17, s[20:23], s51 offen offset:2048
v_mfma_f32_16x16x32_bf16 v[180:183], v[204:207], v[48:51], v[180:183]
ds_read_b128 v[144:147], v3 offset:2368
v_mfma_f32_16x16x32_bf16 v[180:183], v[200:203], v[52:55], v[180:183]
ds_read_b64_tr_b16 v[116:117], v2 offset:2720
v_mfma_f32_16x16x32_bf16 v[180:183], v[196:199], v[56:59], v[180:183]
ds_read_b64_tr_b16 v[118:119], v2 offset:2712
v_mfma_f32_16x16x32_bf16 v[180:183], v[192:195], v[60:63], v[180:183]
ds_read_b128 v[148:151], v3 offset:2880
v_mfma_f32_16x16x32_bf16 v[184:187], v[216:219], v[40:43], v[184:187]
ds_read_b64_tr_b16 v[120:121], v2 offset:3232
v_mfma_f32_16x16x32_bf16 v[184:187], v[212:215], v[44:47], v[184:187]
buffer_load_dwordx4 a[204:207], v17, s[20:23], s51 offen offset:3072
v_mfma_f32_16x16x32_bf16 v[184:187], v[208:211], v[48:51], v[184:187]
ds_read_b64_tr_b16 v[122:123], v2 offset:3224
s_add_u32 s51, s45, 8396800
v_mfma_f32_16x16x32_bf16 v[184:187], v[204:207], v[52:55], v[184:187]
ds_read_b128 v[152:155], v3 offset:3392
v_mfma_f32_16x16x32_bf16 v[184:187], v[200:203], v[56:59], v[184:187]
ds_read_b64_tr_b16 v[124:125], v2 offset:3744
v_mfma_f32_16x16x32_bf16 v[184:187], v[196:199], v[60:63], v[184:187]
ds_read_b64_tr_b16 v[126:127], v2 offset:3736
v_mfma_f32_16x16x32_bf16 v[184:187], v[192:195], v[64:67], v[184:187]
ds_read_b128 v[156:159], v3 offset:3904
v_mfma_f32_16x16x32_bf16 v[188:191], v[220:223], v[40:43], v[188:191]
buffer_load_dwordx4 a[208:211], v17, s[20:23], s51 offen offset:0
v_mfma_f32_16x16x32_bf16 v[188:191], v[216:219], v[44:47], v[188:191]
ds_read_b128 a[116:119], v23 offset:9216
v_mfma_f32_16x16x32_bf16 v[188:191], v[212:215], v[48:51], v[188:191]
ds_read_b128 a[120:123], v23 offset:10240
v_mfma_f32_16x16x32_bf16 v[188:191], v[208:211], v[52:55], v[188:191]
ds_read_b128 a[124:127], v23 offset:11264
ds_read_b64 v[26:27], v80 offset:0
ds_read_b128 v[28:31], v80 offset:8
s_waitcnt lgkmcnt(1)
v_alignbit_b32 v36, v27, v26, 16
s_waitcnt lgkmcnt(0)
v_alignbit_b32 v32, v28, v27, 16
v_alignbit_b32 v33, v29, v28, 16
v_alignbit_b32 v34, v30, v29, 16
v_alignbit_b32 v35, v31, v30, 16
v_alignbit_b32 v37, v28, v27, 16
ds_write_b128 v80, v[32:35] offset:4168
v_alignbit_b32 v38, v29, v28, 16
v_alignbit_b32 v39, v30, v29, 16
ds_write_b128 v80, v[36:39] offset:12488
v_mfma_f32_16x16x32_bf16 v[188:191], v[204:207], v[56:59], v[188:191]
buffer_load_dwordx4 a[212:215], v17, s[20:23], s51 offen offset:1024
v_mfma_f32_16x16x32_bf16 v[188:191], v[200:203], v[60:63], v[188:191]
v_mfma_f32_16x16x32_bf16 v[188:191], v[196:199], v[64:67], v[188:191]
s_waitcnt lgkmcnt(0)
v_mfma_f32_16x16x32_bf16 v[188:191], v[192:195], v[68:71], v[188:191]
s_barrier
v_mfma_f32_16x16x32_bf16 v[160:163], v[96:99], v[128:131], v[160:163]
ds_read_b64_tr_b16 v[192:193], v2 offset:96
v_mfma_f32_16x16x32_bf16 v[164:167], v[100:103], v[128:131], v[164:167]
ds_read_b64_tr_b16 v[194:195], v2 offset:88
v_mfma_f32_16x16x32_bf16 v[164:167], v[96:99], v[132:135], v[164:167]
ds_read_b128 v[40:43], v3 offset:384
v_mfma_f32_16x16x32_bf16 v[168:171], v[104:107], v[128:131], v[168:171]
ds_read_b64_tr_b16 v[196:197], v2 offset:608
v_mfma_f32_16x16x32_bf16 v[168:171], v[100:103], v[132:135], v[168:171]
buffer_load_dwordx4 a[216:219], v17, s[20:23], s51 offen offset:2048
v_mfma_f32_16x16x32_bf16 v[168:171], v[96:99], v[136:139], v[168:171]
ds_read_b64_tr_b16 v[198:199], v2 offset:600
v_mfma_f32_16x16x32_bf16 v[172:175], v[108:111], v[128:131], v[172:175]
ds_read_b128 v[44:47], v3 offset:896
v_mfma_f32_16x16x32_bf16 v[172:175], v[104:107], v[132:135], v[172:175]
ds_read_b64_tr_b16 v[200:201], v2 offset:1120
v_mfma_f32_16x16x32_bf16 v[172:175], v[100:103], v[136:139], v[172:175]
ds_read_b64_tr_b16 v[202:203], v2 offset:1112
v_mfma_f32_16x16x32_bf16 v[172:175], v[96:99], v[140:143], v[172:175]
ds_read_b128 v[48:51], v3 offset:1408
v_mfma_f32_16x16x32_bf16 v[176:179], v[112:115], v[128:131], v[176:179]
buffer_load_dwordx4 a[220:223], v17, s[20:23], s51 offen offset:3072
v_mfma_f32_16x16x32_bf16 v[176:179], v[108:111], v[132:135], v[176:179]
ds_read_b64_tr_b16 v[204:205], v2 offset:1632
v_mfma_f32_16x16x32_bf16 v[176:179], v[104:107], v[136:139], v[176:179]
ds_read_b64_tr_b16 v[206:207], v2 offset:1624
v_mfma_f32_16x16x32_bf16 v[176:179], v[100:103], v[140:143], v[176:179]
ds_read_b128 v[52:55], v3 offset:1920
v_mfma_f32_16x16x32_bf16 v[176:179], v[96:99], v[144:147], v[176:179]
ds_read_b64_tr_b16 v[208:209], v2 offset:2144
v_mfma_f32_16x16x32_bf16 v[180:183], v[116:119], v[128:131], v[180:183]
ds_read_b64_tr_b16 v[210:211], v2 offset:2136
v_mfma_f32_16x16x32_bf16 v[180:183], v[112:115], v[132:135], v[180:183]
v_mfma_f32_16x16x32_bf16 v[180:183], v[108:111], v[136:139], v[180:183]
ds_read_b128 v[56:59], v3 offset:2432
v_mfma_f32_16x16x32_bf16 v[180:183], v[104:107], v[140:143], v[180:183]
ds_read_b64_tr_b16 v[212:213], v2 offset:2656
v_mfma_f32_16x16x32_bf16 v[180:183], v[100:103], v[144:147], v[180:183]
ds_read_b64_tr_b16 v[214:215], v2 offset:2648
v_mfma_f32_16x16x32_bf16 v[180:183], v[96:99], v[148:151], v[180:183]
ds_read_b128 v[60:63], v3 offset:2944
v_mfma_f32_16x16x32_bf16 v[184:187], v[120:123], v[128:131], v[184:187]
ds_read_b64_tr_b16 v[216:217], v2 offset:3168
v_mfma_f32_16x16x32_bf16 v[184:187], v[116:119], v[132:135], v[184:187]
v_mfma_f32_16x16x32_bf16 v[184:187], v[112:115], v[136:139], v[184:187]
ds_read_b64_tr_b16 v[218:219], v2 offset:3160
v_mfma_f32_16x16x32_bf16 v[184:187], v[108:111], v[140:143], v[184:187]
ds_read_b128 v[64:67], v3 offset:3456
v_mfma_f32_16x16x32_bf16 v[184:187], v[104:107], v[144:147], v[184:187]
ds_read_b64_tr_b16 v[220:221], v2 offset:3680
v_mfma_f32_16x16x32_bf16 v[184:187], v[100:103], v[148:151], v[184:187]
ds_read_b64_tr_b16 v[222:223], v2 offset:3672
v_mfma_f32_16x16x32_bf16 v[184:187], v[96:99], v[152:155], v[184:187]
ds_read_b128 v[68:71], v3 offset:3968
v_mfma_f32_16x16x32_bf16 v[188:191], v[124:127], v[128:131], v[188:191]
v_mfma_f32_16x16x32_bf16 v[188:191], v[120:123], v[132:135], v[188:191]
v_mfma_f32_16x16x32_bf16 v[188:191], v[116:119], v[136:139], v[188:191]
v_mfma_f32_16x16x32_bf16 v[188:191], v[112:115], v[140:143], v[188:191]
v_mfma_f32_16x16x32_bf16 v[188:191], v[108:111], v[144:147], v[188:191]
v_mfma_f32_16x16x32_bf16 v[188:191], v[104:107], v[148:151], v[188:191]
v_mfma_f32_16x16x32_bf16 v[188:191], v[100:103], v[152:155], v[188:191]
v_mfma_f32_16x16x32_bf16 v[188:191], v[96:99], v[156:159], v[188:191]
s_waitcnt lgkmcnt(0)
v_mfma_f32_16x16x32_bf16 v[160:163], v[192:195], v[40:43], v[160:163]
ds_read_b64_tr_b16 v[96:97], v2 offset:32
v_mfma_f32_16x16x32_bf16 v[164:167], v[196:199], v[40:43], v[164:167]
ds_read_b64_tr_b16 v[98:99], v2 offset:24
v_mfma_f32_16x16x32_bf16 v[164:167], v[192:195], v[44:47], v[164:167]
ds_read_b128 v[128:131], v3 offset:448
v_mfma_f32_16x16x32_bf16 v[168:171], v[200:203], v[40:43], v[168:171]
ds_read_b64_tr_b16 v[100:101], v2 offset:544
v_mfma_f32_16x16x32_bf16 v[168:171], v[196:199], v[44:47], v[168:171]
v_mfma_f32_16x16x32_bf16 v[168:171], v[192:195], v[48:51], v[168:171]
ds_read_b64_tr_b16 v[102:103], v2 offset:536
s_add_u32 m0, s37, 131072
v_mfma_f32_16x16x32_bf16 v[172:175], v[204:207], v[40:43], v[172:175]
ds_read_b128 v[132:135], v3 offset:960
s_mov_b32 s48, 445056
v_mfma_f32_16x16x32_bf16 v[172:175], v[200:203], v[44:47], v[172:175]
ds_read_b64_tr_b16 v[104:105], v2 offset:1056
v_mfma_f32_16x16x32_bf16 v[172:175], v[196:199], v[48:51], v[172:175]
ds_read_b64_tr_b16 v[106:107], v2 offset:1048
v_mfma_f32_16x16x32_bf16 v[172:175], v[192:195], v[52:55], v[172:175]
ds_read_b128 v[136:139], v3 offset:1472
v_mfma_f32_16x16x32_bf16 v[176:179], v[208:211], v[40:43], v[176:179]
buffer_load_dwordx4 v12, s[16:19], s48 offen offset:0 lds
v_mfma_f32_16x16x32_bf16 v[176:179], v[204:207], v[44:47], v[176:179]
ds_read_b64_tr_b16 v[108:109], v2 offset:1568
v_mfma_f32_16x16x32_bf16 v[176:179], v[200:203], v[48:51], v[176:179]
ds_read_b64_tr_b16 v[110:111], v2 offset:1560
v_mfma_f32_16x16x32_bf16 v[176:179], v[196:199], v[52:55], v[176:179]
ds_read_b128 v[140:143], v3 offset:1984
v_mfma_f32_16x16x32_bf16 v[176:179], v[192:195], v[56:59], v[176:179]
ds_read_b64_tr_b16 v[112:113], v2 offset:2080
v_mfma_f32_16x16x32_bf16 v[180:183], v[212:215], v[40:43], v[180:183]
ds_read_b64_tr_b16 v[114:115], v2 offset:2072
v_mfma_f32_16x16x32_bf16 v[180:183], v[208:211], v[44:47], v[180:183]
buffer_load_dwordx4 v13, s[16:19], s48 offen offset:1024 lds
v_mfma_f32_16x16x32_bf16 v[180:183], v[204:207], v[48:51], v[180:183]
ds_read_b128 v[144:147], v3 offset:2496
s_mov_b32 s49, 443136
v_mfma_f32_16x16x32_bf16 v[180:183], v[200:203], v[52:55], v[180:183]
ds_read_b64_tr_b16 v[116:117], v2 offset:2592
v_mfma_f32_16x16x32_bf16 v[180:183], v[196:199], v[56:59], v[180:183]
ds_read_b64_tr_b16 v[118:119], v2 offset:2584
v_mfma_f32_16x16x32_bf16 v[180:183], v[192:195], v[60:63], v[180:183]
ds_read_b128 v[148:151], v3 offset:3008
v_mfma_f32_16x16x32_bf16 v[184:187], v[216:219], v[40:43], v[184:187]
ds_read_b64_tr_b16 v[120:121], v2 offset:3104
v_mfma_f32_16x16x32_bf16 v[184:187], v[212:215], v[44:47], v[184:187]
buffer_load_dwordx4 v12, s[16:19], s49 offen offset:2048 lds
v_mfma_f32_16x16x32_bf16 v[184:187], v[208:211], v[48:51], v[184:187]
ds_read_b64_tr_b16 v[122:123], v2 offset:3096
v_mfma_f32_16x16x32_bf16 v[184:187], v[204:207], v[52:55], v[184:187]
ds_read_b128 v[152:155], v3 offset:3520
v_mfma_f32_16x16x32_bf16 v[184:187], v[200:203], v[56:59], v[184:187]
ds_read_b64_tr_b16 v[124:125], v2 offset:3616
v_mfma_f32_16x16x32_bf16 v[184:187], v[196:199], v[60:63], v[184:187]
ds_read_b64_tr_b16 v[126:127], v2 offset:3608
v_mfma_f32_16x16x32_bf16 v[184:187], v[192:195], v[64:67], v[184:187]
ds_read_b128 v[156:159], v3 offset:4032
v_mfma_f32_16x16x32_bf16 v[188:191], v[220:223], v[40:43], v[188:191]
buffer_load_dwordx4 v13, s[16:19], s49 offen offset:3072 lds
v_mfma_f32_16x16x32_bf16 v[188:191], v[216:219], v[44:47], v[188:191]
v_mfma_f32_16x16x32_bf16 v[188:191], v[212:215], v[48:51], v[188:191]
v_mfma_f32_16x16x32_bf16 v[188:191], v[208:211], v[52:55], v[188:191]
v_mfma_f32_16x16x32_bf16 v[188:191], v[204:207], v[56:59], v[188:191]
v_mfma_f32_16x16x32_bf16 v[188:191], v[200:203], v[60:63], v[188:191]
v_mfma_f32_16x16x32_bf16 v[188:191], v[196:199], v[64:67], v[188:191]
v_mfma_f32_16x16x32_bf16 v[188:191], v[192:195], v[68:71], v[188:191]
s_waitcnt lgkmcnt(0)
v_mfma_f32_16x16x32_bf16 v[160:163], v[96:99], v[128:131], v[160:163]
ds_read_b64_tr_b16 v[192:193], v4 offset:480
v_mfma_f32_16x16x32_bf16 v[164:167], v[100:103], v[128:131], v[164:167]
ds_read_b64_tr_b16 v[194:195], v4 offset:472
v_mfma_f32_16x16x32_bf16 v[164:167], v[96:99], v[132:135], v[164:167]
ds_read_b128 v[40:43], v5 offset:0
v_mfma_f32_16x16x32_bf16 v[168:171], v[104:107], v[128:131], v[168:171]
ds_read_b64_tr_b16 v[196:197], v4 offset:992
v_mfma_f32_16x16x32_bf16 v[168:171], v[100:103], v[132:135], v[168:171]
v_mfma_f32_16x16x32_bf16 v[168:171], v[96:99], v[136:139], v[168:171]
ds_read_b64_tr_b16 v[198:199], v4 offset:984
s_add_u32 m0, s37, 147456
v_mfma_f32_16x16x32_bf16 v[172:175], v[108:111], v[128:131], v[172:175]
ds_read_b128 v[44:47], v5 offset:512
s_mov_b32 s48, 518784
v_mfma_f32_16x16x32_bf16 v[172:175], v[104:107], v[132:135], v[172:175]
ds_read_b64_tr_b16 v[200:201], v4 offset:1504
v_mfma_f32_16x16x32_bf16 v[172:175], v[100:103], v[136:139], v[172:175]
ds_read_b64_tr_b16 v[202:203], v4 offset:1496
v_mfma_f32_16x16x32_bf16 v[172:175], v[96:99], v[140:143], v[172:175]
ds_read_b128 v[48:51], v5 offset:1024
v_mfma_f32_16x16x32_bf16 v[176:179], v[112:115], v[128:131], v[176:179]
buffer_load_dwordx4 v12, s[16:19], s48 offen offset:0 lds
v_mfma_f32_16x16x32_bf16 v[176:179], v[108:111], v[132:135], v[176:179]
ds_read_b64_tr_b16 v[204:205], v4 offset:2016
v_mfma_f32_16x16x32_bf16 v[176:179], v[104:107], v[136:139], v[176:179]
ds_read_b64_tr_b16 v[206:207], v4 offset:2008
v_mfma_f32_16x16x32_bf16 v[176:179], v[100:103], v[140:143], v[176:179]
ds_read_b128 v[52:55], v5 offset:1536
v_mfma_f32_16x16x32_bf16 v[176:179], v[96:99], v[144:147], v[176:179]
ds_read_b64_tr_b16 v[208:209], v4 offset:2528
v_mfma_f32_16x16x32_bf16 v[180:183], v[116:119], v[128:131], v[180:183]
ds_read_b64_tr_b16 v[210:211], v4 offset:2520
v_mfma_f32_16x16x32_bf16 v[180:183], v[112:115], v[132:135], v[180:183]
buffer_load_dwordx4 v13, s[16:19], s48 offen offset:1024 lds
v_mfma_f32_16x16x32_bf16 v[180:183], v[108:111], v[136:139], v[180:183]
ds_read_b128 v[56:59], v5 offset:2048
s_mov_b32 s49, 516864
v_mfma_f32_16x16x32_bf16 v[180:183], v[104:107], v[140:143], v[180:183]
ds_read_b64_tr_b16 v[212:213], v4 offset:3040
v_mfma_f32_16x16x32_bf16 v[180:183], v[100:103], v[144:147], v[180:183]
ds_read_b64_tr_b16 v[214:215], v4 offset:3032
v_mfma_f32_16x16x32_bf16 v[180:183], v[96:99], v[148:151], v[180:183]
ds_read_b128 v[60:63], v5 offset:2560
v_mfma_f32_16x16x32_bf16 v[184:187], v[120:123], v[128:131], v[184:187]
ds_read_b64_tr_b16 v[216:217], v4 offset:3552
v_mfma_f32_16x16x32_bf16 v[184:187], v[116:119], v[132:135], v[184:187]
buffer_load_dwordx4 v12, s[16:19], s49 offen offset:2048 lds
v_mfma_f32_16x16x32_bf16 v[184:187], v[112:115], v[136:139], v[184:187]
ds_read_b64_tr_b16 v[218:219], v4 offset:3544
v_mfma_f32_16x16x32_bf16 v[184:187], v[108:111], v[140:143], v[184:187]
ds_read_b128 v[64:67], v5 offset:3072
v_mfma_f32_16x16x32_bf16 v[184:187], v[104:107], v[144:147], v[184:187]
ds_read_b64_tr_b16 v[220:221], v4 offset:4064
v_mfma_f32_16x16x32_bf16 v[184:187], v[100:103], v[148:151], v[184:187]
ds_read_b64_tr_b16 v[222:223], v4 offset:4056
v_mfma_f32_16x16x32_bf16 v[184:187], v[96:99], v[152:155], v[184:187]
ds_read_b128 v[68:71], v5 offset:3584
v_mfma_f32_16x16x32_bf16 v[188:191], v[124:127], v[128:131], v[188:191]
buffer_load_dwordx4 v13, s[16:19], s49 offen offset:3072 lds
v_mfma_f32_16x16x32_bf16 v[188:191], v[120:123], v[132:135], v[188:191]
v_mfma_f32_16x16x32_bf16 v[188:191], v[116:119], v[136:139], v[188:191]
v_mfma_f32_16x16x32_bf16 v[188:191], v[112:115], v[140:143], v[188:191]
v_mfma_f32_16x16x32_bf16 v[188:191], v[108:111], v[144:147], v[188:191]
v_mfma_f32_16x16x32_bf16 v[188:191], v[104:107], v[148:151], v[188:191]
v_mfma_f32_16x16x32_bf16 v[188:191], v[100:103], v[152:155], v[188:191]
v_mfma_f32_16x16x32_bf16 v[188:191], v[96:99], v[156:159], v[188:191]
s_bitcmp1_b32 s2, 6
s_cbranch_scc1 L_odd
s_waitcnt lgkmcnt(0)
v_mfma_f32_16x16x32_bf16 v[24:27], v[192:195], v[40:43], 0
ds_read_b64_tr_b16 v[96:97], v4 offset:416
v_mfma_f32_16x16x32_bf16 v[28:31], v[196:199], v[40:43], 0
ds_read_b64_tr_b16 v[98:99], v4 offset:408
v_mfma_f32_16x16x32_bf16 v[28:31], v[192:195], v[44:47], v[28:31]
ds_read_b128 v[128:131], v5 offset:64
v_mfma_f32_16x16x32_bf16 v[32:35], v[200:203], v[40:43], 0
ds_read_b64_tr_b16 v[100:101], v4 offset:928
v_mfma_f32_16x16x32_bf16 v[32:35], v[196:199], v[44:47], v[32:35]
v_mfma_f32_16x16x32_bf16 v[32:35], v[192:195], v[48:51], v[32:35]
ds_read_b64_tr_b16 v[102:103], v4 offset:920
v_mfma_f32_16x16x32_bf16 v[36:39], v[204:207], v[40:43], 0
ds_read_b128 v[132:135], v5 offset:576
v_mfma_f32_16x16x32_bf16 v[36:39], v[200:203], v[44:47], v[36:39]
ds_read_b64_tr_b16 v[104:105], v4 offset:1440
v_mfma_f32_16x16x32_bf16 v[36:39], v[196:199], v[48:51], v[36:39]
ds_read_b64_tr_b16 v[106:107], v4 offset:1432
v_mfma_f32_16x16x32_bf16 v[36:39], v[192:195], v[52:55], v[36:39]
ds_read_b128 v[136:139], v5 offset:1088
v_mfma_f32_16x16x32_bf16 v[80:83], v[208:211], v[40:43], 0
v_mfma_f32_16x16x32_bf16 v[80:83], v[204:207], v[44:47], v[80:83]
ds_read_b64_tr_b16 v[108:109], v4 offset:1952
v_mfma_f32_16x16x32_bf16 v[80:83], v[200:203], v[48:51], v[80:83]
ds_read_b64_tr_b16 v[110:111], v4 offset:1944
v_mfma_f32_16x16x32_bf16 v[80:83], v[196:199], v[52:55], v[80:83]
ds_read_b128 v[140:143], v5 offset:1600
v_mfma_f32_16x16x32_bf16 v[80:83], v[192:195], v[56:59], v[80:83]
ds_read_b64_tr_b16 v[112:113], v4 offset:2464
v_mfma_f32_16x16x32_bf16 v[84:87], v[212:215], v[40:43], 0
ds_read_b64_tr_b16 v[114:115], v4 offset:2456
v_mfma_f32_16x16x32_bf16 v[84:87], v[208:211], v[44:47], v[84:87]
v_mfma_f32_16x16x32_bf16 v[84:87], v[204:207], v[48:51], v[84:87]
ds_read_b128 v[144:147], v5 offset:2112
v_mfma_f32_16x16x32_bf16 v[84:87], v[200:203], v[52:55], v[84:87]
ds_read_b64_tr_b16 v[116:117], v4 offset:2976
v_mfma_f32_16x16x32_bf16 v[84:87], v[196:199], v[56:59], v[84:87]
ds_read_b64_tr_b16 v[118:119], v4 offset:2968
v_mfma_f32_16x16x32_bf16 v[84:87], v[192:195], v[60:63], v[84:87]
ds_read_b128 v[148:151], v5 offset:2624
v_mfma_f32_16x16x32_bf16 v[88:91], v[216:219], v[40:43], 0
ds_read_b64_tr_b16 v[120:121], v4 offset:3488
v_mfma_f32_16x16x32_bf16 v[88:91], v[212:215], v[44:47], v[88:91]
v_mfma_f32_16x16x32_bf16 v[88:91], v[208:211], v[48:51], v[88:91]
ds_read_b64_tr_b16 v[122:123], v4 offset:3480
v_mfma_f32_16x16x32_bf16 v[88:91], v[204:207], v[52:55], v[88:91]
ds_read_b128 v[152:155], v5 offset:3136
v_mfma_f32_16x16x32_bf16 v[88:91], v[200:203], v[56:59], v[88:91]
ds_read_b64_tr_b16 v[124:125], v4 offset:4000
v_mfma_f32_16x16x32_bf16 v[88:91], v[196:199], v[60:63], v[88:91]
ds_read_b64_tr_b16 v[126:127], v4 offset:3992
v_mfma_f32_16x16x32_bf16 v[88:91], v[192:195], v[64:67], v[88:91]
ds_read_b128 v[156:159], v5 offset:3648
v_mfma_f32_16x16x32_bf16 v[92:95], v[220:223], v[40:43], 0
v_mfma_f32_16x16x32_bf16 v[92:95], v[216:219], v[44:47], v[92:95]
v_mfma_f32_16x16x32_bf16 v[92:95], v[212:215], v[48:51], v[92:95]
v_mfma_f32_16x16x32_bf16 v[92:95], v[208:211], v[52:55], v[92:95]
v_mfma_f32_16x16x32_bf16 v[92:95], v[204:207], v[56:59], v[92:95]
v_mfma_f32_16x16x32_bf16 v[92:95], v[200:203], v[60:63], v[92:95]
v_mfma_f32_16x16x32_bf16 v[92:95], v[196:199], v[64:67], v[92:95]
s_waitcnt vmcnt(33) lgkmcnt(0)
v_mfma_f32_16x16x32_bf16 v[92:95], v[192:195], v[68:71], v[92:95]
s_barrier
v_mfma_f32_16x16x32_bf16 v[24:27], v[96:99], v[128:131], v[24:27]
ds_read_b64_tr_b16 v[40:41], v6 offset:0
v_mfma_f32_16x16x32_bf16 v[28:31], v[100:103], v[128:131], v[28:31]
ds_read_b64_tr_b16 v[42:43], v6 offset:4096
v_mfma_f32_16x16x32_bf16 v[28:31], v[96:99], v[132:135], v[28:31]
ds_read_b64_tr_b16 v[44:45], v6 offset:8192
v_mfma_f32_16x16x32_bf16 v[32:35], v[104:107], v[128:131], v[32:35]
ds_read_b64_tr_b16 v[46:47], v6 offset:12288
v_mfma_f32_16x16x32_bf16 v[32:35], v[100:103], v[132:135], v[32:35]
v_mfma_f32_16x16x32_bf16 v[32:35], v[96:99], v[136:139], v[32:35]
ds_read_b64_tr_b16 v[48:49], v7 offset:0
v_mfma_f32_16x16x32_bf16 v[36:39], v[108:111], v[128:131], v[36:39]
ds_read_b64_tr_b16 v[50:51], v7 offset:4096
v_mfma_f32_16x16x32_bf16 v[36:39], v[104:107], v[132:135], v[36:39]
ds_read_b64_tr_b16 v[52:53], v7 offset:8192
v_mfma_f32_16x16x32_bf16 v[36:39], v[100:103], v[136:139], v[36:39]
ds_read_b64_tr_b16 v[54:55], v7 offset:12288
v_mfma_f32_16x16x32_bf16 v[36:39], v[96:99], v[140:143], v[36:39]
ds_read_b64 v[192:193], v10 offset:0
v_mfma_f32_16x16x32_bf16 v[80:83], v[112:115], v[128:131], v[80:83]
v_mfma_f32_16x16x32_bf16 v[80:83], v[108:111], v[132:135], v[80:83]
ds_read_b64 v[194:195], v10 offset:512
v_mfma_f32_16x16x32_bf16 v[80:83], v[104:107], v[136:139], v[80:83]
ds_read_b64 v[196:197], v10 offset:1024
v_mfma_f32_16x16x32_bf16 v[80:83], v[100:103], v[140:143], v[80:83]
ds_read_b64 v[198:199], v10 offset:1536
v_mfma_f32_16x16x32_bf16 v[80:83], v[96:99], v[144:147], v[80:83]
ds_read_b64 v[200:201], v10 offset:2048
v_mfma_f32_16x16x32_bf16 v[84:87], v[116:119], v[128:131], v[84:87]
ds_read_b64 v[202:203], v10 offset:2560
v_mfma_f32_16x16x32_bf16 v[84:87], v[112:115], v[132:135], v[84:87]
v_mfma_f32_16x16x32_bf16 v[84:87], v[108:111], v[136:139], v[84:87]
ds_read_b64 v[204:205], v10 offset:3072
v_mfma_f32_16x16x32_bf16 v[84:87], v[104:107], v[140:143], v[84:87]
ds_read_b64 v[206:207], v10 offset:3584
v_mfma_f32_16x16x32_bf16 v[84:87], v[100:103], v[144:147], v[84:87]
ds_read_b64 v[208:209], v76 offset:0
v_mfma_f32_16x16x32_bf16 v[84:87], v[96:99], v[148:151], v[84:87]
ds_read_b64 v[210:211], v76 offset:512
v_mfma_f32_16x16x32_bf16 v[88:91], v[120:123], v[128:131], v[88:91]
v_mfma_f32_16x16x32_bf16 v[88:91], v[116:119], v[132:135], v[88:91]
ds_write_b128 v72, v[24:27] offset:0
v_mfma_f32_16x16x32_bf16 v[88:91], v[112:115], v[136:139], v[88:91]
ds_write_b128 v72, v[28:31] offset:1024
v_mfma_f32_16x16x32_bf16 v[88:91], v[108:111], v[140:143], v[88:91]
ds_write_b128 v72, v[32:35] offset:2048
v_mfma_f32_16x16x32_bf16 v[88:91], v[104:107], v[144:147], v[88:91]
ds_write_b128 v72, v[36:39] offset:3072
v_mfma_f32_16x16x32_bf16 v[88:91], v[100:103], v[148:151], v[88:91]
ds_write_b128 v72, v[80:83] offset:4096
v_mfma_f32_16x16x32_bf16 v[88:91], v[96:99], v[152:155], v[88:91]
v_mfma_f32_16x16x32_bf16 v[92:95], v[124:127], v[128:131], v[92:95]
ds_write_b128 v72, v[84:87] offset:5120
v_mfma_f32_16x16x32_bf16 v[92:95], v[120:123], v[132:135], v[92:95]
v_mfma_f32_16x16x32_bf16 v[92:95], v[116:119], v[136:139], v[92:95]
v_mfma_f32_16x16x32_bf16 v[92:95], v[112:115], v[140:143], v[92:95]
v_mfma_f32_16x16x32_bf16 v[92:95], v[108:111], v[144:147], v[92:95]
v_mfma_f32_16x16x32_bf16 v[92:95], v[104:107], v[148:151], v[92:95]
v_mfma_f32_16x16x32_bf16 v[92:95], v[100:103], v[152:155], v[92:95]
v_mfma_f32_16x16x32_bf16 v[92:95], v[96:99], v[156:159], v[92:95]
ds_write_b128 v72, v[88:91] offset:6144
L_join:
s_waitcnt lgkmcnt(0)
v_mfma_f32_16x16x32_bf16 v[96:99], v[40:43], a[0:3], 0
v_mfma_f32_16x16x32_bf16 v[96:99], v[44:47], a[16:19], v[96:99]
ds_read_b64_tr_b16 v[56:57], v6 offset:2048
v_mfma_f32_16x16x32_bf16 v[100:103], v[40:43], a[4:7], 0
ds_read_b64_tr_b16 v[58:59], v6 offset:6144
v_lshlrev_b32 v212, 16, v192
v_mfma_f32_16x16x32_bf16 v[100:103], v[44:47], a[20:23], v[100:103]
ds_read_b64_tr_b16 v[60:61], v6 offset:10240
v_and_b32 v192, 0xffff0000, v192
v_mfma_f32_16x16x32_bf16 v[104:107], v[40:43], a[8:11], 0
v_lshlrev_b32 v213, 16, v193
v_and_b32 v193, 0xffff0000, v193
v_mfma_f32_16x16x32_bf16 v[104:107], v[44:47], a[24:27], v[104:107]
ds_read_b64_tr_b16 v[62:63], v6 offset:14336
v_fmac_f32 v160, s56, v212
v_mfma_f32_16x16x32_bf16 v[108:111], v[40:43], a[12:15], 0
ds_read_b64_tr_b16 v[64:65], v7 offset:2048
v_fmac_f32 v161, s56, v192
v_mfma_f32_16x16x32_bf16 v[108:111], v[44:47], a[28:31], v[108:111]
ds_read_b64_tr_b16 v[66:67], v7 offset:6144
v_fmac_f32 v162, s56, v213
v_mfma_f32_16x16x32_bf16 v[112:115], v[48:51], a[0:3], 0
ds_write_b128 v72, v[92:95] offset:7168
v_mfma_f32_16x16x32_bf16 v[112:115], v[52:55], a[16:19], v[112:115]
ds_read_b64_tr_b16 v[68:69], v7 offset:10240
s_add_u32 m0, s37, 16384
v_mfma_f32_16x16x32_bf16 v[116:119], v[48:51], a[4:7], 0
ds_read_b64_tr_b16 v[70:71], v7 offset:14336
s_mov_b32 s48, 592512
v_mfma_f32_16x16x32_bf16 v[116:119], v[52:55], a[20:23], v[116:119]
v_fmac_f32 v163, s56, v193
v_cvt_pk_bf16_f32 v160, v160, v161
v_mfma_f32_16x16x32_bf16 v[120:123], v[48:51], a[8:11], 0
v_cvt_pk_bf16_f32 v161, v162, v163
v_lshlrev_b32 v214, 16, v194
v_mfma_f32_16x16x32_bf16 v[120:123], v[52:55], a[24:27], v[120:123]
v_and_b32 v194, 0xffff0000, v194
v_lshlrev_b32 v215, 16, v195
v_mfma_f32_16x16x32_bf16 v[124:127], v[48:51], a[12:15], 0
v_and_b32 v195, 0xffff0000, v195
s_waitcnt vmcnt(4) lgkmcnt(0)
v_mfma_f32_16x16x32_bf16 v[124:127], v[52:55], a[28:31], v[124:127]
s_barrier
v_mfma_f32_16x16x32_bf16 v[128:131], v[56:59], a[0:3], 0
buffer_load_dwordx4 v12, s[16:19], s48 offen offset:0 lds
v_mfma_f32_16x16x32_bf16 v[128:131], v[60:63], a[16:19], v[128:131]
ds_read_b64_tr_b16 v[40:41], v8 offset:16384
v_fmac_f32 v164, s56, v214
v_mfma_f32_16x16x32_bf16 v[132:135], v[56:59], a[4:7], 0
ds_read_b64_tr_b16 v[42:43], v8 offset:20480
ds_read_b128 v[24:27], v73 offset:0
v_mfma_f32_16x16x32_bf16 v[132:135], v[60:63], a[20:23], v[132:135]
ds_read_b64_tr_b16 v[44:45], v8 offset:24576
v_fmac_f32 v165, s56, v194
v_mfma_f32_16x16x32_bf16 v[136:139], v[56:59], a[8:11], 0
buffer_load_dwordx4 v13, s[16:19], s48 offen offset:1024 lds
v_mfma_f32_16x16x32_bf16 v[136:139], v[60:63], a[24:27], v[136:139]
ds_read_b64_tr_b16 v[46:47], v8 offset:28672
s_mov_b32 s49, 590592
v_mfma_f32_16x16x32_bf16 v[140:143], v[56:59], a[12:15], 0
ds_read_b64_tr_b16 v[48:49], v9 offset:16384
ds_read_b128 v[28:31], v73 offset:8192
v_mfma_f32_16x16x32_bf16 v[140:143], v[60:63], a[28:31], v[140:143]
ds_read_b64_tr_b16 v[50:51], v9 offset:20480
v_fmac_f32 v166, s56, v215
v_fmac_f32 v167, s56, v195
v_mfma_f32_16x16x32_bf16 v[144:147], v[64:67], a[0:3], 0
buffer_load_dwordx4 v12, s[16:19], s49 offen offset:2048 lds
v_mfma_f32_16x16x32_bf16 v[144:147], v[68:71], a[16:19], v[144:147]
ds_read_b64_tr_b16 v[52:53], v9 offset:24576
v_cvt_pk_bf16_f32 v164, v164, v165
v_mfma_f32_16x16x32_bf16 v[148:151], v[64:67], a[4:7], 0
ds_read_b64_tr_b16 v[54:55], v9 offset:28672
ds_read_b128 v[32:35], v73 offset:21504
v_mfma_f32_16x16x32_bf16 v[148:151], v[68:71], a[20:23], v[148:151]
ds_read_b128 v[36:39], v73 offset:29696
v_cvt_pk_bf16_f32 v165, v166, v167
v_mfma_f32_16x16x32_bf16 v[152:155], v[64:67], a[8:11], 0
buffer_load_dwordx4 v13, s[16:19], s49 offen offset:3072 lds
v_mfma_f32_16x16x32_bf16 v[152:155], v[68:71], a[24:27], v[152:155]
s_add_u32 m0, s37, 32768
v_lshlrev_b32 v216, 16, v196
v_mfma_f32_16x16x32_bf16 v[156:159], v[64:67], a[12:15], 0
s_mov_b32 s48, 2688
v_and_b32 v196, 0xffff0000, v196
v_mfma_f32_16x16x32_bf16 v[156:159], v[68:71], a[28:31], v[156:159]
v_lshlrev_b32 v217, 16, v197
v_and_b32 v197, 0xffff0000, v197
s_waitcnt lgkmcnt(0)
v_mfma_f32_16x16x32_bf16 v[96:99], v[40:43], a[32:35], v[96:99]
buffer_load_dwordx4 v12, s[16:19], s48 offen offset:0 lds
v_mfma_f32_16x16x32_bf16 v[96:99], v[44:47], a[48:51], v[96:99]
ds_read_b64_tr_b16 v[56:57], v8 offset:18432
v_fmac_f32 v168, s56, v216
v_mfma_f32_16x16x32_bf16 v[100:103], v[40:43], a[36:39], v[100:103]
ds_read_b64_tr_b16 v[58:59], v8 offset:22528
ds_read_b128 v[80:83], v73 offset:1024
v_mfma_f32_16x16x32_bf16 v[100:103], v[44:47], a[52:55], v[100:103]
ds_read_b64_tr_b16 v[60:61], v8 offset:26624
v_fmac_f32 v169, s56, v196
v_mfma_f32_16x16x32_bf16 v[104:107], v[40:43], a[40:43], v[104:107]
buffer_load_dwordx4 v13, s[16:19], s48 offen offset:1024 lds
v_mfma_f32_16x16x32_bf16 v[104:107], v[44:47], a[56:59], v[104:107]
ds_read_b64_tr_b16 v[62:63], v8 offset:30720
s_mov_b32 s49, 768
v_mfma_f32_16x16x32_bf16 v[108:111], v[40:43], a[44:47], v[108:111]
ds_read_b64_tr_b16 v[64:65], v9 offset:18432
ds_read_b128 v[84:87], v73 offset:9216
v_mfma_f32_16x16x32_bf16 v[108:111], v[44:47], a[60:63], v[108:111]
ds_read_b64_tr_b16 v[66:67], v9 offset:22528
v_fmac_f32 v170, s56, v217
v_mfma_f32_16x16x32_bf16 v[112:115], v[48:51], a[32:35], v[112:115]
buffer_load_dwordx4 v12, s[16:19], s49 offen offset:2048 lds
v_mfma_f32_16x16x32_bf16 v[112:115], v[52:55], a[48:51], v[112:115]
ds_read_b64_tr_b16 v[68:69], v9 offset:26624
v_fmac_f32 v171, s56, v197
v_cvt_pk_bf16_f32 v168, v168, v169
v_mfma_f32_16x16x32_bf16 v[116:119], v[48:51], a[36:39], v[116:119]
ds_read_b64_tr_b16 v[70:71], v9 offset:30720
ds_read_b128 v[88:91], v73 offset:22528
v_mfma_f32_16x16x32_bf16 v[116:119], v[52:55], a[52:55], v[116:119]
ds_read_b128 v[92:95], v73 offset:30720
v_cvt_pk_bf16_f32 v169, v170, v171
v_mfma_f32_16x16x32_bf16 v[120:123], v[48:51], a[40:43], v[120:123]
buffer_load_dwordx4 v13, s[16:19], s49 offen offset:3072 lds
v_mfma_f32_16x16x32_bf16 v[120:123], v[52:55], a[56:59], v[120:123]
s_add_u32 m0, s37, 0
v_lshlrev_b32 v218, 16, v198
v_mfma_f32_16x16x32_bf16 v[124:127], v[48:51], a[44:47], v[124:127]
s_mov_b32 s48, 76416
s_waitcnt vmcnt(8) lgkmcnt(0)
v_mfma_f32_16x16x32_bf16 v[124:127], v[52:55], a[60:63], v[124:127]
s_barrier
v_mfma_f32_16x16x32_bf16 v[128:131], v[56:59], a[32:35], v[128:131]
buffer_load_dwordx4 v12, s[16:19], s48 offen offset:0 lds
v_mfma_f32_16x16x32_bf16 v[128:131], v[60:63], a[48:51], v[128:131]
ds_read_b64_tr_b16 v[40:41], v8 offset:32768
v_and_b32 v198, 0xffff0000, v198
v_lshlrev_b32 v219, 16, v199
v_mfma_f32_16x16x32_bf16 v[132:135], v[56:59], a[36:39], v[132:135]
ds_read_b64_tr_b16 v[42:43], v8 offset:36864
v_and_b32 v199, 0xffff0000, v199
v_mfma_f32_16x16x32_bf16 v[132:135], v[60:63], a[52:55], v[132:135]
ds_read_b64_tr_b16 v[44:45], v8 offset:40960
v_fmac_f32 v172, s56, v218
v_mfma_f32_16x16x32_bf16 v[136:139], v[56:59], a[40:43], v[136:139]
buffer_load_dwordx4 v13, s[16:19], s48 offen offset:1024 lds
v_mfma_f32_16x16x32_bf16 v[136:139], v[60:63], a[56:59], v[136:139]
ds_read_b64_tr_b16 v[46:47], v8 offset:45056
s_mov_b32 s49, 74496
v_mfma_f32_16x16x32_bf16 v[140:143], v[56:59], a[44:47], v[140:143]
ds_read_b64_tr_b16 v[48:49], v9 offset:32768
v_fmac_f32 v173, s56, v198
v_mfma_f32_16x16x32_bf16 v[140:143], v[60:63], a[60:63], v[140:143]
ds_read_b64_tr_b16 v[50:51], v9 offset:36864
v_fmac_f32 v174, s56, v219
v_mfma_f32_16x16x32_bf16 v[144:147], v[64:67], a[32:35], v[144:147]
buffer_load_dwordx4 v12, s[16:19], s49 offen offset:2048 lds
v_mfma_f32_16x16x32_bf16 v[144:147], v[68:71], a[48:51], v[144:147]
ds_read_b64_tr_b16 v[52:53], v9 offset:40960
v_fmac_f32 v175, s56, v199
v_cvt_pk_bf16_f32 v172, v172, v173
v_mfma_f32_16x16x32_bf16 v[148:151], v[64:67], a[36:39], v[148:151]
ds_read_b64_tr_b16 v[54:55], v9 offset:45056
v_cvt_pk_bf16_f32 v173, v174, v175
v_mfma_f32_16x16x32_bf16 v[148:151], v[68:71], a[52:55], v[148:151]
v_lshlrev_b32 v212, 16, v200
v_and_b32 v200, 0xffff0000, v200
v_mfma_f32_16x16x32_bf16 v[152:155], v[64:67], a[40:43], v[152:155]
buffer_load_dwordx4 v13, s[16:19], s49 offen offset:3072 lds
v_mfma_f32_16x16x32_bf16 v[152:155], v[68:71], a[56:59], v[152:155]
s_add_u32 m0, s37, 131072
v_lshlrev_b32 v213, 16, v201
v_mfma_f32_16x16x32_bf16 v[156:159], v[64:67], a[44:47], v[156:159]
s_mov_b32 s48, 150144
v_and_b32 v201, 0xffff0000, v201
v_mfma_f32_16x16x32_bf16 v[156:159], v[68:71], a[60:63], v[156:159]
v_fmac_f32 v176, s56, v212
s_waitcnt lgkmcnt(0)
v_mfma_f32_16x16x32_bf16 v[96:99], v[40:43], a[64:67], v[96:99]
buffer_load_dwordx4 v12, s[16:19], s48 offen offset:0 lds
v_mfma_f32_16x16x32_bf16 v[96:99], v[44:47], a[80:83], v[96:99]
ds_read_b64_tr_b16 v[56:57], v8 offset:34816
v_fmac_f32 v177, s56, v200
v_fmac_f32 v178, s56, v213
v_mfma_f32_16x16x32_bf16 v[100:103], v[40:43], a[68:71], v[100:103]
ds_read_b64_tr_b16 v[58:59], v8 offset:38912
v_fmac_f32 v179, s56, v201
v_mfma_f32_16x16x32_bf16 v[100:103], v[44:47], a[84:87], v[100:103]
ds_read_b64_tr_b16 v[60:61], v8 offset:43008
v_cvt_pk_bf16_f32 v176, v176, v177
v_mfma_f32_16x16x32_bf16 v[104:107], v[40:43], a[72:75], v[104:107]
buffer_load_dwordx4 v13, s[16:19], s48 offen offset:1024 lds
v_mfma_f32_16x16x32_bf16 v[104:107], v[44:47], a[88:91], v[104:107]
ds_read_b64_tr_b16 v[62:63], v8 offset:47104
s_mov_b32 s49, 148224
v_mfma_f32_16x16x32_bf16 v[108:111], v[40:43], a[76:79], v[108:111]
ds_read_b64_tr_b16 v[64:65], v9 offset:34816
v_cvt_pk_bf16_f32 v177, v178, v179
v_mfma_f32_16x16x32_bf16 v[108:111], v[44:47], a[92:95], v[108:111]
ds_read_b64_tr_b16 v[66:67], v9 offset:38912
v_lshlrev_b32 v214, 16, v202
v_mfma_f32_16x16x32_bf16 v[112:115], v[48:51], a[64:67], v[112:115]
buffer_load_dwordx4 v12, s[16:19], s49 offen offset:2048 lds
v_mfma_f32_16x16x32_bf16 v[112:115], v[52:55], a[80:83], v[112:115]
ds_read_b64_tr_b16 v[68:69], v9 offset:43008
v_and_b32 v202, 0xffff0000, v202
v_lshlrev_b32 v215, 16, v203
v_mfma_f32_16x16x32_bf16 v[116:119], v[48:51], a[68:71], v[116:119]
ds_read_b64_tr_b16 v[70:71], v9 offset:47104
v_and_b32 v203, 0xffff0000, v203
v_mfma_f32_16x16x32_bf16 v[116:119], v[52:55], a[84:87], v[116:119]
v_fmac_f32 v180, s56, v214
v_fmac_f32 v181, s56, v202
v_mfma_f32_16x16x32_bf16 v[120:123], v[48:51], a[72:75], v[120:123]
buffer_load_dwordx4 v13, s[16:19], s49 offen offset:3072 lds
v_mfma_f32_16x16x32_bf16 v[120:123], v[52:55], a[88:91], v[120:123]
s_add_u32 m0, s37, 147456
v_fmac_f32 v182, s56, v215
v_mfma_f32_16x16x32_bf16 v[124:127], v[48:51], a[76:79], v[124:127]
s_mov_b32 s48, 371584
s_waitcnt vmcnt(12) lgkmcnt(0)
v_mfma_f32_16x16x32_bf16 v[124:127], v[52:55], a[92:95], v[124:127]
s_barrier
v_mfma_f32_16x16x32_bf16 v[128:131], v[56:59], a[64:67], v[128:131]
buffer_store_dwordx2 v[160:161], v11, s[20:23], s42 offen offset:0 sc1
v_mfma_f32_16x16x32_bf16 v[128:131], v[60:63], a[80:83], v[128:131]
ds_read_b64_tr_b16 v[40:41], v6 offset:16384
v_fmac_f32 v183, s56, v203
v_cvt_pk_bf16_f32 v180, v180, v181
v_mfma_f32_16x16x32_bf16 v[132:135], v[56:59], a[68:71], v[132:135]
ds_read_b64_tr_b16 v[42:43], v6 offset:20480
v_cvt_pk_bf16_f32 v181, v182, v183
v_mfma_f32_16x16x32_bf16 v[132:135], v[60:63], a[84:87], v[132:135]
ds_read_b64_tr_b16 v[44:45], v6 offset:24576
v_lshlrev_b32 v216, 16, v204
v_mfma_f32_16x16x32_bf16 v[136:139], v[56:59], a[72:75], v[136:139]
buffer_load_dwordx4 v12, s[16:19], s48 offen offset:0 lds
v_mfma_f32_16x16x32_bf16 v[136:139], v[60:63], a[88:91], v[136:139]
ds_read_b64_tr_b16 v[46:47], v6 offset:28672
v_and_b32 v204, 0xffff0000, v204
v_mfma_f32_16x16x32_bf16 v[140:143], v[56:59], a[76:79], v[140:143]
ds_read_b64_tr_b16 v[48:49], v7 offset:16384
v_lshlrev_b32 v217, 16, v205
v_mfma_f32_16x16x32_bf16 v[140:143], v[60:63], a[92:95], v[140:143]
ds_read_b64_tr_b16 v[50:51], v7 offset:20480
v_and_b32 v205, 0xffff0000, v205
v_mfma_f32_16x16x32_bf16 v[144:147], v[64:67], a[64:67], v[144:147]
buffer_store_dwordx2 v[164:165], v11, s[20:23], s42 offen offset:512 sc1
v_mfma_f32_16x16x32_bf16 v[144:147], v[68:71], a[80:83], v[144:147]
ds_read_b64_tr_b16 v[52:53], v7 offset:24576
v_fmac_f32 v184, s56, v216
v_mfma_f32_16x16x32_bf16 v[148:151], v[64:67], a[68:71], v[148:151]
ds_read_b64_tr_b16 v[54:55], v7 offset:28672
v_fmac_f32 v185, s56, v204
v_fmac_f32 v186, s56, v217
v_mfma_f32_16x16x32_bf16 v[148:151], v[68:71], a[84:87], v[148:151]
v_fmac_f32 v187, s56, v205
v_cvt_pk_bf16_f32 v184, v184, v185
v_mfma_f32_16x16x32_bf16 v[152:155], v[64:67], a[72:75], v[152:155]
buffer_load_dwordx4 v13, s[16:19], s48 offen offset:1024 lds
v_mfma_f32_16x16x32_bf16 v[152:155], v[68:71], a[88:91], v[152:155]
s_mov_b32 s49, 443264
v_cvt_pk_bf16_f32 v185, v186, v187
v_mfma_f32_16x16x32_bf16 v[156:159], v[64:67], a[76:79], v[156:159]
v_lshlrev_b32 v218, 16, v206
v_and_b32 v206, 0xffff0000, v206
v_mfma_f32_16x16x32_bf16 v[156:159], v[68:71], a[92:95], v[156:159]
v_lshlrev_b32 v219, 16, v207
s_waitcnt lgkmcnt(0)
v_mfma_f32_16x16x32_bf16 v[96:99], v[40:43], a[96:99], v[96:99]
buffer_load_dword v78, v79, s[20:23], 0 offen sc1
v_mfma_f32_16x16x32_bf16 v[96:99], v[44:47], a[112:115], v[96:99]
ds_read_b64_tr_b16 v[56:57], v6 offset:18432
v_and_b32 v207, 0xffff0000, v207
v_mfma_f32_16x16x32_bf16 v[100:103], v[40:43], a[100:103], v[100:103]
ds_read_b64_tr_b16 v[58:59], v6 offset:22528
v_fmac_f32 v188, s56, v218
v_mfma_f32_16x16x32_bf16 v[100:103], v[44:47], a[116:119], v[100:103]
ds_read_b64_tr_b16 v[60:61], v6 offset:26624
v_fmac_f32 v189, s56, v206
v_mfma_f32_16x16x32_bf16 v[104:107], v[40:43], a[104:107], v[104:107]
buffer_load_dwordx4 v12, s[16:19], s49 offen offset:2048 lds
v_mfma_f32_16x16x32_bf16 v[104:107], v[44:47], a[120:123], v[104:107]
ds_read_b64_tr_b16 v[62:63], v6 offset:30720
v_fmac_f32 v190, s56, v219
v_fmac_f32 v191, s56, v207
v_mfma_f32_16x16x32_bf16 v[108:111], v[40:43], a[108:111], v[108:111]
ds_read_b64_tr_b16 v[64:65], v7 offset:18432
v_cvt_pk_bf16_f32 v188, v188, v189
v_mfma_f32_16x16x32_bf16 v[108:111], v[44:47], a[124:127], v[108:111]
ds_read_b64_tr_b16 v[66:67], v7 offset:22528
v_cvt_pk_bf16_f32 v189, v190, v191
v_mfma_f32_16x16x32_bf16 v[112:115], v[48:51], a[96:99], v[112:115]
buffer_store_dwordx2 v[168:169], v11, s[20:23], s42 offen offset:1024 sc1
v_mfma_f32_16x16x32_bf16 v[112:115], v[52:55], a[112:115], v[112:115]
ds_read_b64_tr_b16 v[68:69], v7 offset:26624
v_add_f32 v24, v24, v28
v_mfma_f32_16x16x32_bf16 v[116:119], v[48:51], a[100:103], v[116:119]
ds_read_b64_tr_b16 v[70:71], v7 offset:30720
v_add_f32 v25, v25, v29
v_mfma_f32_16x16x32_bf16 v[116:119], v[52:55], a[116:119], v[116:119]
v_add_f32 v26, v26, v30
v_add_f32 v27, v27, v31
v_mfma_f32_16x16x32_bf16 v[120:123], v[48:51], a[104:107], v[120:123]
buffer_load_dwordx4 v13, s[16:19], s49 offen offset:3072 lds
v_mfma_f32_16x16x32_bf16 v[120:123], v[52:55], a[120:123], v[120:123]
s_add_u32 m0, s37, 16384
v_add_f32 v32, v32, v36
v_add_f32 v33, v33, v37
v_mfma_f32_16x16x32_bf16 v[124:127], v[48:51], a[108:111], v[124:127]
s_mov_b32 s48, 519040
s_waitcnt vmcnt(16) lgkmcnt(0)
v_mfma_f32_16x16x32_bf16 v[124:127], v[52:55], a[124:127], v[124:127]
s_barrier
v_mfma_f32_16x16x32_bf16 v[128:131], v[56:59], a[96:99], v[128:131]
buffer_store_dwordx2 v[172:173], v11, s[20:23], s42 offen offset:1536 sc1
v_mfma_f32_16x16x32_bf16 v[128:131], v[60:63], a[112:115], v[128:131]
ds_read_b64_tr_b16 v[40:41], v6 offset:32768
v_add_f32 v34, v34, v38
v_mfma_f32_16x16x32_bf16 v[132:135], v[56:59], a[100:103], v[132:135]
ds_read_b64_tr_b16 v[42:43], v6 offset:36864
v_add_f32 v35, v35, v39
v_mfma_f32_16x16x32_bf16 v[132:135], v[60:63], a[116:119], v[132:135]
ds_read_b64_tr_b16 v[44:45], v6 offset:40960
v_add_f32 v24, v24, v32
v_mfma_f32_16x16x32_bf16 v[136:139], v[56:59], a[104:107], v[136:139]
buffer_load_dwordx4 v12, s[16:19], s48 offen offset:0 lds
v_mfma_f32_16x16x32_bf16 v[136:139], v[60:63], a[120:123], v[136:139]
ds_read_b64_tr_b16 v[46:47], v6 offset:45056
v_add_f32 v25, v25, v33
v_mfma_f32_16x16x32_bf16 v[140:143], v[56:59], a[108:111], v[140:143]
ds_read_b64_tr_b16 v[48:49], v7 offset:32768
v_add_f32 v26, v26, v34
v_mfma_f32_16x16x32_bf16 v[140:143], v[60:63], a[124:127], v[140:143]
ds_read_b64_tr_b16 v[50:51], v7 offset:36864
v_add_f32 v27, v27, v35
v_mfma_f32_16x16x32_bf16 v[144:147], v[64:67], a[96:99], v[144:147]
buffer_store_dwordx2 v[176:177], v11, s[20:23], s42 offen offset:2048 sc1
v_mfma_f32_16x16x32_bf16 v[144:147], v[68:71], a[112:115], v[144:147]
ds_read_b64_tr_b16 v[52:53], v7 offset:40960
v_lshlrev_b32 v220, 16, v208
v_and_b32 v208, 0xffff0000, v208
v_mfma_f32_16x16x32_bf16 v[148:151], v[64:67], a[100:103], v[148:151]
ds_read_b64_tr_b16 v[54:55], v7 offset:45056
v_lshlrev_b32 v221, 16, v209
v_mfma_f32_16x16x32_bf16 v[148:151], v[68:71], a[116:119], v[148:151]
v_and_b32 v209, 0xffff0000, v209
v_fmac_f32 v24, s59, v220
v_mfma_f32_16x16x32_bf16 v[152:155], v[64:67], a[104:107], v[152:155]
buffer_load_dwordx4 v13, s[16:19], s48 offen offset:1024 lds
v_mfma_f32_16x16x32_bf16 v[152:155], v[68:71], a[120:123], v[152:155]
s_mov_b32 s49, 590720
v_fmac_f32 v25, s59, v208
v_mfma_f32_16x16x32_bf16 v[156:159], v[64:67], a[108:111], v[156:159]
v_fmac_f32 v26, s59, v221
v_fmac_f32 v27, s59, v209
v_mfma_f32_16x16x32_bf16 v[156:159], v[68:71], a[124:127], v[156:159]
v_cvt_pk_bf16_f32 v24, v24, v25
s_waitcnt lgkmcnt(0)
v_mfma_f32_16x16x32_bf16 v[96:99], v[40:43], a[128:131], v[96:99]
buffer_store_dwordx2 v[180:181], v11, s[20:23], s42 offen offset:2560 sc1
v_mfma_f32_16x16x32_bf16 v[96:99], v[44:47], a[144:147], v[96:99]
ds_read_b64_tr_b16 v[56:57], v6 offset:34816
v_cvt_pk_bf16_f32 v25, v26, v27
v_mfma_f32_16x16x32_bf16 v[100:103], v[40:43], a[132:135], v[100:103]
ds_read_b64_tr_b16 v[58:59], v6 offset:38912
v_add_f32 v80, v80, v84
v_mfma_f32_16x16x32_bf16 v[100:103], v[44:47], a[148:151], v[100:103]
ds_read_b64_tr_b16 v[60:61], v6 offset:43008
v_add_f32 v81, v81, v85
v_add_f32 v82, v82, v86
v_mfma_f32_16x16x32_bf16 v[104:107], v[40:43], a[136:139], v[104:107]
buffer_load_dwordx4 v12, s[16:19], s49 offen offset:2048 lds
v_mfma_f32_16x16x32_bf16 v[104:107], v[44:47], a[152:155], v[104:107]
ds_read_b64_tr_b16 v[62:63], v6 offset:47104
v_add_f32 v83, v83, v87
v_mfma_f32_16x16x32_bf16 v[108:111], v[40:43], a[140:143], v[108:111]
ds_read_b64_tr_b16 v[64:65], v7 offset:34816
v_add_f32 v88, v88, v92
v_mfma_f32_16x16x32_bf16 v[108:111], v[44:47], a[156:159], v[108:111]
ds_read_b64_tr_b16 v[66:67], v7 offset:38912
v_add_f32 v89, v89, v93
v_mfma_f32_16x16x32_bf16 v[112:115], v[48:51], a[128:131], v[112:115]
buffer_store_dwordx2 v[184:185], v11, s[20:23], s42 offen offset:3072 sc1
v_mfma_f32_16x16x32_bf16 v[112:115], v[52:55], a[144:147], v[112:115]
ds_read_b64_tr_b16 v[68:69], v7 offset:43008
v_add_f32 v90, v90, v94
v_mfma_f32_16x16x32_bf16 v[116:119], v[48:51], a[132:135], v[116:119]
ds_read_b64_tr_b16 v[70:71], v7 offset:47104
v_add_f32 v91, v91, v95
v_mfma_f32_16x16x32_bf16 v[116:119], v[52:55], a[148:151], v[116:119]
v_add_f32 v80, v80, v88
v_add_f32 v81, v81, v89
v_mfma_f32_16x16x32_bf16 v[120:123], v[48:51], a[136:139], v[120:123]
buffer_load_dwordx4 v13, s[16:19], s49 offen offset:3072 lds
v_mfma_f32_16x16x32_bf16 v[120:123], v[52:55], a[152:155], v[120:123]
s_add_u32 m0, s37, 32768
v_add_f32 v82, v82, v90
v_add_f32 v83, v83, v91
v_mfma_f32_16x16x32_bf16 v[124:127], v[48:51], a[140:143], v[124:127]
s_mov_b32 s48, 2944
s_waitcnt vmcnt(20) lgkmcnt(0)
v_mfma_f32_16x16x32_bf16 v[124:127], v[52:55], a[156:159], v[124:127]
buffer_store_dwordx2 v[188:189], v11, s[20:23], s42 offen offset:3584 sc1
s_barrier
v_mfma_f32_16x16x32_bf16 v[128:131], v[56:59], a[128:131], v[128:131]
buffer_store_dwordx2 v[24:25], v77, s[20:23], s43 offen offset:0 sc1
v_mfma_f32_16x16x32_bf16 v[128:131], v[60:63], a[144:147], v[128:131]
ds_read_b64_tr_b16 v[40:41], v6 offset:0
v_lshlrev_b32 v222, 16, v210
v_mfma_f32_16x16x32_bf16 v[132:135], v[56:59], a[132:135], v[132:135]
ds_read_b64_tr_b16 v[42:43], v6 offset:4096
v_and_b32 v210, 0xffff0000, v210
v_mfma_f32_16x16x32_bf16 v[132:135], v[60:63], a[148:151], v[132:135]
ds_read_b64_tr_b16 v[44:45], v6 offset:8192
v_lshlrev_b32 v223, 16, v211
v_mfma_f32_16x16x32_bf16 v[136:139], v[56:59], a[136:139], v[136:139]
buffer_load_dwordx4 v12, s[16:19], s48 offen offset:0 lds
v_mfma_f32_16x16x32_bf16 v[136:139], v[60:63], a[152:155], v[136:139]
ds_read_b64_tr_b16 v[46:47], v6 offset:12288
v_and_b32 v211, 0xffff0000, v211
v_mfma_f32_16x16x32_bf16 v[140:143], v[56:59], a[140:143], v[140:143]
ds_read_b64_tr_b16 v[48:49], v7 offset:0
v_fmac_f32 v80, s59, v222
v_mfma_f32_16x16x32_bf16 v[140:143], v[60:63], a[156:159], v[140:143]
ds_read_b64_tr_b16 v[50:51], v7 offset:4096
v_fmac_f32 v81, s59, v210
v_mfma_f32_16x16x32_bf16 v[144:147], v[64:67], a[128:131], v[144:147]
v_fmac_f32 v82, s59, v223
v_fmac_f32 v83, s59, v211
v_mfma_f32_16x16x32_bf16 v[144:147], v[68:71], a[144:147], v[144:147]
ds_read_b64_tr_b16 v[52:53], v7 offset:8192
v_cvt_pk_bf16_f32 v80, v80, v81
v_mfma_f32_16x16x32_bf16 v[148:151], v[64:67], a[132:135], v[148:151]
ds_read_b64_tr_b16 v[54:55], v7 offset:12288
v_cvt_pk_bf16_f32 v81, v82, v83
v_mfma_f32_16x16x32_bf16 v[148:151], v[68:71], a[148:151], v[148:151]
s_waitcnt vmcnt(14)
v_readfirstlane_b32 s58, v78
s_cmp_ge_u32 s58, 3
s_cbranch_scc0 L_spin12
L_back12:
v_mfma_f32_16x16x32_bf16 v[152:155], v[64:67], a[136:139], v[152:155]
buffer_load_dwordx4 v13, s[16:19], s48 offen offset:1024 lds
v_mfma_f32_16x16x32_bf16 v[152:155], v[68:71], a[152:155], v[152:155]
s_mov_b32 s49, 74624
v_mfma_f32_16x16x32_bf16 v[156:159], v[64:67], a[140:143], v[156:159]
v_mfma_f32_16x16x32_bf16 v[156:159], v[68:71], a[156:159], v[156:159]
buffer_store_dwordx2 v[80:81], v77, s[20:23], s43 offen offset:512 sc1
s_waitcnt lgkmcnt(0)
v_mfma_f32_16x16x32_bf16 v[96:99], v[40:43], a[160:163], v[96:99]
s_add_u32 s51, s45, 12582912
v_mfma_f32_16x16x32_bf16 v[96:99], v[44:47], a[176:179], v[96:99]
ds_read_b64_tr_b16 v[56:57], v6 offset:2048
v_mfma_f32_16x16x32_bf16 v[100:103], v[40:43], a[164:167], v[100:103]
ds_read_b64_tr_b16 v[58:59], v6 offset:6144
v_mfma_f32_16x16x32_bf16 v[100:103], v[44:47], a[180:183], v[100:103]
ds_read_b64_tr_b16 v[60:61], v6 offset:10240
v_mfma_f32_16x16x32_bf16 v[104:107], v[40:43], a[168:171], v[104:107]
buffer_load_dwordx4 v12, s[16:19], s49 offen offset:2048 lds
v_mfma_f32_16x16x32_bf16 v[104:107], v[44:47], a[184:187], v[104:107]
ds_read_b64_tr_b16 v[62:63], v6 offset:14336
v_mfma_f32_16x16x32_bf16 v[108:111], v[40:43], a[172:175], v[108:111]
ds_read_b64_tr_b16 v[64:65], v7 offset:2048
v_mfma_f32_16x16x32_bf16 v[108:111], v[44:47], a[188:191], v[108:111]
ds_read_b64_tr_b16 v[66:67], v7 offset:6144
v_mfma_f32_16x16x32_bf16 v[112:115], v[48:51], a[160:163], v[112:115]
buffer_load_dwordx4 a[224:227], v17, s[20:23], s51 offen offset:0
v_mfma_f32_16x16x32_bf16 v[112:115], v[52:55], a[176:179], v[112:115]
ds_read_b64_tr_b16 v[68:69], v7 offset:10240
v_mfma_f32_16x16x32_bf16 v[116:119], v[48:51], a[164:167], v[116:119]
ds_read_b64_tr_b16 v[70:71], v7 offset:14336
v_mfma_f32_16x16x32_bf16 v[116:119], v[52:55], a[180:183], v[116:119]
v_mfma_f32_16x16x32_bf16 v[120:123], v[48:51], a[168:171], v[120:123]
buffer_load_dwordx4 v13, s[16:19], s49 offen offset:3072 lds
v_mfma_f32_16x16x32_bf16 v[120:123], v[52:55], a[184:187], v[120:123]
s_add_u32 m0, s37, 0
v_mfma_f32_16x16x32_bf16 v[124:127], v[48:51], a[172:175], v[124:127]
s_mov_b32 s48, 150400
s_waitcnt lgkmcnt(0)
v_mfma_f32_16x16x32_bf16 v[124:127], v[52:55], a[188:191], v[124:127]
s_barrier
v_mfma_f32_16x16x32_bf16 v[128:131], v[56:59], a[160:163], v[128:131]
buffer_load_dwordx4 a[228:231], v17, s[20:23], s51 offen offset:1024
v_mfma_f32_16x16x32_bf16 v[128:131], v[60:63], a[176:179], v[128:131]
ds_read_b64_tr_b16 v[40:41], v8 offset:16384
v_mfma_f32_16x16x32_bf16 v[132:135], v[56:59], a[164:167], v[132:135]
ds_read_b64_tr_b16 v[42:43], v8 offset:20480
v_mfma_f32_16x16x32_bf16 v[132:135], v[60:63], a[180:183], v[132:135]
ds_read_b64_tr_b16 v[44:45], v8 offset:24576
v_mfma_f32_16x16x32_bf16 v[136:139], v[56:59], a[168:171], v[136:139]
buffer_load_dwordx4 v12, s[16:19], s48 offen offset:0 lds
v_mfma_f32_16x16x32_bf16 v[136:139], v[60:63], a[184:187], v[136:139]
ds_read_b64_tr_b16 v[46:47], v8 offset:28672
v_mfma_f32_16x16x32_bf16 v[140:143], v[56:59], a[172:175], v[140:143]
ds_read_b64_tr_b16 v[48:49], v9 offset:16384
v_mfma_f32_16x16x32_bf16 v[140:143], v[60:63], a[188:191], v[140:143]
ds_read_b64_tr_b16 v[50:51], v9 offset:20480
v_mfma_f32_16x16x32_bf16 v[144:147], v[64:67], a[160:163], v[144:147]
buffer_load_dwordx4 a[232:235], v17, s[20:23], s51 offen offset:2048
v_mfma_f32_16x16x32_bf16 v[144:147], v[68:71], a[176:179], v[144:147]
ds_read_b64_tr_b16 v[52:53], v9 offset:24576
v_mfma_f32_16x16x32_bf16 v[148:151], v[64:67], a[164:167], v[148:151]
ds_read_b64_tr_b16 v[54:55], v9 offset:28672
v_mfma_f32_16x16x32_bf16 v[148:151], v[68:71], a[180:183], v[148:151]
v_mfma_f32_16x16x32_bf16 v[152:155], v[64:67], a[168:171], v[152:155]
buffer_load_dwordx4 v13, s[16:19], s48 offen offset:1024 lds
v_mfma_f32_16x16x32_bf16 v[152:155], v[68:71], a[184:187], v[152:155]
s_mov_b32 s49, 221824
v_mfma_f32_16x16x32_bf16 v[156:159], v[64:67], a[172:175], v[156:159]
v_mfma_f32_16x16x32_bf16 v[156:159], v[68:71], a[188:191], v[156:159]
s_waitcnt lgkmcnt(0)
v_mfma_f32_16x16x32_bf16 v[96:99], v[40:43], a[192:195], v[96:99]
buffer_load_dwordx4 a[236:239], v17, s[20:23], s51 offen offset:3072
v_mfma_f32_16x16x32_bf16 v[96:99], v[44:47], a[208:211], v[96:99]
ds_read_b64_tr_b16 v[56:57], v8 offset:18432
s_bfe_u32 s36, s46, 0x1000c
v_mfma_f32_16x16x32_bf16 v[100:103], v[40:43], a[196:199], v[100:103]
ds_read_b64_tr_b16 v[58:59], v8 offset:22528
s_xor_b32 s36, s36, 1
v_mfma_f32_16x16x32_bf16 v[100:103], v[44:47], a[212:215], v[100:103]
ds_read_b64_tr_b16 v[60:61], v8 offset:26624
s_lshl_b32 s36, s36, 28
v_mfma_f32_16x16x32_bf16 v[104:107], v[40:43], a[200:203], v[104:107]
buffer_load_dwordx4 v12, s[16:19], s49 offen offset:2048 lds
v_mfma_f32_16x16x32_bf16 v[104:107], v[44:47], a[216:219], v[104:107]
ds_read_b64_tr_b16 v[62:63], v8 offset:30720
v_add_u32 v14, s36, v21
v_mfma_f32_16x16x32_bf16 v[108:111], v[40:43], a[204:207], v[108:111]
ds_read_b64_tr_b16 v[64:65], v9 offset:18432
v_lshlrev_b32 v16, 4, v0
v_mfma_f32_16x16x32_bf16 v[108:111], v[44:47], a[220:223], v[108:111]
ds_read_b64_tr_b16 v[66:67], v9 offset:22528
v_add_u32 v16, 81920, v16
v_mfma_f32_16x16x32_bf16 v[112:115], v[48:51], a[192:195], v[112:115]
s_add_u32 s51, s45, 12591104
v_mfma_f32_16x16x32_bf16 v[112:115], v[52:55], a[208:211], v[112:115]
ds_read_b64_tr_b16 v[68:69], v9 offset:26624
v_mfma_f32_16x16x32_bf16 v[116:119], v[48:51], a[196:199], v[116:119]
ds_read_b64_tr_b16 v[70:71], v9 offset:30720
v_mfma_f32_16x16x32_bf16 v[116:119], v[52:55], a[212:215], v[116:119]
v_mfma_f32_16x16x32_bf16 v[120:123], v[48:51], a[200:203], v[120:123]
buffer_load_dwordx4 v13, s[16:19], s49 offen offset:3072 lds
v_mfma_f32_16x16x32_bf16 v[120:123], v[52:55], a[216:219], v[120:123]
s_add_u32 m0, s37, 131072
v_mfma_f32_16x16x32_bf16 v[124:127], v[48:51], a[204:207], v[124:127]
s_mov_b32 s48, 224000
s_waitcnt vmcnt(23) lgkmcnt(0)
v_mfma_f32_16x16x32_bf16 v[124:127], v[52:55], a[220:223], v[124:127]
s_barrier
v_mfma_f32_16x16x32_bf16 v[128:131], v[56:59], a[192:195], v[128:131]
buffer_load_dwordx4 a[240:243], v17, s[20:23], s51 offen offset:0
v_mfma_f32_16x16x32_bf16 v[128:131], v[60:63], a[208:211], v[128:131]
ds_read_b64_tr_b16 v[40:41], v8 offset:32768
v_mfma_f32_16x16x32_bf16 v[132:135], v[56:59], a[196:199], v[132:135]
ds_read_b64_tr_b16 v[42:43], v8 offset:36864
v_mfma_f32_16x16x32_bf16 v[132:135], v[60:63], a[212:215], v[132:135]
ds_read_b64_tr_b16 v[44:45], v8 offset:40960
v_mfma_f32_16x16x32_bf16 v[136:139], v[56:59], a[200:203], v[136:139]
buffer_load_dwordx4 v12, s[16:19], s48 offen offset:0 lds
v_mfma_f32_16x16x32_bf16 v[136:139], v[60:63], a[216:219], v[136:139]
ds_read_b64_tr_b16 v[46:47], v8 offset:45056
v_mfma_f32_16x16x32_bf16 v[140:143], v[56:59], a[204:207], v[140:143]
ds_read_b64_tr_b16 v[48:49], v9 offset:32768
v_mfma_f32_16x16x32_bf16 v[140:143], v[60:63], a[220:223], v[140:143]
ds_read_b64_tr_b16 v[50:51], v9 offset:36864
v_mfma_f32_16x16x32_bf16 v[144:147], v[64:67], a[192:195], v[144:147]
buffer_load_dword v78, v79, s[20:23], 0 offen sc1
v_mfma_f32_16x16x32_bf16 v[144:147], v[68:71], a[208:211], v[144:147]
ds_read_b64_tr_b16 v[52:53], v9 offset:40960
v_mfma_f32_16x16x32_bf16 v[148:151], v[64:67], a[196:199], v[148:151]
ds_read_b64_tr_b16 v[54:55], v9 offset:45056
v_mfma_f32_16x16x32_bf16 v[148:151], v[68:71], a[212:215], v[148:151]
v_mfma_f32_16x16x32_bf16 v[152:155], v[64:67], a[200:203], v[152:155]
buffer_load_dwordx4 v13, s[16:19], s48 offen offset:1024 lds
v_mfma_f32_16x16x32_bf16 v[152:155], v[68:71], a[216:219], v[152:155]
s_mov_b32 s49, 222080
v_mfma_f32_16x16x32_bf16 v[156:159], v[64:67], a[204:207], v[156:159]
v_mfma_f32_16x16x32_bf16 v[156:159], v[68:71], a[220:223], v[156:159]
s_waitcnt lgkmcnt(0)
v_mfma_f32_16x16x32_bf16 v[160:163], v[40:43], a[0:3], 0
buffer_load_dwordx4 a[244:247], v17, s[20:23], s51 offen offset:1024
v_mfma_f32_16x16x32_bf16 v[160:163], v[44:47], a[16:19], v[160:163]
ds_read_b64_tr_b16 v[56:57], v8 offset:34816
v_mfma_f32_16x16x32_bf16 v[164:167], v[40:43], a[4:7], 0
ds_read_b64_tr_b16 v[58:59], v8 offset:38912
v_mfma_f32_16x16x32_bf16 v[164:167], v[44:47], a[20:23], v[164:167]
ds_read_b64_tr_b16 v[60:61], v8 offset:43008
v_mfma_f32_16x16x32_bf16 v[168:171], v[40:43], a[8:11], 0
buffer_load_dwordx4 v12, s[16:19], s49 offen offset:2048 lds
v_mfma_f32_16x16x32_bf16 v[168:171], v[44:47], a[24:27], v[168:171]
ds_read_b64_tr_b16 v[62:63], v8 offset:47104
v_mfma_f32_16x16x32_bf16 v[172:175], v[40:43], a[12:15], 0
ds_read_b64_tr_b16 v[64:65], v9 offset:34816
v_mfma_f32_16x16x32_bf16 v[172:175], v[44:47], a[28:31], v[172:175]
ds_read_b64_tr_b16 v[66:67], v9 offset:38912
v_mfma_f32_16x16x32_bf16 v[176:179], v[48:51], a[0:3], 0
buffer_load_dwordx4 a[248:251], v17, s[20:23], s51 offen offset:2048
v_mfma_f32_16x16x32_bf16 v[176:179], v[52:55], a[16:19], v[176:179]
ds_read_b64_tr_b16 v[68:69], v9 offset:43008
v_mfma_f32_16x16x32_bf16 v[180:183], v[48:51], a[4:7], 0
ds_read_b64_tr_b16 v[70:71], v9 offset:47104
v_mfma_f32_16x16x32_bf16 v[180:183], v[52:55], a[20:23], v[180:183]
v_mfma_f32_16x16x32_bf16 v[184:187], v[48:51], a[8:11], 0
buffer_load_dwordx4 v13, s[16:19], s49 offen offset:3072 lds
v_mfma_f32_16x16x32_bf16 v[184:187], v[52:55], a[24:27], v[184:187]
s_add_u32 m0, s37, 147456
v_mfma_f32_16x16x32_bf16 v[188:191], v[48:51], a[12:15], 0
s_mov_b32 s48, 297600
s_waitcnt vmcnt(18) lgkmcnt(0)
v_mfma_f32_16x16x32_bf16 v[188:191], v[52:55], a[28:31], v[188:191]
s_barrier
v_mfma_f32_16x16x32_bf16 v[160:163], v[56:59], a[32:35], v[160:163]
buffer_load_dwordx4 a[252:255], v17, s[20:23], s51 offen offset:3072
v_mfma_f32_16x16x32_bf16 v[160:163], v[60:63], a[48:51], v[160:163]
ds_read_b64_tr_b16 v[40:41], v6 offset:16384
s_bfe_u32 s36, s2, 0x30003
v_mfma_f32_16x16x32_bf16 v[164:167], v[56:59], a[36:39], v[164:167]
ds_read_b64_tr_b16 v[42:43], v6 offset:20480
s_and_b32 s35, s2, 1
v_mfma_f32_16x16x32_bf16 v[164:167], v[60:63], a[52:55], v[164:167]
ds_read_b64_tr_b16 v[44:45], v6 offset:24576
s_lshl3_add_u32 s36, s36, s35
v_mfma_f32_16x16x32_bf16 v[168:171], v[56:59], a[40:43], v[168:171]
buffer_load_dwordx4 v12, s[16:19], s48 offen offset:0 lds
v_mfma_f32_16x16x32_bf16 v[168:171], v[60:63], a[56:59], v[168:171]
ds_read_b64_tr_b16 v[46:47], v6 offset:28672
s_lshl_b32 s36, s36, 10
v_mfma_f32_16x16x32_bf16 v[172:175], v[56:59], a[44:47], v[172:175]
ds_read_b64_tr_b16 v[48:49], v7 offset:16384
v_mov_b32 v20, 5
v_mfma_f32_16x16x32_bf16 v[172:175], v[60:63], a[60:63], v[172:175]
ds_read_b64_tr_b16 v[50:51], v7 offset:20480
s_add_u32 s36, s36, 76546560
v_mfma_f32_16x16x32_bf16 v[176:179], v[64:67], a[32:35], v[176:179]
buffer_store_dword v20, v19, s[20:23], 0 offen sc1
v_mfma_f32_16x16x32_bf16 v[176:179], v[68:71], a[48:51], v[176:179]
ds_read_b64_tr_b16 v[52:53], v7 offset:24576
s_lshr_b32 s59, s40, 1
v_mfma_f32_16x16x32_bf16 v[180:183], v[64:67], a[36:39], v[180:183]
ds_read_b64_tr_b16 v[54:55], v7 offset:28672
s_and_b32 s35, s40, 1
v_mfma_f32_16x16x32_bf16 v[180:183], v[68:71], a[52:55], v[180:183]
s_lshl3_add_u32 s59, s59, s35
s_and_b32 s35, s38, 1
v_mfma_f32_16x16x32_bf16 v[184:187], v[64:67], a[40:43], v[184:187]
buffer_load_dwordx4 v13, s[16:19], s48 offen offset:1024 lds
v_mfma_f32_16x16x32_bf16 v[184:187], v[68:71], a[56:59], v[184:187]
s_mov_b32 s49, 295680
s_lshl3_add_u32 s59, s59, s35
v_mfma_f32_16x16x32_bf16 v[188:191], v[64:67], a[44:47], v[188:191]
s_lshl_b32 s59, s59, 5
s_add_u32 s59, s59, s36
v_mfma_f32_16x16x32_bf16 v[188:191], v[68:71], a[60:63], v[188:191]
s_add_u32 s59, s59, 128
s_waitcnt lgkmcnt(0)
v_mfma_f32_16x16x32_bf16 v[160:163], v[40:43], a[64:67], v[160:163]
v_and_b32 v72, 7, v0
v_lshl_add_u32 v94, v72, 2, s59
v_mfma_f32_16x16x32_bf16 v[160:163], v[44:47], a[80:83], v[160:163]
ds_read_b64_tr_b16 v[56:57], v6 offset:18432
s_lshl3_add_u32 s35, s35, s40
v_mfma_f32_16x16x32_bf16 v[164:167], v[40:43], a[68:71], v[164:167]
ds_read_b64_tr_b16 v[58:59], v6 offset:22528
s_lshl2_add_u32 s35, s35, s36
v_mfma_f32_16x16x32_bf16 v[164:167], v[44:47], a[84:87], v[164:167]
ds_read_b64_tr_b16 v[60:61], v6 offset:26624
s_and_b32 s34, s38, 2
v_mfma_f32_16x16x32_bf16 v[168:171], v[40:43], a[72:75], v[168:171]
buffer_load_dwordx4 v12, s[16:19], s49 offen offset:2048 lds
v_mfma_f32_16x16x32_bf16 v[168:171], v[44:47], a[88:91], v[168:171]
ds_read_b64_tr_b16 v[62:63], v6 offset:30720
s_lshl_b32 s34, s34, 11
v_mfma_f32_16x16x32_bf16 v[172:175], v[40:43], a[76:79], v[172:175]
ds_read_b64_tr_b16 v[64:65], v7 offset:18432
s_add_u32 s35, s35, s34
v_mfma_f32_16x16x32_bf16 v[172:175], v[44:47], a[92:95], v[172:175]
ds_read_b64_tr_b16 v[66:67], v7 offset:22528
v_and_b32 v72, 2, v1
v_mfma_f32_16x16x32_bf16 v[176:179], v[48:51], a[64:67], v[176:179]
v_mad_u32_u24 v72, v72, 3, v1
v_lshl_add_u32 v75, v72, 8, s35
v_mfma_f32_16x16x32_bf16 v[176:179], v[52:55], a[80:83], v[176:179]
ds_read_b64_tr_b16 v[68:69], v7 offset:26624
v_and_b32 v72, 60, v1
v_mfma_f32_16x16x32_bf16 v[180:183], v[48:51], a[68:71], v[180:183]
ds_read_b64_tr_b16 v[70:71], v7 offset:30720
v_lshl_add_u32 v75, v72, 26, v75
v_mfma_f32_16x16x32_bf16 v[180:183], v[52:55], a[84:87], v[180:183]
s_waitcnt vmcnt(10)
v_readfirstlane_b32 s58, v78
s_cmp_ge_u32 s58, 4
s_cbranch_scc0 L_spin13
L_back13:
v_mfma_f32_16x16x32_bf16 v[184:187], v[48:51], a[72:75], v[184:187]
buffer_load_dwordx4 v13, s[16:19], s49 offen offset:3072 lds
v_mfma_f32_16x16x32_bf16 v[184:187], v[52:55], a[88:91], v[184:187]
s_add_u32 m0, s37, 16384
s_mul_i32 s34, s38, 16
v_mfma_f32_16x16x32_bf16 v[188:191], v[48:51], a[76:79], v[188:191]
s_mov_b32 s48, 297856
s_waitcnt lgkmcnt(0)
v_mfma_f32_16x16x32_bf16 v[188:191], v[52:55], a[92:95], v[188:191]
s_barrier
v_mfma_f32_16x16x32_bf16 v[160:163], v[56:59], a[96:99], v[160:163]
v_min_u32 v73, 15, v1
v_add_u32 v73, s34, v73
v_mfma_f32_16x16x32_bf16 v[160:163], v[60:63], a[112:115], v[160:163]
ds_read_b64_tr_b16 v[40:41], v6 offset:32768
v_and_b32 v72, 1, v73
v_mfma_f32_16x16x32_bf16 v[164:167], v[56:59], a[100:103], v[164:167]
ds_read_b64_tr_b16 v[42:43], v6 offset:36864
v_lshrrev_b32 v73, 1, v73
v_mfma_f32_16x16x32_bf16 v[164:167], v[60:63], a[116:119], v[164:167]
ds_read_b64_tr_b16 v[44:45], v6 offset:40960
v_lshl_add_u32 v73, v73, 2, v72
v_mfma_f32_16x16x32_bf16 v[168:171], v[56:59], a[104:107], v[168:171]
buffer_load_dwordx4 v12, s[16:19], s48 offen offset:0 lds
v_mfma_f32_16x16x32_bf16 v[168:171], v[60:63], a[120:123], v[168:171]
ds_read_b64_tr_b16 v[46:47], v6 offset:45056
v_lshlrev_b32 v73, 8, v73
v_mfma_f32_16x16x32_bf16 v[172:175], v[56:59], a[108:111], v[172:175]
ds_read_b64_tr_b16 v[48:49], v7 offset:32768
v_add_u32 v10, 76579328, v73
v_mfma_f32_16x16x32_bf16 v[172:175], v[60:63], a[124:127], v[172:175]
ds_read_b64_tr_b16 v[50:51], v7 offset:36864
v_lshlrev_b32 v2, 4, v1
v_mfma_f32_16x16x32_bf16 v[176:179], v[64:67], a[96:99], v[176:179]
s_add_u32 s51, s45, 16777216
v_mfma_f32_16x16x32_bf16 v[176:179], v[68:71], a[112:115], v[176:179]
ds_read_b64_tr_b16 v[52:53], v7 offset:40960
v_mfma_f32_16x16x32_bf16 v[180:183], v[64:67], a[100:103], v[180:183]
ds_read_b64_tr_b16 v[54:55], v7 offset:45056
v_mfma_f32_16x16x32_bf16 v[180:183], v[68:71], a[116:119], v[180:183]
v_mfma_f32_16x16x32_bf16 v[184:187], v[64:67], a[104:107], v[184:187]
buffer_load_dwordx4 v13, s[16:19], s48 offen offset:1024 lds
v_mfma_f32_16x16x32_bf16 v[184:187], v[68:71], a[120:123], v[184:187]
s_mov_b32 s49, 369664
v_mfma_f32_16x16x32_bf16 v[188:191], v[64:67], a[108:111], v[188:191]
v_mfma_f32_16x16x32_bf16 v[188:191], v[68:71], a[124:127], v[188:191]
s_waitcnt lgkmcnt(0)
v_mfma_f32_16x16x32_bf16 v[160:163], v[40:43], a[128:131], v[160:163]
buffer_load_dwordx4 v[224:227], v17, s[20:23], s51 offen offset:0
v_mfma_f32_16x16x32_bf16 v[160:163], v[44:47], a[144:147], v[160:163]
ds_read_b64_tr_b16 v[56:57], v6 offset:34816
v_mfma_f32_16x16x32_bf16 v[164:167], v[40:43], a[132:135], v[164:167]
ds_read_b64_tr_b16 v[58:59], v6 offset:38912
v_mfma_f32_16x16x32_bf16 v[164:167], v[44:47], a[148:151], v[164:167]
ds_read_b64_tr_b16 v[60:61], v6 offset:43008
v_mfma_f32_16x16x32_bf16 v[168:171], v[40:43], a[136:139], v[168:171]
buffer_load_dwordx4 v12, s[16:19], s49 offen offset:2048 lds
v_mfma_f32_16x16x32_bf16 v[168:171], v[44:47], a[152:155], v[168:171]
ds_read_b64_tr_b16 v[62:63], v6 offset:47104
v_mfma_f32_16x16x32_bf16 v[172:175], v[40:43], a[140:143], v[172:175]
ds_read_b64_tr_b16 v[64:65], v7 offset:34816
v_mfma_f32_16x16x32_bf16 v[172:175], v[44:47], a[156:159], v[172:175]
ds_read_b64_tr_b16 v[66:67], v7 offset:38912
v_mfma_f32_16x16x32_bf16 v[176:179], v[48:51], a[128:131], v[176:179]
buffer_load_dwordx4 v[228:231], v17, s[20:23], s51 offen offset:1024
v_mfma_f32_16x16x32_bf16 v[176:179], v[52:55], a[144:147], v[176:179]
ds_read_b64_tr_b16 v[68:69], v7 offset:43008
v_mfma_f32_16x16x32_bf16 v[180:183], v[48:51], a[132:135], v[180:183]
ds_read_b64_tr_b16 v[70:71], v7 offset:47104
v_mfma_f32_16x16x32_bf16 v[180:183], v[52:55], a[148:151], v[180:183]
v_mfma_f32_16x16x32_bf16 v[184:187], v[48:51], a[136:139], v[184:187]
buffer_load_dwordx4 v13, s[16:19], s49 offen offset:3072 lds
v_mfma_f32_16x16x32_bf16 v[184:187], v[52:55], a[152:155], v[184:187]
s_add_u32 m0, s37, 32768
v_mfma_f32_16x16x32_bf16 v[188:191], v[48:51], a[140:143], v[188:191]
s_mov_b32 s48, 445440
s_waitcnt lgkmcnt(0)
v_mfma_f32_16x16x32_bf16 v[188:191], v[52:55], a[156:159], v[188:191]
s_barrier
v_mfma_f32_16x16x32_bf16 v[160:163], v[56:59], a[160:163], v[160:163]
buffer_load_dwordx4 v[232:235], v17, s[20:23], s51 offen offset:2048
v_mfma_f32_16x16x32_bf16 v[160:163], v[60:63], a[176:179], v[160:163]
ds_read_b64_tr_b16 v[40:41], v6 offset:0
s_mov_b64 s[4:5], s[0:1]
v_mfma_f32_16x16x32_bf16 v[164:167], v[56:59], a[164:167], v[164:167]
ds_read_b64_tr_b16 v[42:43], v6 offset:4096
s_mov_b32 s6, 2359296
v_mfma_f32_16x16x32_bf16 v[164:167], v[60:63], a[180:183], v[164:167]
ds_read_b64_tr_b16 v[44:45], v6 offset:8192
s_lshr_b32 s28, s40, 2
v_mfma_f32_16x16x32_bf16 v[168:171], v[56:59], a[168:171], v[168:171]
buffer_load_dwordx4 v12, s[16:19], s48 offen offset:0 lds
v_mfma_f32_16x16x32_bf16 v[168:171], v[60:63], a[184:187], v[168:171]
ds_read_b64_tr_b16 v[46:47], v6 offset:12288
s_and_b32 s29, s40, 3
v_mfma_f32_16x16x32_bf16 v[172:175], v[56:59], a[172:175], v[172:175]
ds_read_b64_tr_b16 v[48:49], v7 offset:0
s_lshl3_add_u32 s28, s28, s29
v_mfma_f32_16x16x32_bf16 v[172:175], v[60:63], a[188:191], v[172:175]
ds_read_b64_tr_b16 v[50:51], v7 offset:4096
s_and_b32 s29, s38, 1
v_mfma_f32_16x16x32_bf16 v[176:179], v[64:67], a[160:163], v[176:179]
buffer_load_dwordx4 v[236:239], v17, s[20:23], s51 offen offset:3072
v_mfma_f32_16x16x32_bf16 v[176:179], v[68:71], a[176:179], v[176:179]
ds_read_b64_tr_b16 v[52:53], v7 offset:8192
s_add_u32 s51, s45, 16785408
v_mfma_f32_16x16x32_bf16 v[180:183], v[64:67], a[164:167], v[180:183]
ds_read_b64_tr_b16 v[54:55], v7 offset:12288
s_lshl2_add_u32 s28, s29, s28
v_mfma_f32_16x16x32_bf16 v[180:183], v[68:71], a[180:183], v[180:183]
s_lshr_b32 s29, s38, 1
s_lshl_b32 s28, s28, 13
v_mfma_f32_16x16x32_bf16 v[184:187], v[64:67], a[168:171], v[184:187]
buffer_load_dwordx4 v13, s[16:19], s48 offen offset:1024 lds
v_mfma_f32_16x16x32_bf16 v[184:187], v[68:71], a[184:187], v[184:187]
s_mov_b32 s49, 517120
s_mul_i32 s29, s29, 2097152
v_mfma_f32_16x16x32_bf16 v[188:191], v[64:67], a[172:175], v[188:191]
s_add_u32 s28, s28, s29
s_mul_i32 s29, s39, 131072
v_mfma_f32_16x16x32_bf16 v[188:191], v[68:71], a[188:191], v[188:191]
s_add_u32 s28, s28, s29
s_waitcnt lgkmcnt(0)
v_mfma_f32_16x16x32_bf16 v[160:163], v[40:43], a[192:195], v[160:163]
buffer_load_dwordx4 v[240:243], v17, s[20:23], s51 offen offset:0
v_mfma_f32_16x16x32_bf16 v[160:163], v[44:47], a[208:211], v[160:163]
ds_read_b64_tr_b16 v[56:57], v6 offset:2048
s_add_u32 s28, s28, 44040192
v_mfma_f32_16x16x32_bf16 v[164:167], v[40:43], a[196:199], v[164:167]
ds_read_b64_tr_b16 v[58:59], v6 offset:6144
s_mul_i32 s8, s40, 288
v_mfma_f32_16x16x32_bf16 v[164:167], v[44:47], a[212:215], v[164:167]
ds_read_b64_tr_b16 v[60:61], v6 offset:10240
s_add_u32 s8, s8, s38
v_mfma_f32_16x16x32_bf16 v[168:171], v[40:43], a[200:203], v[168:171]
buffer_load_dwordx4 v12, s[16:19], s49 offen offset:2048 lds
v_mfma_f32_16x16x32_bf16 v[168:171], v[44:47], a[216:219], v[168:171]
ds_read_b64_tr_b16 v[62:63], v6 offset:14336
s_lshl_b32 s8, s8, 6
v_mfma_f32_16x16x32_bf16 v[172:175], v[40:43], a[204:207], v[172:175]
ds_read_b64_tr_b16 v[64:65], v7 offset:2048
s_mul_i32 s9, s39, 147456
v_mfma_f32_16x16x32_bf16 v[172:175], v[44:47], a[220:223], v[172:175]
ds_read_b64_tr_b16 v[66:67], v7 offset:6144
s_add_u32 s9, s9, s8
v_mfma_f32_16x16x32_bf16 v[176:179], v[48:51], a[192:195], v[176:179]
buffer_load_dwordx4 v[244:247], v17, s[20:23], s51 offen offset:1024
v_mfma_f32_16x16x32_bf16 v[176:179], v[52:55], a[208:211], v[176:179]
ds_read_b64_tr_b16 v[68:69], v7 offset:10240
s_lshl3_add_u32 s36, s39, s40
v_mfma_f32_16x16x32_bf16 v[180:183], v[48:51], a[196:199], v[180:183]
ds_read_b64_tr_b16 v[70:71], v7 offset:14336
s_lshl_b32 s11, s36, 7
v_mfma_f32_16x16x32_bf16 v[180:183], v[52:55], a[212:215], v[180:183]
s_add_u32 s11, s11, 75497472
s_mul_i32 s10, s38, 4224
v_mfma_f32_16x16x32_bf16 v[184:187], v[48:51], a[200:203], v[184:187]
buffer_load_dwordx4 v13, s[16:19], s49 offen offset:3072 lds
v_mfma_f32_16x16x32_bf16 v[184:187], v[52:55], a[216:219], v[184:187]
s_add_u32 m0, s37, 0
s_add_u32 s10, s10, s36
s_lshl_b32 s10, s10, 5
s_add_u32 s10, s10, 72654848
v_mfma_f32_16x16x32_bf16 v[188:191], v[48:51], a[204:207], v[188:191]
s_mov_b32 s48, 592896
s_waitcnt vmcnt(19) lgkmcnt(0)
v_mfma_f32_16x16x32_bf16 v[188:191], v[52:55], a[220:223], v[188:191]
buffer_load_dwordx4 v[248:251], v17, s[20:23], s51 offen offset:2048
buffer_load_dwordx4 v[252:255], v17, s[20:23], s51 offen offset:3072
s_barrier
v_mfma_f32_16x16x32_bf16 v[96:99], v[56:59], a[224:227], v[96:99]
s_lshr_b32 s36, s40, 2
s_and_b32 s29, s38, 2
s_add_u32 s36, s36, s29
s_and_b32 s29, s38, 1
s_lshl1_add_u32 s36, s36, s29
s_lshl_b32 s36, s36, 10
s_add_u32 s36, s36, 81920
v_add_u32 v22, s36, v2
v_mfma_f32_16x16x32_bf16 v[96:99], v[60:63], a[240:243], v[96:99]
ds_read_b64_tr_b16 v[40:41], v8 offset:16384
s_add_u32 s29, s28, 4096
v_mfma_f32_16x16x32_bf16 v[100:103], v[56:59], a[228:231], v[100:103]
ds_read_b64_tr_b16 v[42:43], v8 offset:20480
s_add_u32 s30, s28, 4194304
v_mfma_f32_16x16x32_bf16 v[100:103], v[60:63], a[244:247], v[100:103]
ds_read_b64_tr_b16 v[44:45], v8 offset:24576
s_add_u32 s31, s28, 4198400
v_mfma_f32_16x16x32_bf16 v[104:107], v[56:59], a[232:235], v[104:107]
buffer_load_dwordx4 v12, s[16:19], s48 offen offset:0 lds
v_mfma_f32_16x16x32_bf16 v[104:107], v[60:63], a[248:251], v[104:107]
ds_read_b64_tr_b16 v[46:47], v8 offset:28672
v_and_b32 v72, 15, v1
v_mfma_f32_16x16x32_bf16 v[108:111], v[56:59], a[236:239], v[108:111]
ds_read_b64_tr_b16 v[48:49], v9 offset:16384
v_lshrrev_b32 v73, 4, v1
v_mfma_f32_16x16x32_bf16 v[108:111], v[60:63], a[252:255], v[108:111]
ds_read_b64_tr_b16 v[50:51], v9 offset:20480
v_lshlrev_b32 v5, 3, v72
v_mfma_f32_16x16x32_bf16 v[112:115], v[64:67], a[224:227], v[112:115]
buffer_load_dwordx2 v[92:93], v5, s[20:23], s11 offen sc1
v_mfma_f32_16x16x32_bf16 v[112:115], v[68:71], a[240:243], v[112:115]
ds_read_b64_tr_b16 v[52:53], v9 offset:24576
v_mul_u32_u24 v3, 0x480, v72
v_mfma_f32_16x16x32_bf16 v[116:119], v[64:67], a[228:231], v[116:119]
ds_read_b64_tr_b16 v[54:55], v9 offset:28672
v_lshl_add_u32 v3, v73, 4, v3
v_mfma_f32_16x16x32_bf16 v[116:119], v[68:71], a[244:247], v[116:119]
v_and_b32 v74, 12, v72
v_add_u32 v74, v74, v72
v_mfma_f32_16x16x32_bf16 v[120:123], v[64:67], a[232:235], v[120:123]
buffer_load_dwordx4 v13, s[16:19], s48 offen offset:1024 lds
v_mfma_f32_16x16x32_bf16 v[120:123], v[68:71], a[248:251], v[120:123]
s_mov_b32 s49, 1024
v_bfe_u32 v76, v1, 5, 1
v_mfma_f32_16x16x32_bf16 v[124:127], v[64:67], a[236:239], v[124:127]
v_lshl_add_u32 v74, v76, 2, v74
v_mul_u32_u24 v74, 4224, v74
v_mfma_f32_16x16x32_bf16 v[124:127], v[68:71], a[252:255], v[124:127]
v_and_b32 v76, 16, v1
s_waitcnt lgkmcnt(0)
v_mfma_f32_16x16x32_bf16 v[128:131], v[40:43], a[224:227], v[128:131]
buffer_load_dwordx4 v[80:83], v3, s[12:15], s8 offen offset:2688
v_mfma_f32_16x16x32_bf16 v[128:131], v[44:47], a[240:243], v[128:131]
ds_read_b64_tr_b16 v[56:57], v8 offset:18432
v_add_u32 v4, v76, v74
v_mfma_f32_16x16x32_bf16 v[132:135], v[40:43], a[228:231], v[132:135]
ds_read_b64_tr_b16 v[58:59], v8 offset:22528
v_and_b32 v74, 1, v72
v_mfma_f32_16x16x32_bf16 v[132:135], v[44:47], a[244:247], v[132:135]
ds_read_b64_tr_b16 v[60:61], v8 offset:26624
v_lshlrev_b32 v74, 4, v74
v_mfma_f32_16x16x32_bf16 v[136:139], v[40:43], a[232:235], v[136:139]
buffer_load_dwordx4 v12, s[16:19], s49 offen offset:2048 lds
v_mfma_f32_16x16x32_bf16 v[136:139], v[44:47], a[248:251], v[136:139]
ds_read_b64_tr_b16 v[62:63], v8 offset:30720
v_mov_b32 v77, 0x3f80
v_mfma_f32_16x16x32_bf16 v[140:143], v[40:43], a[236:239], v[140:143]
ds_read_b64_tr_b16 v[64:65], v9 offset:18432
v_lshlrev_b32 v77, v74, v77
v_mfma_f32_16x16x32_bf16 v[140:143], v[44:47], a[252:255], v[140:143]
ds_read_b64_tr_b16 v[66:67], v9 offset:22528
v_lshrrev_b32 v74, 1, v72
v_mfma_f32_16x16x32_bf16 v[144:147], v[48:51], a[224:227], v[144:147]
buffer_load_dwordx4 v[84:87], v3, s[12:15], s8 offen offset:2944
v_mfma_f32_16x16x32_bf16 v[144:147], v[52:55], a[240:243], v[144:147]
ds_read_b64_tr_b16 v[68:69], v9 offset:26624
v_and_b32 v76, 2, v74
v_mfma_f32_16x16x32_bf16 v[148:151], v[48:51], a[228:231], v[148:151]
ds_read_b64_tr_b16 v[70:71], v9 offset:30720
v_xor_b32 v76, v76, v73
v_mfma_f32_16x16x32_bf16 v[148:151], v[52:55], a[244:247], v[148:151]
v_lshrrev_b32 v72, 3, v72
v_xor_b32 v73, v73, v72
v_mfma_f32_16x16x32_bf16 v[152:155], v[48:51], a[232:235], v[152:155]
buffer_load_dwordx4 v13, s[16:19], s49 offen offset:3072 lds
v_mfma_f32_16x16x32_bf16 v[152:155], v[52:55], a[248:251], v[152:155]
s_add_u32 m0, s37, 131072
v_lshl_add_u32 v76, v76, 1, v72
v_mfma_f32_16x16x32_bf16 v[156:159], v[48:51], a[236:239], v[156:159]
s_mov_b32 s48, 76800
s_waitcnt vmcnt(23) lgkmcnt(0)
v_mfma_f32_16x16x32_bf16 v[156:159], v[52:55], a[252:255], v[156:159]
s_barrier
v_mfma_f32_16x16x32_bf16 v[160:163], v[56:59], a[224:227], v[160:163]
v_and_b32 v72, 1, v74
v_lshl_add_u32 v76, v76, 1, v72
v_mfma_f32_16x16x32_bf16 v[160:163], v[60:63], a[240:243], v[160:163]
ds_read_b64_tr_b16 v[40:41], v8 offset:32768
v_and_b32 v74, 3, v74
v_mfma_f32_16x16x32_bf16 v[164:167], v[56:59], a[228:231], v[164:167]
ds_read_b64_tr_b16 v[42:43], v8 offset:36864
v_lshl_add_u32 v73, v73, 2, v74
v_mfma_f32_16x16x32_bf16 v[164:167], v[60:63], a[244:247], v[164:167]
ds_read_b64_tr_b16 v[44:45], v8 offset:40960
v_lshlrev_b32 v76, v76, 1
v_mfma_f32_16x16x32_bf16 v[168:171], v[56:59], a[232:235], v[168:171]
buffer_load_dwordx4 v12, s[16:19], s48 offen offset:0 lds
v_mfma_f32_16x16x32_bf16 v[168:171], v[60:63], a[248:251], v[168:171]
ds_read_b64_tr_b16 v[46:47], v8 offset:45056
v_lshlrev_b32 v73, v73, 1
v_mfma_f32_16x16x32_bf16 v[172:175], v[56:59], a[236:239], v[172:175]
ds_read_b64_tr_b16 v[48:49], v9 offset:32768
v_bfe_i32 v24, v76, 0, 1
v_mfma_f32_16x16x32_bf16 v[172:175], v[60:63], a[252:255], v[172:175]
ds_read_b64_tr_b16 v[50:51], v9 offset:36864
v_bfe_i32 v32, v73, 0, 1
v_mfma_f32_16x16x32_bf16 v[176:179], v[64:67], a[224:227], v[176:179]
v_bfe_i32 v25, v76, 1, 1
v_bfe_i32 v33, v73, 1, 1
v_mfma_f32_16x16x32_bf16 v[176:179], v[68:71], a[240:243], v[176:179]
ds_read_b64_tr_b16 v[52:53], v9 offset:40960
v_bfe_i32 v26, v76, 2, 1
v_mfma_f32_16x16x32_bf16 v[180:183], v[64:67], a[228:231], v[180:183]
ds_read_b64_tr_b16 v[54:55], v9 offset:45056
v_bfe_i32 v34, v73, 2, 1
v_mfma_f32_16x16x32_bf16 v[180:183], v[68:71], a[244:247], v[180:183]
v_bfe_i32 v27, v76, 3, 1
v_bfe_i32 v35, v73, 3, 1
v_mfma_f32_16x16x32_bf16 v[184:187], v[64:67], a[232:235], v[184:187]
buffer_load_dwordx4 v13, s[16:19], s48 offen offset:1024 lds
v_mfma_f32_16x16x32_bf16 v[184:187], v[68:71], a[248:251], v[184:187]
s_mov_b32 s49, 148480
v_bfe_i32 v28, v76, 4, 1
v_mfma_f32_16x16x32_bf16 v[188:191], v[64:67], a[236:239], v[188:191]
v_bfe_i32 v36, v73, 8, 1
v_bfe_i32 v29, v76, 5, 1
v_mfma_f32_16x16x32_bf16 v[188:191], v[68:71], a[252:255], v[188:191]
v_bfe_i32 v37, v73, 9, 1
s_waitcnt vmcnt(9) lgkmcnt(0)
v_mfma_f32_16x16x32_bf16 v[96:99], v[40:43], v[224:227], v[96:99]
v_bfe_i32 v30, v76, 6, 1
v_bfe_i32 v38, v73, 10, 1
v_mfma_f32_16x16x32_bf16 v[96:99], v[44:47], v[240:243], v[96:99]
ds_read_b64_tr_b16 v[56:57], v8 offset:34816
v_bfe_i32 v31, v76, 7, 1
v_mfma_f32_16x16x32_bf16 v[100:103], v[40:43], v[228:231], v[100:103]
ds_read_b64_tr_b16 v[58:59], v8 offset:38912
v_bfe_i32 v39, v73, 11, 1
v_mfma_f32_16x16x32_bf16 v[100:103], v[44:47], v[244:247], v[100:103]
ds_read_b64_tr_b16 v[60:61], v8 offset:43008
v_and_b32 v24, v77, v24
v_mfma_f32_16x16x32_bf16 v[104:107], v[40:43], v[232:235], v[104:107]
buffer_load_dwordx4 v12, s[16:19], s49 offen offset:2048 lds
v_mfma_f32_16x16x32_bf16 v[104:107], v[44:47], v[248:251], v[104:107]
ds_read_b64_tr_b16 v[62:63], v8 offset:47104
v_and_b32 v25, v77, v25
v_mfma_f32_16x16x32_bf16 v[108:111], v[40:43], v[236:239], v[108:111]
ds_read_b64_tr_b16 v[64:65], v9 offset:34816
v_and_b32 v26, v77, v26
v_mfma_f32_16x16x32_bf16 v[108:111], v[44:47], v[252:255], v[108:111]
ds_read_b64_tr_b16 v[66:67], v9 offset:38912
v_and_b32 v27, v77, v27
v_mfma_f32_16x16x32_bf16 v[112:115], v[48:51], v[224:227], v[112:115]
v_and_b32 v28, v77, v28
v_and_b32 v29, v77, v29
v_mfma_f32_16x16x32_bf16 v[112:115], v[52:55], v[240:243], v[112:115]
ds_read_b64_tr_b16 v[68:69], v9 offset:43008
v_and_b32 v30, v77, v30
v_mfma_f32_16x16x32_bf16 v[116:119], v[48:51], v[228:231], v[116:119]
ds_read_b64_tr_b16 v[70:71], v9 offset:47104
v_and_b32 v31, v77, v31
v_mfma_f32_16x16x32_bf16 v[116:119], v[52:55], v[244:247], v[116:119]
v_and_b32 v32, v77, v32
v_and_b32 v33, v77, v33
v_mfma_f32_16x16x32_bf16 v[120:123], v[48:51], v[232:235], v[120:123]
buffer_load_dwordx4 v13, s[16:19], s49 offen offset:3072 lds
v_mfma_f32_16x16x32_bf16 v[120:123], v[52:55], v[248:251], v[120:123]
s_add_u32 m0, s37, 147456
v_and_b32 v34, v77, v34
v_mfma_f32_16x16x32_bf16 v[124:127], v[48:51], v[236:239], v[124:127]
s_mov_b32 s48, 224256
s_waitcnt lgkmcnt(0)
v_mfma_f32_16x16x32_bf16 v[124:127], v[52:55], v[252:255], v[124:127]
s_barrier
v_mfma_f32_16x16x32_bf16 v[128:131], v[56:59], v[224:227], v[128:131]
v_and_b32 v35, v77, v35
v_and_b32 v36, v77, v36
v_mfma_f32_16x16x32_bf16 v[128:131], v[60:63], v[240:243], v[128:131]
ds_read_b64_tr_b16 v[40:41], v6 offset:16384
v_and_b32 v37, v77, v37
v_mfma_f32_16x16x32_bf16 v[132:135], v[56:59], v[228:231], v[132:135]
ds_read_b64_tr_b16 v[42:43], v6 offset:20480
v_and_b32 v38, v77, v38
v_mfma_f32_16x16x32_bf16 v[132:135], v[60:63], v[244:247], v[132:135]
ds_read_b64_tr_b16 v[44:45], v6 offset:24576
v_and_b32 v39, v77, v39
v_mfma_f32_16x16x32_bf16 v[136:139], v[56:59], v[232:235], v[136:139]
buffer_load_dwordx4 v12, s[16:19], s48 offen offset:0 lds
v_mfma_f32_16x16x32_bf16 v[136:139], v[60:63], v[248:251], v[136:139]
ds_read_b64_tr_b16 v[46:47], v6 offset:28672
v_mfma_f32_16x16x32_bf16 v[140:143], v[56:59], v[236:239], v[140:143]
ds_read_b64_tr_b16 v[48:49], v7 offset:16384
v_mfma_f32_16x16x32_bf16 v[140:143], v[60:63], v[252:255], v[140:143]
ds_read_b64_tr_b16 v[50:51], v7 offset:20480
v_mfma_f32_16x16x32_bf16 v[144:147], v[64:67], v[224:227], v[144:147]
v_cvt_pk_bf16_f32 v96, v96, v97
v_cvt_pk_bf16_f32 v97, v98, v99
v_mfma_f32_16x16x32_bf16 v[144:147], v[68:71], v[240:243], v[144:147]
ds_read_b64_tr_b16 v[52:53], v7 offset:24576
v_cvt_pk_bf16_f32 v98, v112, v113
v_mfma_f32_16x16x32_bf16 v[148:151], v[64:67], v[228:231], v[148:151]
ds_read_b64_tr_b16 v[54:55], v7 offset:28672
v_cvt_pk_bf16_f32 v99, v114, v115
v_mfma_f32_16x16x32_bf16 v[148:151], v[68:71], v[244:247], v[148:151]
ds_write_b128 v16, v[96:99] offset:0
v_mfma_f32_16x16x32_bf16 v[152:155], v[64:67], v[232:235], v[152:155]
buffer_load_dwordx4 v13, s[16:19], s48 offen offset:1024 lds
v_mfma_f32_16x16x32_bf16 v[152:155], v[68:71], v[248:251], v[152:155]
s_mov_b32 s49, 295936
s_xor_b32 s50, s46, 10485760
v_mfma_f32_16x16x32_bf16 v[156:159], v[64:67], v[236:239], v[156:159]
v_cvt_pk_bf16_f32 v100, v100, v101
v_cvt_pk_bf16_f32 v101, v102, v103
v_mfma_f32_16x16x32_bf16 v[156:159], v[68:71], v[252:255], v[156:159]
v_cvt_pk_bf16_f32 v102, v116, v117
s_waitcnt lgkmcnt(0)
v_mfma_f32_16x16x32_bf16 v[160:163], v[40:43], v[224:227], v[160:163]
buffer_store_dwordx4 v[96:99], v14, s[20:23], s50 offen sc1
v_mfma_f32_16x16x32_bf16 v[160:163], v[44:47], v[240:243], v[160:163]
ds_read_b64_tr_b16 v[56:57], v6 offset:18432
v_cvt_pk_bf16_f32 v103, v118, v119
v_mfma_f32_16x16x32_bf16 v[164:167], v[40:43], v[228:231], v[164:167]
ds_read_b64_tr_b16 v[58:59], v6 offset:22528
s_xor_b32 s50, s46, 10494976
v_mfma_f32_16x16x32_bf16 v[164:167], v[44:47], v[244:247], v[164:167]
ds_read_b64_tr_b16 v[60:61], v6 offset:26624
v_cvt_pk_bf16_f32 v104, v104, v105
v_mfma_f32_16x16x32_bf16 v[168:171], v[40:43], v[232:235], v[168:171]
buffer_load_dwordx4 v12, s[16:19], s49 offen offset:2048 lds
v_mfma_f32_16x16x32_bf16 v[168:171], v[44:47], v[248:251], v[168:171]
ds_read_b64_tr_b16 v[62:63], v6 offset:30720
v_cvt_pk_bf16_f32 v105, v106, v107
v_mfma_f32_16x16x32_bf16 v[172:175], v[40:43], v[236:239], v[172:175]
ds_read_b64_tr_b16 v[64:65], v7 offset:18432
v_cvt_pk_bf16_f32 v106, v120, v121
v_mfma_f32_16x16x32_bf16 v[172:175], v[44:47], v[252:255], v[172:175]
ds_read_b64_tr_b16 v[66:67], v7 offset:22528
v_cvt_pk_bf16_f32 v107, v122, v123
v_mfma_f32_16x16x32_bf16 v[176:179], v[48:51], v[224:227], v[176:179]
buffer_store_dwordx4 v[100:103], v21, s[20:23], s50 offen sc1
v_mfma_f32_16x16x32_bf16 v[176:179], v[52:55], v[240:243], v[176:179]
ds_read_b64_tr_b16 v[68:69], v7 offset:26624
s_xor_b32 s50, s46, 10504192
v_mfma_f32_16x16x32_bf16 v[180:183], v[48:51], v[228:231], v[180:183]
ds_read_b64_tr_b16 v[70:71], v7 offset:30720
v_cvt_pk_bf16_f32 v108, v108, v109
v_mfma_f32_16x16x32_bf16 v[180:183], v[52:55], v[244:247], v[180:183]
v_cvt_pk_bf16_f32 v109, v110, v111
v_cvt_pk_bf16_f32 v110, v124, v125
v_mfma_f32_16x16x32_bf16 v[184:187], v[48:51], v[232:235], v[184:187]
buffer_load_dwordx4 v13, s[16:19], s49 offen offset:3072 lds
v_mfma_f32_16x16x32_bf16 v[184:187], v[52:55], v[248:251], v[184:187]
v_cvt_pk_bf16_f32 v111, v126, v127
v_cvt_pk_bf16_f32 v128, v128, v129
v_mfma_f32_16x16x32_bf16 v[188:191], v[48:51], v[236:239], v[188:191]
v_cvt_pk_bf16_f32 v129, v130, v131
s_waitcnt lgkmcnt(0)
v_mfma_f32_16x16x32_bf16 v[188:191], v[52:55], v[252:255], v[188:191]
s_barrier
v_mfma_f32_16x16x32_bf16 v[192:195], v[56:59], a[0:3], 0
buffer_store_dwordx4 v[104:107], v21, s[20:23], s50 offen sc1
v_mfma_f32_16x16x32_bf16 v[192:195], v[60:63], a[16:19], v[192:195]
ds_read_b64_tr_b16 v[40:41], v6 offset:32768
s_xor_b32 s50, s46, 10513408
v_mfma_f32_16x16x32_bf16 v[196:199], v[56:59], a[4:7], 0
ds_read_b64_tr_b16 v[42:43], v6 offset:36864
v_cvt_pk_bf16_f32 v130, v144, v145
v_mfma_f32_16x16x32_bf16 v[196:199], v[60:63], a[20:23], v[196:199]
ds_read_b64_tr_b16 v[44:45], v6 offset:40960
v_cvt_pk_bf16_f32 v131, v146, v147
v_mfma_f32_16x16x32_bf16 v[200:203], v[56:59], a[8:11], 0
buffer_store_dwordx4 v[108:111], v21, s[20:23], s50 offen sc1
v_mfma_f32_16x16x32_bf16 v[200:203], v[60:63], a[24:27], v[200:203]
ds_read_b64_tr_b16 v[46:47], v6 offset:45056
s_xor_b32 s50, s46, 12582912
v_mfma_f32_16x16x32_bf16 v[204:207], v[56:59], a[12:15], 0
ds_read_b64_tr_b16 v[48:49], v7 offset:32768
v_cvt_pk_bf16_f32 v132, v132, v133
v_mfma_f32_16x16x32_bf16 v[204:207], v[60:63], a[28:31], v[204:207]
ds_read_b64_tr_b16 v[50:51], v7 offset:36864
v_cvt_pk_bf16_f32 v133, v134, v135
v_mfma_f32_16x16x32_bf16 v[208:211], v[64:67], a[0:3], 0
buffer_store_dwordx4 v[128:131], v14, s[20:23], s50 offen sc1
v_mfma_f32_16x16x32_bf16 v[208:211], v[68:71], a[16:19], v[208:211]
ds_read_b64_tr_b16 v[52:53], v7 offset:40960
v_cvt_pk_bf16_f32 v134, v148, v149
v_mfma_f32_16x16x32_bf16 v[212:215], v[64:67], a[4:7], 0
ds_read_b64_tr_b16 v[54:55], v7 offset:45056
v_cvt_pk_bf16_f32 v135, v150, v151
v_mfma_f32_16x16x32_bf16 v[212:215], v[68:71], a[20:23], v[212:215]
ds_write_b128 v16, v[128:131] offset:4096
v_mfma_f32_16x16x32_bf16 v[216:219], v[64:67], a[8:11], 0
s_xor_b32 s50, s46, 12592128
v_cvt_pk_bf16_f32 v136, v136, v137
v_mfma_f32_16x16x32_bf16 v[216:219], v[68:71], a[24:27], v[216:219]
v_cvt_pk_bf16_f32 v137, v138, v139
v_cvt_pk_bf16_f32 v138, v152, v153
v_mfma_f32_16x16x32_bf16 v[220:223], v[64:67], a[12:15], 0
v_cvt_pk_bf16_f32 v139, v154, v155
v_cvt_pk_bf16_f32 v140, v140, v141
v_mfma_f32_16x16x32_bf16 v[220:223], v[68:71], a[28:31], v[220:223]
v_cvt_pk_bf16_f32 v141, v142, v143
s_waitcnt lgkmcnt(0)
v_mfma_f32_16x16x32_bf16 v[192:195], v[40:43], a[32:35], v[192:195]
buffer_store_dwordx4 v[132:135], v21, s[20:23], s50 offen sc1
v_mfma_f32_16x16x32_bf16 v[192:195], v[44:47], a[48:51], v[192:195]
ds_read_b64_tr_b16 v[56:57], v6 offset:34816
s_xor_b32 s50, s46, 12601344
v_mfma_f32_16x16x32_bf16 v[196:199], v[40:43], a[36:39], v[196:199]
ds_read_b64_tr_b16 v[58:59], v6 offset:38912
v_cvt_pk_bf16_f32 v142, v156, v157
v_mfma_f32_16x16x32_bf16 v[196:199], v[44:47], a[52:55], v[196:199]
ds_read_b64_tr_b16 v[60:61], v6 offset:43008
v_cvt_pk_bf16_f32 v143, v158, v159
v_mfma_f32_16x16x32_bf16 v[200:203], v[40:43], a[40:43], v[200:203]
buffer_store_dwordx4 v[136:139], v21, s[20:23], s50 offen sc1
v_mfma_f32_16x16x32_bf16 v[200:203], v[44:47], a[56:59], v[200:203]
ds_read_b64_tr_b16 v[62:63], v6 offset:47104
s_xor_b32 s50, s46, 12610560
v_mfma_f32_16x16x32_bf16 v[204:207], v[40:43], a[44:47], v[204:207]
ds_read_b64_tr_b16 v[64:65], v7 offset:34816
v_cvt_pk_bf16_f32 v160, v160, v161
v_mfma_f32_16x16x32_bf16 v[204:207], v[44:47], a[60:63], v[204:207]
ds_read_b64_tr_b16 v[66:67], v7 offset:38912
v_cvt_pk_bf16_f32 v161, v162, v163
v_mfma_f32_16x16x32_bf16 v[208:211], v[48:51], a[32:35], v[208:211]
buffer_load_dword v95, v10, s[20:23], 0 offen sc1
v_mfma_f32_16x16x32_bf16 v[208:211], v[52:55], a[48:51], v[208:211]
ds_read_b64_tr_b16 v[68:69], v7 offset:43008
v_cvt_pk_bf16_f32 v162, v176, v177
v_mfma_f32_16x16x32_bf16 v[212:215], v[48:51], a[36:39], v[212:215]
ds_read_b64_tr_b16 v[70:71], v7 offset:47104
v_cvt_pk_bf16_f32 v163, v178, v179
v_mfma_f32_16x16x32_bf16 v[212:215], v[52:55], a[52:55], v[212:215]
ds_write_b128 v16, v[160:163] offset:8192
v_mfma_f32_16x16x32_bf16 v[216:219], v[48:51], a[40:43], v[216:219]
buffer_store_dwordx4 v[140:143], v21, s[20:23], s50 offen sc1
v_mfma_f32_16x16x32_bf16 v[216:219], v[52:55], a[56:59], v[216:219]
s_xor_b32 s50, s46, 14680064
v_cvt_pk_bf16_f32 v164, v164, v165
v_mfma_f32_16x16x32_bf16 v[220:223], v[48:51], a[44:47], v[220:223]
v_cvt_pk_bf16_f32 v165, v166, v167
s_waitcnt vmcnt(17) lgkmcnt(0)
v_mfma_f32_16x16x32_bf16 v[220:223], v[52:55], a[60:63], v[220:223]
s_barrier
v_mfma_f32_16x16x32_bf16 v[192:195], v[56:59], a[64:67], v[192:195]
buffer_store_dwordx4 v[160:163], v14, s[20:23], s50 offen sc1
v_mfma_f32_16x16x32_bf16 v[192:195], v[60:63], a[80:83], v[192:195]
ds_read_b64_tr_b16 v[40:41], v6 offset:0
v_cvt_pk_bf16_f32 v166, v180, v181
v_mfma_f32_16x16x32_bf16 v[196:199], v[56:59], a[68:71], v[196:199]
ds_read_b64_tr_b16 v[42:43], v6 offset:4096
v_cvt_pk_bf16_f32 v167, v182, v183
v_mfma_f32_16x16x32_bf16 v[196:199], v[60:63], a[84:87], v[196:199]
ds_read_b64_tr_b16 v[44:45], v6 offset:8192
s_xor_b32 s50, s46, 14689280
v_mfma_f32_16x16x32_bf16 v[200:203], v[56:59], a[72:75], v[200:203]
buffer_store_dwordx4 v[164:167], v21, s[20:23], s50 offen sc1
v_mfma_f32_16x16x32_bf16 v[200:203], v[60:63], a[88:91], v[200:203]
ds_read_b64_tr_b16 v[46:47], v6 offset:12288
v_cvt_pk_bf16_f32 v168, v168, v169
v_mfma_f32_16x16x32_bf16 v[204:207], v[56:59], a[76:79], v[204:207]
ds_read_b64_tr_b16 v[48:49], v7 offset:0
v_cvt_pk_bf16_f32 v169, v170, v171
v_mfma_f32_16x16x32_bf16 v[204:207], v[60:63], a[92:95], v[204:207]
ds_read_b64_tr_b16 v[50:51], v7 offset:4096
v_cvt_pk_bf16_f32 v170, v184, v185
v_mfma_f32_16x16x32_bf16 v[208:211], v[64:67], a[64:67], v[208:211]
v_cvt_pk_bf16_f32 v171, v186, v187
s_xor_b32 s50, s46, 14698496
v_mfma_f32_16x16x32_bf16 v[208:211], v[68:71], a[80:83], v[208:211]
ds_read_b64_tr_b16 v[52:53], v7 offset:8192
v_cvt_pk_bf16_f32 v172, v172, v173
v_mfma_f32_16x16x32_bf16 v[212:215], v[64:67], a[68:71], v[212:215]
ds_read_b64_tr_b16 v[54:55], v7 offset:12288
v_cvt_pk_bf16_f32 v173, v174, v175
v_mfma_f32_16x16x32_bf16 v[212:215], v[68:71], a[84:87], v[212:215]
v_cvt_pk_bf16_f32 v174, v188, v189
v_cvt_pk_bf16_f32 v175, v190, v191
v_mfma_f32_16x16x32_bf16 v[216:219], v[64:67], a[72:75], v[216:219]
buffer_store_dwordx4 v[168:171], v21, s[20:23], s50 offen sc1
v_mfma_f32_16x16x32_bf16 v[216:219], v[68:71], a[88:91], v[216:219]
s_xor_b32 s50, s46, 14707712
v_mfma_f32_16x16x32_bf16 v[220:223], v[64:67], a[76:79], v[220:223]
v_mfma_f32_16x16x32_bf16 v[220:223], v[68:71], a[92:95], v[220:223]
s_waitcnt lgkmcnt(0)
v_mfma_f32_16x16x32_bf16 v[192:195], v[40:43], a[96:99], v[192:195]
buffer_store_dwordx4 v[172:175], v21, s[20:23], s50 offen sc1
v_mfma_f32_16x16x32_bf16 v[192:195], v[44:47], a[112:115], v[192:195]
ds_read_b64_tr_b16 v[56:57], v6 offset:2048
v_mfma_f32_16x16x32_bf16 v[196:199], v[40:43], a[100:103], v[196:199]
ds_read_b64_tr_b16 v[58:59], v6 offset:6144
v_mfma_f32_16x16x32_bf16 v[196:199], v[44:47], a[116:119], v[196:199]
ds_read_b64_tr_b16 v[60:61], v6 offset:10240
v_mfma_f32_16x16x32_bf16 v[200:203], v[40:43], a[104:107], v[200:203]
v_mfma_f32_16x16x32_bf16 v[200:203], v[44:47], a[120:123], v[200:203]
ds_read_b64_tr_b16 v[62:63], v6 offset:14336
v_mfma_f32_16x16x32_bf16 v[204:207], v[40:43], a[108:111], v[204:207]
ds_read_b64_tr_b16 v[64:65], v7 offset:2048
v_mfma_f32_16x16x32_bf16 v[204:207], v[44:47], a[124:127], v[204:207]
ds_read_b64_tr_b16 v[66:67], v7 offset:6144
v_mfma_f32_16x16x32_bf16 v[208:211], v[48:51], a[96:99], v[208:211]
v_mfma_f32_16x16x32_bf16 v[208:211], v[52:55], a[112:115], v[208:211]
ds_read_b64_tr_b16 v[68:69], v7 offset:10240
v_mfma_f32_16x16x32_bf16 v[212:215], v[48:51], a[100:103], v[212:215]
ds_read_b64_tr_b16 v[70:71], v7 offset:14336
v_mfma_f32_16x16x32_bf16 v[212:215], v[52:55], a[116:119], v[212:215]
v_mfma_f32_16x16x32_bf16 v[216:219], v[48:51], a[104:107], v[216:219]
v_mfma_f32_16x16x32_bf16 v[216:219], v[52:55], a[120:123], v[216:219]
v_mfma_f32_16x16x32_bf16 v[220:223], v[48:51], a[108:111], v[220:223]
s_waitcnt vmcnt(17) lgkmcnt(0)
v_mfma_f32_16x16x32_bf16 v[220:223], v[52:55], a[124:127], v[220:223]
s_barrier
v_mfma_f32_16x16x32_bf16 v[192:195], v[56:59], a[128:131], v[192:195]
v_mfma_f32_16x16x32_bf16 v[192:195], v[60:63], a[144:147], v[192:195]
ds_read_b64_tr_b16 v[40:41], v8 offset:16384
v_mfma_f32_16x16x32_bf16 v[196:199], v[56:59], a[132:135], v[196:199]
ds_read_b64_tr_b16 v[42:43], v8 offset:20480
v_mfma_f32_16x16x32_bf16 v[196:199], v[60:63], a[148:151], v[196:199]
ds_read_b64_tr_b16 v[44:45], v8 offset:24576
v_mfma_f32_16x16x32_bf16 v[200:203], v[56:59], a[136:139], v[200:203]
v_mfma_f32_16x16x32_bf16 v[200:203], v[60:63], a[152:155], v[200:203]
ds_read_b64_tr_b16 v[46:47], v8 offset:28672
v_mfma_f32_16x16x32_bf16 v[204:207], v[56:59], a[140:143], v[204:207]
ds_read_b64_tr_b16 v[48:49], v9 offset:16384
v_mfma_f32_16x16x32_bf16 v[204:207], v[60:63], a[156:159], v[204:207]
ds_read_b64_tr_b16 v[50:51], v9 offset:20480
v_mfma_f32_16x16x32_bf16 v[208:211], v[64:67], a[128:131], v[208:211]
v_mfma_f32_16x16x32_bf16 v[208:211], v[68:71], a[144:147], v[208:211]
ds_read_b64_tr_b16 v[52:53], v9 offset:24576
v_mfma_f32_16x16x32_bf16 v[212:215], v[64:67], a[132:135], v[212:215]
ds_read_b64_tr_b16 v[54:55], v9 offset:28672
v_mfma_f32_16x16x32_bf16 v[212:215], v[68:71], a[148:151], v[212:215]
v_mfma_f32_16x16x32_bf16 v[216:219], v[64:67], a[136:139], v[216:219]
v_mfma_f32_16x16x32_bf16 v[216:219], v[68:71], a[152:155], v[216:219]
v_mfma_f32_16x16x32_bf16 v[220:223], v[64:67], a[140:143], v[220:223]
v_mfma_f32_16x16x32_bf16 v[220:223], v[68:71], a[156:159], v[220:223]
s_waitcnt lgkmcnt(0)
v_mfma_f32_16x16x32_bf16 v[192:195], v[40:43], a[160:163], v[192:195]
v_mfma_f32_16x16x32_bf16 v[192:195], v[44:47], a[176:179], v[192:195]
ds_read_b64_tr_b16 v[56:57], v8 offset:18432
v_mfma_f32_16x16x32_bf16 v[196:199], v[40:43], a[164:167], v[196:199]
ds_read_b64_tr_b16 v[58:59], v8 offset:22528
v_mfma_f32_16x16x32_bf16 v[196:199], v[44:47], a[180:183], v[196:199]
ds_read_b64_tr_b16 v[60:61], v8 offset:26624
v_mfma_f32_16x16x32_bf16 v[200:203], v[40:43], a[168:171], v[200:203]
v_mfma_f32_16x16x32_bf16 v[200:203], v[44:47], a[184:187], v[200:203]
ds_read_b64_tr_b16 v[62:63], v8 offset:30720
v_mfma_f32_16x16x32_bf16 v[204:207], v[40:43], a[172:175], v[204:207]
ds_read_b64_tr_b16 v[64:65], v9 offset:18432
v_mfma_f32_16x16x32_bf16 v[204:207], v[44:47], a[188:191], v[204:207]
ds_read_b64_tr_b16 v[66:67], v9 offset:22528
v_mfma_f32_16x16x32_bf16 v[208:211], v[48:51], a[160:163], v[208:211]
v_mfma_f32_16x16x32_bf16 v[208:211], v[52:55], a[176:179], v[208:211]
ds_read_b64_tr_b16 v[68:69], v9 offset:26624
v_mfma_f32_16x16x32_bf16 v[212:215], v[48:51], a[164:167], v[212:215]
ds_read_b64_tr_b16 v[70:71], v9 offset:30720
v_mfma_f32_16x16x32_bf16 v[212:215], v[52:55], a[180:183], v[212:215]
s_waitcnt vmcnt(5)
v_cmp_gt_u32 vcc, 5, v95
s_cmp_eq_u32 vcc_lo, 0
s_cbranch_scc0 L_spin14
L_back14:
v_mfma_f32_16x16x32_bf16 v[216:219], v[48:51], a[168:171], v[216:219]
v_mfma_f32_16x16x32_bf16 v[216:219], v[52:55], a[184:187], v[216:219]
v_mfma_f32_16x16x32_bf16 v[220:223], v[48:51], a[172:175], v[220:223]
s_waitcnt lgkmcnt(0)
v_mfma_f32_16x16x32_bf16 v[220:223], v[52:55], a[188:191], v[220:223]
s_barrier
v_mfma_f32_16x16x32_bf16 v[192:195], v[56:59], a[192:195], v[192:195]
buffer_load_dwordx4 a[0:3], v4, s[20:23], s10 offen sc1
v_mfma_f32_16x16x32_bf16 v[192:195], v[60:63], a[208:211], v[192:195]
ds_read_b64_tr_b16 v[40:41], v8 offset:32768
s_add_u32 s10, s10, 540672
v_mfma_f32_16x16x32_bf16 v[196:199], v[56:59], a[196:199], v[196:199]
ds_read_b64_tr_b16 v[42:43], v8 offset:36864
v_mfma_f32_16x16x32_bf16 v[196:199], v[60:63], a[212:215], v[196:199]
ds_read_b64_tr_b16 v[44:45], v8 offset:40960
v_mfma_f32_16x16x32_bf16 v[200:203], v[56:59], a[200:203], v[200:203]
buffer_load_dwordx4 a[4:7], v4, s[20:23], s10 offen sc1
v_mfma_f32_16x16x32_bf16 v[200:203], v[60:63], a[216:219], v[200:203]
ds_read_b64_tr_b16 v[46:47], v8 offset:45056
v_mfma_f32_16x16x32_bf16 v[204:207], v[56:59], a[204:207], v[204:207]
ds_read_b64_tr_b16 v[48:49], v9 offset:32768
v_mfma_f32_16x16x32_bf16 v[204:207], v[60:63], a[220:223], v[204:207]
ds_read_b64_tr_b16 v[50:51], v9 offset:36864
v_mfma_f32_16x16x32_bf16 v[208:211], v[64:67], a[192:195], v[208:211]
v_mfma_f32_16x16x32_bf16 v[208:211], v[68:71], a[208:211], v[208:211]
ds_read_b64_tr_b16 v[52:53], v9 offset:40960
v_mfma_f32_16x16x32_bf16 v[212:215], v[64:67], a[196:199], v[212:215]
ds_read_b64_tr_b16 v[54:55], v9 offset:45056
v_mfma_f32_16x16x32_bf16 v[212:215], v[68:71], a[212:215], v[212:215]
v_mfma_f32_16x16x32_bf16 v[216:219], v[64:67], a[200:203], v[216:219]
v_mfma_f32_16x16x32_bf16 v[216:219], v[68:71], a[216:219], v[216:219]
v_mfma_f32_16x16x32_bf16 v[220:223], v[64:67], a[204:207], v[220:223]
v_mfma_f32_16x16x32_bf16 v[220:223], v[68:71], a[220:223], v[220:223]
s_waitcnt lgkmcnt(0)
v_mfma_f32_16x16x32_bf16 v[192:195], v[40:43], a[224:227], v[192:195]
v_mfma_f32_16x16x32_bf16 v[192:195], v[44:47], a[240:243], v[192:195]
ds_read_b64_tr_b16 v[56:57], v8 offset:34816
v_mfma_f32_16x16x32_bf16 v[196:199], v[40:43], a[228:231], v[196:199]
ds_read_b64_tr_b16 v[58:59], v8 offset:38912
v_mfma_f32_16x16x32_bf16 v[196:199], v[44:47], a[244:247], v[196:199]
ds_read_b64_tr_b16 v[60:61], v8 offset:43008
v_mfma_f32_16x16x32_bf16 v[200:203], v[40:43], a[232:235], v[200:203]
v_mfma_f32_16x16x32_bf16 v[200:203], v[44:47], a[248:251], v[200:203]
ds_read_b64_tr_b16 v[62:63], v8 offset:47104
v_mfma_f32_16x16x32_bf16 v[204:207], v[40:43], a[236:239], v[204:207]
ds_read_b64_tr_b16 v[64:65], v9 offset:34816
v_mfma_f32_16x16x32_bf16 v[204:207], v[44:47], a[252:255], v[204:207]
ds_read_b64_tr_b16 v[66:67], v9 offset:38912
v_mfma_f32_16x16x32_bf16 v[208:211], v[48:51], a[224:227], v[208:211]
v_mfma_f32_16x16x32_bf16 v[208:211], v[52:55], a[240:243], v[208:211]
ds_read_b64_tr_b16 v[68:69], v9 offset:43008
v_mfma_f32_16x16x32_bf16 v[212:215], v[48:51], a[228:231], v[212:215]
ds_read_b64_tr_b16 v[70:71], v9 offset:47104
v_mfma_f32_16x16x32_bf16 v[212:215], v[52:55], a[244:247], v[212:215]
v_mfma_f32_16x16x32_bf16 v[216:219], v[48:51], a[232:235], v[216:219]
v_mfma_f32_16x16x32_bf16 v[216:219], v[52:55], a[248:251], v[216:219]
v_mfma_f32_16x16x32_bf16 v[220:223], v[48:51], a[236:239], v[220:223]
v_mfma_f32_16x16x32_bf16 v[220:223], v[52:55], a[252:255], v[220:223]
s_waitcnt lgkmcnt(0)
v_mfma_f32_16x16x32_bf16 v[192:195], v[56:59], v[224:227], v[192:195]
v_mfma_f32_16x16x32_bf16 v[192:195], v[60:63], v[240:243], v[192:195]
v_mfma_f32_16x16x32_bf16 v[196:199], v[56:59], v[228:231], v[196:199]
v_mfma_f32_16x16x32_bf16 v[196:199], v[60:63], v[244:247], v[196:199]
v_mfma_f32_16x16x32_bf16 v[200:203], v[56:59], v[232:235], v[200:203]
v_mfma_f32_16x16x32_bf16 v[200:203], v[60:63], v[248:251], v[200:203]
v_mfma_f32_16x16x32_bf16 v[204:207], v[56:59], v[236:239], v[204:207]
v_mfma_f32_16x16x32_bf16 v[204:207], v[60:63], v[252:255], v[204:207]
v_mfma_f32_16x16x32_bf16 v[208:211], v[64:67], v[224:227], v[208:211]
v_mfma_f32_16x16x32_bf16 v[208:211], v[68:71], v[240:243], v[208:211]
v_mfma_f32_16x16x32_bf16 v[212:215], v[64:67], v[228:231], v[212:215]
v_mfma_f32_16x16x32_bf16 v[212:215], v[68:71], v[244:247], v[212:215]
v_mfma_f32_16x16x32_bf16 v[216:219], v[64:67], v[232:235], v[216:219]
v_mfma_f32_16x16x32_bf16 v[216:219], v[68:71], v[248:251], v[216:219]
v_mfma_f32_16x16x32_bf16 v[220:223], v[64:67], v[236:239], v[220:223]
v_mfma_f32_16x16x32_bf16 v[220:223], v[68:71], v[252:255], v[220:223]
s_nop 7
v_cvt_pk_bf16_f32 v192, v192, v193
s_xor_b32 s50, s46, 16777216
v_cvt_pk_bf16_f32 v193, v194, v195
v_cvt_pk_bf16_f32 v196, v196, v197
v_cvt_pk_bf16_f32 v194, v208, v209
v_cvt_pk_bf16_f32 v195, v210, v211
v_cvt_pk_bf16_f32 v197, v198, v199
buffer_store_dwordx4 v[192:195], v14, s[20:23], s50 offen sc1
ds_write_b128 v16, v[192:195] offset:12288
v_cvt_pk_bf16_f32 v198, v212, v213
v_cvt_pk_bf16_f32 v199, v214, v215
s_xor_b32 s50, s46, 16786432
v_cvt_pk_bf16_f32 v200, v200, v201
buffer_store_dwordx4 v[196:199], v21, s[20:23], s50 offen sc1
v_cvt_pk_bf16_f32 v201, v202, v203
s_xor_b32 s50, s46, 16795648
v_cvt_pk_bf16_f32 v202, v216, v217
v_cvt_pk_bf16_f32 v203, v218, v219
v_cvt_pk_bf16_f32 v204, v204, v205
buffer_store_dwordx4 v[200:203], v21, s[20:23], s50 offen sc1
v_cvt_pk_bf16_f32 v205, v206, v207
s_xor_b32 s50, s46, 16804864
v_cvt_pk_bf16_f32 v206, v220, v221
v_cvt_pk_bf16_f32 v207, v222, v223
buffer_store_dwordx4 v[204:207], v21, s[20:23], s50 offen sc1
s_waitcnt vmcnt(6)
v_mov_b32 v20, 1
buffer_store_dword v20, v75, s[20:23], 0 offen offset:128 sc1
s_cmp_ge_u32 s38, 2
s_cbranch_scc1 L_hi1
s_waitcnt vmcnt(1) lgkmcnt(0)
v_mov_b32 v20, 2
buffer_store_dword v20, v75, s[20:23], 0 offen offset:128 sc1
L_rc15:
s_add_u32 s57, s57, 1
s_cmp_ge_u32 s57, 0x80000
s_cbranch_scc1 L_rk15
s_buffer_load_dwordx8 s[92:99], s[20:23], s59 glc
s_waitcnt lgkmcnt(0)
s_min_u32 s92, s92, s93
s_min_u32 s92, s92, s94
s_min_u32 s92, s92, s95
s_min_u32 s92, s92, s96
s_min_u32 s92, s92, s97
s_min_u32 s92, s92, s98
s_min_u32 s92, s92, s99
s_cmp_lt_u32 s92, 1
s_cbranch_scc1 L_rc15
L_rk15:
ds_read_b128 v[96:99], v22 offset:0
buffer_load_dwordx4 v[100:103], v2, s[20:23], s28 offen offset:1024 sc1
buffer_load_dwordx4 v[104:107], v2, s[20:23], s28 offen offset:2048 sc1
buffer_load_dwordx4 v[108:111], v2, s[20:23], s28 offen offset:3072 sc1
buffer_load_dwordx4 v[112:115], v2, s[20:23], s29 offen offset:0 sc1
buffer_load_dwordx4 v[116:119], v2, s[20:23], s29 offen offset:1024 sc1
buffer_load_dwordx4 v[120:123], v2, s[20:23], s29 offen offset:2048 sc1
buffer_load_dwordx4 v[124:127], v2, s[20:23], s29 offen offset:3072 sc1
ds_read_b128 v[128:131], v22 offset:8192
buffer_load_dwordx4 v[132:135], v2, s[20:23], s30 offen offset:1024 sc1
buffer_load_dwordx4 v[136:139], v2, s[20:23], s30 offen offset:2048 sc1
buffer_load_dwordx4 v[140:143], v2, s[20:23], s30 offen offset:3072 sc1
buffer_load_dwordx4 v[144:147], v2, s[20:23], s31 offen offset:0 sc1
buffer_load_dwordx4 v[148:151], v2, s[20:23], s31 offen offset:1024 sc1
buffer_load_dwordx4 v[152:155], v2, s[20:23], s31 offen offset:2048 sc1
buffer_load_dwordx4 v[156:159], v2, s[20:23], s31 offen offset:3072 sc1
v_mfma_f32_16x16x32_bf16 v[160:163], a[0:3], v[32:35], 0
v_mfma_f32_16x16x32_bf16 v[164:167], a[0:3], v[36:39], 0
v_mfma_f32_16x16x32_bf16 v[168:171], a[4:7], v[32:35], 0
v_mfma_f32_16x16x32_bf16 v[172:175], a[4:7], v[36:39], 0
v_lshlrev_b32 v40, 16, v80
v_and_b32 v41, 0xffff0000, v80
v_lshlrev_b32 v42, 16, v81
v_and_b32 v43, 0xffff0000, v81
v_lshlrev_b32 v44, 16, v82
v_and_b32 v45, 0xffff0000, v82
v_lshlrev_b32 v46, 16, v83
v_and_b32 v47, 0xffff0000, v83
v_lshlrev_b32 v48, 16, v84
v_and_b32 v49, 0xffff0000, v84
v_lshlrev_b32 v50, 16, v85
v_and_b32 v51, 0xffff0000, v85
v_lshlrev_b32 v52, 16, v86
v_and_b32 v53, 0xffff0000, v86
v_lshlrev_b32 v54, 16, v87
v_and_b32 v55, 0xffff0000, v87
v_pk_mul_f32 v[40:41], v[40:41], v[92:93] op_sel_hi:[1,0]
v_pk_mul_f32 v[42:43], v[42:43], v[92:93] op_sel_hi:[1,0]
v_pk_mul_f32 v[44:45], v[44:45], v[92:93] op_sel_hi:[1,0]
v_pk_mul_f32 v[46:47], v[46:47], v[92:93] op_sel_hi:[1,0]
v_pk_mul_f32 v[48:49], v[48:49], v[92:93] op_sel_hi:[1,0]
v_pk_mul_f32 v[50:51], v[50:51], v[92:93] op_sel_hi:[1,0]
v_pk_mul_f32 v[52:53], v[52:53], v[92:93] op_sel_hi:[1,0]
v_pk_mul_f32 v[54:55], v[54:55], v[92:93] op_sel_hi:[1,0]
v_pk_mul_f32 v[40:41], v[40:41], v[160:161]
v_pk_mul_f32 v[42:43], v[42:43], v[162:163]
v_pk_mul_f32 v[44:45], v[44:45], v[164:165]
v_pk_mul_f32 v[46:47], v[46:47], v[166:167]
v_pk_mul_f32 v[48:49], v[48:49], v[168:169]
v_pk_mul_f32 v[50:51], v[50:51], v[170:171]
v_pk_mul_f32 v[52:53], v[52:53], v[172:173]
v_pk_mul_f32 v[54:55], v[54:55], v[174:175]
s_waitcnt lgkmcnt(1)
v_mfma_f32_16x16x32_bf16 v[224:227], v[24:27], v[96:99], 0
v_mfma_f32_16x16x32_bf16 v[228:231], v[28:31], v[96:99], 0
s_waitcnt vmcnt(13)
v_mfma_f32_16x16x32_bf16 v[224:227], v[24:27], v[100:103], v[224:227]
v_mfma_f32_16x16x32_bf16 v[228:231], v[28:31], v[100:103], v[228:231]
s_waitcnt vmcnt(12)
v_mfma_f32_16x16x32_bf16 v[224:227], v[24:27], v[104:107], v[224:227]
v_mfma_f32_16x16x32_bf16 v[228:231], v[28:31], v[104:107], v[228:231]
s_waitcnt vmcnt(11)
v_mfma_f32_16x16x32_bf16 v[224:227], v[24:27], v[108:111], v[224:227]
v_mfma_f32_16x16x32_bf16 v[228:231], v[28:31], v[108:111], v[228:231]
s_waitcnt vmcnt(10)
v_mfma_f32_16x16x32_bf16 v[224:227], v[24:27], v[112:115], v[224:227]
v_mfma_f32_16x16x32_bf16 v[228:231], v[28:31], v[112:115], v[228:231]
s_waitcnt vmcnt(9)
v_mfma_f32_16x16x32_bf16 v[224:227], v[24:27], v[116:119], v[224:227]
v_mfma_f32_16x16x32_bf16 v[228:231], v[28:31], v[116:119], v[228:231]
s_waitcnt vmcnt(8)
v_mfma_f32_16x16x32_bf16 v[224:227], v[24:27], v[120:123], v[224:227]
v_mfma_f32_16x16x32_bf16 v[228:231], v[28:31], v[120:123], v[228:231]
s_waitcnt vmcnt(7)
v_mfma_f32_16x16x32_bf16 v[224:227], v[24:27], v[124:127], v[224:227]
v_mfma_f32_16x16x32_bf16 v[228:231], v[28:31], v[124:127], v[228:231]
s_nop 6
v_pk_fma_f32 v[224:225], v[224:225], v[92:93], v[40:41] op_sel:[0,1,0]
v_pk_fma_f32 v[226:227], v[226:227], v[92:93], v[42:43] op_sel:[0,1,0]
v_pk_fma_f32 v[228:229], v[228:229], v[92:93], v[44:45] op_sel:[0,1,0]
v_pk_fma_f32 v[230:231], v[230:231], v[92:93], v[46:47] op_sel:[0,1,0]
v_cvt_pk_bf16_f32 v224, v224, v225
v_cvt_pk_bf16_f32 v225, v226, v227
v_cvt_pk_bf16_f32 v226, v228, v229
v_cvt_pk_bf16_f32 v227, v230, v231
buffer_store_dwordx4 v[224:227], v3, s[4:7], s9 offen offset:640 nt
s_waitcnt lgkmcnt(0)
v_mfma_f32_16x16x32_bf16 v[232:235], v[24:27], v[128:131], 0
v_mfma_f32_16x16x32_bf16 v[236:239], v[28:31], v[128:131], 0
s_waitcnt vmcnt(7)
v_mfma_f32_16x16x32_bf16 v[232:235], v[24:27], v[132:135], v[232:235]
v_mfma_f32_16x16x32_bf16 v[236:239], v[28:31], v[132:135], v[236:239]
s_waitcnt vmcnt(6)
v_mfma_f32_16x16x32_bf16 v[232:235], v[24:27], v[136:139], v[232:235]
v_mfma_f32_16x16x32_bf16 v[236:239], v[28:31], v[136:139], v[236:239]
s_waitcnt vmcnt(5)
v_mfma_f32_16x16x32_bf16 v[232:235], v[24:27], v[140:143], v[232:235]
v_mfma_f32_16x16x32_bf16 v[236:239], v[28:31], v[140:143], v[236:239]
s_waitcnt vmcnt(4)
v_mfma_f32_16x16x32_bf16 v[232:235], v[24:27], v[144:147], v[232:235]
v_mfma_f32_16x16x32_bf16 v[236:239], v[28:31], v[144:147], v[236:239]
s_waitcnt vmcnt(3)
v_mfma_f32_16x16x32_bf16 v[232:235], v[24:27], v[148:151], v[232:235]
v_mfma_f32_16x16x32_bf16 v[236:239], v[28:31], v[148:151], v[236:239]
s_waitcnt vmcnt(2)
v_mfma_f32_16x16x32_bf16 v[232:235], v[24:27], v[152:155], v[232:235]
v_mfma_f32_16x16x32_bf16 v[236:239], v[28:31], v[152:155], v[236:239]
s_waitcnt vmcnt(1)
v_mfma_f32_16x16x32_bf16 v[232:235], v[24:27], v[156:159], v[232:235]
v_mfma_f32_16x16x32_bf16 v[236:239], v[28:31], v[156:159], v[236:239]
s_nop 6
v_pk_fma_f32 v[232:233], v[232:233], v[92:93], v[48:49] op_sel:[0,1,0]
v_pk_fma_f32 v[234:235], v[234:235], v[92:93], v[50:51] op_sel:[0,1,0]
v_pk_fma_f32 v[236:237], v[236:237], v[92:93], v[52:53] op_sel:[0,1,0]
v_pk_fma_f32 v[238:239], v[238:239], v[92:93], v[54:55] op_sel:[0,1,0]
v_cvt_pk_bf16_f32 v232, v232, v233
v_cvt_pk_bf16_f32 v233, v234, v235
v_cvt_pk_bf16_f32 v234, v236, v237
v_cvt_pk_bf16_f32 v235, v238, v239
buffer_store_dwordx4 v[232:235], v3, s[4:7], s9 offen offset:896 nt
s_endpgm
L_hi1:
s_waitcnt vmcnt(1) lgkmcnt(0)
v_mov_b32 v20, 2
buffer_store_dword v20, v75, s[20:23], 0 offen offset:128 sc1
L_rc16:
s_add_u32 s57, s57, 1
s_cmp_ge_u32 s57, 0x80000
s_cbranch_scc1 L_rk16
s_buffer_load_dwordx8 s[92:99], s[20:23], s59 glc
s_waitcnt lgkmcnt(0)
s_min_u32 s92, s92, s93
s_min_u32 s92, s92, s94
s_min_u32 s92, s92, s95
s_min_u32 s92, s92, s96
s_min_u32 s92, s92, s97
s_min_u32 s92, s92, s98
s_min_u32 s92, s92, s99
s_cmp_lt_u32 s92, 1
s_cbranch_scc1 L_rc16
L_rk16:
ds_read_b128 v[96:99], v22 offset:0
buffer_load_dwordx4 v[100:103], v2, s[20:23], s28 offen offset:1024 sc1
buffer_load_dwordx4 v[104:107], v2, s[20:23], s28 offen offset:2048 sc1
buffer_load_dwordx4 v[108:111], v2, s[20:23], s28 offen offset:3072 sc1
buffer_load_dwordx4 v[112:115], v2, s[20:23], s29 offen offset:0 sc1
buffer_load_dwordx4 v[116:119], v2, s[20:23], s29 offen offset:1024 sc1
buffer_load_dwordx4 v[120:123], v2, s[20:23], s29 offen offset:2048 sc1
buffer_load_dwordx4 v[124:127], v2, s[20:23], s29 offen offset:3072 sc1
L_rc17:
s_add_u32 s57, s57, 1
s_cmp_ge_u32 s57, 0x80000
s_cbranch_scc1 L_rk17
s_buffer_load_dwordx8 s[92:99], s[20:23], s59 glc
s_waitcnt lgkmcnt(0)
s_min_u32 s92, s92, s93
s_min_u32 s92, s92, s94
s_min_u32 s92, s92, s95
s_min_u32 s92, s92, s96
s_min_u32 s92, s92, s97
s_min_u32 s92, s92, s98
s_min_u32 s92, s92, s99
s_cmp_lt_u32 s92, 2
s_cbranch_scc1 L_rc17
L_rk17:
ds_read_b128 v[128:131], v22 offset:8192
buffer_load_dwordx4 v[132:135], v2, s[20:23], s30 offen offset:1024 sc1
buffer_load_dwordx4 v[136:139], v2, s[20:23], s30 offen offset:2048 sc1
buffer_load_dwordx4 v[140:143], v2, s[20:23], s30 offen offset:3072 sc1
buffer_load_dwordx4 v[144:147], v2, s[20:23], s31 offen offset:0 sc1
buffer_load_dwordx4 v[148:151], v2, s[20:23], s31 offen offset:1024 sc1
buffer_load_dwordx4 v[152:155], v2, s[20:23], s31 offen offset:2048 sc1
buffer_load_dwordx4 v[156:159], v2, s[20:23], s31 offen offset:3072 sc1
v_mfma_f32_16x16x32_bf16 v[160:163], a[0:3], v[32:35], 0
v_mfma_f32_16x16x32_bf16 v[164:167], a[0:3], v[36:39], 0
v_mfma_f32_16x16x32_bf16 v[168:171], a[4:7], v[32:35], 0
v_mfma_f32_16x16x32_bf16 v[172:175], a[4:7], v[36:39], 0
v_lshlrev_b32 v40, 16, v80
v_and_b32 v41, 0xffff0000, v80
v_lshlrev_b32 v42, 16, v81
v_and_b32 v43, 0xffff0000, v81
v_lshlrev_b32 v44, 16, v82
v_and_b32 v45, 0xffff0000, v82
v_lshlrev_b32 v46, 16, v83
v_and_b32 v47, 0xffff0000, v83
v_lshlrev_b32 v48, 16, v84
v_and_b32 v49, 0xffff0000, v84
v_lshlrev_b32 v50, 16, v85
v_and_b32 v51, 0xffff0000, v85
v_lshlrev_b32 v52, 16, v86
v_and_b32 v53, 0xffff0000, v86
v_lshlrev_b32 v54, 16, v87
v_and_b32 v55, 0xffff0000, v87
v_pk_mul_f32 v[40:41], v[40:41], v[92:93] op_sel_hi:[1,0]
v_pk_mul_f32 v[42:43], v[42:43], v[92:93] op_sel_hi:[1,0]
v_pk_mul_f32 v[44:45], v[44:45], v[92:93] op_sel_hi:[1,0]
v_pk_mul_f32 v[46:47], v[46:47], v[92:93] op_sel_hi:[1,0]
v_pk_mul_f32 v[48:49], v[48:49], v[92:93] op_sel_hi:[1,0]
v_pk_mul_f32 v[50:51], v[50:51], v[92:93] op_sel_hi:[1,0]
v_pk_mul_f32 v[52:53], v[52:53], v[92:93] op_sel_hi:[1,0]
v_pk_mul_f32 v[54:55], v[54:55], v[92:93] op_sel_hi:[1,0]
v_pk_mul_f32 v[40:41], v[40:41], v[160:161]
v_pk_mul_f32 v[42:43], v[42:43], v[162:163]
v_pk_mul_f32 v[44:45], v[44:45], v[164:165]
v_pk_mul_f32 v[46:47], v[46:47], v[166:167]
v_pk_mul_f32 v[48:49], v[48:49], v[168:169]
v_pk_mul_f32 v[50:51], v[50:51], v[170:171]
v_pk_mul_f32 v[52:53], v[52:53], v[172:173]
v_pk_mul_f32 v[54:55], v[54:55], v[174:175]
s_waitcnt lgkmcnt(1)
v_mfma_f32_16x16x32_bf16 v[224:227], v[24:27], v[96:99], 0
v_mfma_f32_16x16x32_bf16 v[228:231], v[28:31], v[96:99], 0
s_waitcnt vmcnt(13)
v_mfma_f32_16x16x32_bf16 v[224:227], v[24:27], v[100:103], v[224:227]
v_mfma_f32_16x16x32_bf16 v[228:231], v[28:31], v[100:103], v[228:231]
s_waitcnt vmcnt(12)
v_mfma_f32_16x16x32_bf16 v[224:227], v[24:27], v[104:107], v[224:227]
v_mfma_f32_16x16x32_bf16 v[228:231], v[28:31], v[104:107], v[228:231]
s_waitcnt vmcnt(11)
v_mfma_f32_16x16x32_bf16 v[224:227], v[24:27], v[108:111], v[224:227]
v_mfma_f32_16x16x32_bf16 v[228:231], v[28:31], v[108:111], v[228:231]
s_waitcnt vmcnt(10)
v_mfma_f32_16x16x32_bf16 v[224:227], v[24:27], v[112:115], v[224:227]
v_mfma_f32_16x16x32_bf16 v[228:231], v[28:31], v[112:115], v[228:231]
s_waitcnt vmcnt(9)
v_mfma_f32_16x16x32_bf16 v[224:227], v[24:27], v[116:119], v[224:227]
v_mfma_f32_16x16x32_bf16 v[228:231], v[28:31], v[116:119], v[228:231]
s_waitcnt vmcnt(8)
v_mfma_f32_16x16x32_bf16 v[224:227], v[24:27], v[120:123], v[224:227]
v_mfma_f32_16x16x32_bf16 v[228:231], v[28:31], v[120:123], v[228:231]
s_waitcnt vmcnt(7)
v_mfma_f32_16x16x32_bf16 v[224:227], v[24:27], v[124:127], v[224:227]
v_mfma_f32_16x16x32_bf16 v[228:231], v[28:31], v[124:127], v[228:231]
s_nop 6
v_pk_fma_f32 v[224:225], v[224:225], v[92:93], v[40:41] op_sel:[0,1,0]
v_pk_fma_f32 v[226:227], v[226:227], v[92:93], v[42:43] op_sel:[0,1,0]
v_pk_fma_f32 v[228:229], v[228:229], v[92:93], v[44:45] op_sel:[0,1,0]
v_pk_fma_f32 v[230:231], v[230:231], v[92:93], v[46:47] op_sel:[0,1,0]
v_cvt_pk_bf16_f32 v224, v224, v225
v_cvt_pk_bf16_f32 v225, v226, v227
v_cvt_pk_bf16_f32 v226, v228, v229
v_cvt_pk_bf16_f32 v227, v230, v231
buffer_store_dwordx4 v[224:227], v3, s[4:7], s9 offen offset:640 nt
s_waitcnt lgkmcnt(0)
v_mfma_f32_16x16x32_bf16 v[232:235], v[24:27], v[128:131], 0
v_mfma_f32_16x16x32_bf16 v[236:239], v[28:31], v[128:131], 0
s_waitcnt vmcnt(7)
v_mfma_f32_16x16x32_bf16 v[232:235], v[24:27], v[132:135], v[232:235]
v_mfma_f32_16x16x32_bf16 v[236:239], v[28:31], v[132:135], v[236:239]
s_waitcnt vmcnt(6)
v_mfma_f32_16x16x32_bf16 v[232:235], v[24:27], v[136:139], v[232:235]
v_mfma_f32_16x16x32_bf16 v[236:239], v[28:31], v[136:139], v[236:239]
s_waitcnt vmcnt(5)
v_mfma_f32_16x16x32_bf16 v[232:235], v[24:27], v[140:143], v[232:235]
v_mfma_f32_16x16x32_bf16 v[236:239], v[28:31], v[140:143], v[236:239]
s_waitcnt vmcnt(4)
v_mfma_f32_16x16x32_bf16 v[232:235], v[24:27], v[144:147], v[232:235]
v_mfma_f32_16x16x32_bf16 v[236:239], v[28:31], v[144:147], v[236:239]
s_waitcnt vmcnt(3)
v_mfma_f32_16x16x32_bf16 v[232:235], v[24:27], v[148:151], v[232:235]
v_mfma_f32_16x16x32_bf16 v[236:239], v[28:31], v[148:151], v[236:239]
s_waitcnt vmcnt(2)
v_mfma_f32_16x16x32_bf16 v[232:235], v[24:27], v[152:155], v[232:235]
v_mfma_f32_16x16x32_bf16 v[236:239], v[28:31], v[152:155], v[236:239]
s_waitcnt vmcnt(1)
v_mfma_f32_16x16x32_bf16 v[232:235], v[24:27], v[156:159], v[232:235]
v_mfma_f32_16x16x32_bf16 v[236:239], v[28:31], v[156:159], v[236:239]
s_nop 6
v_pk_fma_f32 v[232:233], v[232:233], v[92:93], v[48:49] op_sel:[0,1,0]
v_pk_fma_f32 v[234:235], v[234:235], v[92:93], v[50:51] op_sel:[0,1,0]
v_pk_fma_f32 v[236:237], v[236:237], v[92:93], v[52:53] op_sel:[0,1,0]
v_pk_fma_f32 v[238:239], v[238:239], v[92:93], v[54:55] op_sel:[0,1,0]
v_cvt_pk_bf16_f32 v232, v232, v233
v_cvt_pk_bf16_f32 v233, v234, v235
v_cvt_pk_bf16_f32 v234, v236, v237
v_cvt_pk_bf16_f32 v235, v238, v239
buffer_store_dwordx4 v[232:235], v3, s[4:7], s9 offen offset:896 nt
L_fin1:
s_endpgm
L_spin9:
s_add_u32 s57, s57, 1
s_cmp_ge_u32 s57, 0x80000
s_cbranch_scc1 L_back9
s_sleep 4
buffer_load_dword v78, v72, s[24:27], 0 offen sc1
s_waitcnt vmcnt(0)
v_readfirstlane_b32 s58, v78
s_cmp_ge_u32 s58, s101
s_cbranch_scc0 L_spin9
s_branch L_back9
L_spin10:
s_add_u32 s57, s57, 1
s_cmp_ge_u32 s57, 0x80000
s_cbranch_scc1 L_back10
s_sleep 4
buffer_load_dword v78, v76, s[20:23], 0 offen sc1
s_waitcnt vmcnt(0)
v_cmp_gt_u32 vcc, s101, v78
s_cmp_eq_u32 vcc_lo, 0
s_cbranch_scc0 L_spin10
s_branch L_back10
L_spin11:
s_add_u32 s57, s57, 1
s_cmp_ge_u32 s57, 0x80000
s_cbranch_scc1 L_back11
s_sleep 4
buffer_load_dword v78, v79, s[20:23], 0 offen sc1
s_waitcnt vmcnt(0)
v_readfirstlane_b32 s58, v78
s_cmp_ge_u32 s58, 2
s_cbranch_scc0 L_spin11
s_branch L_back11
L_odd:
s_waitcnt lgkmcnt(0)
s_waitcnt vmcnt(33)
s_barrier
ds_read_b64_tr_b16 v[40:41], v6 offset:0
ds_read_b64_tr_b16 v[42:43], v6 offset:4096
ds_read_b64_tr_b16 v[44:45], v6 offset:8192
ds_read_b64_tr_b16 v[46:47], v6 offset:12288
ds_read_b64_tr_b16 v[48:49], v7 offset:0
ds_read_b64_tr_b16 v[50:51], v7 offset:4096
ds_read_b64_tr_b16 v[52:53], v7 offset:8192
ds_read_b64_tr_b16 v[54:55], v7 offset:12288
ds_read_b64 v[192:193], v10 offset:0
ds_read_b64 v[194:195], v10 offset:512
ds_read_b64 v[196:197], v10 offset:1024
ds_read_b64 v[198:199], v10 offset:1536
ds_read_b64 v[200:201], v10 offset:2048
ds_read_b64 v[202:203], v10 offset:2560
ds_read_b64 v[204:205], v10 offset:3072
ds_read_b64 v[206:207], v10 offset:3584
ds_read_b64 v[208:209], v76 offset:0
ds_read_b64 v[210:211], v76 offset:512
s_branch L_join

L_spin12:
s_add_u32 s57, s57, 1
s_cmp_ge_u32 s57, 0x80000
s_cbranch_scc1 L_back12
s_sleep 4
buffer_load_dword v78, v79, s[20:23], 0 offen sc1
s_waitcnt vmcnt(0)
v_readfirstlane_b32 s58, v78
s_cmp_ge_u32 s58, 3
s_cbranch_scc0 L_spin12
s_branch L_back12
L_spin13:
s_add_u32 s57, s57, 1
s_cmp_ge_u32 s57, 0x80000
s_cbranch_scc1 L_back13
s_sleep 4
buffer_load_dword v78, v79, s[20:23], 0 offen sc1
s_waitcnt vmcnt(0)
v_readfirstlane_b32 s58, v78
s_cmp_ge_u32 s58, 4
s_cbranch_scc0 L_spin13
s_branch L_back13
L_spin14:
s_add_u32 s57, s57, 1
s_cmp_ge_u32 s57, 0x80000
s_cbranch_scc1 L_back14
s_sleep 4
buffer_load_dword v95, v10, s[20:23], 0 offen sc1
s_waitcnt vmcnt(0)
v_cmp_gt_u32 vcc, 5, v95
s_cmp_eq_u32 vcc_lo, 0
s_cbranch_scc0 L_spin14
s_branch L_back14
L_end1:
s_endpgm
.section .rodata,"a"
.p2align 6
.amdhsa_kernel gated_mix__ssm_conv_h3__geglu_ffn__prompt_kernel
  .amdhsa_next_free_vgpr 512
  .amdhsa_next_free_sgpr 102
  .amdhsa_accum_offset 256
  .amdhsa_group_segment_fixed_size 0
  .amdhsa_kernarg_size 112
  .amdhsa_user_sgpr_count 2
  .amdhsa_user_sgpr_kernarg_segment_ptr 1
  .amdhsa_system_sgpr_workgroup_id_x 1
  .amdhsa_float_denorm_mode_32 3
.end_amdhsa_kernel
```
